```python
import torch

def _softmax(x, axis=-1):
    return torch.softmax(x, dim=axis)
def _gelu(x):
    return torch.nn.functional.gelu(x, approximate="tanh")
def _silu(x):
    return torch.nn.functional.silu(x)
def _sigmoid(x):
    return torch.sigmoid(x)
def _layernorm(x, axis=-1, eps=1e-5):
    m = x.mean(dim=axis, keepdim=True)
    v = x.var(dim=axis, keepdim=True, unbiased=False)
    return (x - m) / torch.sqrt(v + eps)
def _scatter_add(tgt, idx, src, axis=0):
    return tgt.clone().index_add_(axis, idx, src)
def _segment_sum(src, seg, n):
    out = torch.zeros((n,) + src.shape[1:], dtype=src.dtype)
    return out.index_add_(0, seg, src)
def _pad(x, pw):
    flat = tuple(v for pair in reversed(pw) for v in pair)
    return torch.nn.functional.pad(x, flat)

kernel_name = 'parallel_sum__linear_kernel_hedgehog__geglu_ffn__prompt'

def setup_inputs():

    _w = (lambda a: (lambda t: t.to(torch.bfloat16) if t.is_floating_point() else t)(torch.as_tensor(a)))
    def _A_setup():
        B, S, D, H = 1, 2048, 1024, 32
        Dh = D // H
        return {
            "x": _w((lambda *s: torch.randn(*s, dtype=torch.bfloat16) * 0.05)(B, S, D)),
            "wqkv": _w((lambda *s: torch.randn(*s, dtype=torch.bfloat16) * 0.8)(D, 3 * D)),
            "w_phi": _w((lambda *s: torch.randn(*s, dtype=torch.bfloat16) * 0.8)(H, Dh, Dh) * (Dh ** -0.5)),
            "wo": _w((lambda *s: torch.randn(*s, dtype=torch.bfloat16) * 0.2)(D, D)),
        }
    _A_in = _A_setup()

    def _B_setup():
        B, S, D, F = 1, 2048, 1024, 3584
        return {
            "x": _w((lambda *s: torch.randn(*s, dtype=torch.bfloat16) * 0.05)(B, S, D)),
            "w_gate": _w((lambda *s: torch.randn(*s, dtype=torch.bfloat16) * 0.05)(D, F)),
            "w_up": _w((lambda *s: torch.randn(*s, dtype=torch.bfloat16) * 0.05)(D, F)),
            "w_down": _w((lambda *s: torch.randn(*s, dtype=torch.bfloat16) * 0.05)(F, D)),
        }
    _B_in = _B_setup()

    return {
        "A_x": _A_in["x"],
        "A_wqkv": _A_in["wqkv"],
        "A_w_phi": _A_in["w_phi"],
        "A_wo": _A_in["wo"],
        "B_x": _B_in["x"],
        "B_w_gate": _B_in["w_gate"],
        "B_w_up": _B_in["w_up"],
        "B_w_down": _B_in["w_down"],
    }

def reference(A_x, A_wqkv, A_w_phi, A_wo, B_x, B_w_gate, B_w_up, B_w_down):
    def _A_ref(x, wqkv, w_phi, wo):
        B, S, D = x.shape
        H = 32; Dh = D // H
        qkv = (lambda x, *d: x.permute(*d))((x @ wqkv).reshape(B, S, 3, H, Dh), 2, 0, 3, 1, 4)
        q, k, v = qkv[0], qkv[1], qkv[2]
        pq = torch.einsum("bhsd,hdf->bhsf", q, w_phi)
        pk = torch.einsum("bhsd,hdf->bhsf", k, w_phi)
        phi_q = torch.concatenate([_softmax(pq, axis=-1), _softmax(-pq, axis=-1)], axis=-1)
        phi_k = torch.concatenate([_softmax(pk, axis=-1), _softmax(-pk, axis=-1)], axis=-1)
        kv = torch.einsum("bhsf,bhsd->bhfd", phi_k, v)
        z  = torch.einsum("bhsf->bhf", phi_k)
        num = torch.einsum("bhqf,bhfd->bhqd", phi_q, kv)
        den = torch.einsum("bhqf,bhf->bhq", phi_q, z)[..., None] + 1e-6
        o = num / den
        return (lambda x, *d: x.permute(*d))(o, 0, 2, 1, 3).reshape(B, S, D) @ wo

    def _B_ref(x, w_gate, w_up, w_down):
        return (_gelu(x @ w_gate) * (x @ w_up)) @ w_down

    x = A_x
    xn = _layernorm(x, axis=-1)
    return x + _A_ref(xn, A_wqkv, A_w_phi, A_wo) + _B_ref(xn, B_w_gate, B_w_up, B_w_down)
```

```asm
; @launch grid=(256,1,1) block=(512,1,1) lds=163840
.amdgcn_target "amdgcn-amd-amdhsa--gfx950"
.text
.globl parallel_sum__linear_kernel_hedgehog__geglu_ffn__prompt_kernel
.p2align 8
.type parallel_sum__linear_kernel_hedgehog__geglu_ffn__prompt_kernel,@function
parallel_sum__linear_kernel_hedgehog__geglu_ffn__prompt_kernel:
 s_cmp_ge_u32 s2, 256
 s_cbranch_scc1 L_end
 s_load_dwordx2 s[16:17], s[0:1], 0
 v_lshrrev_b32 v2, 6, v0
 v_and_b32 v1, 63, v0
 s_lshr_b32 s93, s2, 3
 s_bfe_u32 s4, s2, 0x20001
 v_readfirstlane_b32 s3, v2
 s_and_b32 s5, s93, 7
 s_lshl3_add_u32 s82, s4, s5
 v_mov_b32 v3, v0
 s_mov_b32 s19, 0x20000
 v_lshlrev_b32 v0, 4, v1
 s_lshr_b32 s83, s2, 6
 s_and_b32 s85, s2, 1
 s_lshl2_add_u32 s83, s85, s83
 s_and_b32 s7, s3, 3
 s_cmp_lt_u32 s3, 4
 s_cbranch_scc1 L0_w
 s_lshl_b32 s97, s83, 5
 s_add_u32 s97, s97, s82
 s_lshl2_add_u32 s97, s97, s7
 s_lshl_b32 s97, s97, 12
 v_lshrrev_b32 v16, 5, v1
 s_movk_i32 s85, 1536
 s_mov_b32 s18, 4194304
 v_mad_u32_u24 v17, v16, s85, v0
 v_lshrrev_b32 v14, 3, v1
 v_and_b32 v15, 7, v1
 v_xor_b32 v15, v14, v15
 s_waitcnt lgkmcnt(0)
 buffer_load_dwordx4 v[96:99], v17, s[16:19], s97 offen offset:0
 s_lshl2_add_u32 s88, s83, s7
 v_lshlrev_b32 v14, 11, v14
 s_lshl_b32 s72, s88, 17
 buffer_load_dwordx4 v[100:103], v17, s[16:19], s97 offen offset:512
 v_lshl_add_u32 v7, v15, 4, v14
 s_bitcmp1_b32 s2, 0
 s_cselect_b32 s87, 1920, 0
 buffer_load_dwordx4 v[104:107], v17, s[16:19], s97 offen offset:1024
 s_cselect_b32 s77, 256, 0
 s_add_u32 s72, s72, s87
 s_lshl_b32 s52, s7, 13
 buffer_load_dwordx4 v[108:111], v17, s[16:19], s97 offen offset:1536
 s_movk_i32 s87, 15360
 s_mov_b32 m0, s52
 s_nop 0
 buffer_load_dwordx4 v7, s[16:19], s72 offen offset:0 lds
 s_add_u32 s72, s72, s87
 buffer_load_dwordx4 v7, s[16:19], s72 offen offset:1024 lds
 s_add_u32 s72, s72, s87
 s_add_u32 s53, s52, 4096
 buffer_load_dwordx4 v7, s[16:19], s72 offen offset:2048 lds
 s_add_u32 s72, s72, s87
 buffer_load_dwordx4 v7, s[16:19], s72 offen offset:3072 lds
 s_add_u32 s72, s72, 0x4c00
 s_mov_b32 m0, s53
 s_nop 0
 buffer_load_dwordx4 v7, s[16:19], s72 offen offset:0 lds
 s_add_u32 s72, s72, s87
 buffer_load_dwordx4 v7, s[16:19], s72 offen offset:1024 lds
 s_add_u32 s72, s72, s87
 s_sub_u32 s77, 0xfffe4c80, s77
 buffer_load_dwordx4 v7, s[16:19], s72 offen offset:2048 lds
 s_add_u32 s72, s72, s87
 buffer_load_dwordx4 v7, s[16:19], s72 offen offset:3072 lds
 s_add_u32 s72, s72, s77
 s_branch L0_x
L0_w:
 s_load_dwordx2 s[32:33], s[0:1], 40
 s_load_dwordx2 s[36:37], s[0:1], 48
 s_load_dwordx2 s[44:45], s[0:1], 8
 s_mul_i32 s72, s82, 224
 s_bitcmp1_b32 s2, 0
 s_cselect_b32 s85, 7110656, 0
 s_cselect_b32 s91, -1, 1
 s_add_u32 s72, s72, s85
 v_mul_u32_u24 v18, 4682, v3
 s_movk_i32 s87, 6944
 s_movk_i32 s88, 7168
 v_lshrrev_b32 v15, 16, v18
 v_lshlrev_b32 v16, 4, v3
 v_mad_u32_u24 v16, v15, s87, v16
 v_and_b32 v17, 12, v15
 v_lshrrev_b32 v15, 4, v15
 v_mad_i32_i24 v17, v15, -12, v17
 s_mov_b32 s34, 7340032
 s_mov_b32 s35, s19
 s_lshl_b32 s92, s3, 10
 s_add_u32 s52, s92, 90112
 v_mad_i32_i24 v7, v17, s88, v16
 s_mul_i32 s77, s91, 229376
 s_mov_b64 s[38:39], s[34:35]
 s_mov_b32 s73, s72
 s_mov_b32 s74, s72
 s_add_u32 s53, s52, 7168
 s_waitcnt lgkmcnt(0)
 s_mov_b32 m0, s52
 s_nop 0
 buffer_load_dwordx4 v7, s[32:35], s72 offen lds
 s_mov_b32 m0, s53
 s_nop 0
 buffer_load_dwordx4 v7, s[36:39], s73 offen lds
 s_lshr_b32 s85, s3, 1
 s_add_u32 s85, s85, 5
 v_lshl_add_u32 v14, s85, 6, v1
 v_mul_u32_u24 v15, 4682, v14
 v_lshrrev_b32 v15, 16, v15
 v_lshlrev_b32 v16, 4, v14
 v_mad_u32_u24 v16, v15, s87, v16
 v_and_b32 v17, 12, v15
 v_subrev_u32 v17, 12, v17
 v_mad_i32_i24 v8, v17, s88, v16
 s_lshl_b32 s85, s85, 10
 s_add_u32 s85, s85, 90112
 s_bitcmp1_b32 s3, 0
 s_cselect_b64 s[40:41], s[36:37], s[32:33]
 s_cselect_b32 s86, s88, 0
 s_add_u32 s54, s85, s86
 s_mov_b64 s[42:43], s[34:35]
 s_mov_b32 m0, s54
 s_nop 0
 buffer_load_dwordx4 v8, s[40:43], s74 offen lds
 s_cmp_eq_u32 s3, 3
 s_cbranch_scc1 L0_w3
 v_mul_u32_u24 v15, 5462, v3
 v_lshrrev_b32 v15, 16, v15
 v_mul_u32_u24 v17, 12, v15
 v_sub_u32 v16, v3, v17
 v_and_b32 v17, 12, v15
 v_add_u32 v17, v15, v17
 v_mul_u32_u24 v17, 6144, v17
 v_lshrrev_b32 v19, 2, v16
 v_lshl_add_u32 v17, v19, 11, v17
 v_and_b32 v16, 3, v16
 v_lshrrev_b32 v19, 1, v15
 v_and_b32 v19, 2, v19
 v_xor_b32 v16, v16, v19
 v_lshl_add_u32 v9, v16, 4, v17
 s_lshl_b32 s75, s82, 6
 s_bitcmp1_b32 s2, 0
 s_cselect_b32 s85, 6094848, 0
 s_add_u32 s75, s75, s85
 s_add_u32 s76, s75, 24576
 s_mul_i32 s80, s91, 196608
 s_mov_b32 s46, 6291456
 s_mov_b64 s[48:49], s[44:45]
 s_add_u32 s55, s92, 65536
 s_add_u32 s56, s92, 68608
 s_movk_i32 s70, 6144
 s_branch L0_wgo
L0_w3:
 v_add_u32 v14, 64, v3
 v_mul_u32_u24 v15, 4682, v14
 v_lshrrev_b32 v15, 16, v15
 v_lshlrev_b32 v16, 4, v14
 v_mad_u32_u24 v16, v15, s87, v16
 v_and_b32 v17, 12, v15
 v_subrev_u32 v17, 12, v17
 v_mad_i32_i24 v9, v17, s88, v16
 s_mov_b32 s75, s72
 s_mov_b32 s76, s72
 s_mov_b32 s80, s77
 s_mov_b32 s46, s34
 s_mov_b64 s[44:45], s[32:33]
 s_mov_b64 s[48:49], s[36:37]
 s_mov_b32 s55, 94208
 s_mov_b32 s56, 101376
 s_movk_i32 s70, 14336
L0_wgo:
 s_mov_b32 s47, s19
 s_mov_b64 s[50:51], s[46:47]
 s_mov_b32 m0, s55
 s_nop 0
 buffer_load_dwordx4 v9, s[44:47], s75 offen lds
 s_mov_b32 m0, s56
 s_nop 0
 buffer_load_dwordx4 v9, s[48:51], s76 offen lds
 s_getpc_b64 s[86:87]
L_pc:
 s_bfe_u32 s85, s2, 0x30003
 s_lshl_b32 s85, s85, 13
 s_lshl_b32 s88, s3, 16
 s_add_u32 s85, s85, s88
 v_lshl_add_u32 v56, v1, 7, s85
 v_cmp_gt_u32 vcc, L_last-L_pc, v56
 v_mov_b32 v59, s87
 s_and_saveexec_b64 s[88:89], vcc
 s_cbranch_execz L_nopf
 v_add_co_u32 v58, vcc, s86, v56
 s_nop 1
 v_addc_co_u32 v59, vcc, 0, v59, vcc
 global_load_dword v22, v[58:59], off
L_nopf:
 s_mov_b64 exec, -1
 s_load_dwordx2 s[88:89], s[0:1], 16
 s_load_dwordx2 s[8:9], s[0:1], 80
 s_load_dwordx2 s[12:13], s[0:1], 72
 s_load_dwordx2 s[20:21], s[0:1], 24
 s_load_dwordx2 s[24:25], s[0:1], 56
 s_load_dwordx2 s[28:29], s[0:1], 64
 s_and_b32 s94, s2, 7
 s_and_b32 s6, s93, 3
 s_lshr_b32 s98, s4, 1
 s_and_b32 s99, s4, 1
 s_mov_b32 s10, 268435456
 s_mov_b32 s11, 0x20000
 s_mov_b32 s14, 256
 s_mov_b32 s15, 0x20000
 s_mov_b32 s22, 2097152
 s_mov_b32 s23, 0x20000
 s_mov_b32 s26, 7340032
 s_mov_b32 s27, 0x20000
 s_mov_b32 s30, 4194304
 s_mov_b32 s31, 0x20000
 s_mov_b32 s18, 4194304
 s_mov_b32 s78, s77
 s_mov_b32 s79, s77
 s_mov_b32 s81, s80
 s_add_u32 s72, s72, s77
 s_add_u32 s73, s73, s78
 s_add_u32 s74, s74, s79
 s_add_u32 s75, s75, s80
 s_add_u32 s76, s76, s81
 s_movk_i32 s67, 14336
 s_movk_i32 s68, 14336
 s_movk_i32 s69, 14336
 s_mov_b32 s71, s70
 s_add_u32 s57, s52, s67
 s_add_u32 s58, s53, s68
 s_add_u32 s59, s54, s69
 s_add_u32 s60, s55, s70
 s_add_u32 s61, s56, s71
 s_add_u32 s62, s57, s67
 s_add_u32 s63, s58, s68
 s_add_u32 s64, s59, s69
 s_add_u32 s65, s60, s70
 s_add_u32 s66, s61, s71
 s_add_u32 s67, s62, s67
 s_add_u32 s68, s63, s68
 s_add_u32 s69, s64, s69
 s_add_u32 s70, s65, s70
 s_add_u32 s71, s66, s71
 s_mov_b32 s90, 65536
 s_mov_b32 s91, 0x20000
 v_lshrrev_b32 v14, 4, v1
 v_lshrrev_b32 v15, 2, v1
 v_and_b32 v16, 3, v1
 v_and_b32 v17, 15, v1
 v_and_b32 v18, 7, v1
 v_xor_b32 v18, v14, v18
 s_and_b32 s85, s2, 1
 s_lshl_b32 s85, s85, 2
 v_xor_b32 v18, s85, v18
 s_lshl_b32 s85, s7, 13
 v_lshlrev_b32 v17, 7, v17
 v_add_u32 v17, s85, v17
 v_lshl_add_u32 v2, v18, 4, v17
 v_xor_b32 v18, 4, v18
 v_lshl_add_u32 v3, v18, 4, v17
 v_mul_u32_u24 v17, 192, v15
 v_lshl_add_u32 v17, v16, 3, v17
 v_add_u32 v17, 65536, v17
 v_and_b32 v18, 1, v14
 v_lshl_add_u32 v4, v18, 5, v17
 v_xor_b32 v18, 1, v18
 v_lshl_add_u32 v5, v18, 5, v17
 v_mul_u32_u24 v17, 224, v15
 v_lshl_add_u32 v17, v16, 3, v17
 v_add_u32 v6, 90112, v17
 v_bfe_u32 v17, v1, 1, 3
 v_lshrrev_b32 v18, 5, v1
 v_cmp_eq_u32 vcc, v17, v18
 v_mov_b32 v17, 0x3e803e80
 s_nop 0
 v_cndmask_b32 v12, 0, v17, vcc
 v_cndmask_b32 v13, 0, v17, vcc
 v_cndmask_b32 v14, 0, v17, vcc
 v_cndmask_b32 v15, 0, v17, vcc
 v_and_b32 v17, 1, v1
 v_mul_u32_u24 v17, 0xaaaa, v17
 v_add_u32 v20, 0x4444, v17
 v_mov_b32 v16, 0
 v_mov_b32 v17, 0
 v_mov_b32 v18, 0
 v_mov_b32 v19, 0
 s_waitcnt vmcnt(0)
 s_mov_b32 m0, s57
 s_nop 0
 buffer_load_dwordx4 v7, s[32:35], s72 offen lds
 s_add_u32 s72, s72, s77
 s_mov_b32 m0, s58
 s_nop 0
 buffer_load_dwordx4 v7, s[36:39], s73 offen lds
 s_add_u32 s73, s73, s78
 s_mov_b32 m0, s59
 s_nop 0
 buffer_load_dwordx4 v8, s[40:43], s74 offen lds
 s_add_u32 s74, s74, s79
 s_mov_b32 m0, s60
 s_nop 0
 buffer_load_dwordx4 v9, s[44:47], s75 offen lds
 s_add_u32 s75, s75, s80
 s_mov_b32 m0, s61
 s_nop 0
 buffer_load_dwordx4 v9, s[48:51], s76 offen lds
 s_add_u32 s76, s76, s81
 s_lshl_b32 s85, s82, 2
 s_add_u32 s85, s85, s3
 s_lshl_b32 s85, s85, 9
 s_lshl_b32 s86, s3, 9
 s_add_u32 m0, s86, 147456
 s_waitcnt lgkmcnt(0)
 s_mov_b32 exec_hi, 0
 buffer_load_dwordx4 v0, s[88:91], s85 offen lds
 s_lshl2_add_u32 s87, s2, s7
 s_lshl_b32 s87, s87, 7
 s_add_u32 s87, s87, 39845888
 v_mov_b32 v60, 0
 v_lshlrev_b32 v61, 2, v1
 buffer_store_dword v60, v61, s[8:11], s87 offen sc1
 s_mov_b32 exec_hi, -1
 s_and_b32 s89, s83, 3
 s_sub_u32 s89, 7, s89
 s_cmp_lt_u32 s7, 2
 s_cselect_b32 s86, s89, 0
 s_cselect_b32 s87, 0, s89
 s_and_b32 s96, s83, 3
 s_lshl2_add_u32 s96, s96, s6
 s_add_u32 s96, s96, 3
 s_cmp_eq_u32 s3, 3
 s_cselect_b32 s88, 1, 0
 s_cselect_b32 s96, s96, -1
 s_waitcnt vmcnt(7)
 s_barrier
 ds_read_b128 v[64:67], v2 offset:0
 ds_read_b64_tr_b16 v[24:25], v4 offset:64
 ds_read_b64_tr_b16 v[26:27], v4 offset:3136
 ds_read_b128 v[68:71], v2 offset:2048
 ds_read_b128 v[72:75], v2 offset:4096
 ds_read_b128 v[76:79], v2 offset:6144
 ds_read_b64_tr_b16 v[28:29], v5 offset:64
 ds_read_b64_tr_b16 v[30:31], v5 offset:3136
 ds_read_b64_tr_b16 v[32:33], v4 offset:128
 ds_read_b64_tr_b16 v[34:35], v4 offset:3200
 ds_read_b64_tr_b16 v[36:37], v5 offset:128
 ds_read_b64_tr_b16 v[38:39], v5 offset:3200
 ds_read_b64_tr_b16 v[40:41], v6 offset:0
 ds_read_b64_tr_b16 v[42:43], v6 offset:3584
 s_waitcnt lgkmcnt(0)
 s_mov_b32 s84, 7
 v_mfma_f32_16x16x32_bf16 v[96:99], v[24:27], v[64:67], 0
 ds_read_b64_tr_b16 v[44:45], v6 offset:7168
 v_mfma_f32_16x16x32_bf16 v[100:103], v[24:27], v[68:71], 0
 ds_read_b64_tr_b16 v[46:47], v6 offset:10752
 v_mfma_f32_16x16x32_bf16 v[104:107], v[24:27], v[72:75], 0
 ds_read_b64_tr_b16 v[48:49], v6 offset:32
 v_mfma_f32_16x16x32_bf16 v[108:111], v[24:27], v[76:79], 0
 ds_read_b64_tr_b16 v[50:51], v6 offset:3616
 v_mfma_f32_16x16x32_bf16 v[124:127], v[28:31], v[76:79], 0
 ds_read_b64_tr_b16 v[52:53], v6 offset:7200
 s_cmp_eq_u32 s84, s86
 s_cbranch_scc1 Lcs_2
Lcb_1:
 v_mfma_f32_16x16x32_bf16 v[120:123], v[28:31], v[72:75], 0
 ds_read_b64_tr_b16 v[54:55], v6 offset:10784
 v_mfma_f32_16x16x32_bf16 v[116:119], v[28:31], v[68:71], 0
 ds_read_b64_tr_b16 v[56:57], v6 offset:64
 v_mfma_f32_16x16x32_bf16 v[112:115], v[28:31], v[64:67], 0
 ds_read_b64_tr_b16 v[58:59], v6 offset:3648
 v_mfma_f32_16x16x32_bf16 v[128:131], v[64:67], v[32:35], 0
 ds_read_b64_tr_b16 v[60:61], v6 offset:7232
 v_mfma_f32_16x16x32_bf16 v[132:135], v[68:71], v[32:35], 0
 ds_read_b64_tr_b16 v[62:63], v6 offset:10816
 v_mfma_f32_16x16x32_bf16 v[136:139], v[72:75], v[32:35], 0
 s_mov_b32 m0, s62
 v_mfma_f32_16x16x32_bf16 v[140:143], v[76:79], v[32:35], 0
 buffer_load_dwordx4 v7, s[32:35], s72 offen lds
 s_add_u32 s72, s72, s77
 v_mfma_f32_16x16x32_bf16 v[156:159], v[76:79], v[36:39], 0
 s_mov_b32 m0, s63
 v_mfma_f32_16x16x32_bf16 v[152:155], v[72:75], v[36:39], 0
 buffer_load_dwordx4 v7, s[36:39], s73 offen lds
 s_add_u32 s73, s73, s78
 v_mfma_f32_16x16x32_bf16 v[148:151], v[68:71], v[36:39], 0
 s_mov_b32 m0, s64
 v_mfma_f32_16x16x32_bf16 v[144:147], v[64:67], v[36:39], 0
 buffer_load_dwordx4 v8, s[40:43], s74 offen lds
 s_add_u32 s74, s74, s79
 v_mfma_f32_16x16x32_bf16 v[160:163], v[40:43], v[64:67], 0
 s_mov_b32 m0, s65
 v_mfma_f32_16x16x32_bf16 v[164:167], v[40:43], v[68:71], 0
 buffer_load_dwordx4 v9, s[44:47], s75 offen lds
 s_add_u32 s75, s75, s80
 v_mfma_f32_16x16x32_bf16 v[168:171], v[40:43], v[72:75], 0
 s_mov_b32 m0, s66
 v_mfma_f32_16x16x32_bf16 v[172:175], v[40:43], v[76:79], 0
 buffer_load_dwordx4 v9, s[48:51], s76 offen lds
 s_add_u32 s76, s76, s81
 s_waitcnt vmcnt(6) lgkmcnt(0)
 s_barrier
 v_mfma_f32_16x16x32_bf16 v[188:191], v[44:47], v[76:79], 0
 ds_read_b128 v[80:83], v3 offset:0
 v_mfma_f32_16x16x32_bf16 v[184:187], v[44:47], v[72:75], 0
 ds_read_b64_tr_b16 v[24:25], v4 offset:6208
 v_mfma_f32_16x16x32_bf16 v[180:183], v[44:47], v[68:71], 0
 ds_read_b64_tr_b16 v[26:27], v4 offset:9280
 v_mfma_f32_16x16x32_bf16 v[176:179], v[44:47], v[64:67], 0
 ds_read_b128 v[84:87], v3 offset:2048
 v_mfma_f32_16x16x32_bf16 v[192:195], v[48:51], v[64:67], 0
 ds_read_b128 v[88:91], v3 offset:4096
 s_cmp_eq_u32 s84, s87
 s_cbranch_scc1 Lcs_5
Lcb_4:
 v_mfma_f32_16x16x32_bf16 v[196:199], v[48:51], v[68:71], 0
 ds_read_b128 v[92:95], v3 offset:6144
 v_mfma_f32_16x16x32_bf16 v[200:203], v[48:51], v[72:75], 0
 ds_read_b64_tr_b16 v[28:29], v5 offset:6208
 v_mfma_f32_16x16x32_bf16 v[204:207], v[48:51], v[76:79], 0
 ds_read_b64_tr_b16 v[30:31], v5 offset:9280
 v_mfma_f32_16x16x32_bf16 v[220:223], v[52:55], v[76:79], 0
 ds_read_b64_tr_b16 v[32:33], v4 offset:6272
 v_mfma_f32_16x16x32_bf16 v[216:219], v[52:55], v[72:75], 0
 ds_read_b64_tr_b16 v[34:35], v4 offset:9344
 v_mfma_f32_16x16x32_bf16 v[212:215], v[52:55], v[68:71], 0
 ds_read_b64_tr_b16 v[36:37], v5 offset:6272
 v_mfma_f32_16x16x32_bf16 v[208:211], v[52:55], v[64:67], 0
 ds_read_b64_tr_b16 v[38:39], v5 offset:9344
 v_mfma_f32_16x16x32_bf16 v[224:227], v[56:59], v[64:67], 0
 ds_read_b64_tr_b16 v[40:41], v6 offset:14336
 v_mfma_f32_16x16x32_bf16 v[228:231], v[56:59], v[68:71], 0
 ds_read_b64_tr_b16 v[42:43], v6 offset:17920
 v_mfma_f32_16x16x32_bf16 v[232:235], v[56:59], v[72:75], 0
 s_mov_b32 m0, s67
 v_mfma_f32_16x16x32_bf16 v[236:239], v[56:59], v[76:79], 0
 buffer_load_dwordx4 v7, s[32:35], s72 offen lds
 s_add_u32 s72, s72, s77
 s_mov_b32 m0, s68
 v_mfma_f32_16x16x32_bf16 v[252:255], v[60:63], v[76:79], 0
 buffer_load_dwordx4 v7, s[36:39], s73 offen lds
 s_add_u32 s73, s73, s78
 s_mov_b32 m0, s69
 v_mfma_f32_16x16x32_bf16 v[248:251], v[60:63], v[72:75], 0
 buffer_load_dwordx4 v8, s[40:43], s74 offen lds
 s_add_u32 s74, s74, s79
 s_mov_b32 m0, s70
 v_mfma_f32_16x16x32_bf16 v[244:247], v[60:63], v[68:71], 0
 buffer_load_dwordx4 v9, s[44:47], s75 offen lds
 s_add_u32 s75, s75, s80
 s_mov_b32 m0, s71
 v_mfma_f32_16x16x32_bf16 v[240:243], v[60:63], v[64:67], 0
 buffer_load_dwordx4 v9, s[48:51], s76 offen lds
 s_add_u32 s76, s76, s81
 s_waitcnt lgkmcnt(0)
 v_mfma_f32_16x16x32_bf16 v[96:99], v[24:27], v[80:83], v[96:99]
 ds_read_b64_tr_b16 v[44:45], v6 offset:21504
 v_mfma_f32_16x16x32_bf16 v[100:103], v[24:27], v[84:87], v[100:103]
 ds_read_b64_tr_b16 v[46:47], v6 offset:25088
 v_mfma_f32_16x16x32_bf16 v[104:107], v[24:27], v[88:91], v[104:107]
 ds_read_b64_tr_b16 v[48:49], v6 offset:14368
 v_mfma_f32_16x16x32_bf16 v[108:111], v[24:27], v[92:95], v[108:111]
 ds_read_b64_tr_b16 v[50:51], v6 offset:17952
 v_mfma_f32_16x16x32_bf16 v[124:127], v[28:31], v[92:95], v[124:127]
 ds_read_b64_tr_b16 v[52:53], v6 offset:21536
 s_cmp_eq_u32 s84, s86
 s_cbranch_scc1 Lcs_8
Lcb_7:
 v_mfma_f32_16x16x32_bf16 v[120:123], v[28:31], v[88:91], v[120:123]
 ds_read_b64_tr_b16 v[54:55], v6 offset:25120
 v_mfma_f32_16x16x32_bf16 v[116:119], v[28:31], v[84:87], v[116:119]
 ds_read_b64_tr_b16 v[56:57], v6 offset:14400
 v_mfma_f32_16x16x32_bf16 v[112:115], v[28:31], v[80:83], v[112:115]
 ds_read_b64_tr_b16 v[58:59], v6 offset:17984
 v_mfma_f32_16x16x32_bf16 v[128:131], v[80:83], v[32:35], v[128:131]
 ds_read_b64_tr_b16 v[60:61], v6 offset:21568
 v_mfma_f32_16x16x32_bf16 v[132:135], v[84:87], v[32:35], v[132:135]
 ds_read_b64_tr_b16 v[62:63], v6 offset:25152
 v_mfma_f32_16x16x32_bf16 v[136:139], v[88:91], v[32:35], v[136:139]
 s_mov_b32 m0, s52
 v_mfma_f32_16x16x32_bf16 v[140:143], v[92:95], v[32:35], v[140:143]
 buffer_load_dwordx4 v7, s[32:35], s72 offen lds
 s_add_u32 s72, s72, s77
 v_mfma_f32_16x16x32_bf16 v[156:159], v[92:95], v[36:39], v[156:159]
 s_mov_b32 m0, s53
 v_mfma_f32_16x16x32_bf16 v[152:155], v[88:91], v[36:39], v[152:155]
 buffer_load_dwordx4 v7, s[36:39], s73 offen lds
 s_add_u32 s73, s73, s78
 v_mfma_f32_16x16x32_bf16 v[148:151], v[84:87], v[36:39], v[148:151]
 s_mov_b32 m0, s54
 v_mfma_f32_16x16x32_bf16 v[144:147], v[80:83], v[36:39], v[144:147]
 buffer_load_dwordx4 v8, s[40:43], s74 offen lds
 s_add_u32 s74, s74, s79
 v_mfma_f32_16x16x32_bf16 v[160:163], v[40:43], v[80:83], v[160:163]
 s_mov_b32 m0, s55
 v_mfma_f32_16x16x32_bf16 v[164:167], v[40:43], v[84:87], v[164:167]
 buffer_load_dwordx4 v9, s[44:47], s75 offen lds
 s_add_u32 s75, s75, s80
 v_mfma_f32_16x16x32_bf16 v[168:171], v[40:43], v[88:91], v[168:171]
 s_mov_b32 m0, s56
 v_mfma_f32_16x16x32_bf16 v[172:175], v[40:43], v[92:95], v[172:175]
 buffer_load_dwordx4 v9, s[48:51], s76 offen lds
 s_add_u32 s76, s76, s81
 s_waitcnt vmcnt(10) lgkmcnt(0)
 s_barrier
 v_mfma_f32_16x16x32_bf16 v[188:191], v[44:47], v[92:95], v[188:191]
 ds_read_b128 v[64:67], v2 offset:32768
 v_mfma_f32_16x16x32_bf16 v[184:187], v[44:47], v[88:91], v[184:187]
 ds_read_b64_tr_b16 v[24:25], v4 offset:12352
 v_mfma_f32_16x16x32_bf16 v[180:183], v[44:47], v[84:87], v[180:183]
 ds_read_b64_tr_b16 v[26:27], v4 offset:15424
 v_mfma_f32_16x16x32_bf16 v[176:179], v[44:47], v[80:83], v[176:179]
 ds_read_b128 v[68:71], v2 offset:34816
 v_mfma_f32_16x16x32_bf16 v[192:195], v[48:51], v[80:83], v[192:195]
 ds_read_b128 v[72:75], v2 offset:36864
 s_cmp_eq_u32 s84, s87
 s_cbranch_scc1 Lcs_11
Lcb_10:
 v_mfma_f32_16x16x32_bf16 v[196:199], v[48:51], v[84:87], v[196:199]
 ds_read_b128 v[76:79], v2 offset:38912
 v_mfma_f32_16x16x32_bf16 v[200:203], v[48:51], v[88:91], v[200:203]
 ds_read_b64_tr_b16 v[28:29], v5 offset:12352
 v_mfma_f32_16x16x32_bf16 v[204:207], v[48:51], v[92:95], v[204:207]
 ds_read_b64_tr_b16 v[30:31], v5 offset:15424
 v_mfma_f32_16x16x32_bf16 v[220:223], v[52:55], v[92:95], v[220:223]
 ds_read_b64_tr_b16 v[32:33], v4 offset:12416
 v_mfma_f32_16x16x32_bf16 v[216:219], v[52:55], v[88:91], v[216:219]
 ds_read_b64_tr_b16 v[34:35], v4 offset:15488
 v_mfma_f32_16x16x32_bf16 v[212:215], v[52:55], v[84:87], v[212:215]
 ds_read_b64_tr_b16 v[36:37], v5 offset:12416
 v_mfma_f32_16x16x32_bf16 v[208:211], v[52:55], v[80:83], v[208:211]
 ds_read_b64_tr_b16 v[38:39], v5 offset:15488
 v_mfma_f32_16x16x32_bf16 v[224:227], v[56:59], v[80:83], v[224:227]
 ds_read_b64_tr_b16 v[40:41], v6 offset:28672
 v_mfma_f32_16x16x32_bf16 v[228:231], v[56:59], v[84:87], v[228:231]
 ds_read_b64_tr_b16 v[42:43], v6 offset:32256
 v_mfma_f32_16x16x32_bf16 v[232:235], v[56:59], v[88:91], v[232:235]
 s_mov_b32 m0, s57
 v_mfma_f32_16x16x32_bf16 v[236:239], v[56:59], v[92:95], v[236:239]
 buffer_load_dwordx4 v7, s[32:35], s72 offen lds
 s_add_u32 s72, s72, s77
 s_mov_b32 m0, s58
 v_mfma_f32_16x16x32_bf16 v[252:255], v[60:63], v[92:95], v[252:255]
 buffer_load_dwordx4 v7, s[36:39], s73 offen lds
 s_add_u32 s73, s73, s78
 s_mov_b32 m0, s59
 v_mfma_f32_16x16x32_bf16 v[248:251], v[60:63], v[88:91], v[248:251]
 buffer_load_dwordx4 v8, s[40:43], s74 offen lds
 s_add_u32 s74, s74, s79
 s_mov_b32 m0, s60
 v_mfma_f32_16x16x32_bf16 v[244:247], v[60:63], v[84:87], v[244:247]
 buffer_load_dwordx4 v9, s[44:47], s75 offen lds
 s_add_u32 s75, s75, s80
 s_mov_b32 m0, s61
 v_mfma_f32_16x16x32_bf16 v[240:243], v[60:63], v[80:83], v[240:243]
 buffer_load_dwordx4 v9, s[48:51], s76 offen lds
 s_add_u32 s76, s76, s81
 s_waitcnt lgkmcnt(0)
 v_mfma_f32_16x16x32_bf16 v[96:99], v[24:27], v[64:67], v[96:99]
 ds_read_b64_tr_b16 v[44:45], v6 offset:35840
 v_mfma_f32_16x16x32_bf16 v[100:103], v[24:27], v[68:71], v[100:103]
 ds_read_b64_tr_b16 v[46:47], v6 offset:39424
 v_mfma_f32_16x16x32_bf16 v[104:107], v[24:27], v[72:75], v[104:107]
 ds_read_b64_tr_b16 v[48:49], v6 offset:28704
 v_mfma_f32_16x16x32_bf16 v[108:111], v[24:27], v[76:79], v[108:111]
 ds_read_b64_tr_b16 v[50:51], v6 offset:32288
 v_mfma_f32_16x16x32_bf16 v[124:127], v[28:31], v[76:79], v[124:127]
 ds_read_b64_tr_b16 v[52:53], v6 offset:35872
 s_cmp_eq_u32 s84, s86
 s_cbranch_scc1 Lcs_14
Lcb_13:
 v_mfma_f32_16x16x32_bf16 v[120:123], v[28:31], v[72:75], v[120:123]
 ds_read_b64_tr_b16 v[54:55], v6 offset:39456
 v_mfma_f32_16x16x32_bf16 v[116:119], v[28:31], v[68:71], v[116:119]
 ds_read_b64_tr_b16 v[56:57], v6 offset:28736
 v_mfma_f32_16x16x32_bf16 v[112:115], v[28:31], v[64:67], v[112:115]
 ds_read_b64_tr_b16 v[58:59], v6 offset:32320
 v_mfma_f32_16x16x32_bf16 v[128:131], v[64:67], v[32:35], v[128:131]
 ds_read_b64_tr_b16 v[60:61], v6 offset:35904
 v_mfma_f32_16x16x32_bf16 v[132:135], v[68:71], v[32:35], v[132:135]
 ds_read_b64_tr_b16 v[62:63], v6 offset:39488
 v_mfma_f32_16x16x32_bf16 v[136:139], v[72:75], v[32:35], v[136:139]
 v_mfma_f32_16x16x32_bf16 v[140:143], v[76:79], v[32:35], v[140:143]
 v_mfma_f32_16x16x32_bf16 v[156:159], v[76:79], v[36:39], v[156:159]
 v_mfma_f32_16x16x32_bf16 v[152:155], v[72:75], v[36:39], v[152:155]
 v_mfma_f32_16x16x32_bf16 v[148:151], v[68:71], v[36:39], v[148:151]
 v_mfma_f32_16x16x32_bf16 v[144:147], v[64:67], v[36:39], v[144:147]
 v_mfma_f32_16x16x32_bf16 v[160:163], v[40:43], v[64:67], v[160:163]
 v_mfma_f32_16x16x32_bf16 v[164:167], v[40:43], v[68:71], v[164:167]
 v_mfma_f32_16x16x32_bf16 v[168:171], v[40:43], v[72:75], v[168:171]
 v_mfma_f32_16x16x32_bf16 v[172:175], v[40:43], v[76:79], v[172:175]
 s_waitcnt vmcnt(10) lgkmcnt(0)
 s_barrier
 v_mfma_f32_16x16x32_bf16 v[188:191], v[44:47], v[76:79], v[188:191]
 ds_read_b128 v[80:83], v3 offset:32768
 v_mfma_f32_16x16x32_bf16 v[184:187], v[44:47], v[72:75], v[184:187]
 ds_read_b64_tr_b16 v[24:25], v4 offset:18496
 v_mfma_f32_16x16x32_bf16 v[180:183], v[44:47], v[68:71], v[180:183]
 ds_read_b64_tr_b16 v[26:27], v4 offset:21568
 v_mfma_f32_16x16x32_bf16 v[176:179], v[44:47], v[64:67], v[176:179]
 ds_read_b128 v[84:87], v3 offset:34816
 v_mfma_f32_16x16x32_bf16 v[192:195], v[48:51], v[64:67], v[192:195]
 ds_read_b128 v[88:91], v3 offset:36864
 s_cmp_eq_u32 s84, s87
 s_cbranch_scc1 Lcs_17
Lcb_16:
 v_mfma_f32_16x16x32_bf16 v[196:199], v[48:51], v[68:71], v[196:199]
 ds_read_b128 v[92:95], v3 offset:38912
 v_mfma_f32_16x16x32_bf16 v[200:203], v[48:51], v[72:75], v[200:203]
 ds_read_b64_tr_b16 v[28:29], v5 offset:18496
 v_mfma_f32_16x16x32_bf16 v[204:207], v[48:51], v[76:79], v[204:207]
 ds_read_b64_tr_b16 v[30:31], v5 offset:21568
 v_mfma_f32_16x16x32_bf16 v[220:223], v[52:55], v[76:79], v[220:223]
 ds_read_b64_tr_b16 v[32:33], v4 offset:18560
 v_mfma_f32_16x16x32_bf16 v[216:219], v[52:55], v[72:75], v[216:219]
 ds_read_b64_tr_b16 v[34:35], v4 offset:21632
 v_mfma_f32_16x16x32_bf16 v[212:215], v[52:55], v[68:71], v[212:215]
 ds_read_b64_tr_b16 v[36:37], v5 offset:18560
 v_mfma_f32_16x16x32_bf16 v[208:211], v[52:55], v[64:67], v[208:211]
 ds_read_b64_tr_b16 v[38:39], v5 offset:21632
 v_mfma_f32_16x16x32_bf16 v[224:227], v[56:59], v[64:67], v[224:227]
 ds_read_b64_tr_b16 v[40:41], v6 offset:43008
 v_mfma_f32_16x16x32_bf16 v[228:231], v[56:59], v[68:71], v[228:231]
 ds_read_b64_tr_b16 v[42:43], v6 offset:46592
 v_mfma_f32_16x16x32_bf16 v[232:235], v[56:59], v[72:75], v[232:235]
 s_mov_b32 m0, s62
 v_mfma_f32_16x16x32_bf16 v[236:239], v[56:59], v[76:79], v[236:239]
 buffer_load_dwordx4 v7, s[32:35], s72 offen lds
 s_add_u32 s72, s72, s77
 s_mov_b32 m0, s63
 v_mfma_f32_16x16x32_bf16 v[252:255], v[60:63], v[76:79], v[252:255]
 buffer_load_dwordx4 v7, s[36:39], s73 offen lds
 s_add_u32 s73, s73, s78
 s_mov_b32 m0, s64
 v_mfma_f32_16x16x32_bf16 v[248:251], v[60:63], v[72:75], v[248:251]
 buffer_load_dwordx4 v8, s[40:43], s74 offen lds
 s_add_u32 s74, s74, s79
 s_mov_b32 m0, s65
 v_mfma_f32_16x16x32_bf16 v[244:247], v[60:63], v[68:71], v[244:247]
 buffer_load_dwordx4 v9, s[44:47], s75 offen lds
 s_add_u32 s75, s75, s80
 s_mov_b32 m0, s66
 v_mfma_f32_16x16x32_bf16 v[240:243], v[60:63], v[64:67], v[240:243]
 buffer_load_dwordx4 v9, s[48:51], s76 offen lds
 s_add_u32 s76, s76, s81
 s_waitcnt lgkmcnt(0)
 v_mfma_f32_16x16x32_bf16 v[96:99], v[24:27], v[80:83], v[96:99]
 ds_read_b64_tr_b16 v[44:45], v6 offset:50176
 v_mfma_f32_16x16x32_bf16 v[100:103], v[24:27], v[84:87], v[100:103]
 ds_read_b64_tr_b16 v[46:47], v6 offset:53760
 v_mfma_f32_16x16x32_bf16 v[104:107], v[24:27], v[88:91], v[104:107]
 ds_read_b64_tr_b16 v[48:49], v6 offset:43040
 v_mfma_f32_16x16x32_bf16 v[108:111], v[24:27], v[92:95], v[108:111]
 ds_read_b64_tr_b16 v[50:51], v6 offset:46624
 v_mfma_f32_16x16x32_bf16 v[124:127], v[28:31], v[92:95], v[124:127]
 ds_read_b64_tr_b16 v[52:53], v6 offset:50208
 s_cmp_eq_u32 s84, s86
 s_cbranch_scc1 Lcs_20
Lcb_19:
 v_mfma_f32_16x16x32_bf16 v[120:123], v[28:31], v[88:91], v[120:123]
 ds_read_b64_tr_b16 v[54:55], v6 offset:53792
 v_mfma_f32_16x16x32_bf16 v[116:119], v[28:31], v[84:87], v[116:119]
 ds_read_b64_tr_b16 v[56:57], v6 offset:43072
 v_mfma_f32_16x16x32_bf16 v[112:115], v[28:31], v[80:83], v[112:115]
 ds_read_b64_tr_b16 v[58:59], v6 offset:46656
 v_mfma_f32_16x16x32_bf16 v[128:131], v[80:83], v[32:35], v[128:131]
 ds_read_b64_tr_b16 v[60:61], v6 offset:50240
 v_mfma_f32_16x16x32_bf16 v[132:135], v[84:87], v[32:35], v[132:135]
 ds_read_b64_tr_b16 v[62:63], v6 offset:53824
 v_mfma_f32_16x16x32_bf16 v[136:139], v[88:91], v[32:35], v[136:139]
 v_mfma_f32_16x16x32_bf16 v[140:143], v[92:95], v[32:35], v[140:143]
 v_mfma_f32_16x16x32_bf16 v[156:159], v[92:95], v[36:39], v[156:159]
 v_mfma_f32_16x16x32_bf16 v[152:155], v[88:91], v[36:39], v[152:155]
 v_mfma_f32_16x16x32_bf16 v[148:151], v[84:87], v[36:39], v[148:151]
 v_mfma_f32_16x16x32_bf16 v[144:147], v[80:83], v[36:39], v[144:147]
 v_mfma_f32_16x16x32_bf16 v[160:163], v[40:43], v[80:83], v[160:163]
 v_mfma_f32_16x16x32_bf16 v[164:167], v[40:43], v[84:87], v[164:167]
 v_mfma_f32_16x16x32_bf16 v[168:171], v[40:43], v[88:91], v[168:171]
 v_mfma_f32_16x16x32_bf16 v[172:175], v[40:43], v[92:95], v[172:175]
 s_waitcnt vmcnt(10) lgkmcnt(0)
 s_barrier
 v_mfma_f32_16x16x32_bf16 v[188:191], v[44:47], v[92:95], v[188:191]
 ds_read_b128 v[64:67], v2 offset:0
 v_mfma_f32_16x16x32_bf16 v[184:187], v[44:47], v[88:91], v[184:187]
 ds_read_b64_tr_b16 v[24:25], v4 offset:64
 v_mfma_f32_16x16x32_bf16 v[180:183], v[44:47], v[84:87], v[180:183]
 ds_read_b64_tr_b16 v[26:27], v4 offset:3136
 v_mfma_f32_16x16x32_bf16 v[176:179], v[44:47], v[80:83], v[176:179]
 ds_read_b128 v[68:71], v2 offset:2048
 v_mfma_f32_16x16x32_bf16 v[192:195], v[48:51], v[80:83], v[192:195]
 ds_read_b128 v[72:75], v2 offset:4096
 s_cmp_eq_u32 s84, s87
 s_cbranch_scc1 Lcs_23
Lcb_22:
 v_mfma_f32_16x16x32_bf16 v[196:199], v[48:51], v[84:87], v[196:199]
 ds_read_b128 v[76:79], v2 offset:6144
 v_mfma_f32_16x16x32_bf16 v[200:203], v[48:51], v[88:91], v[200:203]
 ds_read_b64_tr_b16 v[28:29], v5 offset:64
 v_mfma_f32_16x16x32_bf16 v[204:207], v[48:51], v[92:95], v[204:207]
 ds_read_b64_tr_b16 v[30:31], v5 offset:3136
 v_mfma_f32_16x16x32_bf16 v[220:223], v[52:55], v[92:95], v[220:223]
 ds_read_b64_tr_b16 v[32:33], v4 offset:128
 v_mfma_f32_16x16x32_bf16 v[216:219], v[52:55], v[88:91], v[216:219]
 ds_read_b64_tr_b16 v[34:35], v4 offset:3200
 v_mfma_f32_16x16x32_bf16 v[212:215], v[52:55], v[84:87], v[212:215]
 ds_read_b64_tr_b16 v[36:37], v5 offset:128
 v_mfma_f32_16x16x32_bf16 v[208:211], v[52:55], v[80:83], v[208:211]
 ds_read_b64_tr_b16 v[38:39], v5 offset:3200
 v_mfma_f32_16x16x32_bf16 v[224:227], v[56:59], v[80:83], v[224:227]
 ds_read_b64_tr_b16 v[40:41], v6 offset:0
 v_mfma_f32_16x16x32_bf16 v[228:231], v[56:59], v[84:87], v[228:231]
 ds_read_b64_tr_b16 v[42:43], v6 offset:3584
 v_mfma_f32_16x16x32_bf16 v[232:235], v[56:59], v[88:91], v[232:235]
 s_mov_b32 m0, s67
 v_mfma_f32_16x16x32_bf16 v[236:239], v[56:59], v[92:95], v[236:239]
 buffer_load_dwordx4 v7, s[32:35], s72 offen lds
 s_add_u32 s72, s72, s77
 s_mov_b32 m0, s68
 v_mfma_f32_16x16x32_bf16 v[252:255], v[60:63], v[92:95], v[252:255]
 buffer_load_dwordx4 v7, s[36:39], s73 offen lds
 s_add_u32 s73, s73, s78
 s_cmp_eq_u32 s84, s89
 s_cbranch_scc1 Lrp_25
Lrq_26:
 s_mov_b32 m0, s69
 v_mfma_f32_16x16x32_bf16 v[248:251], v[60:63], v[88:91], v[248:251]
 buffer_load_dwordx4 v8, s[40:43], s74 offen lds
 s_add_u32 s74, s74, s79
 s_mov_b32 m0, s70
 v_mfma_f32_16x16x32_bf16 v[244:247], v[60:63], v[84:87], v[244:247]
 buffer_load_dwordx4 v9, s[44:47], s75 offen lds
 s_add_u32 s75, s75, s80
 s_mov_b32 m0, s71
 v_mfma_f32_16x16x32_bf16 v[240:243], v[60:63], v[80:83], v[240:243]
 buffer_load_dwordx4 v9, s[48:51], s76 offen lds
 s_add_u32 s76, s76, s81
 s_waitcnt lgkmcnt(0)
 s_mov_b32 s84, 6
L1_loop0:
 v_mfma_f32_16x16x32_bf16 v[96:99], v[24:27], v[64:67], v[96:99]
 ds_read_b64_tr_b16 v[44:45], v6 offset:7168
 v_mfma_f32_16x16x32_bf16 v[100:103], v[24:27], v[68:71], v[100:103]
 ds_read_b64_tr_b16 v[46:47], v6 offset:10752
 v_mfma_f32_16x16x32_bf16 v[104:107], v[24:27], v[72:75], v[104:107]
 ds_read_b64_tr_b16 v[48:49], v6 offset:32
 s_sub_u32 s96, s96, 1
 s_cbranch_scc1 Ldg_27
Ldb_28:
 v_mfma_f32_16x16x32_bf16 v[108:111], v[24:27], v[76:79], v[108:111]
 ds_read_b64_tr_b16 v[50:51], v6 offset:3616
 v_mfma_f32_16x16x32_bf16 v[124:127], v[28:31], v[76:79], v[124:127]
 ds_read_b64_tr_b16 v[52:53], v6 offset:7200
 s_cmp_eq_u32 s84, s86
 s_cbranch_scc1 Lcs_30
Lcb_29:
 v_mfma_f32_16x16x32_bf16 v[120:123], v[28:31], v[72:75], v[120:123]
 ds_read_b64_tr_b16 v[54:55], v6 offset:10784
 v_mfma_f32_16x16x32_bf16 v[116:119], v[28:31], v[68:71], v[116:119]
 ds_read_b64_tr_b16 v[56:57], v6 offset:64
 v_mfma_f32_16x16x32_bf16 v[112:115], v[28:31], v[64:67], v[112:115]
 ds_read_b64_tr_b16 v[58:59], v6 offset:3648
 v_mfma_f32_16x16x32_bf16 v[128:131], v[64:67], v[32:35], v[128:131]
 ds_read_b64_tr_b16 v[60:61], v6 offset:7232
 v_mfma_f32_16x16x32_bf16 v[132:135], v[68:71], v[32:35], v[132:135]
 ds_read_b64_tr_b16 v[62:63], v6 offset:10816
 v_mfma_f32_16x16x32_bf16 v[136:139], v[72:75], v[32:35], v[136:139]
 v_mfma_f32_16x16x32_bf16 v[140:143], v[76:79], v[32:35], v[140:143]
 v_mfma_f32_16x16x32_bf16 v[156:159], v[76:79], v[36:39], v[156:159]
 v_mfma_f32_16x16x32_bf16 v[152:155], v[72:75], v[36:39], v[152:155]
 v_mfma_f32_16x16x32_bf16 v[148:151], v[68:71], v[36:39], v[148:151]
 v_mfma_f32_16x16x32_bf16 v[144:147], v[64:67], v[36:39], v[144:147]
 v_mfma_f32_16x16x32_bf16 v[160:163], v[40:43], v[64:67], v[160:163]
 v_mfma_f32_16x16x32_bf16 v[164:167], v[40:43], v[68:71], v[164:167]
 v_mfma_f32_16x16x32_bf16 v[168:171], v[40:43], v[72:75], v[168:171]
 v_mfma_f32_16x16x32_bf16 v[172:175], v[40:43], v[76:79], v[172:175]
 s_waitcnt vmcnt(10) lgkmcnt(0)
 s_barrier
 v_mfma_f32_16x16x32_bf16 v[188:191], v[44:47], v[76:79], v[188:191]
 ds_read_b128 v[80:83], v3 offset:0
 v_mfma_f32_16x16x32_bf16 v[184:187], v[44:47], v[72:75], v[184:187]
 ds_read_b64_tr_b16 v[24:25], v4 offset:6208
 v_mfma_f32_16x16x32_bf16 v[180:183], v[44:47], v[68:71], v[180:183]
 ds_read_b64_tr_b16 v[26:27], v4 offset:9280
 v_mfma_f32_16x16x32_bf16 v[176:179], v[44:47], v[64:67], v[176:179]
 ds_read_b128 v[84:87], v3 offset:2048
 v_mfma_f32_16x16x32_bf16 v[192:195], v[48:51], v[64:67], v[192:195]
 ds_read_b128 v[88:91], v3 offset:4096
 s_cmp_eq_u32 s84, s87
 s_cbranch_scc1 Lcs_33
Lcb_32:
 v_mfma_f32_16x16x32_bf16 v[196:199], v[48:51], v[68:71], v[196:199]
 ds_read_b128 v[92:95], v3 offset:6144
 v_mfma_f32_16x16x32_bf16 v[200:203], v[48:51], v[72:75], v[200:203]
 ds_read_b64_tr_b16 v[28:29], v5 offset:6208
 v_mfma_f32_16x16x32_bf16 v[204:207], v[48:51], v[76:79], v[204:207]
 ds_read_b64_tr_b16 v[30:31], v5 offset:9280
 v_mfma_f32_16x16x32_bf16 v[220:223], v[52:55], v[76:79], v[220:223]
 ds_read_b64_tr_b16 v[32:33], v4 offset:6272
 v_mfma_f32_16x16x32_bf16 v[216:219], v[52:55], v[72:75], v[216:219]
 ds_read_b64_tr_b16 v[34:35], v4 offset:9344
 v_mfma_f32_16x16x32_bf16 v[212:215], v[52:55], v[68:71], v[212:215]
 ds_read_b64_tr_b16 v[36:37], v5 offset:6272
 v_mfma_f32_16x16x32_bf16 v[208:211], v[52:55], v[64:67], v[208:211]
 ds_read_b64_tr_b16 v[38:39], v5 offset:9344
 v_mfma_f32_16x16x32_bf16 v[224:227], v[56:59], v[64:67], v[224:227]
 ds_read_b64_tr_b16 v[40:41], v6 offset:14336
 v_mfma_f32_16x16x32_bf16 v[228:231], v[56:59], v[68:71], v[228:231]
 ds_read_b64_tr_b16 v[42:43], v6 offset:17920
 v_mfma_f32_16x16x32_bf16 v[232:235], v[56:59], v[72:75], v[232:235]
 s_mov_b32 m0, s52
 v_mfma_f32_16x16x32_bf16 v[236:239], v[56:59], v[76:79], v[236:239]
 buffer_load_dwordx4 v7, s[32:35], s72 offen lds
 s_add_u32 s72, s72, s77
 s_mov_b32 m0, s53
 v_mfma_f32_16x16x32_bf16 v[252:255], v[60:63], v[76:79], v[252:255]
 buffer_load_dwordx4 v7, s[36:39], s73 offen lds
 s_add_u32 s73, s73, s78
 s_mov_b32 m0, s54
 v_mfma_f32_16x16x32_bf16 v[248:251], v[60:63], v[72:75], v[248:251]
 buffer_load_dwordx4 v8, s[40:43], s74 offen lds
 s_add_u32 s74, s74, s79
 s_mov_b32 m0, s55
 v_mfma_f32_16x16x32_bf16 v[244:247], v[60:63], v[68:71], v[244:247]
 buffer_load_dwordx4 v9, s[44:47], s75 offen lds
 s_add_u32 s75, s75, s80
 s_mov_b32 m0, s56
 v_mfma_f32_16x16x32_bf16 v[240:243], v[60:63], v[64:67], v[240:243]
 buffer_load_dwordx4 v9, s[48:51], s76 offen lds
 s_add_u32 s76, s76, s81
 s_waitcnt lgkmcnt(0)
 v_mfma_f32_16x16x32_bf16 v[96:99], v[24:27], v[80:83], v[96:99]
 ds_read_b64_tr_b16 v[44:45], v6 offset:21504
 v_mfma_f32_16x16x32_bf16 v[100:103], v[24:27], v[84:87], v[100:103]
 ds_read_b64_tr_b16 v[46:47], v6 offset:25088
 v_mfma_f32_16x16x32_bf16 v[104:107], v[24:27], v[88:91], v[104:107]
 ds_read_b64_tr_b16 v[48:49], v6 offset:14368
 s_sub_u32 s96, s96, 1
 s_cbranch_scc1 Ldg_35
Ldb_36:
 v_mfma_f32_16x16x32_bf16 v[108:111], v[24:27], v[92:95], v[108:111]
 ds_read_b64_tr_b16 v[50:51], v6 offset:17952
 v_mfma_f32_16x16x32_bf16 v[124:127], v[28:31], v[92:95], v[124:127]
 ds_read_b64_tr_b16 v[52:53], v6 offset:21536
 s_cmp_eq_u32 s84, s86
 s_cbranch_scc1 Lcs_38
Lcb_37:
 v_mfma_f32_16x16x32_bf16 v[120:123], v[28:31], v[88:91], v[120:123]
 ds_read_b64_tr_b16 v[54:55], v6 offset:25120
 v_mfma_f32_16x16x32_bf16 v[116:119], v[28:31], v[84:87], v[116:119]
 ds_read_b64_tr_b16 v[56:57], v6 offset:14400
 v_mfma_f32_16x16x32_bf16 v[112:115], v[28:31], v[80:83], v[112:115]
 ds_read_b64_tr_b16 v[58:59], v6 offset:17984
 v_mfma_f32_16x16x32_bf16 v[128:131], v[80:83], v[32:35], v[128:131]
 ds_read_b64_tr_b16 v[60:61], v6 offset:21568
 v_mfma_f32_16x16x32_bf16 v[132:135], v[84:87], v[32:35], v[132:135]
 ds_read_b64_tr_b16 v[62:63], v6 offset:25152
 v_mfma_f32_16x16x32_bf16 v[136:139], v[88:91], v[32:35], v[136:139]
 v_mfma_f32_16x16x32_bf16 v[140:143], v[92:95], v[32:35], v[140:143]
 v_mfma_f32_16x16x32_bf16 v[156:159], v[92:95], v[36:39], v[156:159]
 v_mfma_f32_16x16x32_bf16 v[152:155], v[88:91], v[36:39], v[152:155]
 v_mfma_f32_16x16x32_bf16 v[148:151], v[84:87], v[36:39], v[148:151]
 v_mfma_f32_16x16x32_bf16 v[144:147], v[80:83], v[36:39], v[144:147]
 v_mfma_f32_16x16x32_bf16 v[160:163], v[40:43], v[80:83], v[160:163]
 v_mfma_f32_16x16x32_bf16 v[164:167], v[40:43], v[84:87], v[164:167]
 v_mfma_f32_16x16x32_bf16 v[168:171], v[40:43], v[88:91], v[168:171]
 v_mfma_f32_16x16x32_bf16 v[172:175], v[40:43], v[92:95], v[172:175]
 s_waitcnt vmcnt(10) lgkmcnt(0)
 s_barrier
 v_mfma_f32_16x16x32_bf16 v[188:191], v[44:47], v[92:95], v[188:191]
 ds_read_b128 v[64:67], v2 offset:32768
 v_mfma_f32_16x16x32_bf16 v[184:187], v[44:47], v[88:91], v[184:187]
 ds_read_b64_tr_b16 v[24:25], v4 offset:12352
 v_mfma_f32_16x16x32_bf16 v[180:183], v[44:47], v[84:87], v[180:183]
 ds_read_b64_tr_b16 v[26:27], v4 offset:15424
 v_mfma_f32_16x16x32_bf16 v[176:179], v[44:47], v[80:83], v[176:179]
 ds_read_b128 v[68:71], v2 offset:34816
 v_mfma_f32_16x16x32_bf16 v[192:195], v[48:51], v[80:83], v[192:195]
 ds_read_b128 v[72:75], v2 offset:36864
 s_cmp_eq_u32 s84, s87
 s_cbranch_scc1 Lcs_41
Lcb_40:
 v_mfma_f32_16x16x32_bf16 v[196:199], v[48:51], v[84:87], v[196:199]
 ds_read_b128 v[76:79], v2 offset:38912
 v_mfma_f32_16x16x32_bf16 v[200:203], v[48:51], v[88:91], v[200:203]
 ds_read_b64_tr_b16 v[28:29], v5 offset:12352
 v_mfma_f32_16x16x32_bf16 v[204:207], v[48:51], v[92:95], v[204:207]
 ds_read_b64_tr_b16 v[30:31], v5 offset:15424
 v_mfma_f32_16x16x32_bf16 v[220:223], v[52:55], v[92:95], v[220:223]
 ds_read_b64_tr_b16 v[32:33], v4 offset:12416
 v_mfma_f32_16x16x32_bf16 v[216:219], v[52:55], v[88:91], v[216:219]
 ds_read_b64_tr_b16 v[34:35], v4 offset:15488
 v_mfma_f32_16x16x32_bf16 v[212:215], v[52:55], v[84:87], v[212:215]
 ds_read_b64_tr_b16 v[36:37], v5 offset:12416
 v_mfma_f32_16x16x32_bf16 v[208:211], v[52:55], v[80:83], v[208:211]
 ds_read_b64_tr_b16 v[38:39], v5 offset:15488
 v_mfma_f32_16x16x32_bf16 v[224:227], v[56:59], v[80:83], v[224:227]
 ds_read_b64_tr_b16 v[40:41], v6 offset:28672
 v_mfma_f32_16x16x32_bf16 v[228:231], v[56:59], v[84:87], v[228:231]
 ds_read_b64_tr_b16 v[42:43], v6 offset:32256
 v_mfma_f32_16x16x32_bf16 v[232:235], v[56:59], v[88:91], v[232:235]
 s_mov_b32 m0, s57
 v_mfma_f32_16x16x32_bf16 v[236:239], v[56:59], v[92:95], v[236:239]
 buffer_load_dwordx4 v7, s[32:35], s72 offen lds
 s_add_u32 s72, s72, s77
 s_mov_b32 m0, s58
 v_mfma_f32_16x16x32_bf16 v[252:255], v[60:63], v[92:95], v[252:255]
 buffer_load_dwordx4 v7, s[36:39], s73 offen lds
 s_add_u32 s73, s73, s78
 s_mov_b32 m0, s59
 v_mfma_f32_16x16x32_bf16 v[248:251], v[60:63], v[88:91], v[248:251]
 buffer_load_dwordx4 v8, s[40:43], s74 offen lds
 s_add_u32 s74, s74, s79
 s_mov_b32 m0, s60
 v_mfma_f32_16x16x32_bf16 v[244:247], v[60:63], v[84:87], v[244:247]
 buffer_load_dwordx4 v9, s[44:47], s75 offen lds
 s_add_u32 s75, s75, s80
 s_mov_b32 m0, s61
 v_mfma_f32_16x16x32_bf16 v[240:243], v[60:63], v[80:83], v[240:243]
 buffer_load_dwordx4 v9, s[48:51], s76 offen lds
 s_add_u32 s76, s76, s81
 s_waitcnt lgkmcnt(0)
 v_mfma_f32_16x16x32_bf16 v[96:99], v[24:27], v[64:67], v[96:99]
 ds_read_b64_tr_b16 v[44:45], v6 offset:35840
 s_cmp_eq_u32 s84, s88
 s_cbranch_scc1 Ldp_43
Ldq_44:
 v_mfma_f32_16x16x32_bf16 v[100:103], v[24:27], v[68:71], v[100:103]
 ds_read_b64_tr_b16 v[46:47], v6 offset:39424
 v_mfma_f32_16x16x32_bf16 v[104:107], v[24:27], v[72:75], v[104:107]
 ds_read_b64_tr_b16 v[48:49], v6 offset:28704
 s_sub_u32 s96, s96, 1
 s_cbranch_scc1 Ldg_45
Ldb_46:
 v_mfma_f32_16x16x32_bf16 v[108:111], v[24:27], v[76:79], v[108:111]
 ds_read_b64_tr_b16 v[50:51], v6 offset:32288
 v_mfma_f32_16x16x32_bf16 v[124:127], v[28:31], v[76:79], v[124:127]
 ds_read_b64_tr_b16 v[52:53], v6 offset:35872
 s_cmp_eq_u32 s84, s86
 s_cbranch_scc1 Lcs_48
Lcb_47:
 v_mfma_f32_16x16x32_bf16 v[120:123], v[28:31], v[72:75], v[120:123]
 ds_read_b64_tr_b16 v[54:55], v6 offset:39456
 v_mfma_f32_16x16x32_bf16 v[116:119], v[28:31], v[68:71], v[116:119]
 ds_read_b64_tr_b16 v[56:57], v6 offset:28736
 v_mfma_f32_16x16x32_bf16 v[112:115], v[28:31], v[64:67], v[112:115]
 ds_read_b64_tr_b16 v[58:59], v6 offset:32320
 v_mfma_f32_16x16x32_bf16 v[128:131], v[64:67], v[32:35], v[128:131]
 ds_read_b64_tr_b16 v[60:61], v6 offset:35904
 v_mfma_f32_16x16x32_bf16 v[132:135], v[68:71], v[32:35], v[132:135]
 ds_read_b64_tr_b16 v[62:63], v6 offset:39488
 v_mfma_f32_16x16x32_bf16 v[136:139], v[72:75], v[32:35], v[136:139]
 v_mfma_f32_16x16x32_bf16 v[140:143], v[76:79], v[32:35], v[140:143]
 v_mfma_f32_16x16x32_bf16 v[156:159], v[76:79], v[36:39], v[156:159]
 v_mfma_f32_16x16x32_bf16 v[152:155], v[72:75], v[36:39], v[152:155]
 v_mfma_f32_16x16x32_bf16 v[148:151], v[68:71], v[36:39], v[148:151]
 v_mfma_f32_16x16x32_bf16 v[144:147], v[64:67], v[36:39], v[144:147]
 v_mfma_f32_16x16x32_bf16 v[160:163], v[40:43], v[64:67], v[160:163]
 v_mfma_f32_16x16x32_bf16 v[164:167], v[40:43], v[68:71], v[164:167]
 v_mfma_f32_16x16x32_bf16 v[168:171], v[40:43], v[72:75], v[168:171]
 v_mfma_f32_16x16x32_bf16 v[172:175], v[40:43], v[76:79], v[172:175]
 s_waitcnt vmcnt(10) lgkmcnt(0)
 s_barrier
 v_mfma_f32_16x16x32_bf16 v[188:191], v[44:47], v[76:79], v[188:191]
 ds_read_b128 v[80:83], v3 offset:32768
 v_mfma_f32_16x16x32_bf16 v[184:187], v[44:47], v[72:75], v[184:187]
 ds_read_b64_tr_b16 v[24:25], v4 offset:18496
 v_mfma_f32_16x16x32_bf16 v[180:183], v[44:47], v[68:71], v[180:183]
 ds_read_b64_tr_b16 v[26:27], v4 offset:21568
 v_mfma_f32_16x16x32_bf16 v[176:179], v[44:47], v[64:67], v[176:179]
 ds_read_b128 v[84:87], v3 offset:34816
 v_mfma_f32_16x16x32_bf16 v[192:195], v[48:51], v[64:67], v[192:195]
 ds_read_b128 v[88:91], v3 offset:36864
 s_cmp_eq_u32 s84, s87
 s_cbranch_scc1 Lcs_51
Lcb_50:
 v_mfma_f32_16x16x32_bf16 v[196:199], v[48:51], v[68:71], v[196:199]
 ds_read_b128 v[92:95], v3 offset:38912
 v_mfma_f32_16x16x32_bf16 v[200:203], v[48:51], v[72:75], v[200:203]
 ds_read_b64_tr_b16 v[28:29], v5 offset:18496
 v_mfma_f32_16x16x32_bf16 v[204:207], v[48:51], v[76:79], v[204:207]
 ds_read_b64_tr_b16 v[30:31], v5 offset:21568
 v_mfma_f32_16x16x32_bf16 v[220:223], v[52:55], v[76:79], v[220:223]
 ds_read_b64_tr_b16 v[32:33], v4 offset:18560
 v_mfma_f32_16x16x32_bf16 v[216:219], v[52:55], v[72:75], v[216:219]
 ds_read_b64_tr_b16 v[34:35], v4 offset:21632
 v_mfma_f32_16x16x32_bf16 v[212:215], v[52:55], v[68:71], v[212:215]
 ds_read_b64_tr_b16 v[36:37], v5 offset:18560
 v_mfma_f32_16x16x32_bf16 v[208:211], v[52:55], v[64:67], v[208:211]
 ds_read_b64_tr_b16 v[38:39], v5 offset:21632
 v_mfma_f32_16x16x32_bf16 v[224:227], v[56:59], v[64:67], v[224:227]
 ds_read_b64_tr_b16 v[40:41], v6 offset:43008
 v_mfma_f32_16x16x32_bf16 v[228:231], v[56:59], v[68:71], v[228:231]
 ds_read_b64_tr_b16 v[42:43], v6 offset:46592
 v_mfma_f32_16x16x32_bf16 v[232:235], v[56:59], v[72:75], v[232:235]
 s_mov_b32 m0, s62
 v_mfma_f32_16x16x32_bf16 v[236:239], v[56:59], v[76:79], v[236:239]
 buffer_load_dwordx4 v7, s[32:35], s72 offen lds
 s_add_u32 s72, s72, s77
 s_mov_b32 m0, s63
 v_mfma_f32_16x16x32_bf16 v[252:255], v[60:63], v[76:79], v[252:255]
 buffer_load_dwordx4 v7, s[36:39], s73 offen lds
 s_add_u32 s73, s73, s78
 s_mov_b32 m0, s64
 v_mfma_f32_16x16x32_bf16 v[248:251], v[60:63], v[72:75], v[248:251]
 buffer_load_dwordx4 v8, s[40:43], s74 offen lds
 s_add_u32 s74, s74, s79
 s_mov_b32 m0, s65
 v_mfma_f32_16x16x32_bf16 v[244:247], v[60:63], v[68:71], v[244:247]
 buffer_load_dwordx4 v9, s[44:47], s75 offen lds
 s_add_u32 s75, s75, s80
 s_mov_b32 m0, s66
 v_mfma_f32_16x16x32_bf16 v[240:243], v[60:63], v[64:67], v[240:243]
 buffer_load_dwordx4 v9, s[48:51], s76 offen lds
 s_add_u32 s76, s76, s81
 s_waitcnt lgkmcnt(0)
 v_mfma_f32_16x16x32_bf16 v[96:99], v[24:27], v[80:83], v[96:99]
 ds_read_b64_tr_b16 v[44:45], v6 offset:50176
 v_mfma_f32_16x16x32_bf16 v[100:103], v[24:27], v[84:87], v[100:103]
 ds_read_b64_tr_b16 v[46:47], v6 offset:53760
 v_mfma_f32_16x16x32_bf16 v[104:107], v[24:27], v[88:91], v[104:107]
 ds_read_b64_tr_b16 v[48:49], v6 offset:43040
 s_sub_u32 s96, s96, 1
 s_cbranch_scc1 Ldg_53
Ldb_54:
 v_mfma_f32_16x16x32_bf16 v[108:111], v[24:27], v[92:95], v[108:111]
 ds_read_b64_tr_b16 v[50:51], v6 offset:46624
 v_mfma_f32_16x16x32_bf16 v[124:127], v[28:31], v[92:95], v[124:127]
 ds_read_b64_tr_b16 v[52:53], v6 offset:50208
 s_cmp_eq_u32 s84, s86
 s_cbranch_scc1 Lcs_56
Lcb_55:
 v_mfma_f32_16x16x32_bf16 v[120:123], v[28:31], v[88:91], v[120:123]
 ds_read_b64_tr_b16 v[54:55], v6 offset:53792
 v_mfma_f32_16x16x32_bf16 v[116:119], v[28:31], v[84:87], v[116:119]
 ds_read_b64_tr_b16 v[56:57], v6 offset:43072
 v_mfma_f32_16x16x32_bf16 v[112:115], v[28:31], v[80:83], v[112:115]
 ds_read_b64_tr_b16 v[58:59], v6 offset:46656
 v_mfma_f32_16x16x32_bf16 v[128:131], v[80:83], v[32:35], v[128:131]
 ds_read_b64_tr_b16 v[60:61], v6 offset:50240
 v_mfma_f32_16x16x32_bf16 v[132:135], v[84:87], v[32:35], v[132:135]
 ds_read_b64_tr_b16 v[62:63], v6 offset:53824
 v_mfma_f32_16x16x32_bf16 v[136:139], v[88:91], v[32:35], v[136:139]
 v_mfma_f32_16x16x32_bf16 v[140:143], v[92:95], v[32:35], v[140:143]
 v_mfma_f32_16x16x32_bf16 v[156:159], v[92:95], v[36:39], v[156:159]
 v_mfma_f32_16x16x32_bf16 v[152:155], v[88:91], v[36:39], v[152:155]
 v_mfma_f32_16x16x32_bf16 v[148:151], v[84:87], v[36:39], v[148:151]
 v_mfma_f32_16x16x32_bf16 v[144:147], v[80:83], v[36:39], v[144:147]
 v_mfma_f32_16x16x32_bf16 v[160:163], v[40:43], v[80:83], v[160:163]
 v_mfma_f32_16x16x32_bf16 v[164:167], v[40:43], v[84:87], v[164:167]
 v_mfma_f32_16x16x32_bf16 v[168:171], v[40:43], v[88:91], v[168:171]
 v_mfma_f32_16x16x32_bf16 v[172:175], v[40:43], v[92:95], v[172:175]
 s_waitcnt vmcnt(10) lgkmcnt(0)
 s_barrier
 v_mfma_f32_16x16x32_bf16 v[188:191], v[44:47], v[92:95], v[188:191]
 ds_read_b128 v[64:67], v2 offset:0
 v_mfma_f32_16x16x32_bf16 v[184:187], v[44:47], v[88:91], v[184:187]
 ds_read_b64_tr_b16 v[24:25], v4 offset:64
 v_mfma_f32_16x16x32_bf16 v[180:183], v[44:47], v[84:87], v[180:183]
 ds_read_b64_tr_b16 v[26:27], v4 offset:3136
 v_mfma_f32_16x16x32_bf16 v[176:179], v[44:47], v[80:83], v[176:179]
 ds_read_b128 v[68:71], v2 offset:2048
 v_mfma_f32_16x16x32_bf16 v[192:195], v[48:51], v[80:83], v[192:195]
 ds_read_b128 v[72:75], v2 offset:4096
 s_cmp_eq_u32 s84, s87
 s_cbranch_scc1 Lcs_59
Lcb_58:
 v_mfma_f32_16x16x32_bf16 v[196:199], v[48:51], v[84:87], v[196:199]
 ds_read_b128 v[76:79], v2 offset:6144
 v_mfma_f32_16x16x32_bf16 v[200:203], v[48:51], v[88:91], v[200:203]
 ds_read_b64_tr_b16 v[28:29], v5 offset:64
 v_mfma_f32_16x16x32_bf16 v[204:207], v[48:51], v[92:95], v[204:207]
 ds_read_b64_tr_b16 v[30:31], v5 offset:3136
 v_mfma_f32_16x16x32_bf16 v[220:223], v[52:55], v[92:95], v[220:223]
 ds_read_b64_tr_b16 v[32:33], v4 offset:128
 v_mfma_f32_16x16x32_bf16 v[216:219], v[52:55], v[88:91], v[216:219]
 ds_read_b64_tr_b16 v[34:35], v4 offset:3200
 v_mfma_f32_16x16x32_bf16 v[212:215], v[52:55], v[84:87], v[212:215]
 ds_read_b64_tr_b16 v[36:37], v5 offset:128
 v_mfma_f32_16x16x32_bf16 v[208:211], v[52:55], v[80:83], v[208:211]
 ds_read_b64_tr_b16 v[38:39], v5 offset:3200
 v_mfma_f32_16x16x32_bf16 v[224:227], v[56:59], v[80:83], v[224:227]
 ds_read_b64_tr_b16 v[40:41], v6 offset:0
 v_mfma_f32_16x16x32_bf16 v[228:231], v[56:59], v[84:87], v[228:231]
 ds_read_b64_tr_b16 v[42:43], v6 offset:3584
 v_mfma_f32_16x16x32_bf16 v[232:235], v[56:59], v[88:91], v[232:235]
 s_mov_b32 m0, s67
 v_mfma_f32_16x16x32_bf16 v[236:239], v[56:59], v[92:95], v[236:239]
 buffer_load_dwordx4 v7, s[32:35], s72 offen lds
 s_add_u32 s72, s72, s77
 s_mov_b32 m0, s68
 v_mfma_f32_16x16x32_bf16 v[252:255], v[60:63], v[92:95], v[252:255]
 buffer_load_dwordx4 v7, s[36:39], s73 offen lds
 s_add_u32 s73, s73, s78
 s_cmp_eq_u32 s84, s89
 s_cbranch_scc1 Lrp_61
Lrq_62:
 s_mov_b32 m0, s69
 v_mfma_f32_16x16x32_bf16 v[248:251], v[60:63], v[88:91], v[248:251]
 buffer_load_dwordx4 v8, s[40:43], s74 offen lds
 s_add_u32 s74, s74, s79
 s_mov_b32 m0, s70
 v_mfma_f32_16x16x32_bf16 v[244:247], v[60:63], v[84:87], v[244:247]
 buffer_load_dwordx4 v9, s[44:47], s75 offen lds
 s_add_u32 s75, s75, s80
 s_mov_b32 m0, s71
 v_mfma_f32_16x16x32_bf16 v[240:243], v[60:63], v[80:83], v[240:243]
 buffer_load_dwordx4 v9, s[48:51], s76 offen lds
 s_add_u32 s76, s76, s81
 s_waitcnt lgkmcnt(0)
 s_sub_u32 s84, s84, 1
 s_cmp_lg_u32 s84, 0
 s_cbranch_scc1 L1_loop0
 s_cmp_lg_u32 s3, 3
 s_cbranch_scc1 L1_last0
 s_waitcnt vmcnt(10)
 s_mov_b32 s85, 0x01010101
 v_lshlrev_b32 v22, 2, v1
 v_cmp_ne_u32 vcc, s85, v21
 s_cbranch_vccnz Lsp_63
Lok_64:
L1_last0:
 v_mfma_f32_16x16x32_bf16 v[96:99], v[24:27], v[64:67], v[96:99]
 ds_read_b64_tr_b16 v[44:45], v6 offset:7168
 v_lshlrev_b32 v21, 7, v1
 v_mov_b32 v22, 1073741824
 v_cmp_gt_u32 vcc, 16, v1
 s_nop 1
 v_cndmask_b32 v21, v22, v21, vcc
 v_mfma_f32_16x16x32_bf16 v[100:103], v[24:27], v[68:71], v[100:103]
 ds_read_b64_tr_b16 v[46:47], v6 offset:10752
 s_lshl2_add_u32 s91, s2, s7
 s_lshl_b32 s91, s91, 11
 s_lshl_b32 s90, s7, 11
 s_add_u32 s90, s90, 90112
 v_mfma_f32_16x16x32_bf16 v[104:107], v[24:27], v[72:75], v[104:107]
 ds_read_b64_tr_b16 v[48:49], v6 offset:32
 s_mov_b32 s65, 0x07060302
 v_mfma_f32_16x16x32_bf16 v[108:111], v[24:27], v[76:79], v[108:111]
 ds_read_b64_tr_b16 v[50:51], v6 offset:3616
 v_mfma_f32_16x16x32_bf16 v[124:127], v[28:31], v[76:79], v[124:127]
 ds_read_b64_tr_b16 v[52:53], v6 offset:7200
 v_mfma_f32_16x16x32_bf16 v[120:123], v[28:31], v[72:75], v[120:123]
 ds_read_b64_tr_b16 v[54:55], v6 offset:10784
 v_mfma_f32_16x16x32_bf16 v[116:119], v[28:31], v[68:71], v[116:119]
 ds_read_b64_tr_b16 v[56:57], v6 offset:64
 v_mfma_f32_16x16x32_bf16 v[112:115], v[28:31], v[64:67], v[112:115]
 ds_read_b64_tr_b16 v[58:59], v6 offset:3648
 v_mfma_f32_16x16x32_bf16 v[128:131], v[64:67], v[32:35], v[128:131]
 ds_read_b64_tr_b16 v[60:61], v6 offset:7232
 v_mfma_f32_16x16x32_bf16 v[132:135], v[68:71], v[32:35], v[132:135]
 ds_read_b64_tr_b16 v[62:63], v6 offset:10816
 v_mfma_f32_16x16x32_bf16 v[136:139], v[72:75], v[32:35], v[136:139]
 v_mfma_f32_16x16x32_bf16 v[140:143], v[76:79], v[32:35], v[140:143]
 v_mfma_f32_16x16x32_bf16 v[156:159], v[76:79], v[36:39], v[156:159]
 v_mfma_f32_16x16x32_bf16 v[152:155], v[72:75], v[36:39], v[152:155]
 v_mfma_f32_16x16x32_bf16 v[148:151], v[68:71], v[36:39], v[148:151]
 v_mfma_f32_16x16x32_bf16 v[144:147], v[64:67], v[36:39], v[144:147]
 v_mfma_f32_16x16x32_bf16 v[160:163], v[40:43], v[64:67], v[160:163]
 v_mfma_f32_16x16x32_bf16 v[164:167], v[40:43], v[68:71], v[164:167]
 v_mfma_f32_16x16x32_bf16 v[168:171], v[40:43], v[72:75], v[168:171]
 v_mfma_f32_16x16x32_bf16 v[172:175], v[40:43], v[76:79], v[172:175]
 s_waitcnt vmcnt(10) lgkmcnt(0)
 s_barrier
 v_mfma_f32_16x16x32_bf16 v[188:191], v[44:47], v[76:79], v[188:191]
 ds_read_b128 v[80:83], v3 offset:0
 v_mfma_f32_16x16x32_bf16 v[184:187], v[44:47], v[72:75], v[184:187]
 ds_read_b64_tr_b16 v[24:25], v4 offset:6208
 v_mfma_f32_16x16x32_bf16 v[180:183], v[44:47], v[68:71], v[180:183]
 ds_read_b64_tr_b16 v[26:27], v4 offset:9280
 v_mfma_f32_16x16x32_bf16 v[176:179], v[44:47], v[64:67], v[176:179]
 ds_read_b128 v[84:87], v3 offset:2048
 v_mfma_f32_16x16x32_bf16 v[192:195], v[48:51], v[64:67], v[192:195]
 ds_read_b128 v[88:91], v3 offset:4096
 v_mfma_f32_16x16x32_bf16 v[196:199], v[48:51], v[68:71], v[196:199]
 ds_read_b128 v[92:95], v3 offset:6144
 s_lshl3_add_u32 s89, s82, s3
 s_lshl_b32 s89, s89, 11
 v_mfma_f32_16x16x32_bf16 v[200:203], v[48:51], v[72:75], v[200:203]
 ds_read_b64_tr_b16 v[28:29], v5 offset:6208
 buffer_load_dwordx2 v[12:13], v20, s[8:11], s89 offen offset:0 sc1
 v_mfma_f32_16x16x32_bf16 v[204:207], v[48:51], v[76:79], v[204:207]
 ds_read_b64_tr_b16 v[30:31], v5 offset:9280
 v_mfma_f32_16x16x32_bf16 v[220:223], v[52:55], v[76:79], v[220:223]
 ds_read_b64_tr_b16 v[32:33], v4 offset:6272
 buffer_load_dwordx2 v[14:15], v20, s[8:11], s89 offen offset:512 sc1
 v_mfma_f32_16x16x32_bf16 v[216:219], v[52:55], v[72:75], v[216:219]
 ds_read_b64_tr_b16 v[34:35], v4 offset:9344
 v_mfma_f32_16x16x32_bf16 v[212:215], v[52:55], v[68:71], v[212:215]
 ds_read_b64_tr_b16 v[36:37], v5 offset:6272
 buffer_load_dwordx2 v[16:17], v20, s[8:11], s89 offen offset:1024 sc1
 v_mfma_f32_16x16x32_bf16 v[208:211], v[52:55], v[64:67], v[208:211]
 ds_read_b64_tr_b16 v[38:39], v5 offset:9344
 v_mfma_f32_16x16x32_bf16 v[224:227], v[56:59], v[64:67], v[224:227]
 ds_read_b64_tr_b16 v[40:41], v6 offset:14336
 buffer_load_dwordx2 v[18:19], v20, s[8:11], s89 offen offset:1536 sc1
 v_mfma_f32_16x16x32_bf16 v[228:231], v[56:59], v[68:71], v[228:231]
 ds_read_b64_tr_b16 v[42:43], v6 offset:17920
 v_mfma_f32_16x16x32_bf16 v[232:235], v[56:59], v[72:75], v[232:235]
 buffer_load_dword v8, v21, s[20:23], s91 offen
 v_mfma_f32_16x16x32_bf16 v[236:239], v[56:59], v[76:79], v[236:239]
 v_mfma_f32_16x16x32_bf16 v[252:255], v[60:63], v[76:79], v[252:255]
 v_mfma_f32_16x16x32_bf16 v[248:251], v[60:63], v[72:75], v[248:251]
 v_mfma_f32_16x16x32_bf16 v[244:247], v[60:63], v[68:71], v[244:247]
 v_mfma_f32_16x16x32_bf16 v[240:243], v[60:63], v[64:67], v[240:243]
 s_waitcnt lgkmcnt(0)
 v_mfma_f32_16x16x32_bf16 v[96:99], v[24:27], v[80:83], v[96:99]
 ds_read_b64_tr_b16 v[44:45], v6 offset:21504
 s_mul_i32 s49, s4, 1835008
 s_lshl_b32 s85, s5, 8
 s_add_u32 s49, s49, s85
 v_mfma_f32_16x16x32_bf16 v[100:103], v[24:27], v[84:87], v[100:103]
 ds_read_b64_tr_b16 v[46:47], v6 offset:25088
 s_lshl_b32 s48, s4, 3
 s_add_u32 s48, s48, s83
 s_mul_i32 s48, s48, 458752
 v_mfma_f32_16x16x32_bf16 v[104:107], v[24:27], v[88:91], v[104:107]
 ds_read_b64_tr_b16 v[48:49], v6 offset:14368
 s_add_u32 s48, s48, 4194304
 s_lshr_b32 s86, s5, 2
 s_add_u32 s54, s6, s86
 v_mfma_f32_16x16x32_bf16 v[108:111], v[24:27], v[92:95], v[108:111]
 ds_read_b64_tr_b16 v[50:51], v6 offset:17952
 s_add_u32 s54, s54, 3
 s_and_b32 s54, s54, 3
 s_mov_b32 s85, s5
 v_mfma_f32_16x16x32_bf16 v[124:127], v[28:31], v[92:95], v[124:127]
 ds_read_b64_tr_b16 v[52:53], v6 offset:21536
 s_mul_i32 s32, s85, 229376
 s_add_u32 s32, s32, s49
 s_mul_i32 s40, s85, 49152
 v_mfma_f32_16x16x32_bf16 v[120:123], v[28:31], v[88:91], v[120:123]
 ds_read_b64_tr_b16 v[54:55], v6 offset:25120
 s_add_u32 s40, s40, s48
 s_add_u32 s85, s54, 1
 s_and_b32 s85, s85, 3
 v_mfma_f32_16x16x32_bf16 v[116:119], v[28:31], v[84:87], v[116:119]
 ds_read_b64_tr_b16 v[56:57], v6 offset:14400
 s_or_b32 s85, s85, 4
 s_mul_i32 s33, s85, 229376
 s_add_u32 s33, s33, s49
 v_mfma_f32_16x16x32_bf16 v[112:115], v[28:31], v[80:83], v[112:115]
 ds_read_b64_tr_b16 v[58:59], v6 offset:17984
 s_mul_i32 s41, s85, 49152
 s_add_u32 s41, s41, s48
 s_add_u32 s85, s54, 2
 v_mfma_f32_16x16x32_bf16 v[128:131], v[80:83], v[32:35], v[128:131]
 ds_read_b64_tr_b16 v[60:61], v6 offset:21568
 s_and_b32 s85, s85, 3
 s_mul_i32 s34, s85, 229376
 s_add_u32 s34, s34, s49
 v_mfma_f32_16x16x32_bf16 v[132:135], v[84:87], v[32:35], v[132:135]
 ds_read_b64_tr_b16 v[62:63], v6 offset:25152
 s_mul_i32 s42, s85, 49152
 s_add_u32 s42, s42, s48
 s_add_u32 s85, s54, 2
 v_mfma_f32_16x16x32_bf16 v[136:139], v[88:91], v[32:35], v[136:139]
 s_and_b32 s85, s85, 3
 s_or_b32 s85, s85, 4
 s_mul_i32 s35, s85, 229376
 v_mfma_f32_16x16x32_bf16 v[140:143], v[92:95], v[32:35], v[140:143]
 s_add_u32 s35, s35, s49
 s_mul_i32 s43, s85, 49152
 s_add_u32 s43, s43, s48
 v_mfma_f32_16x16x32_bf16 v[156:159], v[92:95], v[36:39], v[156:159]
 s_add_u32 s85, s54, 3
 s_and_b32 s85, s85, 3
 s_mul_i32 s36, s85, 229376
 v_mfma_f32_16x16x32_bf16 v[152:155], v[88:91], v[36:39], v[152:155]
 s_add_u32 s36, s36, s49
 s_mul_i32 s44, s85, 49152
 s_add_u32 s44, s44, s48
 v_mfma_f32_16x16x32_bf16 v[148:151], v[84:87], v[36:39], v[148:151]
 s_add_u32 s85, s54, 3
 s_and_b32 s85, s85, 3
 s_or_b32 s85, s85, 4
 v_mfma_f32_16x16x32_bf16 v[144:147], v[80:83], v[36:39], v[144:147]
 s_mul_i32 s37, s85, 229376
 s_add_u32 s37, s37, s49
 s_mul_i32 s45, s85, 49152
 v_mfma_f32_16x16x32_bf16 v[160:163], v[40:43], v[80:83], v[160:163]
 s_add_u32 s45, s45, s48
 s_add_u32 s85, s54, 4
 v_mfma_f32_16x16x32_bf16 v[164:167], v[40:43], v[84:87], v[164:167]
 v_mfma_f32_16x16x32_bf16 v[168:171], v[40:43], v[88:91], v[168:171]
 v_mfma_f32_16x16x32_bf16 v[172:175], v[40:43], v[92:95], v[172:175]
 s_waitcnt vmcnt(10) lgkmcnt(0)
 s_barrier
 v_mfma_f32_16x16x32_bf16 v[188:191], v[44:47], v[92:95], v[188:191]
 ds_read_b128 v[64:67], v2 offset:32768
 s_and_b32 s85, s85, 3
 s_mul_i32 s38, s85, 229376
 v_mfma_f32_16x16x32_bf16 v[184:187], v[44:47], v[88:91], v[184:187]
 ds_read_b64_tr_b16 v[24:25], v4 offset:12352
 s_add_u32 s38, s38, s49
 s_mul_i32 s46, s85, 49152
 v_mfma_f32_16x16x32_bf16 v[180:183], v[44:47], v[84:87], v[180:183]
 ds_read_b64_tr_b16 v[26:27], v4 offset:15424
 s_add_u32 s46, s46, s48
 s_add_u32 s85, s54, s86
 v_mfma_f32_16x16x32_bf16 v[176:179], v[44:47], v[80:83], v[176:179]
 ds_read_b128 v[68:71], v2 offset:34816
 s_and_b32 s85, s85, 3
 s_andn2_b32 s87, 4, s5
 v_mfma_f32_16x16x32_bf16 v[192:195], v[48:51], v[80:83], v[192:195]
 ds_read_b128 v[72:75], v2 offset:36864
 s_or_b32 s85, s85, s87
 s_mul_i32 s39, s85, 229376
 v_mfma_f32_16x16x32_bf16 v[196:199], v[48:51], v[84:87], v[196:199]
 ds_read_b128 v[76:79], v2 offset:38912
 s_add_u32 s39, s39, s49
 s_mul_i32 s47, s85, 49152
 v_mfma_f32_16x16x32_bf16 v[200:203], v[48:51], v[88:91], v[200:203]
 ds_read_b64_tr_b16 v[28:29], v5 offset:12352
 s_add_u32 s47, s47, s48
 s_lshl_b32 s50, s3, 11
 v_mfma_f32_16x16x32_bf16 v[204:207], v[48:51], v[92:95], v[204:207]
 ds_read_b64_tr_b16 v[30:31], v5 offset:15424
 s_lshl_b32 s51, s3, 10
 s_add_u32 s51, s51, 98304
 v_mfma_f32_16x16x32_bf16 v[220:223], v[52:55], v[92:95], v[220:223]
 ds_read_b64_tr_b16 v[32:33], v4 offset:12416
 s_lshl_b32 s85, s3, 2
 v_lshrrev_b32 v9, 4, v1
 v_mfma_f32_16x16x32_bf16 v[216:219], v[52:55], v[88:91], v[216:219]
 ds_read_b64_tr_b16 v[34:35], v4 offset:15488
 v_add_u32 v9, s85, v9
 v_and_b32 v21, 7, v9
 v_mfma_f32_16x16x32_bf16 v[212:215], v[52:55], v[84:87], v[212:215]
 ds_read_b64_tr_b16 v[36:37], v5 offset:12416
 v_lshlrev_b32 v21, 1, v21
 v_and_b32 v22, 15, v1
 v_mfma_f32_16x16x32_bf16 v[208:211], v[52:55], v[80:83], v[208:211]
 ds_read_b64_tr_b16 v[38:39], v5 offset:15488
 v_xor_b32 v21, v21, v22
 v_lshlrev_b32 v9, 11, v9
 v_mfma_f32_16x16x32_bf16 v[224:227], v[56:59], v[80:83], v[224:227]
 ds_read_b64_tr_b16 v[40:41], v6 offset:28672
 v_lshl_add_u32 v10, v21, 4, v9
 v_lshrrev_b32 v22, 3, v21
 v_mfma_f32_16x16x32_bf16 v[228:231], v[56:59], v[84:87], v[228:231]
 ds_read_b64_tr_b16 v[42:43], v6 offset:32256
 v_lshl_add_u32 v9, v22, 16, v9
 v_and_b32 v21, 7, v21
 v_mfma_f32_16x16x32_bf16 v[232:235], v[56:59], v[88:91], v[232:235]
 v_lshl_add_u32 v11, v21, 4, v9
 s_lshr_b32 s87, s3, 2
 v_mfma_f32_16x16x32_bf16 v[236:239], v[56:59], v[92:95], v[236:239]
 v_mfma_f32_16x16x32_bf16 v[252:255], v[60:63], v[92:95], v[252:255]
 v_mfma_f32_16x16x32_bf16 v[248:251], v[60:63], v[88:91], v[248:251]
 v_mfma_f32_16x16x32_bf16 v[244:247], v[60:63], v[84:87], v[244:247]
 v_mfma_f32_16x16x32_bf16 v[240:243], v[60:63], v[80:83], v[240:243]
 s_waitcnt lgkmcnt(0)
 v_mfma_f32_16x16x32_bf16 v[96:99], v[24:27], v[64:67], v[96:99]
 ds_read_b64_tr_b16 v[44:45], v6 offset:35840
 s_xor_b32 s85, s99, 0
 s_lshl_b32 s85, s85, 1
 s_add_u32 s85, s85, s87
 v_mfma_f32_16x16x32_bf16 v[100:103], v[24:27], v[68:71], v[100:103]
 ds_read_b64_tr_b16 v[46:47], v6 offset:39424
 s_lshl1_add_u32 s67, s85, 0
 s_xor_b32 s85, s99, 0
 s_lshl_b32 s85, s85, 1
 v_mfma_f32_16x16x32_bf16 v[104:107], v[24:27], v[72:75], v[104:107]
 ds_read_b64_tr_b16 v[48:49], v6 offset:28704
 s_add_u32 s85, s85, s87
 s_lshl1_add_u32 s68, s85, 1
 s_xor_b32 s85, s99, 1
 v_mfma_f32_16x16x32_bf16 v[108:111], v[24:27], v[76:79], v[108:111]
 ds_read_b64_tr_b16 v[50:51], v6 offset:32288
 s_lshl_b32 s85, s85, 1
 s_add_u32 s85, s85, s87
 s_lshl1_add_u32 s69, s85, 0
 v_mfma_f32_16x16x32_bf16 v[124:127], v[28:31], v[76:79], v[124:127]
 ds_read_b64_tr_b16 v[52:53], v6 offset:35872
 s_xor_b32 s85, s99, 1
 s_lshl_b32 s85, s85, 1
 s_add_u32 s85, s85, s87
 v_mfma_f32_16x16x32_bf16 v[120:123], v[28:31], v[72:75], v[120:123]
 ds_read_b64_tr_b16 v[54:55], v6 offset:39456
 s_lshl1_add_u32 s70, s85, 1
 s_lshl1_add_u32 s58, s5, s99
 s_lshl_b32 s58, s58, 7
 v_mfma_f32_16x16x32_bf16 v[116:119], v[28:31], v[68:71], v[116:119]
 ds_read_b64_tr_b16 v[56:57], v6 offset:28736
 s_lshr_b32 s85, s7, 1
 s_mul_i32 s85, s85, 104
 s_and_b32 s86, s7, 1
 v_mfma_f32_16x16x32_bf16 v[112:115], v[28:31], v[64:67], v[112:115]
 ds_read_b64_tr_b16 v[58:59], v6 offset:32320
 s_lshl2_add_u32 s85, s86, s85
 s_mul_i32 s86, s87, 12
 s_sub_u32 s85, s85, s86
 v_mfma_f32_16x16x32_bf16 v[128:131], v[64:67], v[32:35], v[128:131]
 ds_read_b64_tr_b16 v[60:61], v6 offset:35904
 s_add_u32 s85, s85, 32
 s_lshl_b32 s85, s85, 11
 s_add_u32 s59, s85, s49
 v_mfma_f32_16x16x32_bf16 v[132:135], v[68:71], v[32:35], v[132:135]
 ds_read_b64_tr_b16 v[62:63], v6 offset:39488
 s_xor_b32 s85, s87, s99
 s_lshl_b32 s85, s85, 14
 s_lshl1_add_u32 s86, s7, s98
 v_mfma_f32_16x16x32_bf16 v[136:139], v[72:75], v[32:35], v[136:139]
 s_lshl_b32 s88, s86, 11
 s_add_u32 s85, s85, s88
 s_lshl_b32 s57, s83, 19
 v_mfma_f32_16x16x32_bf16 v[140:143], v[76:79], v[32:35], v[140:143]
 s_add_u32 s57, s57, s85
 s_add_u32 s57, s57, 18874368
 s_add_u32 s56, s48, 393216
 v_mfma_f32_16x16x32_bf16 v[156:159], v[76:79], v[36:39], v[156:159]
 s_lshl_b32 s85, s83, 3
 s_add_u32 s86, s86, s85
 s_lshl_b32 s61, s86, 16
 v_mfma_f32_16x16x32_bf16 v[152:155], v[72:75], v[36:39], v[152:155]
 s_add_u32 s61, s61, s58
 s_lshl_b32 s87, s87, 6
 s_add_u32 s61, s61, s87
 v_mfma_f32_16x16x32_bf16 v[148:151], v[68:71], v[36:39], v[148:151]
 s_add_u32 s66, s61, 32768
 s_lshl_b32 s55, s7, 12
 s_add_u32 s85, s85, s5
 v_mfma_f32_16x16x32_bf16 v[144:147], v[64:67], v[36:39], v[144:147]
 s_mul_i32 s60, s85, 196608
 s_add_u32 s60, s60, 27262976
 v_lshrrev_b32 v21, 2, v1
 v_mfma_f32_16x16x32_bf16 v[160:163], v[40:43], v[64:67], v[160:163]
 v_lshlrev_b32 v21, 6, v21
 v_and_b32 v22, 3, v1
 v_lshl_add_u32 v21, v22, 3, v21
 v_mfma_f32_16x16x32_bf16 v[164:167], v[40:43], v[68:71], v[164:167]
 v_add_u32 v2, 147456, v21
 v_mfma_f32_16x16x32_bf16 v[168:171], v[40:43], v[72:75], v[168:171]
 v_mfma_f32_16x16x32_bf16 v[172:175], v[40:43], v[76:79], v[172:175]
 s_waitcnt vmcnt(1) lgkmcnt(0)
 s_barrier
 v_mfma_f32_16x16x32_bf16 v[188:191], v[44:47], v[76:79], v[188:191]
 ds_read_b128 v[80:83], v3 offset:32768
 v_pk_add_f32 v[12:13], v[12:13], v[14:15]
 v_mfma_f32_16x16x32_bf16 v[184:187], v[44:47], v[72:75], v[184:187]
 ds_read_b64_tr_b16 v[24:25], v4 offset:18496
 v_pk_add_f32 v[16:17], v[16:17], v[18:19]
 v_mfma_f32_16x16x32_bf16 v[180:183], v[44:47], v[68:71], v[180:183]
 ds_read_b64_tr_b16 v[26:27], v4 offset:21568
 s_lshl_b32 s85, s3, 8
 v_mfma_f32_16x16x32_bf16 v[176:179], v[44:47], v[64:67], v[176:179]
 ds_read_b128 v[84:87], v3 offset:34816
 s_add_u32 s85, s85, 65536
 v_mfma_f32_16x16x32_bf16 v[192:195], v[48:51], v[64:67], v[192:195]
 ds_read_b128 v[88:91], v3 offset:36864
 v_pk_add_f32 v[12:13], v[12:13], v[16:17]
 v_mfma_f32_16x16x32_bf16 v[196:199], v[48:51], v[68:71], v[196:199]
 ds_read_b128 v[92:95], v3 offset:38912
 v_lshl_add_u32 v20, v1, 2, s85
 v_mfma_f32_16x16x32_bf16 v[200:203], v[48:51], v[72:75], v[200:203]
 ds_read_b64_tr_b16 v[28:29], v5 offset:18496
 v_permlane32_swap_b32 v12, v13
 v_mfma_f32_16x16x32_bf16 v[204:207], v[48:51], v[76:79], v[204:207]
 ds_read_b64_tr_b16 v[30:31], v5 offset:21568
 v_add_f32 v16, v12, v13
 v_mfma_f32_16x16x32_bf16 v[220:223], v[52:55], v[76:79], v[220:223]
 ds_read_b64_tr_b16 v[32:33], v4 offset:18560
 v_and_b32 v17, 0xffff0000, v16
 v_mfma_f32_16x16x32_bf16 v[216:219], v[52:55], v[72:75], v[216:219]
 ds_read_b64_tr_b16 v[34:35], v4 offset:21632
 v_sub_f32 v16, v16, v17
 v_mfma_f32_16x16x32_bf16 v[212:215], v[52:55], v[68:71], v[212:215]
 ds_read_b64_tr_b16 v[36:37], v5 offset:18560
 v_cvt_pk_bf16_f32 v16, v17, v16
 v_mfma_f32_16x16x32_bf16 v[208:211], v[52:55], v[64:67], v[208:211]
 ds_read_b64_tr_b16 v[38:39], v5 offset:21632
 ds_write_b32 v20, v16
 v_mfma_f32_16x16x32_bf16 v[224:227], v[56:59], v[64:67], v[224:227]
 ds_read_b64_tr_b16 v[40:41], v6 offset:43008
 v_mfma_f32_16x16x32_bf16 v[228:231], v[56:59], v[68:71], v[228:231]
 ds_read_b64_tr_b16 v[42:43], v6 offset:46592
 v_mfma_f32_16x16x32_bf16 v[232:235], v[56:59], v[72:75], v[232:235]
 v_and_b32 v21, 15, v1
 v_mfma_f32_16x16x32_bf16 v[236:239], v[56:59], v[76:79], v[236:239]
 v_lshl_add_u32 v3, v21, 5, s90
 v_mfma_f32_16x16x32_bf16 v[252:255], v[60:63], v[76:79], v[252:255]
 s_mov_b32 s85, 65536
 v_mfma_f32_16x16x32_bf16 v[248:251], v[60:63], v[72:75], v[248:251]
 v_lshl_add_u32 v5, v21, 2, s85
 v_mfma_f32_16x16x32_bf16 v[244:247], v[60:63], v[68:71], v[244:247]
 v_mfma_f32_16x16x32_bf16 v[240:243], v[60:63], v[64:67], v[240:243]
 s_waitcnt lgkmcnt(0)
 v_mfma_f32_16x16x32_bf16 v[96:99], v[24:27], v[80:83], v[96:99]
 ds_read_b64_tr_b16 v[44:45], v6 offset:50176
 v_mfma_f32_16x16x32_bf16 v[100:103], v[24:27], v[84:87], v[100:103]
 ds_read_b64_tr_b16 v[46:47], v6 offset:53760
 v_mfma_f32_16x16x32_bf16 v[104:107], v[24:27], v[88:91], v[104:107]
 ds_read_b64_tr_b16 v[48:49], v6 offset:43040
 v_mfma_f32_16x16x32_bf16 v[108:111], v[24:27], v[92:95], v[108:111]
 ds_read_b64_tr_b16 v[50:51], v6 offset:46624
 v_mfma_f32_16x16x32_bf16 v[124:127], v[28:31], v[92:95], v[124:127]
 ds_read_b64_tr_b16 v[52:53], v6 offset:50208
 v_mfma_f32_16x16x32_bf16 v[120:123], v[28:31], v[88:91], v[120:123]
 ds_read_b64_tr_b16 v[54:55], v6 offset:53792
 v_mfma_f32_16x16x32_bf16 v[116:119], v[28:31], v[84:87], v[116:119]
 ds_read_b64_tr_b16 v[56:57], v6 offset:43072
 ds_read_b64_tr_b16 v[64:65], v2 offset:0
 v_mfma_f32_16x16x32_bf16 v[112:115], v[28:31], v[80:83], v[112:115]
 ds_read_b64_tr_b16 v[58:59], v6 offset:46656
 ds_read_b64_tr_b16 v[66:67], v2 offset:1024
 v_mfma_f32_16x16x32_bf16 v[128:131], v[80:83], v[32:35], v[128:131]
 ds_read_b64_tr_b16 v[60:61], v6 offset:50240
 ds_read_b64_tr_b16 v[68:69], v2 offset:32
 v_mfma_f32_16x16x32_bf16 v[132:135], v[84:87], v[32:35], v[132:135]
 ds_read_b64_tr_b16 v[62:63], v6 offset:53824
 ds_read_b64_tr_b16 v[70:71], v2 offset:1056
 v_mfma_f32_16x16x32_bf16 v[136:139], v[88:91], v[32:35], v[136:139]
 ds_read_b64 v[72:73], v3 offset:0
 v_mfma_f32_16x16x32_bf16 v[140:143], v[92:95], v[32:35], v[140:143]
 ds_read_b64 v[74:75], v3 offset:512
 v_mfma_f32_16x16x32_bf16 v[156:159], v[92:95], v[36:39], v[156:159]
 ds_read_b64 v[76:77], v3 offset:1024
 v_mfma_f32_16x16x32_bf16 v[152:155], v[88:91], v[36:39], v[152:155]
 ds_read_b64 v[78:79], v3 offset:1536
 v_mfma_f32_16x16x32_bf16 v[148:151], v[84:87], v[36:39], v[148:151]
 v_mfma_f32_16x16x32_bf16 v[144:147], v[80:83], v[36:39], v[144:147]
 v_mfma_f32_16x16x32_bf16 v[160:163], v[40:43], v[80:83], v[160:163]
 v_mfma_f32_16x16x32_bf16 v[164:167], v[40:43], v[84:87], v[164:167]
 v_mfma_f32_16x16x32_bf16 v[168:171], v[40:43], v[88:91], v[168:171]
 v_mfma_f32_16x16x32_bf16 v[172:175], v[40:43], v[92:95], v[172:175]
 s_waitcnt vmcnt(0) lgkmcnt(0)
 s_barrier
 v_mfma_f32_16x16x32_bf16 v[188:191], v[44:47], v[92:95], v[188:191]
 ds_read_b128 v[24:27], v3 offset:16
 v_mfma_f32_16x16x32_bf16 v[184:187], v[44:47], v[88:91], v[184:187]
 ds_read_b128 v[28:31], v3 offset:528
 v_mfma_f32_16x16x32_bf16 v[180:183], v[44:47], v[84:87], v[180:183]
 ds_read_b128 v[32:35], v3 offset:1040
 v_mfma_f32_16x16x32_bf16 v[176:179], v[44:47], v[80:83], v[176:179]
 ds_read_b128 v[36:39], v3 offset:1552
 v_mfma_f32_16x16x32_bf16 v[192:195], v[48:51], v[80:83], v[192:195]
 ds_read2_b32 v[40:41], v5 offset0:144 offset1:144
 v_mfma_f32_16x16x32_bf16 v[196:199], v[48:51], v[84:87], v[196:199]
 ds_read2_b32 v[42:43], v5 offset0:128 offset1:128
 v_mfma_f32_16x16x32_bf16 v[200:203], v[48:51], v[88:91], v[200:203]
 ds_read2_b32 v[44:45], v5 offset0:176 offset1:176
 v_mfma_f32_16x16x32_bf16 v[204:207], v[48:51], v[92:95], v[204:207]
 ds_read2_b32 v[46:47], v5 offset0:160 offset1:160
 v_mfma_f32_16x16x32_bf16 v[220:223], v[52:55], v[92:95], v[220:223]
 s_add_u32 m0, s51, 0
 s_add_u32 s63, s32, 0
 v_mfma_f32_16x16x32_bf16 v[216:219], v[52:55], v[88:91], v[216:219]
 buffer_load_dwordx4 v10, s[24:27], s63 offen lds
 ds_read2_b32 v[48:49], v5 offset0:0 offset1:0
 v_mfma_f32_16x16x32_bf16 v[212:215], v[52:55], v[84:87], v[212:215]
 ds_read2_b32 v[50:51], v5 offset0:32 offset1:32
 s_add_u32 m0, s51, 8192
 s_add_u32 s63, s32, 98304
 v_mfma_f32_16x16x32_bf16 v[208:211], v[52:55], v[80:83], v[208:211]
 buffer_load_dwordx4 v10, s[24:27], s63 offen lds
 v_mfma_f32_16x16x32_bf16 v[224:227], v[56:59], v[80:83], v[224:227]
 s_add_u32 m0, s51, 16384
 s_add_u32 s63, s32, 163840
 v_mfma_f32_16x16x32_bf16 v[228:231], v[56:59], v[84:87], v[228:231]
 buffer_load_dwordx4 v10, s[24:27], s63 offen lds
 ds_read2_b32 v[52:53], v5 offset0:64 offset1:64
 v_mfma_f32_16x16x32_bf16 v[232:235], v[56:59], v[88:91], v[232:235]
 ds_read2_b32 v[54:55], v5 offset0:96 offset1:96
 s_add_u32 m0, s51, 24576
 s_add_u32 s63, s33, 98304
 v_mfma_f32_16x16x32_bf16 v[236:239], v[56:59], v[92:95], v[236:239]
 buffer_load_dwordx4 v10, s[24:27], s63 offen lds
 v_mfma_f32_16x16x32_bf16 v[252:255], v[60:63], v[92:95], v[252:255]
 s_add_u32 m0, s51, 32768
 s_add_u32 s63, s33, 163840
 v_mfma_f32_16x16x32_bf16 v[248:251], v[60:63], v[88:91], v[248:251]
 buffer_load_dwordx4 v10, s[24:27], s63 offen lds
 ds_read2_b32 v[56:57], v5 offset0:192 offset1:192
 v_mfma_f32_16x16x32_bf16 v[244:247], v[60:63], v[84:87], v[244:247]
 ds_read2_b32 v[58:59], v5 offset0:224 offset1:224
 s_add_u32 m0, s51, 40960
 s_add_u32 s63, s34, 98304
 v_mfma_f32_16x16x32_bf16 v[240:243], v[60:63], v[80:83], v[240:243]
 buffer_load_dwordx4 v10, s[24:27], s63 offen lds
 s_waitcnt lgkmcnt(4)
L5_p0:
 v_mov_b32 v12, v27
 v_mov_b32 v14, v31
 v_mov_b32 v16, v35
 v_mov_b32 v18, v39
 s_lshl_b32 s85, s7, 12
 v_add_u32 v20, s85, v0
 v_and_b32 v21, 15, v1
 v_lshl_add_u32 v21, v21, 4, s85
 v_bfe_u32 v22, v1, 4, 1
 v_lshl_add_u32 v21, v22, 10, v21
 v_lshrrev_b32 v22, 5, v1
 v_lshl_add_u32 v21, v22, 8, v21
 s_add_u32 s85, s85, 149504
 v_and_b32 v22, 48, v1
 v_add_u32 v22, s85, v22
 v_add_u32 v13, s50, v0
 s_xor_b32 s85, s98, 0
 s_lshl_b32 s86, s85, 11
 v_add_u32 v2, s86, v20
 v_add_u32 v4, 0x10000, v2
 s_xor_b32 s85, s98, 1
 s_lshl_b32 s86, s85, 11
 v_add_u32 v3, s86, v20
 v_add_u32 v5, 0x10000, v3
 v_mfma_f32_16x16x16_bf16 v[160:163], v[40:41], v[72:73], v[160:163]
 v_mfma_f32_16x16x16_bf16 v[192:195], v[42:43], v[72:73], v[192:195]
 v_mfma_f32_16x16x16_bf16 v[176:179], v[44:45], v[72:73], v[176:179]
 v_mfma_f32_16x16x16_bf16 v[208:211], v[46:47], v[72:73], v[208:211]
 v_lshrrev_b32 v19, 2, v1
 v_and_b32 v15, 3, v1
 v_lshlrev_b32 v15, 3, v15
 v_lshl_add_u32 v15, v19, 8, v15
 v_add_u32 v15, 98304, v15
 v_and_b32 v19, 7, v19
 v_xor_b32 v6, s67, v19
 v_lshl_add_u32 v6, v6, 5, v15
 v_xor_b32 v7, s68, v19
 v_lshl_add_u32 v7, v7, 5, v15
 v_xor_b32 v8, s69, v19
 v_lshl_add_u32 v8, v8, 5, v15
 v_xor_b32 v9, s70, v19
 v_lshl_add_u32 v9, v9, 5, v15
 s_waitcnt lgkmcnt(0)
 s_mul_i32 s85, s5, 49152
 s_add_u32 s85, s85, s48
 v_pk_mul_f32 v[80:81], v[160:161], v[160:161]
 v_pk_mul_f32 v[82:83], v[162:163], v[162:163]
 v_pk_mul_f32 v[84:85], v[192:193], v[192:193]
 v_pk_mul_f32 v[86:87], v[194:195], v[194:195]
 v_pk_fma_f32 v[80:81], v[80:81], v[26:27], v[24:25] op_sel_hi:[1,0,0]
 v_pk_fma_f32 v[82:83], v[82:83], v[26:27], v[24:25] op_sel_hi:[1,0,0]
 v_pk_fma_f32 v[84:85], v[84:85], v[26:27], v[24:25] op_sel_hi:[1,0,0]
 v_pk_fma_f32 v[86:87], v[86:87], v[26:27], v[24:25] op_sel_hi:[1,0,0]
 v_pk_mul_f32 v[80:81], v[80:81], v[160:161]
 v_pk_mul_f32 v[82:83], v[82:83], v[162:163]
 v_pk_mul_f32 v[84:85], v[84:85], v[192:193]
 v_pk_mul_f32 v[86:87], v[86:87], v[194:195]
 v_pk_mul_f32 v[160:161], v[160:161], v[176:177]
 v_pk_mul_f32 v[162:163], v[162:163], v[178:179]
 v_pk_mul_f32 v[192:193], v[192:193], v[208:209]
 v_pk_mul_f32 v[194:195], v[194:195], v[210:211]
 v_mfma_f32_16x16x16_bf16 v[164:167], v[40:41], v[74:75], v[164:167]
 v_exp_f32 v80, v80
 v_exp_f32 v81, v81
 v_mfma_f32_16x16x16_bf16 v[196:199], v[42:43], v[74:75], v[196:199]
 v_exp_f32 v82, v82
 v_exp_f32 v83, v83
 v_mfma_f32_16x16x16_bf16 v[180:183], v[44:45], v[74:75], v[180:183]
 v_exp_f32 v84, v84
 v_exp_f32 v85, v85
 v_mfma_f32_16x16x16_bf16 v[212:215], v[46:47], v[74:75], v[212:215]
 v_exp_f32 v86, v86
 v_exp_f32 v87, v87
 v_pk_fma_f32 v[80:81], v[80:81], v[12:13], v[12:13] op_sel_hi:[1,0,0]
 v_pk_fma_f32 v[82:83], v[82:83], v[12:13], v[12:13] op_sel_hi:[1,0,0]
 v_pk_fma_f32 v[84:85], v[84:85], v[12:13], v[12:13] op_sel_hi:[1,0,0]
 v_pk_fma_f32 v[86:87], v[86:87], v[12:13], v[12:13] op_sel_hi:[1,0,0]
 v_mfma_f32_16x16x16_bf16 v[96:99], v[48:49], v[72:73], v[96:99]
 v_rcp_f32 v80, v80
 v_rcp_f32 v81, v81
 v_mfma_f32_16x16x16_bf16 v[112:115], v[50:51], v[72:73], v[112:115]
 v_rcp_f32 v82, v82
 v_rcp_f32 v83, v83
 v_mfma_f32_16x16x16_bf16 v[128:131], v[72:73], v[52:53], v[128:131]
 v_rcp_f32 v84, v84
 v_rcp_f32 v85, v85
 v_mfma_f32_16x16x16_bf16 v[144:147], v[72:73], v[54:55], v[144:147]
 v_rcp_f32 v86, v86
 v_rcp_f32 v87, v87
 v_pk_mul_f32 v[160:161], v[160:161], v[80:81]
 v_pk_mul_f32 v[162:163], v[162:163], v[82:83]
 v_pk_mul_f32 v[192:193], v[192:193], v[84:85]
 v_pk_mul_f32 v[194:195], v[194:195], v[86:87]
 v_cvt_pk_bf16_f32 v176, v160, v161
 v_cvt_pk_bf16_f32 v177, v162, v163
 v_cvt_pk_bf16_f32 v178, v192, v193
 v_cvt_pk_bf16_f32 v179, v194, v195
 buffer_store_dwordx4 v[176:179], v20, s[8:11], s85 offen offset:0 sc1
 ds_write_b128 v20, v[176:179] offset:0
 v_pk_mul_f32 v[88:89], v[164:165], v[164:165]
 v_pk_mul_f32 v[90:91], v[166:167], v[166:167]
 v_pk_mul_f32 v[92:93], v[196:197], v[196:197]
 v_pk_mul_f32 v[94:95], v[198:199], v[198:199]
 v_pk_fma_f32 v[88:89], v[88:89], v[30:31], v[28:29] op_sel_hi:[1,0,0]
 v_pk_fma_f32 v[90:91], v[90:91], v[30:31], v[28:29] op_sel_hi:[1,0,0]
 v_pk_fma_f32 v[92:93], v[92:93], v[30:31], v[28:29] op_sel_hi:[1,0,0]
 v_pk_fma_f32 v[94:95], v[94:95], v[30:31], v[28:29] op_sel_hi:[1,0,0]
 v_pk_mul_f32 v[88:89], v[88:89], v[164:165]
 v_pk_mul_f32 v[90:91], v[90:91], v[166:167]
 v_pk_mul_f32 v[92:93], v[92:93], v[196:197]
 v_pk_mul_f32 v[94:95], v[94:95], v[198:199]
 v_pk_mul_f32 v[164:165], v[164:165], v[180:181]
 v_pk_mul_f32 v[166:167], v[166:167], v[182:183]
 v_pk_mul_f32 v[196:197], v[196:197], v[212:213]
 v_pk_mul_f32 v[198:199], v[198:199], v[214:215]
 v_mfma_f32_16x16x16_bf16 v[168:171], v[40:41], v[76:77], v[168:171]
 v_exp_f32 v88, v88
 v_exp_f32 v89, v89
 v_mfma_f32_16x16x16_bf16 v[200:203], v[42:43], v[76:77], v[200:203]
 v_exp_f32 v90, v90
 v_exp_f32 v91, v91
 v_mfma_f32_16x16x16_bf16 v[184:187], v[44:45], v[76:77], v[184:187]
 v_exp_f32 v92, v92
 v_exp_f32 v93, v93
 v_mfma_f32_16x16x16_bf16 v[216:219], v[46:47], v[76:77], v[216:219]
 v_exp_f32 v94, v94
 v_exp_f32 v95, v95
 v_pk_fma_f32 v[88:89], v[88:89], v[14:15], v[14:15] op_sel_hi:[1,0,0]
 v_pk_fma_f32 v[90:91], v[90:91], v[14:15], v[14:15] op_sel_hi:[1,0,0]
 v_pk_fma_f32 v[92:93], v[92:93], v[14:15], v[14:15] op_sel_hi:[1,0,0]
 v_pk_fma_f32 v[94:95], v[94:95], v[14:15], v[14:15] op_sel_hi:[1,0,0]
 v_mfma_f32_16x16x16_bf16 v[100:103], v[48:49], v[74:75], v[100:103]
 v_rcp_f32 v88, v88
 v_rcp_f32 v89, v89
 v_mfma_f32_16x16x16_bf16 v[116:119], v[50:51], v[74:75], v[116:119]
 v_rcp_f32 v90, v90
 v_rcp_f32 v91, v91
 v_mfma_f32_16x16x16_bf16 v[132:135], v[74:75], v[52:53], v[132:135]
 v_rcp_f32 v92, v92
 v_rcp_f32 v93, v93
 v_mfma_f32_16x16x16_bf16 v[148:151], v[74:75], v[54:55], v[148:151]
 v_rcp_f32 v94, v94
 v_rcp_f32 v95, v95
 v_pk_mul_f32 v[164:165], v[164:165], v[88:89]
 v_pk_mul_f32 v[166:167], v[166:167], v[90:91]
 v_pk_mul_f32 v[196:197], v[196:197], v[92:93]
 v_pk_mul_f32 v[198:199], v[198:199], v[94:95]
 v_cvt_pk_bf16_f32 v180, v164, v165
 v_cvt_pk_bf16_f32 v181, v166, v167
 v_cvt_pk_bf16_f32 v182, v196, v197
 v_cvt_pk_bf16_f32 v183, v198, v199
 buffer_store_dwordx4 v[180:183], v20, s[8:11], s85 offen offset:1024 sc1
 ds_write_b128 v20, v[180:183] offset:1024
 v_pk_mul_f32 v[80:81], v[168:169], v[168:169]
 v_pk_mul_f32 v[82:83], v[170:171], v[170:171]
 v_pk_mul_f32 v[84:85], v[200:201], v[200:201]
 v_pk_mul_f32 v[86:87], v[202:203], v[202:203]
 v_pk_fma_f32 v[80:81], v[80:81], v[34:35], v[32:33] op_sel_hi:[1,0,0]
 v_pk_fma_f32 v[82:83], v[82:83], v[34:35], v[32:33] op_sel_hi:[1,0,0]
 v_pk_fma_f32 v[84:85], v[84:85], v[34:35], v[32:33] op_sel_hi:[1,0,0]
 v_pk_fma_f32 v[86:87], v[86:87], v[34:35], v[32:33] op_sel_hi:[1,0,0]
 v_pk_mul_f32 v[80:81], v[80:81], v[168:169]
 v_pk_mul_f32 v[82:83], v[82:83], v[170:171]
 v_pk_mul_f32 v[84:85], v[84:85], v[200:201]
 v_pk_mul_f32 v[86:87], v[86:87], v[202:203]
 v_pk_mul_f32 v[168:169], v[168:169], v[184:185]
 v_pk_mul_f32 v[170:171], v[170:171], v[186:187]
 v_pk_mul_f32 v[200:201], v[200:201], v[216:217]
 v_pk_mul_f32 v[202:203], v[202:203], v[218:219]
 v_mfma_f32_16x16x16_bf16 v[172:175], v[40:41], v[78:79], v[172:175]
 v_exp_f32 v80, v80
 v_exp_f32 v81, v81
 v_mfma_f32_16x16x16_bf16 v[204:207], v[42:43], v[78:79], v[204:207]
 v_exp_f32 v82, v82
 v_exp_f32 v83, v83
 v_mfma_f32_16x16x16_bf16 v[188:191], v[44:45], v[78:79], v[188:191]
 v_exp_f32 v84, v84
 v_exp_f32 v85, v85
 v_mfma_f32_16x16x16_bf16 v[220:223], v[46:47], v[78:79], v[220:223]
 v_exp_f32 v86, v86
 v_exp_f32 v87, v87
 v_pk_fma_f32 v[80:81], v[80:81], v[16:17], v[16:17] op_sel_hi:[1,0,0]
 v_pk_fma_f32 v[82:83], v[82:83], v[16:17], v[16:17] op_sel_hi:[1,0,0]
 v_pk_fma_f32 v[84:85], v[84:85], v[16:17], v[16:17] op_sel_hi:[1,0,0]
 v_pk_fma_f32 v[86:87], v[86:87], v[16:17], v[16:17] op_sel_hi:[1,0,0]
 v_mfma_f32_16x16x16_bf16 v[104:107], v[48:49], v[76:77], v[104:107]
 v_rcp_f32 v80, v80
 v_rcp_f32 v81, v81
 v_mfma_f32_16x16x16_bf16 v[120:123], v[50:51], v[76:77], v[120:123]
 v_rcp_f32 v82, v82
 v_rcp_f32 v83, v83
 v_mfma_f32_16x16x16_bf16 v[136:139], v[76:77], v[52:53], v[136:139]
 v_rcp_f32 v84, v84
 v_rcp_f32 v85, v85
 v_mfma_f32_16x16x16_bf16 v[152:155], v[76:77], v[54:55], v[152:155]
 v_rcp_f32 v86, v86
 v_rcp_f32 v87, v87
 v_pk_mul_f32 v[168:169], v[168:169], v[80:81]
 v_pk_mul_f32 v[170:171], v[170:171], v[82:83]
 v_pk_mul_f32 v[200:201], v[200:201], v[84:85]
 v_pk_mul_f32 v[202:203], v[202:203], v[86:87]
 v_cvt_pk_bf16_f32 v184, v168, v169
 v_cvt_pk_bf16_f32 v185, v170, v171
 v_cvt_pk_bf16_f32 v186, v200, v201
 v_cvt_pk_bf16_f32 v187, v202, v203
 buffer_store_dwordx4 v[184:187], v20, s[8:11], s85 offen offset:2048 sc1
 ds_write_b128 v20, v[184:187] offset:2048
 v_pk_mul_f32 v[88:89], v[172:173], v[172:173]
 v_pk_mul_f32 v[90:91], v[174:175], v[174:175]
 v_pk_mul_f32 v[92:93], v[204:205], v[204:205]
 v_pk_mul_f32 v[94:95], v[206:207], v[206:207]
 v_pk_fma_f32 v[88:89], v[88:89], v[38:39], v[36:37] op_sel_hi:[1,0,0]
 v_pk_fma_f32 v[90:91], v[90:91], v[38:39], v[36:37] op_sel_hi:[1,0,0]
 v_pk_fma_f32 v[92:93], v[92:93], v[38:39], v[36:37] op_sel_hi:[1,0,0]
 v_pk_fma_f32 v[94:95], v[94:95], v[38:39], v[36:37] op_sel_hi:[1,0,0]
 v_pk_mul_f32 v[88:89], v[88:89], v[172:173]
 v_pk_mul_f32 v[90:91], v[90:91], v[174:175]
 v_pk_mul_f32 v[92:93], v[92:93], v[204:205]
 v_pk_mul_f32 v[94:95], v[94:95], v[206:207]
 v_pk_mul_f32 v[172:173], v[172:173], v[188:189]
 v_pk_mul_f32 v[174:175], v[174:175], v[190:191]
 v_pk_mul_f32 v[204:205], v[204:205], v[220:221]
 v_pk_mul_f32 v[206:207], v[206:207], v[222:223]
 v_mfma_f32_16x16x16_bf16 v[224:227], v[56:57], v[72:73], v[224:227]
 v_exp_f32 v88, v88
 v_exp_f32 v89, v89
 v_mfma_f32_16x16x16_bf16 v[228:231], v[56:57], v[74:75], v[228:231]
 v_exp_f32 v90, v90
 v_exp_f32 v91, v91
 v_mfma_f32_16x16x16_bf16 v[240:243], v[58:59], v[72:73], v[240:243]
 v_exp_f32 v92, v92
 v_exp_f32 v93, v93
 v_mfma_f32_16x16x16_bf16 v[244:247], v[58:59], v[74:75], v[244:247]
 v_exp_f32 v94, v94
 v_exp_f32 v95, v95
 v_pk_fma_f32 v[88:89], v[88:89], v[18:19], v[18:19] op_sel_hi:[1,0,0]
 v_pk_fma_f32 v[90:91], v[90:91], v[18:19], v[18:19] op_sel_hi:[1,0,0]
 v_pk_fma_f32 v[92:93], v[92:93], v[18:19], v[18:19] op_sel_hi:[1,0,0]
 v_pk_fma_f32 v[94:95], v[94:95], v[18:19], v[18:19] op_sel_hi:[1,0,0]
 v_mfma_f32_16x16x16_bf16 v[108:111], v[48:49], v[78:79], v[108:111]
 v_rcp_f32 v88, v88
 v_rcp_f32 v89, v89
 v_mfma_f32_16x16x16_bf16 v[124:127], v[50:51], v[78:79], v[124:127]
 v_rcp_f32 v90, v90
 v_rcp_f32 v91, v91
 v_mfma_f32_16x16x16_bf16 v[140:143], v[78:79], v[52:53], v[140:143]
 v_rcp_f32 v92, v92
 v_rcp_f32 v93, v93
 v_mfma_f32_16x16x16_bf16 v[156:159], v[78:79], v[54:55], v[156:159]
 v_rcp_f32 v94, v94
 v_rcp_f32 v95, v95
 v_pk_mul_f32 v[172:173], v[172:173], v[88:89]
 v_pk_mul_f32 v[174:175], v[174:175], v[90:91]
 v_pk_mul_f32 v[204:205], v[204:205], v[92:93]
 v_pk_mul_f32 v[206:207], v[206:207], v[94:95]
 v_cvt_pk_bf16_f32 v188, v172, v173
 v_cvt_pk_bf16_f32 v189, v174, v175
 v_cvt_pk_bf16_f32 v190, v204, v205
 v_cvt_pk_bf16_f32 v191, v206, v207
 buffer_store_dwordx4 v[188:191], v20, s[8:11], s85 offen offset:3072 sc1
 ds_write_b128 v20, v[188:191] offset:3072
 ds_read_b128 v[208:211], v22 offset:0
 ds_read_b128 v[212:215], v22 offset:64
 ds_read_b128 v[216:219], v22 offset:128
 ds_read_b128 v[220:223], v22 offset:192
 s_lshr_b32 s85, s5, 1
 s_lshl_b32 s85, s85, 14
 s_add_u32 s85, s85, s48
 s_add_u32 s85, s85, 393216
 s_and_b32 s86, s5, 1
 s_lshl_b32 s86, s86, 9
 s_add_u32 s85, s85, s86
 v_pk_mul_f32 v[80:81], v[224:225], v[224:225]
 v_pk_mul_f32 v[82:83], v[226:227], v[226:227]
 v_pk_mul_f32 v[84:85], v[228:229], v[228:229]
 v_pk_mul_f32 v[86:87], v[230:231], v[230:231]
 v_pk_fma_f32 v[80:81], v[80:81], v[26:27], v[24:25] op_sel_hi:[1,0,0]
 v_pk_fma_f32 v[82:83], v[82:83], v[26:27], v[24:25] op_sel_hi:[1,0,0]
 v_pk_fma_f32 v[84:85], v[84:85], v[30:31], v[28:29] op_sel_hi:[1,0,0]
 v_pk_fma_f32 v[86:87], v[86:87], v[30:31], v[28:29] op_sel_hi:[1,0,0]
 v_pk_mul_f32 v[80:81], v[80:81], v[224:225]
 v_pk_mul_f32 v[82:83], v[82:83], v[226:227]
 v_pk_mul_f32 v[84:85], v[84:85], v[228:229]
 v_pk_mul_f32 v[86:87], v[86:87], v[230:231]
 v_pk_mul_f32 v[224:225], v[224:225], v[240:241]
 v_pk_mul_f32 v[226:227], v[226:227], v[242:243]
 v_pk_mul_f32 v[228:229], v[228:229], v[244:245]
 v_pk_mul_f32 v[230:231], v[230:231], v[246:247]
 v_mfma_f32_16x16x16_bf16 v[232:235], v[56:57], v[76:77], v[232:235]
 v_exp_f32 v80, v80
 v_exp_f32 v81, v81
 v_exp_f32 v82, v82
 v_mfma_f32_16x16x16_bf16 v[236:239], v[56:57], v[78:79], v[236:239]
 v_exp_f32 v83, v83
 v_exp_f32 v84, v84
 v_exp_f32 v85, v85
 v_exp_f32 v86, v86
 v_exp_f32 v87, v87
 v_pk_fma_f32 v[80:81], v[80:81], v[12:13], v[12:13] op_sel_hi:[1,0,0]
 v_pk_fma_f32 v[82:83], v[82:83], v[12:13], v[12:13] op_sel_hi:[1,0,0]
 v_pk_fma_f32 v[84:85], v[84:85], v[14:15], v[14:15] op_sel_hi:[1,0,0]
 v_pk_fma_f32 v[86:87], v[86:87], v[14:15], v[14:15] op_sel_hi:[1,0,0]
 v_mfma_f32_16x16x16_bf16 v[248:251], v[58:59], v[76:77], v[248:251]
 v_rcp_f32 v80, v80
 v_rcp_f32 v81, v81
 v_rcp_f32 v82, v82
 v_mfma_f32_16x16x16_bf16 v[252:255], v[58:59], v[78:79], v[252:255]
 v_rcp_f32 v83, v83
 v_rcp_f32 v84, v84
 v_rcp_f32 v85, v85
 v_rcp_f32 v86, v86
 v_rcp_f32 v87, v87
 v_pk_mul_f32 v[224:225], v[224:225], v[80:81]
 v_pk_mul_f32 v[226:227], v[226:227], v[82:83]
 v_pk_mul_f32 v[228:229], v[228:229], v[84:85]
 v_pk_mul_f32 v[230:231], v[230:231], v[86:87]
 v_cvt_pk_bf16_f32 v240, v224, v225
 v_cvt_pk_bf16_f32 v241, v226, v227
 v_cvt_pk_bf16_f32 v242, v228, v229
 v_cvt_pk_bf16_f32 v243, v230, v231
 s_nop 0
 v_permlane16_swap_b32 v240, v242
 v_permlane16_swap_b32 v241, v243
 buffer_store_dwordx4 v[240:243], v21, s[8:11], s85 offen offset:0 sc1
 v_pk_mul_f32 v[88:89], v[232:233], v[232:233]
 v_pk_mul_f32 v[90:91], v[234:235], v[234:235]
 v_pk_mul_f32 v[92:93], v[236:237], v[236:237]
 v_pk_mul_f32 v[94:95], v[238:239], v[238:239]
 v_pk_fma_f32 v[88:89], v[88:89], v[34:35], v[32:33] op_sel_hi:[1,0,0]
 v_pk_fma_f32 v[90:91], v[90:91], v[34:35], v[32:33] op_sel_hi:[1,0,0]
 v_pk_fma_f32 v[92:93], v[92:93], v[38:39], v[36:37] op_sel_hi:[1,0,0]
 v_pk_fma_f32 v[94:95], v[94:95], v[38:39], v[36:37] op_sel_hi:[1,0,0]
 v_pk_mul_f32 v[88:89], v[88:89], v[232:233]
 v_pk_mul_f32 v[90:91], v[90:91], v[234:235]
 v_pk_mul_f32 v[92:93], v[92:93], v[236:237]
 v_pk_mul_f32 v[94:95], v[94:95], v[238:239]
 v_pk_mul_f32 v[232:233], v[232:233], v[248:249]
 v_pk_mul_f32 v[234:235], v[234:235], v[250:251]
 v_pk_mul_f32 v[236:237], v[236:237], v[252:253]
 v_pk_mul_f32 v[238:239], v[238:239], v[254:255]
 v_exp_f32 v88, v88
 v_exp_f32 v89, v89
 v_exp_f32 v90, v90
 v_exp_f32 v91, v91
 v_exp_f32 v92, v92
 v_exp_f32 v93, v93
 v_exp_f32 v94, v94
 v_exp_f32 v95, v95
 v_pk_fma_f32 v[88:89], v[88:89], v[16:17], v[16:17] op_sel_hi:[1,0,0]
 v_pk_fma_f32 v[90:91], v[90:91], v[16:17], v[16:17] op_sel_hi:[1,0,0]
 v_pk_fma_f32 v[92:93], v[92:93], v[18:19], v[18:19] op_sel_hi:[1,0,0]
 v_pk_fma_f32 v[94:95], v[94:95], v[18:19], v[18:19] op_sel_hi:[1,0,0]
 v_rcp_f32 v88, v88
 v_rcp_f32 v89, v89
 v_rcp_f32 v90, v90
 v_rcp_f32 v91, v91
 v_rcp_f32 v92, v92
 v_rcp_f32 v93, v93
 v_rcp_f32 v94, v94
 v_rcp_f32 v95, v95
 v_pk_mul_f32 v[232:233], v[232:233], v[88:89]
 v_pk_mul_f32 v[234:235], v[234:235], v[90:91]
 v_pk_mul_f32 v[236:237], v[236:237], v[92:93]
 v_pk_mul_f32 v[238:239], v[238:239], v[94:95]
 v_cvt_pk_bf16_f32 v248, v232, v233
 v_cvt_pk_bf16_f32 v249, v234, v235
 v_cvt_pk_bf16_f32 v250, v236, v237
 v_cvt_pk_bf16_f32 v251, v238, v239
 s_nop 0
 v_permlane16_swap_b32 v248, v250
 v_permlane16_swap_b32 v249, v251
 buffer_store_dwordx4 v[248:251], v21, s[8:11], s85 offen offset:2048 sc1
 v_cvt_pk_bf16_f32 v40, v96, v97
 v_cvt_pk_bf16_f32 v41, v98, v99
 v_cvt_pk_bf16_f32 v42, v112, v113
 v_cvt_pk_bf16_f32 v43, v114, v115
 v_cvt_pk_bf16_f32 v44, v100, v101
 v_cvt_pk_bf16_f32 v45, v102, v103
 v_cvt_pk_bf16_f32 v46, v116, v117
 v_cvt_pk_bf16_f32 v47, v118, v119
 v_mfma_f32_16x16x32_bf16 v[160:163], v[64:67], v[40:43], 0
 v_mfma_f32_16x16x32_bf16 v[164:167], v[68:71], v[40:43], 0
 v_cvt_pk_bf16_f32 v48, v104, v105
 v_cvt_pk_bf16_f32 v49, v106, v107
 v_cvt_pk_bf16_f32 v50, v120, v121
 v_cvt_pk_bf16_f32 v51, v122, v123
 v_mfma_f32_16x16x32_bf16 v[168:171], v[64:67], v[44:47], 0
 v_mfma_f32_16x16x32_bf16 v[172:175], v[68:71], v[44:47], 0
 v_cvt_pk_bf16_f32 v52, v108, v109
 v_cvt_pk_bf16_f32 v53, v110, v111
 v_cvt_pk_bf16_f32 v54, v124, v125
 v_cvt_pk_bf16_f32 v55, v126, v127
 v_mfma_f32_16x16x32_bf16 v[176:179], v[64:67], v[48:51], 0
 v_mfma_f32_16x16x32_bf16 v[180:183], v[68:71], v[48:51], 0
 v_mul_f32 v12, 0x3fb8aa3b, v25
 v_mul_f32 v14, 0x3fb8aa3b, v29
 v_mul_f32 v16, 0x3fb8aa3b, v33
 v_mul_f32 v18, 0x3fb8aa3b, v37
 v_mfma_f32_16x16x32_bf16 v[184:187], v[64:67], v[52:55], 0
 v_mfma_f32_16x16x32_bf16 v[188:191], v[68:71], v[52:55], 0
 s_waitcnt lgkmcnt(0)
 v_add_u32 v22, 147456, v20
 v_pk_mul_f32 v[128:129], v[128:129], v[208:209]
 v_pk_mul_f32 v[130:131], v[130:131], v[210:211]
 v_pk_mul_f32 v[132:133], v[132:133], v[212:213]
 v_pk_mul_f32 v[134:135], v[134:135], v[214:215]
 v_pk_mul_f32 v[136:137], v[136:137], v[216:217]
 v_pk_mul_f32 v[138:139], v[138:139], v[218:219]
 v_pk_mul_f32 v[140:141], v[140:141], v[220:221]
 v_pk_mul_f32 v[142:143], v[142:143], v[222:223]
 v_cvt_pk_bf16_f32 v192, v128, v129
 v_cvt_pk_bf16_f32 v193, v130, v131
 v_cvt_pk_bf16_f32 v194, v132, v133
 v_cvt_pk_bf16_f32 v195, v134, v135
 ds_write_b128 v22, v[192:195] offset:0
 v_cvt_pk_bf16_f32 v196, v136, v137
 v_cvt_pk_bf16_f32 v197, v138, v139
 v_cvt_pk_bf16_f32 v198, v140, v141
 v_cvt_pk_bf16_f32 v199, v142, v143
 ds_write_b128 v22, v[196:199] offset:1024
 v_pk_mul_f32 v[144:145], v[144:145], v[208:209]
 v_pk_mul_f32 v[146:147], v[146:147], v[210:211]
 v_pk_mul_f32 v[148:149], v[148:149], v[212:213]
 v_pk_mul_f32 v[150:151], v[150:151], v[214:215]
 v_pk_mul_f32 v[152:153], v[152:153], v[216:217]
 v_pk_mul_f32 v[154:155], v[154:155], v[218:219]
 v_pk_mul_f32 v[156:157], v[156:157], v[220:221]
 v_pk_mul_f32 v[158:159], v[158:159], v[222:223]
 v_cvt_pk_bf16_f32 v200, v144, v145
 v_cvt_pk_bf16_f32 v201, v146, v147
 v_cvt_pk_bf16_f32 v202, v148, v149
 v_cvt_pk_bf16_f32 v203, v150, v151
 ds_write_b128 v22, v[200:203] offset:2048
 v_cvt_pk_bf16_f32 v204, v152, v153
 v_cvt_pk_bf16_f32 v205, v154, v155
 v_cvt_pk_bf16_f32 v206, v156, v157
 v_cvt_pk_bf16_f32 v207, v158, v159
 ds_write_b128 v22, v[204:207] offset:3072
 s_waitcnt vmcnt(11) lgkmcnt(0)
 s_barrier
 ds_read_b128 v[40:43], v2 offset:0
 ds_read_b64_tr_b16 v[24:25], v6 offset:0
 ds_read_b64_tr_b16 v[26:27], v6 offset:4096
 ds_read_b64_tr_b16 v[28:29], v7 offset:0
 ds_read_b64_tr_b16 v[30:31], v7 offset:4096
 ds_read_b128 v[44:47], v2 offset:1024
 ds_read_b64_tr_b16 v[32:33], v8 offset:0
 ds_read_b64_tr_b16 v[34:35], v8 offset:4096
 ds_read_b128 v[48:51], v3 offset:0
 ds_read_b64_tr_b16 v[36:37], v9 offset:0
 ds_read_b64_tr_b16 v[38:39], v9 offset:4096
 ds_read_b128 v[52:55], v3 offset:1024
 v_lshrrev_b32 v252, 2, v1
 v_lshrrev_b32 v92, 4, v1
 v_xor_b32 v252, v252, v92
 v_and_b32 v252, 3, v252
 s_lshl_b32 s85, s7, 13
 v_lshl_add_u32 v252, v252, 3, s85
 v_and_b32 v92, 15, v1
 v_lshl_add_u32 v252, v92, 5, v252
 v_max3_f32 v240, v160, v161, v162
 v_max3_f32 v241, -v160, -v161, -v162
 v_max3_f32 v242, v168, v169, v170
 v_max3_f32 v243, -v168, -v169, -v170
 v_max3_f32 v244, v176, v177, v178
 v_max3_f32 v245, -v176, -v177, -v178
 v_max3_f32 v246, v184, v185, v186
 v_max3_f32 v247, -v184, -v185, -v186
 v_max3_f32 v240, v240, v163, v164
 v_max3_f32 v241, v241, -v163, -v164
 v_max3_f32 v242, v242, v171, v172
 v_max3_f32 v243, v243, -v171, -v172
 v_max3_f32 v244, v244, v179, v180
 v_max3_f32 v245, v245, -v179, -v180
 v_max3_f32 v246, v246, v187, v188
 v_max3_f32 v247, v247, -v187, -v188
 v_max3_f32 v240, v240, v165, v166
 v_max3_f32 v241, v241, -v165, -v166
 v_max3_f32 v242, v242, v173, v174
 v_max3_f32 v243, v243, -v173, -v174
 v_max3_f32 v244, v244, v181, v182
 v_max3_f32 v245, v245, -v181, -v182
 v_max3_f32 v246, v246, v189, v190
 v_max3_f32 v247, v247, -v189, -v190
 v_max_f32 v240, v240, v167
 v_max_f32_e64 v241, v241, -v167
 s_waitcnt vmcnt(10) lgkmcnt(0)
 s_barrier
 v_mfma_f32_16x16x32_bf16 v[96:99], v[24:27], v[40:43], 0
 ds_read_b128 v[72:75], v2 offset:16384
 v_max_f32 v242, v242, v175
 v_max_f32_e64 v243, v243, -v175
 v_max_f32 v244, v244, v183
 v_max_f32_e64 v245, v245, -v183
 v_max_f32 v246, v246, v191
 v_max_f32_e64 v247, v247, -v191
 v_mfma_f32_16x16x32_bf16 v[100:103], v[28:31], v[40:43], 0
 ds_read_b64_tr_b16 v[56:57], v6 offset:8192
 v_permlane32_swap_b32 v240, v244
 v_permlane32_swap_b32 v241, v245
 v_permlane32_swap_b32 v242, v246
 v_permlane32_swap_b32 v243, v247
 v_max_f32 v240, v240, v244
 v_mfma_f32_16x16x32_bf16 v[104:107], v[32:35], v[40:43], 0
 ds_read_b64_tr_b16 v[58:59], v6 offset:12288
 v_max_f32 v241, v241, v245
 v_max_f32 v242, v242, v246
 v_max_f32 v243, v243, v247
 s_nop 0
 v_permlane16_swap_b32 v240, v242
 v_permlane16_swap_b32 v241, v243
 v_mfma_f32_16x16x32_bf16 v[108:111], v[36:39], v[40:43], 0
 ds_read_b64_tr_b16 v[60:61], v7 offset:8192
 v_max_f32 v240, v240, v242
 v_max_f32 v241, v241, v243
 v_mov_b32 v242, v240
 v_mov_b32 v243, v241
 s_nop 0
 v_permlane16_swap_b32 v240, v242
 v_mfma_f32_16x16x32_bf16 v[124:127], v[36:39], v[44:47], 0
 ds_read_b64_tr_b16 v[62:63], v7 offset:12288
 v_permlane16_swap_b32 v241, v243
 v_mov_b32 v244, v240
 v_mov_b32 v245, v241
 v_mov_b32 v246, v242
 v_mov_b32 v247, v243
 v_permlane32_swap_b32 v240, v244
 v_mfma_f32_16x16x32_bf16 v[120:123], v[32:35], v[44:47], 0
 ds_read_b128 v[76:79], v2 offset:17408
 v_permlane32_swap_b32 v241, v245
 v_permlane32_swap_b32 v242, v246
 v_permlane32_swap_b32 v243, v247
 v_mul_f32_e64 v240, v240, -v12
 v_mul_f32_e64 v241, v241, -v12
 v_mfma_f32_16x16x32_bf16 v[116:119], v[28:31], v[44:47], 0
 ds_read_b64_tr_b16 v[64:65], v8 offset:8192
 v_mul_f32_e64 v242, v242, -v14
 v_mul_f32_e64 v243, v243, -v14
 v_mul_f32_e64 v244, v244, -v16
 v_mul_f32_e64 v245, v245, -v16
 v_mul_f32_e64 v246, v246, -v18
 v_mfma_f32_16x16x32_bf16 v[112:115], v[24:27], v[44:47], 0
 ds_read_b64_tr_b16 v[66:67], v8 offset:12288
 v_mul_f32_e64 v247, v247, -v18
 s_lshl2_add_u32 s92, s83, s4
 s_lshl2_add_u32 s92, s92, s7
 s_lshl_b32 s92, s92, 7
 s_add_u32 s92, s92, 39944192
 v_mfma_f32_16x16x32_bf16 v[128:131], v[24:27], v[48:51], 0
 ds_read_b128 v[80:83], v3 offset:16384
 s_add_u32 s92, s92, s5
 v_mov_b32 v91, 1
 s_waitcnt vmcnt(0)
 buffer_store_byte v91, off, s[8:11], s92 sc1
 v_fma_f32 v208, v160, v12, v240
 v_fma_f32 v160, v160, -v12, v241
 s_add_u32 m0, s51, 0
 s_add_u32 s63, s34, 163840
 v_mfma_f32_16x16x32_bf16 v[132:135], v[28:31], v[48:51], 0
 ds_read_b64_tr_b16 v[68:69], v9 offset:8192
 buffer_load_dwordx4 v10, s[24:27], s63 offen lds
 v_fma_f32 v209, v161, v12, v240
 v_fma_f32 v161, v161, -v12, v241
 v_fma_f32 v210, v162, v12, v240
 v_fma_f32 v162, v162, -v12, v241
 v_fma_f32 v211, v163, v12, v240
 v_mfma_f32_16x16x32_bf16 v[136:139], v[32:35], v[48:51], 0
 ds_read_b64_tr_b16 v[70:71], v9 offset:12288
 v_fma_f32 v163, v163, -v12, v241
 v_fma_f32 v212, v164, v12, v240
 v_fma_f32 v164, v164, -v12, v241
 v_fma_f32 v213, v165, v12, v240
 v_fma_f32 v165, v165, -v12, v241
 v_mfma_f32_16x16x32_bf16 v[140:143], v[36:39], v[48:51], 0
 ds_read_b128 v[84:87], v3 offset:17408
 v_fma_f32 v214, v166, v12, v240
 v_fma_f32 v166, v166, -v12, v241
 v_fma_f32 v215, v167, v12, v240
 v_fma_f32 v167, v167, -v12, v241
 v_exp_f32 v208, v208
 v_mfma_f32_16x16x32_bf16 v[156:159], v[36:39], v[52:55], 0
 v_fma_f32 v216, v168, v14, v242
 v_fma_f32 v168, v168, -v14, v243
 v_exp_f32 v160, v160
 v_fma_f32 v217, v169, v14, v242
 v_fma_f32 v169, v169, -v14, v243
 v_exp_f32 v209, v209
 v_mfma_f32_16x16x32_bf16 v[152:155], v[32:35], v[52:55], 0
 v_fma_f32 v218, v170, v14, v242
 v_fma_f32 v170, v170, -v14, v243
 v_exp_f32 v161, v161
 v_fma_f32 v219, v171, v14, v242
 v_fma_f32 v171, v171, -v14, v243
 v_mfma_f32_16x16x32_bf16 v[148:151], v[28:31], v[52:55], 0
 v_exp_f32 v210, v210
 v_fma_f32 v220, v172, v14, v242
 v_fma_f32 v172, v172, -v14, v243
 v_exp_f32 v162, v162
 v_fma_f32 v221, v173, v14, v242
 v_mfma_f32_16x16x32_bf16 v[144:147], v[24:27], v[52:55], 0
 v_fma_f32 v173, v173, -v14, v243
 v_exp_f32 v211, v211
 v_fma_f32 v222, v174, v14, v242
 v_fma_f32 v174, v174, -v14, v243
 v_exp_f32 v163, v163
 s_waitcnt vmcnt(11) lgkmcnt(0)
 s_barrier
 v_mfma_f32_16x16x32_bf16 v[96:99], v[56:59], v[72:75], v[96:99]
 ds_read_b128 v[40:43], v2 offset:32768
 v_fma_f32 v223, v175, v14, v242
 v_fma_f32 v175, v175, -v14, v243
 v_exp_f32 v212, v212
 v_exp_f32 v164, v164
 v_mfma_f32_16x16x32_bf16 v[100:103], v[60:63], v[72:75], v[100:103]
 ds_read_b64_tr_b16 v[24:25], v6 offset:16384
 v_exp_f32 v213, v213
 v_exp_f32 v165, v165
 v_exp_f32 v214, v214
 v_exp_f32 v166, v166
 v_mfma_f32_16x16x32_bf16 v[104:107], v[64:67], v[72:75], v[104:107]
 ds_read_b64_tr_b16 v[26:27], v6 offset:20480
 v_exp_f32 v215, v215
 v_exp_f32 v167, v167
 v_exp_f32 v216, v216
 v_mfma_f32_16x16x32_bf16 v[108:111], v[68:71], v[72:75], v[108:111]
 ds_read_b64_tr_b16 v[28:29], v7 offset:16384
 v_fma_f32 v224, v176, v16, v244
 v_fma_f32 v176, v176, -v16, v245
 v_exp_f32 v168, v168
 v_fma_f32 v225, v177, v16, v244
 v_mfma_f32_16x16x32_bf16 v[124:127], v[68:71], v[76:79], v[124:127]
 ds_read_b64_tr_b16 v[30:31], v7 offset:20480
 v_fma_f32 v177, v177, -v16, v245
 v_exp_f32 v217, v217
 v_fma_f32 v226, v178, v16, v244
 v_fma_f32 v178, v178, -v16, v245
 v_mfma_f32_16x16x32_bf16 v[120:123], v[64:67], v[76:79], v[120:123]
 ds_read_b128 v[44:47], v2 offset:33792
 v_exp_f32 v169, v169
 v_fma_f32 v227, v179, v16, v244
 v_fma_f32 v179, v179, -v16, v245
 v_mfma_f32_16x16x32_bf16 v[116:119], v[60:63], v[76:79], v[116:119]
 ds_read_b64_tr_b16 v[32:33], v8 offset:16384
 v_exp_f32 v218, v218
 v_fma_f32 v228, v180, v16, v244
 v_fma_f32 v180, v180, -v16, v245
 v_exp_f32 v170, v170
 v_mfma_f32_16x16x32_bf16 v[112:115], v[56:59], v[76:79], v[112:115]
 ds_read_b64_tr_b16 v[34:35], v8 offset:20480
 v_fma_f32 v229, v181, v16, v244
 v_fma_f32 v181, v181, -v16, v245
 v_exp_f32 v219, v219
 v_mfma_f32_16x16x32_bf16 v[128:131], v[56:59], v[80:83], v[128:131]
 ds_read_b128 v[48:51], v3 offset:32768
 v_fma_f32 v230, v182, v16, v244
 v_fma_f32 v182, v182, -v16, v245
 v_exp_f32 v171, v171
 v_fma_f32 v231, v183, v16, v244
 s_add_u32 m0, s51, 8192
 s_add_u32 s63, s35, 98304
 v_mfma_f32_16x16x32_bf16 v[132:135], v[60:63], v[80:83], v[132:135]
 ds_read_b64_tr_b16 v[36:37], v9 offset:16384
 buffer_load_dwordx4 v10, s[24:27], s63 offen lds
 v_fma_f32 v183, v183, -v16, v245
 v_exp_f32 v220, v220
 v_add_f32 v240, v208, v209
 v_add_f32 v241, v160, v161
 v_mfma_f32_16x16x32_bf16 v[136:139], v[64:67], v[80:83], v[136:139]
 ds_read_b64_tr_b16 v[38:39], v9 offset:20480
 v_exp_f32 v172, v172
 v_add_f32 v240, v240, v210
 v_add_f32 v241, v241, v162
 v_mfma_f32_16x16x32_bf16 v[140:143], v[68:71], v[80:83], v[140:143]
 ds_read_b128 v[52:55], v3 offset:33792
 v_exp_f32 v221, v221
 v_add_f32 v240, v240, v211
 v_add_f32 v241, v241, v163
 v_exp_f32 v173, v173
 v_mfma_f32_16x16x32_bf16 v[156:159], v[68:71], v[84:87], v[156:159]
 v_add_f32 v240, v240, v212
 v_add_f32 v241, v241, v164
 v_exp_f32 v222, v222
 v_add_f32 v240, v240, v213
 v_mfma_f32_16x16x32_bf16 v[152:155], v[64:67], v[84:87], v[152:155]
 v_add_f32 v241, v241, v165
 v_exp_f32 v174, v174
 v_add_f32 v240, v240, v214
 v_mfma_f32_16x16x32_bf16 v[148:151], v[60:63], v[84:87], v[148:151]
 v_add_f32 v241, v241, v166
 v_exp_f32 v223, v223
 v_add_f32 v240, v240, v215
 v_add_f32 v241, v241, v167
 v_mfma_f32_16x16x32_bf16 v[144:147], v[56:59], v[84:87], v[144:147]
 v_exp_f32 v175, v175
 v_exp_f32 v224, v224
 v_fma_f32 v232, v184, v18, v246
 s_waitcnt vmcnt(11) lgkmcnt(0)
 s_barrier
 v_mfma_f32_16x16x32_bf16 v[96:99], v[24:27], v[40:43], v[96:99]
 ds_read_b128 v[72:75], v2 offset:49152
 v_fma_f32 v184, v184, -v18, v247
 v_exp_f32 v176, v176
 v_fma_f32 v233, v185, v18, v246
 v_fma_f32 v185, v185, -v18, v247
 v_mfma_f32_16x16x32_bf16 v[100:103], v[28:31], v[40:43], v[100:103]
 ds_read_b64_tr_b16 v[56:57], v6 offset:24576
 v_exp_f32 v225, v225
 v_fma_f32 v234, v186, v18, v246
 v_fma_f32 v186, v186, -v18, v247
 v_exp_f32 v177, v177
 v_mfma_f32_16x16x32_bf16 v[104:107], v[32:35], v[40:43], v[104:107]
 ds_read_b64_tr_b16 v[58:59], v6 offset:28672
 v_fma_f32 v235, v187, v18, v246
 v_fma_f32 v187, v187, -v18, v247
 v_exp_f32 v226, v226
 v_fma_f32 v236, v188, v18, v246
 v_mfma_f32_16x16x32_bf16 v[108:111], v[36:39], v[40:43], v[108:111]
 ds_read_b64_tr_b16 v[60:61], v7 offset:24576
 v_fma_f32 v188, v188, -v18, v247
 v_exp_f32 v178, v178
 v_fma_f32 v237, v189, v18, v246
 v_fma_f32 v189, v189, -v18, v247
 s_add_u32 m0, s50, 32768
 s_add_u32 s62, s42, 32768
 v_mfma_f32_16x16x32_bf16 v[124:127], v[36:39], v[44:47], v[124:127]
 ds_read_b64_tr_b16 v[62:63], v7 offset:28672
 buffer_load_dwordx4 v13, s[8:11], s62 offen offset:0 sc1 lds
 v_exp_f32 v227, v227
 v_fma_f32 v238, v190, v18, v246
 v_fma_f32 v190, v190, -v18, v247
 v_exp_f32 v179, v179
 v_mfma_f32_16x16x32_bf16 v[120:123], v[32:35], v[44:47], v[120:123]
 ds_read_b128 v[76:79], v2 offset:50176
 v_fma_f32 v239, v191, v18, v246
 v_fma_f32 v191, v191, -v18, v247
 v_exp_f32 v228, v228
 v_add_f32 v242, v216, v217
 v_mfma_f32_16x16x32_bf16 v[116:119], v[28:31], v[44:47], v[116:119]
 ds_read_b64_tr_b16 v[64:65], v8 offset:24576
 v_add_f32 v243, v168, v169
 v_exp_f32 v180, v180
 v_add_f32 v242, v242, v218
 v_add_f32 v243, v243, v170
 v_mfma_f32_16x16x32_bf16 v[112:115], v[24:27], v[44:47], v[112:115]
 ds_read_b64_tr_b16 v[66:67], v8 offset:28672
 v_exp_f32 v229, v229
 v_add_f32 v242, v242, v219
 v_add_f32 v243, v243, v171
 v_mfma_f32_16x16x32_bf16 v[128:131], v[24:27], v[48:51], v[128:131]
 ds_read_b128 v[80:83], v3 offset:49152
 v_exp_f32 v181, v181
 v_add_f32 v242, v242, v220
 v_add_f32 v243, v243, v172
 v_exp_f32 v230, v230
 v_mfma_f32_16x16x32_bf16 v[132:135], v[28:31], v[48:51], v[132:135]
 ds_read_b64_tr_b16 v[68:69], v9 offset:24576
 buffer_load_dwordx4 v13, s[8:11], s62 offen offset:1024 sc1 lds
 v_add_f32 v242, v242, v221
 v_add_f32 v243, v243, v173
 v_exp_f32 v182, v182
 v_add_f32 v242, v242, v222
 v_mfma_f32_16x16x32_bf16 v[136:139], v[32:35], v[48:51], v[136:139]
 ds_read_b64_tr_b16 v[70:71], v9 offset:28672
 v_add_f32 v243, v243, v174
 v_exp_f32 v231, v231
 v_add_f32 v242, v242, v223
 v_add_f32 v243, v243, v175
 v_mfma_f32_16x16x32_bf16 v[140:143], v[36:39], v[48:51], v[140:143]
 ds_read_b128 v[84:87], v3 offset:50176
 v_exp_f32 v183, v183
 v_exp_f32 v232, v232
 v_add_f32 v244, v224, v225
 v_add_f32 v245, v176, v177
 v_mfma_f32_16x16x32_bf16 v[156:159], v[36:39], v[52:55], v[156:159]
 v_exp_f32 v184, v184
 v_add_f32 v244, v244, v226
 v_add_f32 v245, v245, v178
 v_exp_f32 v233, v233
 s_add_u32 m0, s51, 16384
 s_add_u32 s63, s35, 163840
 v_mfma_f32_16x16x32_bf16 v[152:155], v[32:35], v[52:55], v[152:155]
 buffer_load_dwordx4 v10, s[24:27], s63 offen lds
 v_add_f32 v244, v244, v227
 v_add_f32 v245, v245, v179
 v_exp_f32 v185, v185
 v_add_f32 v244, v244, v228
 v_mfma_f32_16x16x32_bf16 v[148:151], v[28:31], v[52:55], v[148:151]
 v_add_f32 v245, v245, v180
 v_exp_f32 v234, v234
 v_add_f32 v244, v244, v229
 v_add_f32 v245, v245, v181
 v_mfma_f32_16x16x32_bf16 v[144:147], v[24:27], v[52:55], v[144:147]
 v_exp_f32 v186, v186
 v_add_f32 v244, v244, v230
 v_add_f32 v245, v245, v182
 s_waitcnt vmcnt(13) lgkmcnt(0)
 s_barrier
 v_mfma_f32_16x16x32_bf16 v[96:99], v[56:59], v[72:75], v[96:99]
 ds_read_b128 v[40:43], v4 offset:0
 v_exp_f32 v235, v235
 v_add_f32 v244, v244, v231
 v_add_f32 v245, v245, v183
 v_exp_f32 v187, v187
 v_exp_f32 v236, v236
 v_mfma_f32_16x16x32_bf16 v[100:103], v[60:63], v[72:75], v[100:103]
 ds_read_b64_tr_b16 v[24:25], v6 offset:32768
 v_exp_f32 v188, v188
 v_exp_f32 v237, v237
 v_exp_f32 v189, v189
 v_exp_f32 v238, v238
 v_mfma_f32_16x16x32_bf16 v[104:107], v[64:67], v[72:75], v[104:107]
 ds_read_b64_tr_b16 v[26:27], v6 offset:36864
 v_exp_f32 v190, v190
 v_exp_f32 v239, v239
 v_exp_f32 v191, v191
 v_add_f32 v246, v232, v233
 v_add_f32 v247, v184, v185
 v_mfma_f32_16x16x32_bf16 v[108:111], v[68:71], v[72:75], v[108:111]
 ds_read_b64_tr_b16 v[28:29], v7 offset:32768
 v_add_f32 v246, v246, v234
 v_add_f32 v247, v247, v186
 v_add_f32 v246, v246, v235
 v_add_f32 v247, v247, v187
 s_add_u32 m0, s50, 49152
 s_add_u32 s62, s43, 16384
 v_mfma_f32_16x16x32_bf16 v[124:127], v[68:71], v[76:79], v[124:127]
 ds_read_b64_tr_b16 v[30:31], v7 offset:36864
 buffer_load_dwordx4 v13, s[8:11], s62 offen offset:0 sc1 lds
 v_add_f32 v246, v246, v236
 v_add_f32 v247, v247, v188
 v_add_f32 v246, v246, v237
 v_add_f32 v247, v247, v189
 v_add_f32 v246, v246, v238
 v_mfma_f32_16x16x32_bf16 v[120:123], v[64:67], v[76:79], v[120:123]
 ds_read_b128 v[44:47], v4 offset:1024
 v_add_f32 v247, v247, v190
 v_add_f32 v246, v246, v239
 v_add_f32 v247, v247, v191
 v_lshrrev_b32 v88, 4, v1
 v_mfma_f32_16x16x32_bf16 v[116:119], v[60:63], v[76:79], v[116:119]
 ds_read_b64_tr_b16 v[32:33], v8 offset:32768
 v_xor_b32 v88, v88, v1
 v_and_b32 v88, 3, v88
 v_and_b32 v89, 60, v1
 v_or_b32 v89, v89, v88
 s_lshl_b32 s85, s7, 9
 v_lshl_add_u32 v89, v89, 3, s85
 v_mfma_f32_16x16x32_bf16 v[112:115], v[56:59], v[76:79], v[112:115]
 ds_read_b64_tr_b16 v[34:35], v8 offset:36864
 v_add_u32 v88, 147456, v0
 v_permlane32_swap_b32 v240, v244
 v_permlane32_swap_b32 v241, v245
 v_permlane32_swap_b32 v242, v246
 v_mfma_f32_16x16x32_bf16 v[128:131], v[56:59], v[80:83], v[128:131]
 ds_read_b128 v[48:51], v5 offset:0
 v_permlane32_swap_b32 v243, v247
 v_add_f32 v240, v240, v244
 v_add_f32 v241, v241, v245
 v_add_f32 v242, v242, v246
 v_add_f32 v243, v243, v247
 v_mfma_f32_16x16x32_bf16 v[132:135], v[60:63], v[80:83], v[132:135]
 ds_read_b64_tr_b16 v[36:37], v9 offset:32768
 buffer_load_dwordx4 v13, s[8:11], s62 offen offset:1024 sc1 lds
 v_permlane16_swap_b32 v240, v242
 v_permlane16_swap_b32 v241, v243
 v_add_f32 v240, v240, v242
 v_add_f32 v241, v241, v243
 v_mfma_f32_16x16x32_bf16 v[136:139], v[64:67], v[80:83], v[136:139]
 ds_read_b64_tr_b16 v[38:39], v9 offset:36864
 v_rcp_f32 v240, v240
 v_rcp_f32 v241, v241
 v_mov_b32 v242, v240
 v_mov_b32 v243, v241
 s_nop 0
 v_permlane16_swap_b32 v240, v242
 v_mfma_f32_16x16x32_bf16 v[140:143], v[68:71], v[80:83], v[140:143]
 ds_read_b128 v[52:55], v5 offset:1024
 v_permlane16_swap_b32 v241, v243
 v_mov_b32 v244, v240
 v_mov_b32 v245, v241
 v_mov_b32 v246, v242
 v_mfma_f32_16x16x32_bf16 v[156:159], v[68:71], v[84:87], v[156:159]
 v_mov_b32 v247, v243
 v_permlane32_swap_b32 v240, v244
 v_permlane32_swap_b32 v241, v245
 v_permlane32_swap_b32 v242, v246
 v_permlane32_swap_b32 v243, v247
 s_add_u32 m0, s51, 24576
 s_add_u32 s63, s36, 98304
 v_mfma_f32_16x16x32_bf16 v[152:155], v[64:67], v[84:87], v[152:155]
 buffer_load_dwordx4 v10, s[24:27], s63 offen lds
 v_mul_f32 v208, v208, v240
 v_mul_f32 v209, v209, v240
 v_mul_f32 v210, v210, v240
 v_mul_f32 v211, v211, v240
 v_mfma_f32_16x16x32_bf16 v[148:151], v[60:63], v[84:87], v[148:151]
 v_mul_f32 v212, v212, v240
 v_mul_f32 v213, v213, v240
 v_mul_f32 v214, v214, v240
 v_mul_f32 v215, v215, v240
 v_cvt_pk_bf16_f32 v208, v208, v209
 v_mfma_f32_16x16x32_bf16 v[144:147], v[56:59], v[84:87], v[144:147]
 v_cvt_pk_bf16_f32 v209, v210, v211
 v_cvt_pk_bf16_f32 v210, v212, v213
 v_cvt_pk_bf16_f32 v211, v214, v215
 v_mul_f32 v160, v160, v241
 s_waitcnt vmcnt(15) lgkmcnt(0)
 s_barrier
 v_mfma_f32_16x16x32_bf16 v[96:99], v[24:27], v[40:43], v[96:99]
 ds_read_b128 v[72:75], v4 offset:16384
 v_mul_f32 v161, v161, v241
 ds_write2st64_b64 v252, v[208:209], v[210:211] offset0:0 offset1:1
 v_mul_f32 v162, v162, v241
 v_mul_f32 v163, v163, v241
 v_mul_f32 v164, v164, v241
 v_mul_f32 v165, v165, v241
 v_mfma_f32_16x16x32_bf16 v[100:103], v[28:31], v[40:43], v[100:103]
 ds_read_b64_tr_b16 v[56:57], v6 offset:40960
 v_mul_f32 v166, v166, v241
 v_mul_f32 v167, v167, v241
 v_cvt_pk_bf16_f32 v160, v160, v161
 v_cvt_pk_bf16_f32 v161, v162, v163
 v_cvt_pk_bf16_f32 v162, v164, v165
 v_cvt_pk_bf16_f32 v163, v166, v167
 v_mfma_f32_16x16x32_bf16 v[104:107], v[32:35], v[40:43], v[104:107]
 ds_read_b64_tr_b16 v[58:59], v6 offset:45056
 v_mul_f32 v216, v216, v242
 v_mul_f32 v217, v217, v242
 ds_write2st64_b64 v252, v[160:161], v[162:163] offset0:2 offset1:3
 v_mul_f32 v218, v218, v242
 v_mul_f32 v219, v219, v242
 v_mul_f32 v220, v220, v242
 v_mfma_f32_16x16x32_bf16 v[108:111], v[36:39], v[40:43], v[108:111]
 ds_read_b64_tr_b16 v[60:61], v7 offset:40960
 v_mul_f32 v221, v221, v242
 v_mul_f32 v222, v222, v242
 v_mul_f32 v223, v223, v242
 v_cvt_pk_bf16_f32 v216, v216, v217
 v_cvt_pk_bf16_f32 v217, v218, v219
 s_add_u32 m0, s50, 65536
 s_add_u32 s62, s43, 32768
 v_mfma_f32_16x16x32_bf16 v[124:127], v[36:39], v[44:47], v[124:127]
 ds_read_b64_tr_b16 v[62:63], v7 offset:45056
 buffer_load_dwordx4 v13, s[8:11], s62 offen offset:0 sc1 lds
 v_cvt_pk_bf16_f32 v218, v220, v221
 v_cvt_pk_bf16_f32 v219, v222, v223
 v_mul_f32 v168, v168, v243
 v_mul_f32 v169, v169, v243
 ds_write2st64_b64 v252, v[216:217], v[218:219] offset0:4 offset1:5
 v_mul_f32 v170, v170, v243
 v_mfma_f32_16x16x32_bf16 v[120:123], v[32:35], v[44:47], v[120:123]
 ds_read_b128 v[76:79], v4 offset:17408
 v_mul_f32 v171, v171, v243
 v_mul_f32 v172, v172, v243
 v_mul_f32 v173, v173, v243
 v_mul_f32 v174, v174, v243
 v_mul_f32 v175, v175, v243
 v_cvt_pk_bf16_f32 v168, v168, v169
 v_mfma_f32_16x16x32_bf16 v[116:119], v[28:31], v[44:47], v[116:119]
 ds_read_b64_tr_b16 v[64:65], v8 offset:40960
 v_cvt_pk_bf16_f32 v169, v170, v171
 v_cvt_pk_bf16_f32 v170, v172, v173
 v_cvt_pk_bf16_f32 v171, v174, v175
 v_mul_f32 v224, v224, v244
 v_mul_f32 v225, v225, v244
 v_mfma_f32_16x16x32_bf16 v[112:115], v[24:27], v[44:47], v[112:115]
 ds_read_b64_tr_b16 v[66:67], v8 offset:45056
 ds_write2st64_b64 v252, v[168:169], v[170:171] offset0:6 offset1:7
 v_mul_f32 v226, v226, v244
 v_mul_f32 v227, v227, v244
 v_mul_f32 v228, v228, v244
 v_mul_f32 v229, v229, v244
 v_mul_f32 v230, v230, v244
 v_mfma_f32_16x16x32_bf16 v[128:131], v[24:27], v[48:51], v[128:131]
 ds_read_b128 v[80:83], v5 offset:16384
 v_mul_f32 v231, v231, v244
 v_cvt_pk_bf16_f32 v224, v224, v225
 v_cvt_pk_bf16_f32 v225, v226, v227
 v_cvt_pk_bf16_f32 v226, v228, v229
 v_cvt_pk_bf16_f32 v227, v230, v231
 v_mul_f32 v176, v176, v245
 v_mfma_f32_16x16x32_bf16 v[132:135], v[28:31], v[48:51], v[132:135]
 ds_read_b64_tr_b16 v[68:69], v9 offset:40960
 buffer_load_dwordx4 v13, s[8:11], s62 offen offset:1024 sc1 lds
 v_mul_f32 v177, v177, v245
 ds_write2st64_b64 v252, v[224:225], v[226:227] offset0:8 offset1:9
 v_mul_f32 v178, v178, v245
 v_mul_f32 v179, v179, v245
 v_mul_f32 v180, v180, v245
 v_mfma_f32_16x16x32_bf16 v[136:139], v[32:35], v[48:51], v[136:139]
 ds_read_b64_tr_b16 v[70:71], v9 offset:45056
 v_mul_f32 v181, v181, v245
 v_mul_f32 v182, v182, v245
 v_mul_f32 v183, v183, v245
 v_cvt_pk_bf16_f32 v176, v176, v177
 v_cvt_pk_bf16_f32 v177, v178, v179
 v_cvt_pk_bf16_f32 v178, v180, v181
 v_mfma_f32_16x16x32_bf16 v[140:143], v[36:39], v[48:51], v[140:143]
 ds_read_b128 v[84:87], v5 offset:17408
 v_cvt_pk_bf16_f32 v179, v182, v183
 v_mul_f32 v232, v232, v246
 v_mul_f32 v233, v233, v246
 ds_write2st64_b64 v252, v[176:177], v[178:179] offset0:10 offset1:11
 v_mul_f32 v234, v234, v246
 v_mul_f32 v235, v235, v246
 v_mfma_f32_16x16x32_bf16 v[156:159], v[36:39], v[52:55], v[156:159]
 v_mul_f32 v236, v236, v246
 v_mul_f32 v237, v237, v246
 v_mul_f32 v238, v238, v246
 v_mul_f32 v239, v239, v246
 v_cvt_pk_bf16_f32 v232, v232, v233
 s_add_u32 m0, s51, 32768
 s_add_u32 s63, s36, 163840
 v_mfma_f32_16x16x32_bf16 v[152:155], v[32:35], v[52:55], v[152:155]
 buffer_load_dwordx4 v10, s[24:27], s63 offen lds
 v_cvt_pk_bf16_f32 v233, v234, v235
 v_cvt_pk_bf16_f32 v234, v236, v237
 v_cvt_pk_bf16_f32 v235, v238, v239
 v_mul_f32 v184, v184, v247
 v_mul_f32 v185, v185, v247
 ds_write2st64_b64 v252, v[232:233], v[234:235] offset0:12 offset1:13
 v_mfma_f32_16x16x32_bf16 v[148:151], v[28:31], v[52:55], v[148:151]
 v_mul_f32 v186, v186, v247
 v_mul_f32 v187, v187, v247
 v_mul_f32 v188, v188, v247
 v_mul_f32 v189, v189, v247
 v_mul_f32 v190, v190, v247
 v_mul_f32 v191, v191, v247
 v_mfma_f32_16x16x32_bf16 v[144:147], v[24:27], v[52:55], v[144:147]
 v_cvt_pk_bf16_f32 v184, v184, v185
 v_cvt_pk_bf16_f32 v185, v186, v187
 v_cvt_pk_bf16_f32 v186, v188, v189
 v_cvt_pk_bf16_f32 v187, v190, v191
 ds_write2st64_b64 v252, v[184:185], v[186:187] offset0:14 offset1:15
 s_waitcnt vmcnt(7) lgkmcnt(0)
 s_barrier
 v_mfma_f32_16x16x32_bf16 v[96:99], v[56:59], v[72:75], v[96:99]
 ds_read_b128 v[40:43], v2 offset:32768
 ds_read_b64_tr_b16 v[208:209], v89 offset:0
 ds_read_b64_tr_b16 v[210:211], v89 offset:2048
 ds_read_b128 v[192:195], v88 offset:0
 ds_read_b64_tr_b16 v[212:213], v89 offset:4096
 v_mfma_f32_16x16x32_bf16 v[100:103], v[60:63], v[72:75], v[100:103]
 ds_read_b64_tr_b16 v[24:25], v6 offset:0
 ds_read_b64_tr_b16 v[214:215], v89 offset:6144
 ds_read_b128 v[196:199], v88 offset:1024
 ds_read_b64_tr_b16 v[216:217], v89 offset:8192
 v_mfma_f32_16x16x32_bf16 v[104:107], v[64:67], v[72:75], v[104:107]
 ds_read_b64_tr_b16 v[26:27], v6 offset:4096
 ds_read_b64_tr_b16 v[218:219], v89 offset:10240
 ds_read_b128 v[200:203], v88 offset:4096
 ds_read_b64_tr_b16 v[220:221], v89 offset:12288
 v_mfma_f32_16x16x32_bf16 v[108:111], v[68:71], v[72:75], v[108:111]
 ds_read_b64_tr_b16 v[28:29], v7 offset:0
 ds_read_b64_tr_b16 v[222:223], v89 offset:14336
 ds_read_b128 v[204:207], v88 offset:5120
 v_mov_b32 v92, 0x3f803f80
 s_add_u32 m0, s50, 81920
 s_add_u32 s62, s44, 16384
 v_mfma_f32_16x16x32_bf16 v[124:127], v[68:71], v[76:79], v[124:127]
 ds_read_b64_tr_b16 v[30:31], v7 offset:4096
 buffer_load_dwordx4 v13, s[8:11], s62 offen offset:0 sc1 lds
 v_mov_b32 v93, 0x3f803f80
 v_mov_b32 v94, 0x3f803f80
 v_mov_b32 v95, 0x3f803f80
 ds_read_b64_tr_b16 v[224:225], v89 offset:16384
 v_mfma_f32_16x16x32_bf16 v[120:123], v[64:67], v[76:79], v[120:123]
 ds_read_b128 v[44:47], v2 offset:33792
 ds_read_b64_tr_b16 v[226:227], v89 offset:18432
 s_waitcnt lgkmcnt(15)
 v_mfma_f32_16x16x32_bf16 v[248:251], v[208:211], v[192:195], 0
 v_mfma_f32_16x16x32_bf16 v[116:119], v[60:63], v[76:79], v[116:119]
 ds_read_b64_tr_b16 v[32:33], v8 offset:0
 v_mfma_f32_16x16x32_bf16 v[252:255], v[208:211], v[92:95], 0
 ds_read_b64_tr_b16 v[228:229], v89 offset:20480
 ds_read_b64_tr_b16 v[230:231], v89 offset:22528
 v_mfma_f32_16x16x32_bf16 v[112:115], v[56:59], v[76:79], v[112:115]
 ds_read_b64_tr_b16 v[34:35], v8 offset:4096
 s_waitcnt lgkmcnt(15)
 v_mfma_f32_16x16x32_bf16 v[248:251], v[212:215], v[196:199], v[248:251]
 v_mfma_f32_16x16x32_bf16 v[252:255], v[212:215], v[92:95], v[252:255]
 v_mfma_f32_16x16x32_bf16 v[128:131], v[56:59], v[80:83], v[128:131]
 ds_read_b128 v[48:51], v3 offset:32768
 ds_read_b128 v[192:195], v88 offset:8192
 ds_read_b64_tr_b16 v[232:233], v89 offset:24576
 ds_read_b64_tr_b16 v[234:235], v89 offset:26624
 s_waitcnt lgkmcnt(15)
 v_mfma_f32_16x16x32_bf16 v[132:135], v[60:63], v[80:83], v[132:135]
 ds_read_b64_tr_b16 v[36:37], v9 offset:0
 buffer_load_dwordx4 v13, s[8:11], s62 offen offset:1024 sc1 lds
 v_mfma_f32_16x16x32_bf16 v[248:251], v[216:219], v[200:203], v[248:251]
 v_mfma_f32_16x16x32_bf16 v[252:255], v[216:219], v[92:95], v[252:255]
 ds_read_b128 v[196:199], v88 offset:9216
 v_mfma_f32_16x16x32_bf16 v[136:139], v[64:67], v[80:83], v[136:139]
 ds_read_b64_tr_b16 v[38:39], v9 offset:4096
 ds_read_b64_tr_b16 v[236:237], v89 offset:28672
 ds_read_b64_tr_b16 v[238:239], v89 offset:30720
 s_waitcnt lgkmcnt(15)
 v_mfma_f32_16x16x32_bf16 v[140:143], v[68:71], v[80:83], v[140:143]
 ds_read_b128 v[52:55], v3 offset:33792
 v_mfma_f32_16x16x32_bf16 v[248:251], v[220:223], v[204:207], v[248:251]
 v_mfma_f32_16x16x32_bf16 v[252:255], v[220:223], v[92:95], v[252:255]
 ds_read_b128 v[200:203], v88 offset:12288
 v_mfma_f32_16x16x32_bf16 v[156:159], v[68:71], v[84:87], v[156:159]
 s_waitcnt lgkmcnt(9)
 v_mfma_f32_16x16x32_bf16 v[248:251], v[224:227], v[192:195], v[248:251]
 v_mfma_f32_16x16x32_bf16 v[252:255], v[224:227], v[92:95], v[252:255]
 ds_read_b128 v[204:207], v88 offset:13312
 s_add_u32 m0, s51, 40960
 s_add_u32 s63, s37, 98304
 v_mfma_f32_16x16x32_bf16 v[152:155], v[64:67], v[84:87], v[152:155]
 buffer_load_dwordx4 v10, s[24:27], s63 offen lds
 s_waitcnt lgkmcnt(6)
 v_mfma_f32_16x16x32_bf16 v[248:251], v[228:231], v[196:199], v[248:251]
 v_mfma_f32_16x16x32_bf16 v[252:255], v[228:231], v[92:95], v[252:255]
 v_mfma_f32_16x16x32_bf16 v[148:151], v[60:63], v[84:87], v[148:151]
 s_waitcnt lgkmcnt(1)
 v_mfma_f32_16x16x32_bf16 v[248:251], v[232:235], v[200:203], v[248:251]
 v_mfma_f32_16x16x32_bf16 v[252:255], v[232:235], v[92:95], v[252:255]
 v_mfma_f32_16x16x32_bf16 v[144:147], v[56:59], v[84:87], v[144:147]
 s_waitcnt lgkmcnt(0)
 v_mfma_f32_16x16x32_bf16 v[248:251], v[236:239], v[204:207], v[248:251]
 v_mfma_f32_16x16x32_bf16 v[252:255], v[236:239], v[92:95], v[252:255]
 s_waitcnt vmcnt(7) lgkmcnt(0)
 s_barrier
 v_mfma_f32_16x16x32_bf16 v[96:99], v[24:27], v[40:43], v[96:99]
 ds_read_b128 v[72:75], v2 offset:49152
 s_lshl3_add_u32 s85, s82, s83
 s_mul_i32 s85, s85, 8448
 v_mfma_f32_16x16x32_bf16 v[100:103], v[28:31], v[40:43], v[100:103]
 ds_read_b64_tr_b16 v[56:57], v6 offset:8192
 s_add_u32 s85, s85, 23068672
 v_mfma_f32_16x16x32_bf16 v[104:107], v[32:35], v[40:43], v[104:107]
 ds_read_b64_tr_b16 v[58:59], v6 offset:12288
 s_lshl_b32 s86, s3, 10
 s_add_u32 s86, s86, s85
 v_mfma_f32_16x16x32_bf16 v[108:111], v[36:39], v[40:43], v[108:111]
 ds_read_b64_tr_b16 v[60:61], v7 offset:8192
 v_mfma_f32_16x16x32_bf16 v[124:127], v[36:39], v[44:47], v[124:127]
 ds_read_b64_tr_b16 v[62:63], v7 offset:12288
 s_lshl2_add_u32 s64, s83, s4
 s_add_u32 m0, s50, 0
 s_add_u32 s62, s44, 32768
 v_mfma_f32_16x16x32_bf16 v[120:123], v[32:35], v[44:47], v[120:123]
 ds_read_b128 v[76:79], v2 offset:50176
 buffer_load_dwordx4 v13, s[8:11], s62 offen offset:0 sc1 lds
 s_lshl2_add_u32 s64, s64, s7
 s_lshl_b32 s64, s64, 7
 v_mfma_f32_16x16x32_bf16 v[116:119], v[28:31], v[44:47], v[116:119]
 ds_read_b64_tr_b16 v[64:65], v8 offset:8192
 s_add_u32 s64, s64, 39944192
 v_mfma_f32_16x16x32_bf16 v[112:115], v[24:27], v[44:47], v[112:115]
 ds_read_b64_tr_b16 v[66:67], v8 offset:12288
 s_buffer_load_dwordx2 s[72:73], s[8:11], s64 glc
 v_mfma_f32_16x16x32_bf16 v[128:131], v[24:27], v[48:51], v[128:131]
 ds_read_b128 v[80:83], v3 offset:49152
 buffer_store_dwordx4 v[248:251], v0, s[8:11], s86 offen sc1
 s_lshl_b32 s86, s7, 6
 v_mfma_f32_16x16x32_bf16 v[132:135], v[28:31], v[48:51], v[132:135]
 ds_read_b64_tr_b16 v[68:69], v9 offset:8192
 s_add_u32 s86, s86, s85
 v_mfma_f32_16x16x32_bf16 v[136:139], v[32:35], v[48:51], v[136:139]
 ds_read_b64_tr_b16 v[70:71], v9 offset:12288
 s_add_u32 s86, s86, 8192
 s_mov_b32 exec_lo, 0x00010001
 s_mov_b32 exec_hi, 0x00010001
 buffer_store_dwordx4 v[252:255], v1, s[8:11], s86 offen sc1
 s_mov_b64 exec, -1
 v_mfma_f32_16x16x32_bf16 v[140:143], v[36:39], v[48:51], v[140:143]
 ds_read_b128 v[84:87], v3 offset:50176
 ds_read_b32 v90, v0
 ds_read_b32 v90, v0
 v_mfma_f32_16x16x32_bf16 v[156:159], v[36:39], v[52:55], v[156:159]
 buffer_load_dwordx4 v13, s[8:11], s62 offen offset:1024 sc1 lds
 v_mfma_f32_16x16x32_bf16 v[152:155], v[32:35], v[52:55], v[152:155]
 v_mfma_f32_16x16x32_bf16 v[148:151], v[28:31], v[52:55], v[148:151]
 v_mfma_f32_16x16x32_bf16 v[144:147], v[24:27], v[52:55], v[144:147]
 s_waitcnt vmcnt(8) lgkmcnt(2)
 s_barrier
 v_mfma_f32_16x16x32_bf16 v[96:99], v[56:59], v[72:75], v[96:99]
 ds_read_b128 v[40:43], v4 offset:0
 s_lshl_b32 s85, s7, 11
 v_add_u32 v15, s85, v0
 v_mfma_f32_16x16x32_bf16 v[100:103], v[60:63], v[72:75], v[100:103]
 ds_read_b64_tr_b16 v[24:25], v6 offset:16384
 v_add_u32 v17, 0x10000, v15
 v_mfma_f32_16x16x32_bf16 v[104:107], v[64:67], v[72:75], v[104:107]
 ds_read_b64_tr_b16 v[26:27], v6 offset:20480
 s_lshl_b32 s65, s4, 11
 s_add_u32 s65, s65, s5
 s_lshl_b32 s65, s65, 8
 s_lshl2_add_u32 s54, s83, s4
 s_lshl_b32 s54, s54, 17
 s_add_u32 s54, s54, 18874368
 s_add_u32 m0, s50, 16384
 s_add_u32 s62, s45, 16384
 v_mfma_f32_16x16x32_bf16 v[108:111], v[68:71], v[72:75], v[108:111]
 ds_read_b64_tr_b16 v[28:29], v7 offset:16384
 buffer_load_dwordx4 v13, s[8:11], s62 offen offset:0 sc1 lds
 s_lshl_b32 s71, s83, 5
 v_mfma_f32_16x16x32_bf16 v[124:127], v[68:71], v[76:79], v[124:127]
 ds_read_b64_tr_b16 v[30:31], v7 offset:20480
 s_add_u32 s71, s71, s82
 s_lshl_b32 s71, s71, 5
 v_mfma_f32_16x16x32_bf16 v[120:123], v[64:67], v[76:79], v[120:123]
 ds_read_b128 v[44:47], v4 offset:1024
 s_lshl3_add_u32 s92, s82, s3
 v_mfma_f32_16x16x32_bf16 v[116:119], v[60:63], v[76:79], v[116:119]
 ds_read_b64_tr_b16 v[32:33], v8 offset:16384
 s_lshl_b32 s92, s92, 7
 s_add_u32 s92, s92, 39878656
 v_mfma_f32_16x16x32_bf16 v[112:115], v[56:59], v[76:79], v[112:115]
 ds_read_b64_tr_b16 v[34:35], v8 offset:20480
 buffer_load_dwordx4 v13, s[8:11], s62 offen offset:1024 sc1 lds
 s_add_u32 s92, s92, s83
 v_mfma_f32_16x16x32_bf16 v[128:131], v[56:59], v[80:83], v[128:131]
 ds_read_b128 v[48:51], v5 offset:0
 v_mov_b32 v91, 1
 v_mfma_f32_16x16x32_bf16 v[132:135], v[60:63], v[80:83], v[132:135]
 ds_read_b64_tr_b16 v[36:37], v9 offset:16384
 s_waitcnt vmcnt(3)
 buffer_store_byte v91, off, s[8:11], s92 sc1
 s_add_u32 m0, s50, 32768
 s_add_u32 s62, s45, 32768
 v_mfma_f32_16x16x32_bf16 v[136:139], v[64:67], v[80:83], v[136:139]
 ds_read_b64_tr_b16 v[38:39], v9 offset:20480
 buffer_load_dwordx4 v13, s[8:11], s62 offen offset:0 sc1 lds
 s_add_u32 s71, s71, s3
 v_mfma_f32_16x16x32_bf16 v[140:143], v[68:71], v[80:83], v[140:143]
 ds_read_b128 v[52:55], v5 offset:1024
 ds_read_b32 v90, v0
 ds_read_b32 v90, v0
 s_lshl2_add_u32 s71, s71, 39845888
 v_mfma_f32_16x16x32_bf16 v[156:159], v[68:71], v[84:87], v[156:159]
 v_mfma_f32_16x16x32_bf16 v[152:155], v[64:67], v[84:87], v[152:155]
 v_mfma_f32_16x16x32_bf16 v[148:151], v[60:63], v[84:87], v[148:151]
 buffer_load_dwordx4 v13, s[8:11], s62 offen offset:1024 sc1 lds
 v_mfma_f32_16x16x32_bf16 v[144:147], v[56:59], v[84:87], v[144:147]
 s_waitcnt vmcnt(10) lgkmcnt(2)
 s_barrier
 v_mfma_f32_16x16x32_bf16 v[96:99], v[24:27], v[40:43], v[96:99]
 ds_read_b128 v[72:75], v4 offset:16384
 v_mfma_f32_16x16x32_bf16 v[100:103], v[28:31], v[40:43], v[100:103]
 ds_read_b64_tr_b16 v[56:57], v6 offset:24576
 v_mfma_f32_16x16x32_bf16 v[104:107], v[32:35], v[40:43], v[104:107]
 ds_read_b64_tr_b16 v[58:59], v6 offset:28672
 s_add_u32 m0, s51, 0
 s_add_u32 s63, s37, 163840
 v_mfma_f32_16x16x32_bf16 v[108:111], v[36:39], v[40:43], v[108:111]
 ds_read_b64_tr_b16 v[60:61], v7 offset:24576
 buffer_load_dwordx4 v10, s[24:27], s63 offen lds
 v_mfma_f32_16x16x32_bf16 v[124:127], v[36:39], v[44:47], v[124:127]
 ds_read_b64_tr_b16 v[62:63], v7 offset:28672
 v_mfma_f32_16x16x32_bf16 v[120:123], v[32:35], v[44:47], v[120:123]
 ds_read_b128 v[76:79], v4 offset:17408
 v_mfma_f32_16x16x32_bf16 v[116:119], v[28:31], v[44:47], v[116:119]
 ds_read_b64_tr_b16 v[64:65], v8 offset:24576
 s_add_u32 m0, s50, 49152
 s_add_u32 s62, s46, 16384
 v_mfma_f32_16x16x32_bf16 v[112:115], v[24:27], v[44:47], v[112:115]
 ds_read_b64_tr_b16 v[66:67], v8 offset:28672
 buffer_load_dwordx4 v13, s[8:11], s62 offen offset:0 sc1 lds
 v_mfma_f32_16x16x32_bf16 v[128:131], v[24:27], v[48:51], v[128:131]
 ds_read_b128 v[80:83], v5 offset:16384
 v_mfma_f32_16x16x32_bf16 v[132:135], v[28:31], v[48:51], v[132:135]
 ds_read_b64_tr_b16 v[68:69], v9 offset:24576
 v_mfma_f32_16x16x32_bf16 v[136:139], v[32:35], v[48:51], v[136:139]
 ds_read_b64_tr_b16 v[70:71], v9 offset:28672
 buffer_load_dwordx4 v13, s[8:11], s62 offen offset:1024 sc1 lds
 v_mfma_f32_16x16x32_bf16 v[140:143], v[36:39], v[48:51], v[140:143]
 ds_read_b128 v[84:87], v5 offset:17408
 v_mfma_f32_16x16x32_bf16 v[156:159], v[36:39], v[52:55], v[156:159]
 v_mfma_f32_16x16x32_bf16 v[152:155], v[32:35], v[52:55], v[152:155]
 s_add_u32 m0, s51, 8192
 s_add_u32 s63, s38, 98304
 v_mfma_f32_16x16x32_bf16 v[148:151], v[28:31], v[52:55], v[148:151]
 buffer_load_dwordx4 v10, s[24:27], s63 offen lds
 v_mfma_f32_16x16x32_bf16 v[144:147], v[24:27], v[52:55], v[144:147]
 s_waitcnt lgkmcnt(0)
 s_and_b32 s72, s72, s73
 s_cmp_eq_u32 s72, 0x1010101
 s_cbranch_scc0 Lsp_66
Lok_67:
 s_waitcnt vmcnt(9) lgkmcnt(0)
 s_barrier
 v_mfma_f32_16x16x32_bf16 v[96:99], v[56:59], v[72:75], v[96:99]
 ds_read_b128 v[40:43], v2 offset:0
 v_mfma_f32_16x16x32_bf16 v[100:103], v[60:63], v[72:75], v[100:103]
 ds_read_b64_tr_b16 v[24:25], v6 offset:32768
 v_mfma_f32_16x16x32_bf16 v[104:107], v[64:67], v[72:75], v[104:107]
 ds_read_b64_tr_b16 v[26:27], v6 offset:36864
 s_add_u32 m0, s50, 65536
 s_add_u32 s62, s46, 32768
 v_mfma_f32_16x16x32_bf16 v[108:111], v[68:71], v[72:75], v[108:111]
 ds_read_b64_tr_b16 v[28:29], v7 offset:32768
 buffer_load_dwordx4 v13, s[8:11], s62 offen offset:0 sc1 lds
 v_mfma_f32_16x16x32_bf16 v[124:127], v[68:71], v[76:79], v[124:127]
 ds_read_b64_tr_b16 v[30:31], v7 offset:36864
 v_mfma_f32_16x16x32_bf16 v[120:123], v[64:67], v[76:79], v[120:123]
 ds_read_b128 v[44:47], v2 offset:1024
 v_mfma_f32_16x16x32_bf16 v[116:119], v[60:63], v[76:79], v[116:119]
 ds_read_b64_tr_b16 v[32:33], v8 offset:32768
 s_lshl3_add_u32 s64, s82, s3
 v_mfma_f32_16x16x32_bf16 v[112:115], v[56:59], v[76:79], v[112:115]
 ds_read_b64_tr_b16 v[34:35], v8 offset:36864
 buffer_load_dwordx4 v13, s[8:11], s62 offen offset:1024 sc1 lds
 s_lshl_b32 s64, s64, 7
 v_mfma_f32_16x16x32_bf16 v[128:131], v[56:59], v[80:83], v[128:131]
 ds_read_b128 v[48:51], v3 offset:0
 s_add_u32 s64, s64, 39878656
 v_mfma_f32_16x16x32_bf16 v[132:135], v[60:63], v[80:83], v[132:135]
 ds_read_b64_tr_b16 v[36:37], v9 offset:32768
 s_buffer_load_dwordx2 s[72:73], s[8:11], s64 glc
 s_add_u32 m0, s51, 16384
 s_add_u32 s63, s38, 163840
 v_mfma_f32_16x16x32_bf16 v[136:139], v[64:67], v[80:83], v[136:139]
 ds_read_b64_tr_b16 v[38:39], v9 offset:36864
 buffer_load_dwordx4 v10, s[24:27], s63 offen lds
 v_mfma_f32_16x16x32_bf16 v[140:143], v[68:71], v[80:83], v[140:143]
 ds_read_b128 v[52:55], v3 offset:1024
 ds_read_b32 v90, v0
 ds_read_b32 v90, v0
 v_mfma_f32_16x16x32_bf16 v[156:159], v[68:71], v[84:87], v[156:159]
 v_mfma_f32_16x16x32_bf16 v[152:155], v[64:67], v[84:87], v[152:155]
 s_add_u32 m0, s50, 81920
 s_add_u32 s62, s47, 16384
 v_mfma_f32_16x16x32_bf16 v[148:151], v[60:63], v[84:87], v[148:151]
 buffer_load_dwordx4 v13, s[8:11], s62 offen offset:0 sc1 lds
 v_mfma_f32_16x16x32_bf16 v[144:147], v[56:59], v[84:87], v[144:147]
 s_waitcnt vmcnt(11) lgkmcnt(2)
 s_barrier
 v_mfma_f32_16x16x32_bf16 v[96:99], v[24:27], v[40:43], v[96:99]
 ds_read_b128 v[72:75], v2 offset:16384
 v_mfma_f32_16x16x32_bf16 v[100:103], v[28:31], v[40:43], v[100:103]
 ds_read_b64_tr_b16 v[56:57], v6 offset:40960
 v_mfma_f32_16x16x32_bf16 v[104:107], v[32:35], v[40:43], v[104:107]
 ds_read_b64_tr_b16 v[58:59], v6 offset:45056
 v_mfma_f32_16x16x32_bf16 v[108:111], v[36:39], v[40:43], v[108:111]
 ds_read_b64_tr_b16 v[60:61], v7 offset:40960
 buffer_load_dwordx4 v13, s[8:11], s62 offen offset:1024 sc1 lds
 v_mfma_f32_16x16x32_bf16 v[124:127], v[36:39], v[44:47], v[124:127]
 ds_read_b64_tr_b16 v[62:63], v7 offset:45056
 v_mfma_f32_16x16x32_bf16 v[120:123], v[32:35], v[44:47], v[120:123]
 ds_read_b128 v[76:79], v2 offset:17408
 v_mfma_f32_16x16x32_bf16 v[116:119], v[28:31], v[44:47], v[116:119]
 ds_read_b64_tr_b16 v[64:65], v8 offset:40960
 s_add_u32 m0, s51, 24576
 s_add_u32 s63, s39, 98304
 v_mfma_f32_16x16x32_bf16 v[112:115], v[24:27], v[44:47], v[112:115]
 ds_read_b64_tr_b16 v[66:67], v8 offset:45056
 buffer_load_dwordx4 v10, s[24:27], s63 offen lds
 v_mfma_f32_16x16x32_bf16 v[128:131], v[24:27], v[48:51], v[128:131]
 ds_read_b128 v[80:83], v3 offset:16384
 v_mfma_f32_16x16x32_bf16 v[132:135], v[28:31], v[48:51], v[132:135]
 ds_read_b64_tr_b16 v[68:69], v9 offset:40960
 s_add_u32 m0, s50, 0
 s_add_u32 s62, s47, 32768
 v_mfma_f32_16x16x32_bf16 v[136:139], v[32:35], v[48:51], v[136:139]
 ds_read_b64_tr_b16 v[70:71], v9 offset:45056
 buffer_load_dwordx4 v13, s[8:11], s62 offen offset:0 sc1 lds
 v_mfma_f32_16x16x32_bf16 v[140:143], v[36:39], v[48:51], v[140:143]
 ds_read_b128 v[84:87], v3 offset:17408
 v_mfma_f32_16x16x32_bf16 v[156:159], v[36:39], v[52:55], v[156:159]
 v_mfma_f32_16x16x32_bf16 v[152:155], v[32:35], v[52:55], v[152:155]
 v_mfma_f32_16x16x32_bf16 v[148:151], v[28:31], v[52:55], v[148:151]
 buffer_load_dwordx4 v13, s[8:11], s62 offen offset:1024 sc1 lds
 v_mfma_f32_16x16x32_bf16 v[144:147], v[24:27], v[52:55], v[144:147]
 s_waitcnt lgkmcnt(0)
 s_and_b32 s72, s72, s73
 s_cmp_eq_u32 s72, 0x1010101
 s_cbranch_scc0 Lsp_69
Lok_70:
 s_waitcnt vmcnt(11) lgkmcnt(0)
 s_barrier
 v_mfma_f32_16x16x32_bf16 v[96:99], v[56:59], v[72:75], v[96:99]
 ds_read_b128 v[40:43], v2 offset:32768
 s_memrealtime s[72:73]
 s_mul_i32 s87, s82, 67584
 s_add_u32 s87, s87, 23068672
 v_mfma_f32_16x16x32_bf16 v[100:103], v[60:63], v[72:75], v[100:103]
 ds_read_b64_tr_b16 v[24:25], v6 offset:0
 v_lshrrev_b32 v94, 4, v1
 v_mul_u32_u24 v94, 8448, v94
 v_mfma_f32_16x16x32_bf16 v[104:107], v[64:67], v[72:75], v[104:107]
 ds_read_b64_tr_b16 v[26:27], v6 offset:4096
 v_and_b32 v95, 15, v1
 v_lshl_add_u32 v94, v95, 2, v94
 s_lshl_b32 s86, s7, 6
 v_mfma_f32_16x16x32_bf16 v[108:111], v[68:71], v[72:75], v[108:111]
 ds_read_b64_tr_b16 v[28:29], v7 offset:0
 s_add_u32 s86, s86, s87
 s_add_u32 s86, s86, 8192
 v_mfma_f32_16x16x32_bf16 v[124:127], v[68:71], v[76:79], v[124:127]
 ds_read_b64_tr_b16 v[30:31], v7 offset:4096
 buffer_load_dword v92, v94, s[8:11], s86 offen sc1
 s_add_u32 s86, s86, 33792
 buffer_load_dword v93, v94, s[8:11], s86 offen sc1
 v_mfma_f32_16x16x32_bf16 v[120:123], v[64:67], v[76:79], v[120:123]
 ds_read_b128 v[44:47], v2 offset:33792
 s_lshl_b32 s86, s3, 10
 s_add_u32 s87, s87, s86
 v_mfma_f32_16x16x32_bf16 v[116:119], v[60:63], v[76:79], v[116:119]
 ds_read_b64_tr_b16 v[32:33], v8 offset:0
 s_xor_b32 s86, s83, 4
 s_mul_i32 s86, s86, 8448
 s_add_u32 s86, s86, s87
 buffer_load_dwordx4 v[192:195], v0, s[8:11], s86 offen sc1
 v_mfma_f32_16x16x32_bf16 v[112:115], v[56:59], v[76:79], v[112:115]
 ds_read_b64_tr_b16 v[34:35], v8 offset:4096
 v_mfma_f32_16x16x32_bf16 v[128:131], v[56:59], v[80:83], v[128:131]
 ds_read_b128 v[48:51], v3 offset:32768
 s_xor_b32 s86, s83, 5
 s_mul_i32 s86, s86, 8448
 s_add_u32 s86, s86, s87
 v_mfma_f32_16x16x32_bf16 v[132:135], v[60:63], v[80:83], v[132:135]
 ds_read_b64_tr_b16 v[36:37], v9 offset:0
 buffer_load_dwordx4 v[196:199], v0, s[8:11], s86 offen sc1
 v_mfma_f32_16x16x32_bf16 v[136:139], v[64:67], v[80:83], v[136:139]
 ds_read_b64_tr_b16 v[38:39], v9 offset:4096
 v_mfma_f32_16x16x32_bf16 v[140:143], v[68:71], v[80:83], v[140:143]
 ds_read_b128 v[52:55], v3 offset:33792
 s_xor_b32 s86, s83, 6
 s_mul_i32 s86, s86, 8448
 s_add_u32 s86, s86, s87
 buffer_load_dwordx4 v[200:203], v0, s[8:11], s86 offen sc1
 v_mfma_f32_16x16x32_bf16 v[156:159], v[68:71], v[84:87], v[156:159]
 v_mfma_f32_16x16x32_bf16 v[152:155], v[64:67], v[84:87], v[152:155]
 s_xor_b32 s86, s83, 7
 s_mul_i32 s86, s86, 8448
 s_add_u32 s86, s86, s87
 buffer_load_dwordx4 v[204:207], v0, s[8:11], s86 offen sc1
 v_mfma_f32_16x16x32_bf16 v[148:151], v[60:63], v[84:87], v[148:151]
 v_mfma_f32_16x16x32_bf16 v[144:147], v[56:59], v[84:87], v[144:147]
 s_waitcnt vmcnt(14) lgkmcnt(0)
 s_barrier
 v_mfma_f32_16x16x32_bf16 v[96:99], v[24:27], v[40:43], v[96:99]
 ds_read_b128 v[72:75], v2 offset:49152
 s_or_b32 s72, s72, 1
 s_lshr_b32 s84, s2, 3
 v_mfma_f32_16x16x32_bf16 v[100:103], v[28:31], v[40:43], v[100:103]
 ds_read_b64_tr_b16 v[56:57], v6 offset:8192
 s_lshl2_add_u32 s84, s84, s7
 s_and_b32 s96, s2, 7
 v_mfma_f32_16x16x32_bf16 v[104:107], v[32:35], v[40:43], v[104:107]
 ds_read_b64_tr_b16 v[58:59], v6 offset:12288
 s_lshl3_add_u32 s84, s84, s96
 v_mov_b32 v91, s72
 v_mfma_f32_16x16x32_bf16 v[108:111], v[36:39], v[40:43], v[108:111]
 ds_read_b64_tr_b16 v[60:61], v7 offset:8192
 s_lshl2_add_u32 s84, s84, 39960576
 buffer_store_dword v91, off, s[8:11], s84 sc1
 v_mfma_f32_16x16x32_bf16 v[124:127], v[36:39], v[44:47], v[124:127]
 ds_read_b64_tr_b16 v[62:63], v7 offset:12288
 s_xor_b32 s86, s83, 1
 s_mul_i32 s86, s86, 8448
 s_add_u32 s86, s86, s87
 buffer_load_dwordx4 v[252:255], v0, s[8:11], s86 offen sc1
 v_mfma_f32_16x16x32_bf16 v[120:123], v[32:35], v[44:47], v[120:123]
 ds_read_b128 v[76:79], v2 offset:50176
 v_mfma_f32_16x16x32_bf16 v[116:119], v[28:31], v[44:47], v[116:119]
 ds_read_b64_tr_b16 v[64:65], v8 offset:8192
 v_mfma_f32_16x16x32_bf16 v[112:115], v[24:27], v[44:47], v[112:115]
 ds_read_b64_tr_b16 v[66:67], v8 offset:12288
 v_mfma_f32_16x16x32_bf16 v[128:131], v[24:27], v[48:51], v[128:131]
 ds_read_b128 v[80:83], v3 offset:49152
 s_xor_b32 s86, s83, 2
 s_mul_i32 s86, s86, 8448
 s_add_u32 s86, s86, s87
 buffer_load_dwordx4 v[212:215], v0, s[8:11], s86 offen sc1
 s_add_u32 m0, s51, 32768
 s_add_u32 s63, s39, 163840
 v_mfma_f32_16x16x32_bf16 v[132:135], v[28:31], v[48:51], v[132:135]
 ds_read_b64_tr_b16 v[68:69], v9 offset:8192
 buffer_load_dwordx4 v10, s[24:27], s63 offen lds
 v_mfma_f32_16x16x32_bf16 v[136:139], v[32:35], v[48:51], v[136:139]
 ds_read_b64_tr_b16 v[70:71], v9 offset:12288
 v_mfma_f32_16x16x32_bf16 v[140:143], v[36:39], v[48:51], v[140:143]
 ds_read_b128 v[84:87], v3 offset:50176
 s_xor_b32 s86, s83, 3
 s_mul_i32 s86, s86, 8448
 s_add_u32 s86, s86, s87
 v_mfma_f32_16x16x32_bf16 v[156:159], v[36:39], v[52:55], v[156:159]
 buffer_load_dwordx4 v[164:167], v0, s[8:11], s86 offen sc1
 v_mfma_f32_16x16x32_bf16 v[152:155], v[32:35], v[52:55], v[152:155]
 v_mfma_f32_16x16x32_bf16 v[148:151], v[28:31], v[52:55], v[148:151]
 v_mfma_f32_16x16x32_bf16 v[144:147], v[24:27], v[52:55], v[144:147]
 s_waitcnt vmcnt(16) lgkmcnt(0)
 s_barrier
 v_mfma_f32_16x16x32_bf16 v[96:99], v[56:59], v[72:75], v[96:99]
 ds_read_b128 v[40:43], v4 offset:0
 v_mfma_f32_16x16x32_bf16 v[100:103], v[60:63], v[72:75], v[100:103]
 ds_read_b64_tr_b16 v[24:25], v6 offset:16384
 v_mfma_f32_16x16x32_bf16 v[104:107], v[64:67], v[72:75], v[104:107]
 ds_read_b64_tr_b16 v[26:27], v6 offset:20480
 s_add_u32 m0, s50, 16384
 s_add_u32 s62, s41, 0
 v_mfma_f32_16x16x32_bf16 v[108:111], v[68:71], v[72:75], v[108:111]
 ds_read_b64_tr_b16 v[28:29], v7 offset:16384
 buffer_load_dwordx4 v13, s[8:11], s62 offen offset:0 sc1 lds
 v_mfma_f32_16x16x32_bf16 v[124:127], v[68:71], v[76:79], v[124:127]
 ds_read_b64_tr_b16 v[30:31], v7 offset:20480
 v_mfma_f32_16x16x32_bf16 v[120:123], v[64:67], v[76:79], v[120:123]
 ds_read_b128 v[44:47], v4 offset:1024
 v_mfma_f32_16x16x32_bf16 v[116:119], v[60:63], v[76:79], v[116:119]
 ds_read_b64_tr_b16 v[32:33], v8 offset:16384
 v_mfma_f32_16x16x32_bf16 v[112:115], v[56:59], v[76:79], v[112:115]
 ds_read_b64_tr_b16 v[34:35], v8 offset:20480
 buffer_load_dwordx4 v13, s[8:11], s62 offen offset:1024 sc1 lds
 v_mfma_f32_16x16x32_bf16 v[128:131], v[56:59], v[80:83], v[128:131]
 ds_read_b128 v[48:51], v5 offset:0
 v_mfma_f32_16x16x32_bf16 v[132:135], v[60:63], v[80:83], v[132:135]
 ds_read_b64_tr_b16 v[36:37], v9 offset:16384
 s_add_u32 m0, s51, 40960
 s_add_u32 s63, s33, 0
 v_mfma_f32_16x16x32_bf16 v[136:139], v[64:67], v[80:83], v[136:139]
 ds_read_b64_tr_b16 v[38:39], v9 offset:20480
 buffer_load_dwordx4 v10, s[24:27], s63 offen lds
 v_mfma_f32_16x16x32_bf16 v[140:143], v[68:71], v[80:83], v[140:143]
 ds_read_b128 v[52:55], v5 offset:1024
 v_mfma_f32_16x16x32_bf16 v[156:159], v[68:71], v[84:87], v[156:159]
 v_mfma_f32_16x16x32_bf16 v[152:155], v[64:67], v[84:87], v[152:155]
 s_add_u32 m0, s50, 32768
 s_add_u32 s62, s42, 0
 v_mfma_f32_16x16x32_bf16 v[148:151], v[60:63], v[84:87], v[148:151]
 buffer_load_dwordx4 v13, s[8:11], s62 offen offset:0 sc1 lds
 v_mfma_f32_16x16x32_bf16 v[144:147], v[56:59], v[84:87], v[144:147]
 s_waitcnt vmcnt(17) lgkmcnt(0)
 s_barrier
 v_mfma_f32_16x16x32_bf16 v[96:99], v[24:27], v[40:43], v[96:99]
 ds_read_b128 v[72:75], v4 offset:16384
 s_waitcnt vmcnt(12)
 v_add_f32 v192, v192, v248
 v_mfma_f32_16x16x32_bf16 v[100:103], v[28:31], v[40:43], v[100:103]
 ds_read_b64_tr_b16 v[56:57], v6 offset:24576
 v_add_f32 v193, v193, v249
 v_mfma_f32_16x16x32_bf16 v[104:107], v[32:35], v[40:43], v[104:107]
 ds_read_b64_tr_b16 v[58:59], v6 offset:28672
 v_add_f32 v194, v194, v250
 v_mfma_f32_16x16x32_bf16 v[108:111], v[36:39], v[40:43], v[108:111]
 ds_read_b64_tr_b16 v[60:61], v7 offset:24576
 buffer_load_dwordx4 v13, s[8:11], s62 offen offset:1024 sc1 lds
 v_add_f32 v195, v195, v251
 v_mfma_f32_16x16x32_bf16 v[124:127], v[36:39], v[44:47], v[124:127]
 ds_read_b64_tr_b16 v[62:63], v7 offset:28672
 s_waitcnt vmcnt(11)
 v_mfma_f32_16x16x32_bf16 v[120:123], v[32:35], v[44:47], v[120:123]
 ds_read_b128 v[76:79], v4 offset:17408
 v_add_f32 v196, v196, v200
 v_add_f32 v197, v197, v201
 v_mfma_f32_16x16x32_bf16 v[116:119], v[28:31], v[44:47], v[116:119]
 ds_read_b64_tr_b16 v[64:65], v8 offset:24576
 v_add_f32 v198, v198, v202
 s_add_u32 m0, s51, 0
 s_add_u32 s63, s34, 0
 v_mfma_f32_16x16x32_bf16 v[112:115], v[24:27], v[44:47], v[112:115]
 ds_read_b64_tr_b16 v[66:67], v8 offset:28672
 buffer_load_dwordx4 v10, s[24:27], s63 offen lds
 v_add_f32 v199, v199, v203
 v_mfma_f32_16x16x32_bf16 v[128:131], v[24:27], v[48:51], v[128:131]
 ds_read_b128 v[80:83], v5 offset:16384
 s_waitcnt vmcnt(11)
 v_mfma_f32_16x16x32_bf16 v[132:135], v[28:31], v[48:51], v[132:135]
 ds_read_b64_tr_b16 v[68:69], v9 offset:24576
 v_add_f32 v192, v192, v204
 s_add_u32 m0, s50, 49152
 s_add_u32 s62, s43, 0
 v_mfma_f32_16x16x32_bf16 v[136:139], v[32:35], v[48:51], v[136:139]
 ds_read_b64_tr_b16 v[70:71], v9 offset:28672
 buffer_load_dwordx4 v13, s[8:11], s62 offen offset:0 sc1 lds
 v_add_f32 v193, v193, v205
 v_add_f32 v194, v194, v206
 v_mfma_f32_16x16x32_bf16 v[140:143], v[36:39], v[48:51], v[140:143]
 ds_read_b128 v[84:87], v5 offset:17408
 v_add_f32 v195, v195, v207
 v_mfma_f32_16x16x32_bf16 v[156:159], v[36:39], v[52:55], v[156:159]
 v_add_f32 v192, v192, v196
 v_mfma_f32_16x16x32_bf16 v[152:155], v[32:35], v[52:55], v[152:155]
 v_add_f32 v193, v193, v197
 v_mfma_f32_16x16x32_bf16 v[148:151], v[28:31], v[52:55], v[148:151]
 buffer_load_dwordx4 v13, s[8:11], s62 offen offset:1024 sc1 lds
 v_add_f32 v194, v194, v198
 v_mfma_f32_16x16x32_bf16 v[144:147], v[24:27], v[52:55], v[144:147]
 v_add_f32 v195, v195, v199
 s_waitcnt vmcnt(9) lgkmcnt(0)
 s_barrier
 v_mfma_f32_16x16x32_bf16 v[96:99], v[56:59], v[72:75], v[96:99]
 ds_read_b128 v[40:43], v2 offset:0
 s_waitcnt vmcnt(10)
 v_add_f32 v252, v252, v212
 v_mfma_f32_16x16x32_bf16 v[100:103], v[60:63], v[72:75], v[100:103]
 ds_read_b64_tr_b16 v[24:25], v6 offset:32768
 v_add_f32 v253, v253, v213
 v_add_f32 v254, v254, v214
 v_mfma_f32_16x16x32_bf16 v[104:107], v[64:67], v[72:75], v[104:107]
 ds_read_b64_tr_b16 v[26:27], v6 offset:36864
 v_add_f32 v255, v255, v215
 s_waitcnt vmcnt(8)
 s_add_u32 m0, s51, 8192
 s_add_u32 s63, s35, 0
 v_mfma_f32_16x16x32_bf16 v[108:111], v[68:71], v[72:75], v[108:111]
 ds_read_b64_tr_b16 v[28:29], v7 offset:32768
 buffer_load_dwordx4 v10, s[24:27], s63 offen lds
 v_add_f32 v192, v192, v164
 v_mfma_f32_16x16x32_bf16 v[124:127], v[68:71], v[76:79], v[124:127]
 ds_read_b64_tr_b16 v[30:31], v7 offset:36864
 v_add_f32 v193, v193, v165
 v_add_f32 v194, v194, v166
 v_mfma_f32_16x16x32_bf16 v[120:123], v[64:67], v[76:79], v[120:123]
 ds_read_b128 v[44:47], v2 offset:1024
 v_add_f32 v195, v195, v167
 v_add_f32 v192, v192, v252
 v_mfma_f32_16x16x32_bf16 v[116:119], v[60:63], v[76:79], v[116:119]
 ds_read_b64_tr_b16 v[32:33], v8 offset:32768
 v_add_f32 v193, v193, v253
 v_add_f32 v194, v194, v254
 s_add_u32 m0, s50, 65536
 s_add_u32 s62, s44, 0
 v_mfma_f32_16x16x32_bf16 v[112:115], v[56:59], v[76:79], v[112:115]
 ds_read_b64_tr_b16 v[34:35], v8 offset:36864
 buffer_load_dwordx4 v13, s[8:11], s62 offen offset:0 sc1 lds
 v_add_f32 v195, v195, v255
 v_mfma_f32_16x16x32_bf16 v[128:131], v[56:59], v[80:83], v[128:131]
 ds_read_b128 v[48:51], v3 offset:0
 s_lshr_b32 s85, s7, 1
 s_lshl_b32 s85, s85, 11
 s_and_b32 s86, s7, 1
 s_lshl3_add_u32 s85, s86, s85
 s_add_u32 s85, s85, 149504
 v_add_u32 v94, s85, v0
 v_cvt_pk_bf16_f32 v192, v192, v193
 v_mfma_f32_16x16x32_bf16 v[132:135], v[60:63], v[80:83], v[132:135]
 ds_read_b64_tr_b16 v[36:37], v9 offset:32768
 v_cvt_pk_bf16_f32 v193, v194, v195
 ds_write_b64 v94, v[192:193]
 v_mfma_f32_16x16x32_bf16 v[136:139], v[64:67], v[80:83], v[136:139]
 ds_read_b64_tr_b16 v[38:39], v9 offset:36864
 buffer_load_dwordx4 v13, s[8:11], s62 offen offset:1024 sc1 lds
 v_add_f32 v92, v92, v93
 v_mov_b32 v93, v92
 v_mfma_f32_16x16x32_bf16 v[140:143], v[68:71], v[80:83], v[140:143]
 ds_read_b128 v[52:55], v3 offset:1024
 v_permlane32_swap_b32 v92, v93
 v_mfma_f32_16x16x32_bf16 v[156:159], v[68:71], v[84:87], v[156:159]
 v_add_f32 v92, v92, v93
 v_mov_b32 v93, v92
 v_mfma_f32_16x16x32_bf16 v[152:155], v[64:67], v[84:87], v[152:155]
 s_nop 0
 v_permlane16_swap_b32 v92, v93
 v_add_f32 v92, v92, v93
 s_add_u32 m0, s51, 16384
 s_add_u32 s63, s36, 0
 v_mfma_f32_16x16x32_bf16 v[148:151], v[60:63], v[84:87], v[148:151]
 buffer_load_dwordx4 v10, s[24:27], s63 offen lds
 v_cvt_pk_bf16_f32 v92, v92, v92
 s_lshl_b32 s85, s7, 5
 s_add_u32 s85, s85, 153600
 v_lshl_add_u32 v95, v95, 1, s85
 v_mfma_f32_16x16x32_bf16 v[144:147], v[56:59], v[84:87], v[144:147]
 ds_write_b16 v95, v92
 s_waitcnt vmcnt(9) lgkmcnt(0)
 s_barrier
 v_mfma_f32_16x16x32_bf16 v[96:99], v[24:27], v[40:43], v[96:99]
 ds_read_b128 v[72:75], v2 offset:16384
 v_and_b32 v94, 15, v1
 v_mfma_f32_16x16x32_bf16 v[100:103], v[28:31], v[40:43], v[100:103]
 ds_read_b64_tr_b16 v[56:57], v6 offset:40960
 v_mfma_f32_16x16x32_bf16 v[104:107], v[32:35], v[40:43], v[104:107]
 ds_read_b64_tr_b16 v[58:59], v6 offset:45056
 v_lshlrev_b32 v94, 11, v94
 v_mfma_f32_16x16x32_bf16 v[108:111], v[36:39], v[40:43], v[108:111]
 ds_read_b64_tr_b16 v[60:61], v7 offset:40960
 v_mfma_f32_16x16x32_bf16 v[124:127], v[36:39], v[44:47], v[124:127]
 ds_read_b64_tr_b16 v[62:63], v7 offset:45056
 v_bfe_u32 v92, v1, 4, 1
 s_add_u32 m0, s50, 81920
 s_add_u32 s62, s45, 0
 v_mfma_f32_16x16x32_bf16 v[120:123], v[32:35], v[44:47], v[120:123]
 ds_read_b128 v[76:79], v2 offset:17408
 buffer_load_dwordx4 v13, s[8:11], s62 offen offset:0 sc1 lds
 v_mfma_f32_16x16x32_bf16 v[116:119], v[28:31], v[44:47], v[116:119]
 ds_read_b64_tr_b16 v[64:65], v8 offset:40960
 v_lshl_add_u32 v94, v92, 5, v94
 v_mfma_f32_16x16x32_bf16 v[112:115], v[24:27], v[44:47], v[112:115]
 ds_read_b64_tr_b16 v[66:67], v8 offset:45056
 v_mfma_f32_16x16x32_bf16 v[128:131], v[24:27], v[48:51], v[128:131]
 ds_read_b128 v[80:83], v3 offset:16384
 v_lshrrev_b32 v92, 5, v1
 v_mfma_f32_16x16x32_bf16 v[132:135], v[28:31], v[48:51], v[132:135]
 ds_read_b64_tr_b16 v[68:69], v9 offset:40960
 v_mfma_f32_16x16x32_bf16 v[136:139], v[32:35], v[48:51], v[136:139]
 ds_read_b64_tr_b16 v[70:71], v9 offset:45056
 v_lshl_add_u32 v94, v92, 4, v94
 v_mfma_f32_16x16x32_bf16 v[140:143], v[36:39], v[48:51], v[140:143]
 ds_read_b128 v[84:87], v3 offset:17408
 v_mfma_f32_16x16x32_bf16 v[156:159], v[36:39], v[52:55], v[156:159]
 buffer_load_dwordx4 v13, s[8:11], s62 offen offset:1024 sc1 lds
 buffer_load_dwordx4 v[184:187], v94, s[16:19], s61 offen
 v_mfma_f32_16x16x32_bf16 v[152:155], v[32:35], v[52:55], v[152:155]
 v_mfma_f32_16x16x32_bf16 v[148:151], v[28:31], v[52:55], v[148:151]
 buffer_load_dwordx4 v[188:191], v94, s[16:19], s66 offen
 v_mfma_f32_16x16x32_bf16 v[144:147], v[24:27], v[52:55], v[144:147]
 s_waitcnt vmcnt(10) lgkmcnt(0)
 s_barrier
 v_mfma_f32_16x16x32_bf16 v[96:99], v[56:59], v[72:75], v[96:99]
 ds_read_b128 v[40:43], v2 offset:32768
 v_mfma_f32_16x16x32_bf16 v[100:103], v[60:63], v[72:75], v[100:103]
 ds_read_b64_tr_b16 v[24:25], v6 offset:0
 v_mfma_f32_16x16x32_bf16 v[104:107], v[64:67], v[72:75], v[104:107]
 ds_read_b64_tr_b16 v[26:27], v6 offset:4096
 s_add_u32 m0, s51, 24576
 s_add_u32 s63, s37, 0
 v_mfma_f32_16x16x32_bf16 v[108:111], v[68:71], v[72:75], v[108:111]
 ds_read_b64_tr_b16 v[28:29], v7 offset:0
 buffer_load_dwordx4 v10, s[24:27], s63 offen lds
 v_mfma_f32_16x16x32_bf16 v[124:127], v[68:71], v[76:79], v[124:127]
 ds_read_b64_tr_b16 v[30:31], v7 offset:4096
 v_mfma_f32_16x16x32_bf16 v[120:123], v[64:67], v[76:79], v[120:123]
 ds_read_b128 v[44:47], v2 offset:33792
 v_mfma_f32_16x16x32_bf16 v[116:119], v[60:63], v[76:79], v[116:119]
 ds_read_b64_tr_b16 v[32:33], v8 offset:0
 s_add_u32 m0, s50, 0
 s_add_u32 s62, s46, 0
 v_mfma_f32_16x16x32_bf16 v[112:115], v[56:59], v[76:79], v[112:115]
 ds_read_b64_tr_b16 v[34:35], v8 offset:4096
 buffer_load_dwordx4 v13, s[8:11], s62 offen offset:0 sc1 lds
 v_mfma_f32_16x16x32_bf16 v[128:131], v[56:59], v[80:83], v[128:131]
 ds_read_b128 v[48:51], v3 offset:32768
 v_mfma_f32_16x16x32_bf16 v[132:135], v[60:63], v[80:83], v[132:135]
 ds_read_b64_tr_b16 v[36:37], v9 offset:0
 v_mfma_f32_16x16x32_bf16 v[136:139], v[64:67], v[80:83], v[136:139]
 ds_read_b64_tr_b16 v[38:39], v9 offset:4096
 buffer_load_dwordx4 v13, s[8:11], s62 offen offset:1024 sc1 lds
 v_mfma_f32_16x16x32_bf16 v[140:143], v[68:71], v[80:83], v[140:143]
 ds_read_b128 v[52:55], v3 offset:33792
 v_mfma_f32_16x16x32_bf16 v[156:159], v[68:71], v[84:87], v[156:159]
 v_mfma_f32_16x16x32_bf16 v[152:155], v[64:67], v[84:87], v[152:155]
 s_add_u32 m0, s51, 32768
 s_add_u32 s63, s38, 0
 v_mfma_f32_16x16x32_bf16 v[148:151], v[60:63], v[84:87], v[148:151]
 buffer_load_dwordx4 v10, s[24:27], s63 offen lds
 v_mfma_f32_16x16x32_bf16 v[144:147], v[56:59], v[84:87], v[144:147]
 s_waitcnt vmcnt(11) lgkmcnt(0)
 s_barrier
 v_mfma_f32_16x16x32_bf16 v[96:99], v[24:27], v[40:43], v[96:99]
 ds_read_b128 v[72:75], v2 offset:49152
 v_mfma_f32_16x16x32_bf16 v[100:103], v[28:31], v[40:43], v[100:103]
 ds_read_b64_tr_b16 v[56:57], v6 offset:8192
 v_mfma_f32_16x16x32_bf16 v[104:107], v[32:35], v[40:43], v[104:107]
 ds_read_b64_tr_b16 v[58:59], v6 offset:12288
 s_add_u32 m0, s50, 16384
 s_add_u32 s62, s47, 0
 v_mfma_f32_16x16x32_bf16 v[108:111], v[36:39], v[40:43], v[108:111]
 ds_read_b64_tr_b16 v[60:61], v7 offset:8192
 buffer_load_dwordx4 v13, s[8:11], s62 offen offset:0 sc1 lds
 s_andn2_b32 s64, s2, 7
 v_mfma_f32_16x16x32_bf16 v[124:127], v[36:39], v[44:47], v[124:127]
 ds_read_b64_tr_b16 v[62:63], v7 offset:12288
 s_lshl4_add_u32 s64, s64, 39960576
 s_buffer_load_dwordx8 s[72:79], s[8:11], s64 glc
 v_mfma_f32_16x16x32_bf16 v[120:123], v[32:35], v[44:47], v[120:123]
 ds_read_b128 v[76:79], v2 offset:50176
 v_mfma_f32_16x16x32_bf16 v[116:119], v[28:31], v[44:47], v[116:119]
 ds_read_b64_tr_b16 v[64:65], v8 offset:8192
 v_mfma_f32_16x16x32_bf16 v[112:115], v[24:27], v[44:47], v[112:115]
 ds_read_b64_tr_b16 v[66:67], v8 offset:12288
 buffer_load_dwordx4 v13, s[8:11], s62 offen offset:1024 sc1 lds
 v_mfma_f32_16x16x32_bf16 v[128:131], v[24:27], v[48:51], v[128:131]
 ds_read_b128 v[80:83], v3 offset:49152
 v_mfma_f32_16x16x32_bf16 v[132:135], v[28:31], v[48:51], v[132:135]
 ds_read_b64_tr_b16 v[68:69], v9 offset:8192
 s_add_u32 m0, s51, 40960
 s_add_u32 s63, s39, 0
 v_mfma_f32_16x16x32_bf16 v[136:139], v[32:35], v[48:51], v[136:139]
 ds_read_b64_tr_b16 v[70:71], v9 offset:12288
 buffer_load_dwordx4 v10, s[24:27], s63 offen lds
 v_mfma_f32_16x16x32_bf16 v[140:143], v[36:39], v[48:51], v[140:143]
 ds_read_b128 v[84:87], v3 offset:50176
 ds_read_b32 v90, v0
 ds_read_b32 v90, v0
 v_mfma_f32_16x16x32_bf16 v[156:159], v[36:39], v[52:55], v[156:159]
 v_mfma_f32_16x16x32_bf16 v[152:155], v[32:35], v[52:55], v[152:155]
 s_add_u32 m0, s50, 32768
 s_add_u32 s62, s6, 0
 s_and_b32 s62, s62, 3
 s_mul_i32 s62, s62, 16384
 s_add_u32 s62, s62, s56
 v_mfma_f32_16x16x32_bf16 v[148:151], v[28:31], v[52:55], v[148:151]
 buffer_load_dwordx4 v13, s[8:11], s62 offen offset:0 sc1 lds
 v_mfma_f32_16x16x32_bf16 v[144:147], v[24:27], v[52:55], v[144:147]
 s_waitcnt vmcnt(12) lgkmcnt(2)
 s_barrier
 v_mfma_f32_16x16x32_bf16 v[96:99], v[56:59], v[72:75], v[96:99]
 ds_read_b128 v[40:43], v4 offset:0
 v_mfma_f32_16x16x32_bf16 v[100:103], v[60:63], v[72:75], v[100:103]
 ds_read_b64_tr_b16 v[24:25], v6 offset:16384
 v_mfma_f32_16x16x32_bf16 v[104:107], v[64:67], v[72:75], v[104:107]
 ds_read_b64_tr_b16 v[26:27], v6 offset:20480
 v_mfma_f32_16x16x32_bf16 v[108:111], v[68:71], v[72:75], v[108:111]
 ds_read_b64_tr_b16 v[28:29], v7 offset:16384
 buffer_load_dwordx4 v13, s[8:11], s62 offen offset:1024 sc1 lds
 v_mfma_f32_16x16x32_bf16 v[124:127], v[68:71], v[76:79], v[124:127]
 ds_read_b64_tr_b16 v[30:31], v7 offset:20480
 v_mfma_f32_16x16x32_bf16 v[120:123], v[64:67], v[76:79], v[120:123]
 ds_read_b128 v[44:47], v4 offset:1024
 v_mfma_f32_16x16x32_bf16 v[116:119], v[60:63], v[76:79], v[116:119]
 ds_read_b64_tr_b16 v[32:33], v8 offset:16384
 s_add_u32 m0, s51, 0
 s_add_u32 s63, s6, 0
 s_and_b32 s63, s63, 3
 s_mul_i32 s63, s63, 458752
 s_add_u32 s63, s63, s59
 v_mfma_f32_16x16x32_bf16 v[112:115], v[56:59], v[76:79], v[112:115]
 ds_read_b64_tr_b16 v[34:35], v8 offset:20480
 buffer_load_dwordx4 v10, s[24:27], s63 offen lds
 v_mfma_f32_16x16x32_bf16 v[128:131], v[56:59], v[80:83], v[128:131]
 ds_read_b128 v[48:51], v5 offset:0
 v_mfma_f32_16x16x32_bf16 v[132:135], v[60:63], v[80:83], v[132:135]
 ds_read_b64_tr_b16 v[36:37], v9 offset:16384
 s_add_u32 m0, s50, 49152
 s_add_u32 s62, s6, 1
 s_and_b32 s62, s62, 3
 s_mul_i32 s62, s62, 16384
 s_add_u32 s62, s62, s56
 v_mfma_f32_16x16x32_bf16 v[136:139], v[64:67], v[80:83], v[136:139]
 ds_read_b64_tr_b16 v[38:39], v9 offset:20480
 buffer_load_dwordx4 v13, s[8:11], s62 offen offset:0 sc1 lds
 v_mfma_f32_16x16x32_bf16 v[140:143], v[68:71], v[80:83], v[140:143]
 ds_read_b128 v[52:55], v5 offset:1024
 v_mfma_f32_16x16x32_bf16 v[156:159], v[68:71], v[84:87], v[156:159]
 v_mfma_f32_16x16x32_bf16 v[152:155], v[64:67], v[84:87], v[152:155]
 v_mfma_f32_16x16x32_bf16 v[148:151], v[60:63], v[84:87], v[148:151]
 buffer_load_dwordx4 v13, s[8:11], s62 offen offset:1024 sc1 lds
 v_mfma_f32_16x16x32_bf16 v[144:147], v[56:59], v[84:87], v[144:147]
 s_waitcnt lgkmcnt(0)
 s_and_b64 s[96:97], s[72:73], s[74:75]
 s_and_b64 s[80:81], s[76:77], s[78:79]
 s_and_b64 s[96:97], s[96:97], s[80:81]
 s_bitcmp1_b32 s2, 0
 s_cselect_b32 s96, s97, s96
 s_bitcmp1_b32 s96, 0
 s_cbranch_scc0 Lsp_72
Lok_73:
 s_waitcnt vmcnt(11) lgkmcnt(0)
 s_barrier
 v_mfma_f32_16x16x32_bf16 v[96:99], v[24:27], v[40:43], v[96:99]
 ds_read_b128 v[72:75], v4 offset:16384
 s_bitcmp1_b32 s2, 0
 s_cselect_b32 s72, s73, s72
 s_cselect_b32 s74, s75, s74
 s_cselect_b32 s76, s77, s76
 s_cselect_b32 s78, s79, s78
 s_sub_u32 s78, s78, s72
 s_sub_u32 s76, s76, s72
 v_mfma_f32_16x16x32_bf16 v[100:103], v[28:31], v[40:43], v[100:103]
 ds_read_b64_tr_b16 v[56:57], v6 offset:24576
 s_sub_u32 s74, s74, s72
 s_sub_u32 s72, s72, s72
 v_mfma_f32_16x16x32_bf16 v[104:107], v[32:35], v[40:43], v[104:107]
 ds_read_b64_tr_b16 v[58:59], v6 offset:28672
 s_lshl2_add_u32 s72, s72, 0
 s_lshl2_add_u32 s74, s74, 1
 s_lshl2_add_u32 s76, s76, 2
 s_add_u32 m0, s51, 8192
 s_add_u32 s63, s6, 1
 s_and_b32 s63, s63, 3
 s_mul_i32 s63, s63, 458752
 s_add_u32 s63, s63, s59
 v_mfma_f32_16x16x32_bf16 v[108:111], v[36:39], v[40:43], v[108:111]
 ds_read_b64_tr_b16 v[60:61], v7 offset:24576
 buffer_load_dwordx4 v10, s[24:27], s63 offen lds
 s_lshl2_add_u32 s78, s78, 3
 s_min_i32 s73, s72, s74
 v_mfma_f32_16x16x32_bf16 v[124:127], v[36:39], v[44:47], v[124:127]
 ds_read_b64_tr_b16 v[62:63], v7 offset:28672
 s_max_i32 s74, s72, s74
 s_min_i32 s72, s76, s78
 s_max_i32 s78, s76, s78
 v_mfma_f32_16x16x32_bf16 v[120:123], v[32:35], v[44:47], v[120:123]
 ds_read_b128 v[76:79], v4 offset:17408
 s_min_i32 s76, s73, s72
 s_max_i32 s72, s73, s72
 v_mfma_f32_16x16x32_bf16 v[116:119], v[28:31], v[44:47], v[116:119]
 ds_read_b64_tr_b16 v[64:65], v8 offset:24576
 s_min_i32 s73, s74, s78
 s_max_i32 s78, s74, s78
 s_min_i32 s74, s73, s72
 s_add_u32 m0, s50, 65536
 s_add_u32 s62, s6, 2
 s_and_b32 s62, s62, 3
 s_mul_i32 s62, s62, 16384
 s_add_u32 s62, s62, s56
 v_mfma_f32_16x16x32_bf16 v[112:115], v[24:27], v[44:47], v[112:115]
 ds_read_b64_tr_b16 v[66:67], v8 offset:28672
 buffer_load_dwordx4 v13, s[8:11], s62 offen offset:0 sc1 lds
 s_max_i32 s72, s73, s72
 s_mov_b32 s80, 0x08080808
 v_mfma_f32_16x16x32_bf16 v[128:131], v[24:27], v[48:51], v[128:131]
 ds_read_b128 v[80:83], v5 offset:16384
 s_sub_u32 s73, s72, 240
 s_add_u32 s75, s74, 240
 s_sub_u32 s84, s78, 240
 v_mfma_f32_16x16x32_bf16 v[132:135], v[28:31], v[48:51], v[132:135]
 ds_read_b64_tr_b16 v[68:69], v9 offset:24576
 s_add_u32 s96, s76, 240
 s_max_i32 s77, s84, s72
 v_mfma_f32_16x16x32_bf16 v[136:139], v[32:35], v[48:51], v[136:139]
 ds_read_b64_tr_b16 v[70:71], v9 offset:28672
 buffer_load_dwordx4 v13, s[8:11], s62 offen offset:1024 sc1 lds
 s_min_i32 s72, s84, s72
 s_min_i32 s79, s96, s74
 s_max_i32 s74, s96, s74
 v_mfma_f32_16x16x32_bf16 v[140:143], v[36:39], v[48:51], v[140:143]
 ds_read_b128 v[84:87], v5 offset:17408
 s_lshl_b32 s76, s76, 3
 s_lshl_b32 s76, 4, s76
 v_mfma_f32_16x16x32_bf16 v[156:159], v[36:39], v[52:55], v[156:159]
 s_sub_u32 s80, s80, s76
 s_lshl_b32 s79, s79, 3
 s_lshl_b32 s79, 4, s79
 v_mfma_f32_16x16x32_bf16 v[152:155], v[32:35], v[52:55], v[152:155]
 s_sub_u32 s80, s80, s79
 s_sub_u32 s84, s78, s74
 s_add_u32 m0, s51, 16384
 s_add_u32 s63, s6, 2
 s_and_b32 s63, s63, 3
 s_mul_i32 s63, s63, 458752
 s_add_u32 s63, s63, s59
 v_mfma_f32_16x16x32_bf16 v[148:151], v[28:31], v[52:55], v[148:151]
 buffer_load_dwordx4 v10, s[24:27], s63 offen lds
 s_cmp_gt_i32 s84, 288
 s_cselect_b32 s96, 4, 0
 s_lshl_b32 s78, s78, 3
 s_lshl_b32 s78, s96, s78
 v_mfma_f32_16x16x32_bf16 v[144:147], v[24:27], v[52:55], v[144:147]
 s_add_u32 s80, s80, s78
 s_lshl_b32 s74, s74, 3
 s_waitcnt vmcnt(12) lgkmcnt(0)
 s_barrier
 v_mfma_f32_16x16x32_bf16 v[96:99], v[56:59], v[72:75], v[96:99]
 ds_read_b128 v[40:43], v2 offset:0
 s_lshl_b32 s74, s96, s74
 s_sub_u32 s80, s80, s74
 s_sub_u32 s84, s77, s75
 v_mfma_f32_16x16x32_bf16 v[100:103], v[60:63], v[72:75], v[100:103]
 ds_read_b64_tr_b16 v[24:25], v6 offset:32768
 s_cmp_gt_i32 s84, 288
 s_cselect_b32 s96, 4, 0
 s_lshl_b32 s77, s77, 3
 s_lshl_b32 s77, s96, s77
 v_mfma_f32_16x16x32_bf16 v[104:107], v[64:67], v[72:75], v[104:107]
 ds_read_b64_tr_b16 v[26:27], v6 offset:36864
 s_add_u32 s80, s80, s77
 s_lshl_b32 s75, s75, 3
 v_mfma_f32_16x16x32_bf16 v[108:111], v[68:71], v[72:75], v[108:111]
 ds_read_b64_tr_b16 v[28:29], v7 offset:32768
 s_lshl_b32 s75, s96, s75
 s_sub_u32 s80, s80, s75
 s_xor_b32 s84, s4, 1
 s_add_u32 m0, s50, 81920
 s_add_u32 s62, s6, 3
 s_and_b32 s62, s62, 3
 s_mul_i32 s62, s62, 16384
 s_add_u32 s62, s62, s56
 v_mfma_f32_16x16x32_bf16 v[124:127], v[68:71], v[76:79], v[124:127]
 ds_read_b64_tr_b16 v[30:31], v7 offset:36864
 buffer_load_dwordx4 v13, s[8:11], s62 offen offset:0 sc1 lds
 s_lshl3_add_u32 s84, s84, 0x80000
 s_bfe_u32 s84, s80, s84
 v_mfma_f32_16x16x32_bf16 v[120:123], v[64:67], v[76:79], v[120:123]
 ds_read_b128 v[44:47], v2 offset:1024
 s_sub_u32 s96, 16, s84
 s_lshr_b32 s52, 0x7654, s96
 s_mov_b32 s81, s84
 v_mfma_f32_16x16x32_bf16 v[116:119], v[60:63], v[76:79], v[116:119]
 ds_read_b64_tr_b16 v[32:33], v8 offset:32768
 s_xor_b32 s84, s4, 2
 s_lshl3_add_u32 s84, s84, 0x80000
 v_mfma_f32_16x16x32_bf16 v[112:115], v[56:59], v[76:79], v[112:115]
 ds_read_b64_tr_b16 v[34:35], v8 offset:36864
 s_bfe_u32 s84, s80, s84
 s_sub_u32 s96, 16, s84
 s_lshr_b32 s96, 0xba98, s96
 v_mfma_f32_16x16x32_bf16 v[128:131], v[56:59], v[80:83], v[128:131]
 ds_read_b128 v[48:51], v3 offset:0
 s_lshl_b32 s96, s96, s81
 s_or_b32 s52, s52, s96
 s_add_u32 s81, s81, s84
 v_mfma_f32_16x16x32_bf16 v[132:135], v[60:63], v[80:83], v[132:135]
 ds_read_b64_tr_b16 v[36:37], v9 offset:32768
 buffer_load_dwordx4 v13, s[8:11], s62 offen offset:1024 sc1 lds
 s_xor_b32 s84, s4, 3
 s_lshl3_add_u32 s84, s84, 0x80000
 v_mfma_f32_16x16x32_bf16 v[136:139], v[64:67], v[80:83], v[136:139]
 ds_read_b64_tr_b16 v[38:39], v9 offset:36864
 s_bfe_u32 s84, s80, s84
 s_sub_u32 s96, 16, s84
 s_lshr_b32 s96, 0xfedc, s96
 v_mfma_f32_16x16x32_bf16 v[140:143], v[68:71], v[80:83], v[140:143]
 ds_read_b128 v[52:55], v3 offset:1024
 s_lshl_b32 s96, s96, s81
 s_or_b32 s52, s52, s96
 v_mfma_f32_16x16x32_bf16 v[156:159], v[68:71], v[84:87], v[156:159]
 s_add_u32 s81, s81, s84
 s_mul_i32 s84, s5, s81
 s_lshr_b32 s84, s84, 3
 s_add_u32 m0, s51, 24576
 s_add_u32 s63, s6, 3
 s_and_b32 s63, s63, 3
 s_mul_i32 s63, s63, 458752
 s_add_u32 s63, s63, s59
 v_mfma_f32_16x16x32_bf16 v[152:155], v[64:67], v[84:87], v[152:155]
 buffer_load_dwordx4 v10, s[24:27], s63 offen lds
 s_andn2_b32 s84, s84, 3
 s_lshr_b32 s96, s52, s84
 v_mfma_f32_16x16x32_bf16 v[148:151], v[60:63], v[84:87], v[148:151]
 s_sub_u32 s84, s81, s84
 s_lshl_b32 s52, s52, s84
 s_or_b32 s52, s52, s96
 v_mfma_f32_16x16x32_bf16 v[144:147], v[56:59], v[84:87], v[144:147]
 s_lshl_b32 s84, s6, 2
 s_mul_i32 s96, s4, 0x44444444
L5_f0:
 s_cmp_eq_u32 s81, 12
 s_cbranch_scc1 L5_v03
 s_cmp_eq_u32 s81, 8
 s_cbranch_scc1 L5_v04
 s_cmp_eq_u32 s81, 20
 s_cbranch_scc1 L5_v01
 s_cmp_eq_u32 s81, 24
 s_cbranch_scc1 L5_v00
 s_lshl_b32 s52, s52, 8
 s_lshr_b32 s84, 0x32323232, s84
 s_and_b32 s84, s84, 0xff
 s_or_b32 s52, s52, s84
 s_xor_b32 s52, s52, s96
 s_waitcnt vmcnt(12) lgkmcnt(0)
 s_barrier
 v_mfma_f32_16x16x32_bf16 v[96:99], v[24:27], v[40:43], v[96:99]
 ds_read_b128 v[72:75], v2 offset:16384
 v_mfma_f32_16x16x32_bf16 v[100:103], v[28:31], v[40:43], v[100:103]
 ds_read_b64_tr_b16 v[56:57], v6 offset:40960
 v_mfma_f32_16x16x32_bf16 v[104:107], v[32:35], v[40:43], v[104:107]
 ds_read_b64_tr_b16 v[58:59], v6 offset:45056
 v_mfma_f32_16x16x32_bf16 v[108:111], v[36:39], v[40:43], v[108:111]
 ds_read_b64_tr_b16 v[60:61], v7 offset:40960
 v_mfma_f32_16x16x32_bf16 v[124:127], v[36:39], v[44:47], v[124:127]
 ds_read_b64_tr_b16 v[62:63], v7 offset:45056
 v_mfma_f32_16x16x32_bf16 v[120:123], v[32:35], v[44:47], v[120:123]
 ds_read_b128 v[76:79], v2 offset:17408
 v_mfma_f32_16x16x32_bf16 v[116:119], v[28:31], v[44:47], v[116:119]
 ds_read_b64_tr_b16 v[64:65], v8 offset:40960
 v_mfma_f32_16x16x32_bf16 v[112:115], v[24:27], v[44:47], v[112:115]
 ds_read_b64_tr_b16 v[66:67], v8 offset:45056
 v_mfma_f32_16x16x32_bf16 v[128:131], v[24:27], v[48:51], v[128:131]
 ds_read_b128 v[80:83], v3 offset:16384
 s_add_u32 m0, s51, 32768
 s_add_u32 s63, s6, 0
 s_and_b32 s63, s63, 3
 s_mul_i32 s63, s63, 65536
 s_add_u32 s63, s63, s65
 v_mfma_f32_16x16x32_bf16 v[132:135], v[28:31], v[48:51], v[132:135]
 ds_read_b64_tr_b16 v[68:69], v9 offset:40960
 buffer_load_dwordx4 v10, s[20:23], s63 offen lds
 v_mfma_f32_16x16x32_bf16 v[136:139], v[32:35], v[48:51], v[136:139]
 ds_read_b64_tr_b16 v[70:71], v9 offset:45056
 v_mfma_f32_16x16x32_bf16 v[140:143], v[36:39], v[48:51], v[140:143]
 ds_read_b128 v[84:87], v3 offset:17408
 v_mfma_f32_16x16x32_bf16 v[156:159], v[36:39], v[52:55], v[156:159]
 v_mfma_f32_16x16x32_bf16 v[152:155], v[32:35], v[52:55], v[152:155]
 v_mfma_f32_16x16x32_bf16 v[148:151], v[28:31], v[52:55], v[148:151]
 v_mfma_f32_16x16x32_bf16 v[144:147], v[24:27], v[52:55], v[144:147]
 s_waitcnt vmcnt(10) lgkmcnt(0)
 s_barrier
 v_mfma_f32_16x16x32_bf16 v[96:99], v[56:59], v[72:75], v[96:99]
 ds_read_b128 v[40:43], v2 offset:32768
 v_mfma_f32_16x16x32_bf16 v[100:103], v[60:63], v[72:75], v[100:103]
 ds_read_b64_tr_b16 v[24:25], v6 offset:0
 v_mfma_f32_16x16x32_bf16 v[104:107], v[64:67], v[72:75], v[104:107]
 ds_read_b64_tr_b16 v[26:27], v6 offset:4096
 v_mfma_f32_16x16x32_bf16 v[108:111], v[68:71], v[72:75], v[108:111]
 ds_read_b64_tr_b16 v[28:29], v7 offset:0
 v_mfma_f32_16x16x32_bf16 v[124:127], v[68:71], v[76:79], v[124:127]
 ds_read_b64_tr_b16 v[30:31], v7 offset:4096
 s_lshl2_add_u32 s64, s83, s4
 v_mfma_f32_16x16x32_bf16 v[120:123], v[64:67], v[76:79], v[120:123]
 ds_read_b128 v[44:47], v2 offset:33792
 s_lshl2_add_u32 s64, s64, s7
 s_lshl_b32 s64, s64, 7
 v_mfma_f32_16x16x32_bf16 v[116:119], v[60:63], v[76:79], v[116:119]
 ds_read_b64_tr_b16 v[32:33], v8 offset:0
 s_add_u32 s64, s64, 39927808
 v_mfma_f32_16x16x32_bf16 v[112:115], v[56:59], v[76:79], v[112:115]
 ds_read_b64_tr_b16 v[34:35], v8 offset:4096
 s_buffer_load_dwordx2 s[72:73], s[8:11], s64 glc
 v_mfma_f32_16x16x32_bf16 v[128:131], v[56:59], v[80:83], v[128:131]
 ds_read_b128 v[48:51], v3 offset:32768
 s_add_u32 m0, s51, 40960
 s_add_u32 s63, s6, 1
 s_and_b32 s63, s63, 3
 s_mul_i32 s63, s63, 65536
 s_add_u32 s63, s63, s65
 v_mfma_f32_16x16x32_bf16 v[132:135], v[60:63], v[80:83], v[132:135]
 ds_read_b64_tr_b16 v[36:37], v9 offset:0
 buffer_load_dwordx4 v10, s[20:23], s63 offen lds
 v_mfma_f32_16x16x32_bf16 v[136:139], v[64:67], v[80:83], v[136:139]
 ds_read_b64_tr_b16 v[38:39], v9 offset:4096
 v_mfma_f32_16x16x32_bf16 v[140:143], v[68:71], v[80:83], v[140:143]
 ds_read_b128 v[52:55], v3 offset:33792
 ds_read_b32 v90, v0
 ds_read_b32 v90, v0
 v_mfma_f32_16x16x32_bf16 v[156:159], v[68:71], v[84:87], v[156:159]
 v_mfma_f32_16x16x32_bf16 v[152:155], v[64:67], v[84:87], v[152:155]
 v_mfma_f32_16x16x32_bf16 v[148:151], v[60:63], v[84:87], v[148:151]
 v_mfma_f32_16x16x32_bf16 v[144:147], v[56:59], v[84:87], v[144:147]
 s_waitcnt vmcnt(8) lgkmcnt(2)
 s_barrier
 v_mfma_f32_16x16x32_bf16 v[96:99], v[24:27], v[40:43], v[96:99]
 ds_read_b128 v[72:75], v2 offset:49152
 v_mfma_f32_16x16x32_bf16 v[100:103], v[28:31], v[40:43], v[100:103]
 ds_read_b64_tr_b16 v[56:57], v6 offset:8192
 v_mfma_f32_16x16x32_bf16 v[104:107], v[32:35], v[40:43], v[104:107]
 ds_read_b64_tr_b16 v[58:59], v6 offset:12288
 v_mfma_f32_16x16x32_bf16 v[108:111], v[36:39], v[40:43], v[108:111]
 ds_read_b64_tr_b16 v[60:61], v7 offset:8192
 v_mfma_f32_16x16x32_bf16 v[124:127], v[36:39], v[44:47], v[124:127]
 ds_read_b64_tr_b16 v[62:63], v7 offset:12288
 v_mfma_f32_16x16x32_bf16 v[120:123], v[32:35], v[44:47], v[120:123]
 ds_read_b128 v[76:79], v2 offset:50176
 v_mfma_f32_16x16x32_bf16 v[116:119], v[28:31], v[44:47], v[116:119]
 ds_read_b64_tr_b16 v[64:65], v8 offset:8192
 v_mfma_f32_16x16x32_bf16 v[112:115], v[24:27], v[44:47], v[112:115]
 ds_read_b64_tr_b16 v[66:67], v8 offset:12288
 v_mfma_f32_16x16x32_bf16 v[128:131], v[24:27], v[48:51], v[128:131]
 ds_read_b128 v[80:83], v3 offset:49152
 s_add_u32 m0, s51, 0
 s_add_u32 s63, s6, 2
 s_and_b32 s63, s63, 3
 s_mul_i32 s63, s63, 65536
 s_add_u32 s63, s63, s65
 v_mfma_f32_16x16x32_bf16 v[132:135], v[28:31], v[48:51], v[132:135]
 ds_read_b64_tr_b16 v[68:69], v9 offset:8192
 buffer_load_dwordx4 v10, s[20:23], s63 offen lds
 v_mfma_f32_16x16x32_bf16 v[136:139], v[32:35], v[48:51], v[136:139]
 ds_read_b64_tr_b16 v[70:71], v9 offset:12288
 v_mfma_f32_16x16x32_bf16 v[140:143], v[36:39], v[48:51], v[140:143]
 ds_read_b128 v[84:87], v3 offset:50176
 v_mfma_f32_16x16x32_bf16 v[156:159], v[36:39], v[52:55], v[156:159]
 v_mfma_f32_16x16x32_bf16 v[152:155], v[32:35], v[52:55], v[152:155]
 v_mfma_f32_16x16x32_bf16 v[148:151], v[28:31], v[52:55], v[148:151]
 v_mfma_f32_16x16x32_bf16 v[144:147], v[24:27], v[52:55], v[144:147]
 s_waitcnt lgkmcnt(0)
 s_and_b32 s72, s72, s73
 s_cmp_eq_u32 s72, 0x1010101
 s_cbranch_scc0 Lsp_75
Lok_76:
 s_waitcnt vmcnt(6) lgkmcnt(0)
 s_barrier
 v_mfma_f32_16x16x32_bf16 v[96:99], v[56:59], v[72:75], v[96:99]
 ds_read_b128 v[40:43], v4 offset:0
 v_mfma_f32_16x16x32_bf16 v[100:103], v[60:63], v[72:75], v[100:103]
 ds_read_b64_tr_b16 v[24:25], v6 offset:16384
 v_mfma_f32_16x16x32_bf16 v[104:107], v[64:67], v[72:75], v[104:107]
 ds_read_b64_tr_b16 v[26:27], v6 offset:20480
 s_add_u32 m0, s50, 0
 s_add_u32 s62, s6, 0
 s_and_b32 s62, s62, 3
 s_mul_i32 s62, s62, 16384
 s_add_u32 s62, s62, s54
 v_mfma_f32_16x16x32_bf16 v[108:111], v[68:71], v[72:75], v[108:111]
 ds_read_b64_tr_b16 v[28:29], v7 offset:16384
 buffer_load_dwordx4 v13, s[8:11], s62 offen offset:0 sc1 lds
 v_mfma_f32_16x16x32_bf16 v[124:127], v[68:71], v[76:79], v[124:127]
 ds_read_b64_tr_b16 v[30:31], v7 offset:20480
 v_mfma_f32_16x16x32_bf16 v[120:123], v[64:67], v[76:79], v[120:123]
 ds_read_b128 v[44:47], v4 offset:1024
 buffer_load_dwordx4 v13, s[8:11], s62 offen offset:1024 sc1 lds
 v_mfma_f32_16x16x32_bf16 v[116:119], v[60:63], v[76:79], v[116:119]
 ds_read_b64_tr_b16 v[32:33], v8 offset:16384
 s_add_u32 m0, s50, 16384
 s_add_u32 s62, s6, 1
 s_and_b32 s62, s62, 3
 s_mul_i32 s62, s62, 16384
 s_add_u32 s62, s62, s54
 v_mfma_f32_16x16x32_bf16 v[112:115], v[56:59], v[76:79], v[112:115]
 ds_read_b64_tr_b16 v[34:35], v8 offset:20480
 buffer_load_dwordx4 v13, s[8:11], s62 offen offset:0 sc1 lds
 v_mfma_f32_16x16x32_bf16 v[128:131], v[56:59], v[80:83], v[128:131]
 ds_read_b128 v[48:51], v5 offset:0
 v_mfma_f32_16x16x32_bf16 v[132:135], v[60:63], v[80:83], v[132:135]
 ds_read_b64_tr_b16 v[36:37], v9 offset:16384
 v_mfma_f32_16x16x32_bf16 v[136:139], v[64:67], v[80:83], v[136:139]
 ds_read_b64_tr_b16 v[38:39], v9 offset:20480
 buffer_load_dwordx4 v13, s[8:11], s62 offen offset:1024 sc1 lds
 v_mfma_f32_16x16x32_bf16 v[140:143], v[68:71], v[80:83], v[140:143]
 ds_read_b128 v[52:55], v5 offset:1024
 s_add_u32 m0, s50, 32768
 s_add_u32 s62, s6, 2
 s_and_b32 s62, s62, 3
 s_mul_i32 s62, s62, 16384
 s_add_u32 s62, s62, s54
 v_mfma_f32_16x16x32_bf16 v[156:159], v[68:71], v[84:87], v[156:159]
 buffer_load_dwordx4 v13, s[8:11], s62 offen offset:0 sc1 lds
 v_mfma_f32_16x16x32_bf16 v[152:155], v[64:67], v[84:87], v[152:155]
 v_mfma_f32_16x16x32_bf16 v[148:151], v[60:63], v[84:87], v[148:151]
 buffer_load_dwordx4 v13, s[8:11], s62 offen offset:1024 sc1 lds
 v_mfma_f32_16x16x32_bf16 v[144:147], v[56:59], v[84:87], v[144:147]
 s_waitcnt vmcnt(9) lgkmcnt(0)
 s_barrier
 v_mfma_f32_16x16x32_bf16 v[96:99], v[24:27], v[40:43], v[96:99]
 ds_read_b128 v[72:75], v4 offset:16384
 s_mov_b32 s89, 0xffff0000
 s_waitcnt vmcnt(28)
 v_mfma_f32_16x16x32_bf16 v[100:103], v[28:31], v[40:43], v[100:103]
 ds_read_b64_tr_b16 v[56:57], v6 offset:24576
 v_permlane16_swap_b32 v184, v186
 v_mfma_f32_16x16x32_bf16 v[104:107], v[32:35], v[40:43], v[104:107]
 ds_read_b64_tr_b16 v[58:59], v6 offset:28672
 v_permlane16_swap_b32 v185, v187
 v_permlane16_swap_b32 v188, v190
 s_add_u32 m0, s50, 49152
 s_add_u32 s62, s6, 3
 s_and_b32 s62, s62, 3
 s_mul_i32 s62, s62, 16384
 s_add_u32 s62, s62, s54
 v_mfma_f32_16x16x32_bf16 v[108:111], v[36:39], v[40:43], v[108:111]
 ds_read_b64_tr_b16 v[60:61], v7 offset:24576
 buffer_load_dwordx4 v13, s[8:11], s62 offen offset:0 sc1 lds
 v_permlane16_swap_b32 v189, v191
 v_mfma_f32_16x16x32_bf16 v[124:127], v[36:39], v[44:47], v[124:127]
 ds_read_b64_tr_b16 v[62:63], v7 offset:28672
 v_lshlrev_b32 v192, 16, v184
 v_mfma_f32_16x16x32_bf16 v[120:123], v[32:35], v[44:47], v[120:123]
 ds_read_b128 v[76:79], v4 offset:17408
 buffer_load_dwordx4 v13, s[8:11], s62 offen offset:1024 sc1 lds
 v_and_b32 v193, s89, v184
 v_lshlrev_b32 v194, 16, v185
 v_mfma_f32_16x16x32_bf16 v[116:119], v[28:31], v[44:47], v[116:119]
 ds_read_b64_tr_b16 v[64:65], v8 offset:24576
 v_and_b32 v195, s89, v185
 s_add_u32 m0, s51, 8192
 s_add_u32 s63, s6, 3
 s_and_b32 s63, s63, 3
 s_mul_i32 s63, s63, 65536
 s_add_u32 s63, s63, s65
 v_mfma_f32_16x16x32_bf16 v[112:115], v[24:27], v[44:47], v[112:115]
 ds_read_b64_tr_b16 v[66:67], v8 offset:28672
 buffer_load_dwordx4 v10, s[20:23], s63 offen lds
 v_lshlrev_b32 v196, 16, v186
 v_mfma_f32_16x16x32_bf16 v[128:131], v[24:27], v[48:51], v[128:131]
 ds_read_b128 v[80:83], v5 offset:16384
 v_and_b32 v197, s89, v186
 v_lshlrev_b32 v198, 16, v187
 v_mfma_f32_16x16x32_bf16 v[132:135], v[28:31], v[48:51], v[132:135]
 ds_read_b64_tr_b16 v[68:69], v9 offset:24576
 v_and_b32 v199, s89, v187
 s_add_u32 m0, s50, 65536
 s_bfe_u32 s62, s52, 0x40000
 s_lshl_b32 s62, s62, 15
 s_add_u32 s62, s62, s57
 v_mfma_f32_16x16x32_bf16 v[136:139], v[32:35], v[48:51], v[136:139]
 ds_read_b64_tr_b16 v[70:71], v9 offset:28672
 buffer_load_dwordx4 v0, s[8:11], s62 offen offset:0 sc1 lds
 v_lshlrev_b32 v200, 16, v188
 v_and_b32 v201, s89, v188
 v_mfma_f32_16x16x32_bf16 v[140:143], v[36:39], v[48:51], v[140:143]
 ds_read_b128 v[84:87], v5 offset:17408
 v_lshlrev_b32 v202, 16, v189
 v_mfma_f32_16x16x32_bf16 v[156:159], v[36:39], v[52:55], v[156:159]
 buffer_load_dwordx4 v0, s[8:11], s62 offen offset:1024 sc1 lds
 v_and_b32 v203, s89, v189
 v_mfma_f32_16x16x32_bf16 v[152:155], v[32:35], v[52:55], v[152:155]
 v_lshlrev_b32 v204, 16, v190
 v_and_b32 v205, s89, v190
 s_add_u32 m0, s51, 16384
 s_bfe_u32 s63, s52, 0x40000
 s_lshl_b32 s63, s63, 17
 s_add_u32 s63, s63, s58
 v_mfma_f32_16x16x32_bf16 v[148:151], v[28:31], v[52:55], v[148:151]
 buffer_load_dwordx4 v11, s[20:23], s63 offen lds
 v_lshlrev_b32 v206, 16, v191
 v_mfma_f32_16x16x32_bf16 v[144:147], v[24:27], v[52:55], v[144:147]
 v_and_b32 v207, s89, v191
 s_waitcnt vmcnt(10) lgkmcnt(0)
 s_barrier
 v_mfma_f32_16x16x32_bf16 v[96:99], v[56:59], v[72:75], v[96:99]
 ds_read_b128 v[40:43], v2 offset:0
 v_mfma_f32_16x16x32_bf16 v[100:103], v[60:63], v[72:75], v[100:103]
 ds_read_b64_tr_b16 v[24:25], v6 offset:32768
 v_mfma_f32_16x16x32_bf16 v[104:107], v[64:67], v[72:75], v[104:107]
 ds_read_b64_tr_b16 v[26:27], v6 offset:36864
 v_mfma_f32_16x16x32_bf16 v[108:111], v[68:71], v[72:75], v[108:111]
 ds_read_b64_tr_b16 v[28:29], v7 offset:32768
 s_add_u32 m0, s50, 81920
 s_bfe_u32 s62, s52, 0x40004
 s_lshl_b32 s62, s62, 15
 s_add_u32 s62, s62, s57
 v_mfma_f32_16x16x32_bf16 v[124:127], v[68:71], v[76:79], v[124:127]
 ds_read_b64_tr_b16 v[30:31], v7 offset:36864
 buffer_load_dwordx4 v0, s[8:11], s62 offen offset:0 sc1 lds
 v_mfma_f32_16x16x32_bf16 v[120:123], v[64:67], v[76:79], v[120:123]
 ds_read_b128 v[44:47], v2 offset:1024
 v_mfma_f32_16x16x32_bf16 v[116:119], v[60:63], v[76:79], v[116:119]
 ds_read_b64_tr_b16 v[32:33], v8 offset:32768
 v_mfma_f32_16x16x32_bf16 v[112:115], v[56:59], v[76:79], v[112:115]
 ds_read_b64_tr_b16 v[34:35], v8 offset:36864
 v_mfma_f32_16x16x32_bf16 v[128:131], v[56:59], v[80:83], v[128:131]
 ds_read_b128 v[48:51], v3 offset:0
 v_mfma_f32_16x16x32_bf16 v[132:135], v[60:63], v[80:83], v[132:135]
 ds_read_b64_tr_b16 v[36:37], v9 offset:32768
 buffer_load_dwordx4 v0, s[8:11], s62 offen offset:1024 sc1 lds
 v_mfma_f32_16x16x32_bf16 v[136:139], v[64:67], v[80:83], v[136:139]
 ds_read_b64_tr_b16 v[38:39], v9 offset:36864
 v_mfma_f32_16x16x32_bf16 v[140:143], v[68:71], v[80:83], v[140:143]
 ds_read_b128 v[52:55], v3 offset:1024
 v_mfma_f32_16x16x32_bf16 v[156:159], v[68:71], v[84:87], v[156:159]
 s_add_u32 m0, s51, 24576
 s_bfe_u32 s63, s52, 0x40004
 s_lshl_b32 s63, s63, 17
 s_add_u32 s63, s63, s58
 v_mfma_f32_16x16x32_bf16 v[152:155], v[64:67], v[84:87], v[152:155]
 buffer_load_dwordx4 v11, s[20:23], s63 offen lds
 v_mfma_f32_16x16x32_bf16 v[148:151], v[60:63], v[84:87], v[148:151]
 v_mfma_f32_16x16x32_bf16 v[144:147], v[56:59], v[84:87], v[144:147]
 s_waitcnt vmcnt(11) lgkmcnt(0)
 s_barrier
 v_mfma_f32_16x16x32_bf16 v[96:99], v[24:27], v[40:43], v[96:99]
 ds_read_b128 v[72:75], v2 offset:16384
 v_mfma_f32_16x16x32_bf16 v[100:103], v[28:31], v[40:43], v[100:103]
 ds_read_b64_tr_b16 v[56:57], v6 offset:40960
 v_mfma_f32_16x16x32_bf16 v[104:107], v[32:35], v[40:43], v[104:107]
 ds_read_b64_tr_b16 v[58:59], v6 offset:45056
 v_mfma_f32_16x16x32_bf16 v[108:111], v[36:39], v[40:43], v[108:111]
 ds_read_b64_tr_b16 v[60:61], v7 offset:40960
 s_add_u32 m0, s50, 0
 s_bfe_u32 s62, s52, 0x40008
 s_lshl_b32 s62, s62, 15
 s_add_u32 s62, s62, s57
 v_mfma_f32_16x16x32_bf16 v[124:127], v[36:39], v[44:47], v[124:127]
 ds_read_b64_tr_b16 v[62:63], v7 offset:45056
 buffer_load_dwordx4 v0, s[8:11], s62 offen offset:0 sc1 lds
 v_mfma_f32_16x16x32_bf16 v[120:123], v[32:35], v[44:47], v[120:123]
 ds_read_b128 v[76:79], v2 offset:17408
 v_mfma_f32_16x16x32_bf16 v[116:119], v[28:31], v[44:47], v[116:119]
 ds_read_b64_tr_b16 v[64:65], v8 offset:40960
 v_mfma_f32_16x16x32_bf16 v[112:115], v[24:27], v[44:47], v[112:115]
 ds_read_b64_tr_b16 v[66:67], v8 offset:45056
 v_mfma_f32_16x16x32_bf16 v[128:131], v[24:27], v[48:51], v[128:131]
 ds_read_b128 v[80:83], v3 offset:16384
 v_mfma_f32_16x16x32_bf16 v[132:135], v[28:31], v[48:51], v[132:135]
 ds_read_b64_tr_b16 v[68:69], v9 offset:40960
 buffer_load_dwordx4 v0, s[8:11], s62 offen offset:1024 sc1 lds
 v_mfma_f32_16x16x32_bf16 v[136:139], v[32:35], v[48:51], v[136:139]
 ds_read_b64_tr_b16 v[70:71], v9 offset:45056
 v_mfma_f32_16x16x32_bf16 v[140:143], v[36:39], v[48:51], v[140:143]
 ds_read_b128 v[84:87], v3 offset:17408
 v_mfma_f32_16x16x32_bf16 v[156:159], v[36:39], v[52:55], v[156:159]
 s_add_u32 m0, s51, 32768
 s_bfe_u32 s63, s52, 0x40008
 s_lshl_b32 s63, s63, 17
 s_add_u32 s63, s63, s58
 v_mfma_f32_16x16x32_bf16 v[152:155], v[32:35], v[52:55], v[152:155]
 buffer_load_dwordx4 v11, s[20:23], s63 offen lds
 v_mfma_f32_16x16x32_bf16 v[148:151], v[28:31], v[52:55], v[148:151]
 v_mfma_f32_16x16x32_bf16 v[144:147], v[24:27], v[52:55], v[144:147]
 s_waitcnt vmcnt(12) lgkmcnt(0)
 s_barrier
 v_mfma_f32_16x16x32_bf16 v[96:99], v[56:59], v[72:75], v[96:99]
 ds_read_b128 v[40:43], v2 offset:32768
 v_mfma_f32_16x16x32_bf16 v[100:103], v[60:63], v[72:75], v[100:103]
 ds_read_b64_tr_b16 v[24:25], v6 offset:0
 v_mfma_f32_16x16x32_bf16 v[104:107], v[64:67], v[72:75], v[104:107]
 ds_read_b64_tr_b16 v[26:27], v6 offset:4096
 v_mfma_f32_16x16x32_bf16 v[108:111], v[68:71], v[72:75], v[108:111]
 ds_read_b64_tr_b16 v[28:29], v7 offset:0
 s_add_u32 m0, s50, 16384
 s_bfe_u32 s62, s52, 0x4000c
 s_lshl_b32 s62, s62, 15
 s_add_u32 s62, s62, s57
 v_mfma_f32_16x16x32_bf16 v[124:127], v[68:71], v[76:79], v[124:127]
 ds_read_b64_tr_b16 v[30:31], v7 offset:4096
 buffer_load_dwordx4 v0, s[8:11], s62 offen offset:0 sc1 lds
 v_mfma_f32_16x16x32_bf16 v[120:123], v[64:67], v[76:79], v[120:123]
 ds_read_b128 v[44:47], v2 offset:33792
 v_mfma_f32_16x16x32_bf16 v[116:119], v[60:63], v[76:79], v[116:119]
 ds_read_b64_tr_b16 v[32:33], v8 offset:0
 v_mfma_f32_16x16x32_bf16 v[112:115], v[56:59], v[76:79], v[112:115]
 ds_read_b64_tr_b16 v[34:35], v8 offset:4096
 v_mfma_f32_16x16x32_bf16 v[128:131], v[56:59], v[80:83], v[128:131]
 ds_read_b128 v[48:51], v3 offset:32768
 v_mfma_f32_16x16x32_bf16 v[132:135], v[60:63], v[80:83], v[132:135]
 ds_read_b64_tr_b16 v[36:37], v9 offset:0
 buffer_load_dwordx4 v0, s[8:11], s62 offen offset:1024 sc1 lds
 v_mfma_f32_16x16x32_bf16 v[136:139], v[64:67], v[80:83], v[136:139]
 ds_read_b64_tr_b16 v[38:39], v9 offset:4096
 v_mfma_f32_16x16x32_bf16 v[140:143], v[68:71], v[80:83], v[140:143]
 ds_read_b128 v[52:55], v3 offset:33792
 v_mfma_f32_16x16x32_bf16 v[156:159], v[68:71], v[84:87], v[156:159]
 s_add_u32 m0, s51, 40960
 s_bfe_u32 s63, s52, 0x4000c
 s_lshl_b32 s63, s63, 17
 s_add_u32 s63, s63, s58
 v_mfma_f32_16x16x32_bf16 v[152:155], v[64:67], v[84:87], v[152:155]
 buffer_load_dwordx4 v11, s[20:23], s63 offen lds
 v_mfma_f32_16x16x32_bf16 v[148:151], v[60:63], v[84:87], v[148:151]
 v_mfma_f32_16x16x32_bf16 v[144:147], v[56:59], v[84:87], v[144:147]
 s_waitcnt vmcnt(12) lgkmcnt(0)
 s_barrier
 v_mfma_f32_16x16x32_bf16 v[96:99], v[24:27], v[40:43], v[96:99]
 ds_read_b128 v[72:75], v2 offset:49152
 v_mfma_f32_16x16x32_bf16 v[100:103], v[28:31], v[40:43], v[100:103]
 ds_read_b64_tr_b16 v[56:57], v6 offset:8192
 v_mfma_f32_16x16x32_bf16 v[104:107], v[32:35], v[40:43], v[104:107]
 ds_read_b64_tr_b16 v[58:59], v6 offset:12288
 v_mfma_f32_16x16x32_bf16 v[108:111], v[36:39], v[40:43], v[108:111]
 ds_read_b64_tr_b16 v[60:61], v7 offset:8192
 s_add_u32 m0, s50, 32768
 s_bfe_u32 s62, s52, 0x40010
 s_lshl_b32 s62, s62, 15
 s_add_u32 s62, s62, s57
 v_mfma_f32_16x16x32_bf16 v[124:127], v[36:39], v[44:47], v[124:127]
 ds_read_b64_tr_b16 v[62:63], v7 offset:12288
 buffer_load_dwordx4 v0, s[8:11], s62 offen offset:0 sc1 lds
 v_mfma_f32_16x16x32_bf16 v[120:123], v[32:35], v[44:47], v[120:123]
 ds_read_b128 v[76:79], v2 offset:50176
 v_mfma_f32_16x16x32_bf16 v[116:119], v[28:31], v[44:47], v[116:119]
 ds_read_b64_tr_b16 v[64:65], v8 offset:8192
 v_mfma_f32_16x16x32_bf16 v[112:115], v[24:27], v[44:47], v[112:115]
 ds_read_b64_tr_b16 v[66:67], v8 offset:12288
 v_mfma_f32_16x16x32_bf16 v[128:131], v[24:27], v[48:51], v[128:131]
 ds_read_b128 v[80:83], v3 offset:49152
 v_mfma_f32_16x16x32_bf16 v[132:135], v[28:31], v[48:51], v[132:135]
 ds_read_b64_tr_b16 v[68:69], v9 offset:8192
 buffer_load_dwordx4 v0, s[8:11], s62 offen offset:1024 sc1 lds
 v_mfma_f32_16x16x32_bf16 v[136:139], v[32:35], v[48:51], v[136:139]
 ds_read_b64_tr_b16 v[70:71], v9 offset:12288
 v_mfma_f32_16x16x32_bf16 v[140:143], v[36:39], v[48:51], v[140:143]
 ds_read_b128 v[84:87], v3 offset:50176
 v_mfma_f32_16x16x32_bf16 v[156:159], v[36:39], v[52:55], v[156:159]
 s_add_u32 m0, s51, 0
 s_bfe_u32 s63, s52, 0x40010
 s_lshl_b32 s63, s63, 17
 s_add_u32 s63, s63, s58
 v_mfma_f32_16x16x32_bf16 v[152:155], v[32:35], v[52:55], v[152:155]
 buffer_load_dwordx4 v11, s[20:23], s63 offen lds
 v_mfma_f32_16x16x32_bf16 v[148:151], v[28:31], v[52:55], v[148:151]
 v_mfma_f32_16x16x32_bf16 v[144:147], v[24:27], v[52:55], v[144:147]
 s_waitcnt vmcnt(12) lgkmcnt(0)
 s_barrier
 v_mfma_f32_16x16x32_bf16 v[96:99], v[56:59], v[72:75], v[96:99]
 ds_read_b128 v[40:43], v17 offset:0
 v_mfma_f32_16x16x32_bf16 v[100:103], v[60:63], v[72:75], v[100:103]
 ds_read_b64_tr_b16 v[24:25], v6 offset:16384
 v_mfma_f32_16x16x32_bf16 v[104:107], v[64:67], v[72:75], v[104:107]
 ds_read_b64_tr_b16 v[26:27], v6 offset:20480
 v_mfma_f32_16x16x32_bf16 v[108:111], v[68:71], v[72:75], v[108:111]
 ds_read_b64_tr_b16 v[28:29], v7 offset:16384
 s_add_u32 m0, s50, 49152
 s_bfe_u32 s62, s52, 0x40014
 s_lshl_b32 s62, s62, 15
 s_add_u32 s62, s62, s57
 v_mfma_f32_16x16x32_bf16 v[124:127], v[68:71], v[76:79], v[124:127]
 ds_read_b64_tr_b16 v[30:31], v7 offset:20480
 buffer_load_dwordx4 v0, s[8:11], s62 offen offset:0 sc1 lds
 v_mfma_f32_16x16x32_bf16 v[120:123], v[64:67], v[76:79], v[120:123]
 ds_read_b128 v[44:47], v17 offset:1024
 v_mfma_f32_16x16x32_bf16 v[116:119], v[60:63], v[76:79], v[116:119]
 ds_read_b64_tr_b16 v[32:33], v8 offset:16384
 v_mfma_f32_16x16x32_bf16 v[112:115], v[56:59], v[76:79], v[112:115]
 ds_read_b64_tr_b16 v[34:35], v8 offset:20480
 v_mfma_f32_16x16x32_bf16 v[128:131], v[56:59], v[80:83], v[128:131]
 ds_read_b128 v[48:51], v17 offset:8192
 v_mfma_f32_16x16x32_bf16 v[132:135], v[60:63], v[80:83], v[132:135]
 ds_read_b64_tr_b16 v[36:37], v9 offset:16384
 buffer_load_dwordx4 v0, s[8:11], s62 offen offset:1024 sc1 lds
 v_mfma_f32_16x16x32_bf16 v[136:139], v[64:67], v[80:83], v[136:139]
 ds_read_b64_tr_b16 v[38:39], v9 offset:20480
 v_mfma_f32_16x16x32_bf16 v[140:143], v[68:71], v[80:83], v[140:143]
 ds_read_b128 v[52:55], v17 offset:9216
 v_mfma_f32_16x16x32_bf16 v[156:159], v[68:71], v[84:87], v[156:159]
 s_add_u32 m0, s51, 8192
 s_bfe_u32 s63, s52, 0x40014
 s_lshl_b32 s63, s63, 17
 s_add_u32 s63, s63, s58
 v_mfma_f32_16x16x32_bf16 v[152:155], v[64:67], v[84:87], v[152:155]
 buffer_load_dwordx4 v11, s[20:23], s63 offen lds
 v_mfma_f32_16x16x32_bf16 v[148:151], v[60:63], v[84:87], v[148:151]
 v_mfma_f32_16x16x32_bf16 v[144:147], v[56:59], v[84:87], v[144:147]
 s_waitcnt vmcnt(12) lgkmcnt(0)
 s_barrier
 v_mfma_f32_16x16x32_bf16 v[96:99], v[24:27], v[40:43], v[96:99]
 ds_read_b128 v[72:75], v17 offset:16384
 ds_read_b64_tr_b16 v[56:57], v6 offset:24576
 v_cvt_pk_bf16_f32 v104, v104, v105
 v_cvt_pk_bf16_f32 v105, v106, v107
 v_cvt_pk_bf16_f32 v106, v108, v109
 v_cvt_pk_bf16_f32 v107, v110, v111
 s_xor_b32 s85, s4, 1
 s_mul_i32 s85, s85, 49152
 s_add_u32 s85, s85, s60
 v_mfma_f32_16x16x32_bf16 v[100:103], v[28:31], v[40:43], v[100:103]
 ds_read_b64_tr_b16 v[58:59], v6 offset:28672
 ds_read_b64_tr_b16 v[60:61], v7 offset:24576
 buffer_store_dwordx4 v[104:107], v13, s[8:11], s85 offen offset:0 sc1
 v_cvt_pk_bf16_f32 v120, v120, v121
 v_cvt_pk_bf16_f32 v121, v122, v123
 v_cvt_pk_bf16_f32 v122, v124, v125
 v_cvt_pk_bf16_f32 v123, v126, v127
 s_xor_b32 s85, s4, 1
 v_mfma_f32_16x16x32_bf16 v[116:119], v[28:31], v[44:47], v[116:119]
 ds_read_b64_tr_b16 v[62:63], v7 offset:28672
 ds_read_b128 v[76:79], v17 offset:17408
 s_mul_i32 s85, s85, 49152
 s_add_u32 s85, s85, s60
 buffer_store_dwordx4 v[120:123], v13, s[8:11], s85 offen offset:1024 sc1
 v_cvt_pk_bf16_f32 v128, v128, v129
 v_cvt_pk_bf16_f32 v129, v130, v131
 v_cvt_pk_bf16_f32 v130, v132, v133
 v_cvt_pk_bf16_f32 v131, v134, v135
 v_mfma_f32_16x16x32_bf16 v[112:115], v[24:27], v[44:47], v[112:115]
 ds_read_b64_tr_b16 v[64:65], v8 offset:24576
 ds_read_b64_tr_b16 v[66:67], v8 offset:28672
 s_xor_b32 s85, s4, 2
 s_mul_i32 s85, s85, 49152
 s_add_u32 s85, s85, s60
 s_add_u32 s85, s85, 16384
 buffer_store_dwordx4 v[128:131], v13, s[8:11], s85 offen offset:0 sc1
 v_cvt_pk_bf16_f32 v144, v144, v145
 v_mfma_f32_16x16x32_bf16 v[96:99], v[32:35], v[48:51], v[96:99]
 ds_read_b128 v[80:83], v17 offset:24576
 ds_read_b64_tr_b16 v[68:69], v9 offset:24576
 v_cvt_pk_bf16_f32 v145, v146, v147
 v_cvt_pk_bf16_f32 v146, v148, v149
 v_cvt_pk_bf16_f32 v147, v150, v151
 s_xor_b32 s85, s4, 2
 s_mul_i32 s85, s85, 49152
 s_add_u32 s85, s85, s60
 s_add_u32 s85, s85, 16384
 v_mfma_f32_16x16x32_bf16 v[100:103], v[36:39], v[48:51], v[100:103]
 ds_read_b64_tr_b16 v[70:71], v9 offset:28672
 ds_read_b128 v[84:87], v17 offset:25600
 buffer_store_dwordx4 v[144:147], v13, s[8:11], s85 offen offset:1024 sc1
 v_cvt_pk_bf16_f32 v136, v136, v137
 v_cvt_pk_bf16_f32 v137, v138, v139
 v_cvt_pk_bf16_f32 v138, v140, v141
 v_cvt_pk_bf16_f32 v139, v142, v143
 s_xor_b32 s85, s4, 3
 v_mfma_f32_16x16x32_bf16 v[116:119], v[36:39], v[52:55], v[116:119]
 s_mul_i32 s85, s85, 49152
 s_add_u32 s85, s85, s60
 s_add_u32 s85, s85, 32768
 buffer_store_dwordx4 v[136:139], v13, s[8:11], s85 offen offset:0 sc1
 v_cvt_pk_bf16_f32 v152, v152, v153
 v_cvt_pk_bf16_f32 v153, v154, v155
 v_cvt_pk_bf16_f32 v154, v156, v157
 v_mfma_f32_16x16x32_bf16 v[112:115], v[32:35], v[52:55], v[112:115]
 v_cvt_pk_bf16_f32 v155, v158, v159
 s_xor_b32 s85, s4, 3
 s_mul_i32 s85, s85, 49152
 s_add_u32 s85, s85, s60
 s_add_u32 s85, s85, 32768
 buffer_store_dwordx4 v[152:155], v13, s[8:11], s85 offen offset:1024 sc1
 s_waitcnt vmcnt(6) lgkmcnt(0)
 s_barrier
 v_mfma_f32_16x16x32_bf16 v[96:99], v[56:59], v[72:75], v[96:99]
 ds_read_b128 v[40:43], v15 offset:0
 ds_read_b64_tr_b16 v[24:25], v6 offset:32768
 v_mfma_f32_16x16x32_bf16 v[100:103], v[60:63], v[72:75], v[100:103]
 ds_read_b64_tr_b16 v[26:27], v6 offset:36864
 ds_read_b64_tr_b16 v[28:29], v7 offset:32768
 v_mfma_f32_16x16x32_bf16 v[116:119], v[60:63], v[76:79], v[116:119]
 ds_read_b64_tr_b16 v[30:31], v7 offset:36864
 ds_read_b128 v[44:47], v15 offset:1024
 v_mfma_f32_16x16x32_bf16 v[112:115], v[56:59], v[76:79], v[112:115]
 ds_read_b64_tr_b16 v[32:33], v8 offset:32768
 ds_read_b64_tr_b16 v[34:35], v8 offset:36864
 v_mfma_f32_16x16x32_bf16 v[96:99], v[64:67], v[80:83], v[96:99]
 ds_read_b128 v[48:51], v15 offset:8192
 ds_read_b64_tr_b16 v[36:37], v9 offset:32768
 v_mfma_f32_16x16x32_bf16 v[100:103], v[68:71], v[80:83], v[100:103]
 ds_read_b64_tr_b16 v[38:39], v9 offset:36864
 ds_read_b128 v[52:55], v15 offset:9216
 v_mfma_f32_16x16x32_bf16 v[116:119], v[68:71], v[84:87], v[116:119]
 v_mfma_f32_16x16x32_bf16 v[112:115], v[64:67], v[84:87], v[112:115]
 s_waitcnt lgkmcnt(0)
 v_mfma_f32_16x16x32_bf16 v[96:99], v[24:27], v[40:43], v[96:99]
 ds_read_b128 v[72:75], v15 offset:16384
 ds_read_b64_tr_b16 v[56:57], v6 offset:40960
 s_xor_b32 s92, s71, 1024
 v_mov_b32 v91, 1
 v_mfma_f32_16x16x32_bf16 v[100:103], v[28:31], v[40:43], v[100:103]
 ds_read_b64_tr_b16 v[58:59], v6 offset:45056
 ds_read_b64_tr_b16 v[60:61], v7 offset:40960
 s_waitcnt vmcnt(4)
 v_mfma_f32_16x16x32_bf16 v[116:119], v[28:31], v[44:47], v[116:119]
 ds_read_b64_tr_b16 v[62:63], v7 offset:45056
 ds_read_b128 v[76:79], v15 offset:17408
 buffer_store_byte v91, off, s[8:11], s92 sc1
 s_xor_b32 s92, s71, 2048
 v_mfma_f32_16x16x32_bf16 v[112:115], v[24:27], v[44:47], v[112:115]
 ds_read_b64_tr_b16 v[64:65], v8 offset:40960
 ds_read_b64_tr_b16 v[66:67], v8 offset:45056
 v_mov_b32 v91, 1
 v_mfma_f32_16x16x32_bf16 v[96:99], v[32:35], v[48:51], v[96:99]
 ds_read_b128 v[80:83], v15 offset:24576
 ds_read_b64_tr_b16 v[68:69], v9 offset:40960
 s_waitcnt vmcnt(3)
 buffer_store_byte v91, off, s[8:11], s92 offset:1 sc1
 v_mfma_f32_16x16x32_bf16 v[100:103], v[36:39], v[48:51], v[100:103]
 ds_read_b64_tr_b16 v[70:71], v9 offset:45056
 ds_read_b128 v[84:87], v15 offset:25600
 s_xor_b32 s92, s71, 3072
 v_mfma_f32_16x16x32_bf16 v[116:119], v[36:39], v[52:55], v[116:119]
 v_mov_b32 v91, 1
 s_waitcnt vmcnt(2)
 v_mfma_f32_16x16x32_bf16 v[112:115], v[32:35], v[52:55], v[112:115]
 buffer_store_byte v91, off, s[8:11], s92 offset:2 sc1
 s_waitcnt lgkmcnt(0)
 v_mfma_f32_16x16x32_bf16 v[96:99], v[56:59], v[72:75], v[96:99]
 ds_read_b128 v[40:43], v15 offset:32768
 ds_read_b64_tr_b16 v[24:25], v6 offset:0
 v_mfma_f32_16x16x32_bf16 v[100:103], v[60:63], v[72:75], v[100:103]
 ds_read_b64_tr_b16 v[26:27], v6 offset:4096
 ds_read_b64_tr_b16 v[28:29], v7 offset:0
 v_mfma_f32_16x16x32_bf16 v[116:119], v[60:63], v[76:79], v[116:119]
 ds_read_b64_tr_b16 v[30:31], v7 offset:4096
 ds_read_b128 v[44:47], v15 offset:33792
 v_mfma_f32_16x16x32_bf16 v[112:115], v[56:59], v[76:79], v[112:115]
 ds_read_b64_tr_b16 v[32:33], v8 offset:0
 ds_read_b64_tr_b16 v[34:35], v8 offset:4096
 v_mfma_f32_16x16x32_bf16 v[96:99], v[64:67], v[80:83], v[96:99]
 ds_read_b128 v[48:51], v15 offset:40960
 ds_read_b64_tr_b16 v[36:37], v9 offset:0
 v_mfma_f32_16x16x32_bf16 v[100:103], v[68:71], v[80:83], v[100:103]
 ds_read_b64_tr_b16 v[38:39], v9 offset:4096
 ds_read_b128 v[52:55], v15 offset:41984
 v_mfma_f32_16x16x32_bf16 v[116:119], v[68:71], v[84:87], v[116:119]
 v_mfma_f32_16x16x32_bf16 v[112:115], v[64:67], v[84:87], v[112:115]
 s_waitcnt lgkmcnt(0)
 v_mfma_f32_16x16x32_bf16 v[96:99], v[24:27], v[40:43], v[96:99]
 ds_read_b128 v[72:75], v15 offset:49152
 ds_read_b64_tr_b16 v[56:57], v6 offset:8192
 v_mfma_f32_16x16x32_bf16 v[100:103], v[28:31], v[40:43], v[100:103]
 ds_read_b64_tr_b16 v[58:59], v6 offset:12288
 ds_read_b64_tr_b16 v[60:61], v7 offset:8192
 v_mfma_f32_16x16x32_bf16 v[116:119], v[28:31], v[44:47], v[116:119]
 ds_read_b64_tr_b16 v[62:63], v7 offset:12288
 ds_read_b128 v[76:79], v15 offset:50176
 v_mfma_f32_16x16x32_bf16 v[112:115], v[24:27], v[44:47], v[112:115]
 ds_read_b64_tr_b16 v[64:65], v8 offset:8192
 ds_read_b64_tr_b16 v[66:67], v8 offset:12288
 v_mfma_f32_16x16x32_bf16 v[96:99], v[32:35], v[48:51], v[96:99]
 ds_read_b128 v[80:83], v15 offset:57344
 ds_read_b64_tr_b16 v[68:69], v9 offset:8192
 v_mfma_f32_16x16x32_bf16 v[100:103], v[36:39], v[48:51], v[100:103]
 ds_read_b64_tr_b16 v[70:71], v9 offset:12288
 ds_read_b128 v[84:87], v15 offset:58368
 v_mfma_f32_16x16x32_bf16 v[116:119], v[36:39], v[52:55], v[116:119]
 v_mfma_f32_16x16x32_bf16 v[112:115], v[32:35], v[52:55], v[112:115]
 s_waitcnt lgkmcnt(0)
 v_mfma_f32_16x16x32_bf16 v[96:99], v[56:59], v[72:75], v[96:99]
 s_buffer_load_dword s72, s[8:11], s71 glc
 v_mfma_f32_16x16x32_bf16 v[100:103], v[60:63], v[72:75], v[100:103]
 v_mfma_f32_16x16x32_bf16 v[116:119], v[60:63], v[76:79], v[116:119]
 v_mfma_f32_16x16x32_bf16 v[112:115], v[56:59], v[76:79], v[112:115]
 v_mfma_f32_16x16x32_bf16 v[96:99], v[64:67], v[80:83], v[96:99]
 v_mfma_f32_16x16x32_bf16 v[100:103], v[68:71], v[80:83], v[100:103]
 v_mfma_f32_16x16x32_bf16 v[116:119], v[68:71], v[84:87], v[116:119]
 v_mfma_f32_16x16x32_bf16 v[112:115], v[64:67], v[84:87], v[112:115]
 s_waitcnt lgkmcnt(0)
 s_cmp_eq_u32 s72, 0x10101
 s_cbranch_scc0 Lsp_78
Lok_79:
 s_mul_i32 s85, s4, 49152
 s_add_u32 s85, s85, s60
 buffer_load_dwordx4 v[160:163], v13, s[8:11], s85 offen offset:0 sc1
 buffer_load_dwordx4 v[164:167], v13, s[8:11], s85 offen offset:1024 sc1
 s_mul_i32 s85, s4, 49152
 s_add_u32 s85, s85, s60
 s_add_u32 s85, s85, 16384
 buffer_load_dwordx4 v[168:171], v13, s[8:11], s85 offen offset:0 sc1
 buffer_load_dwordx4 v[172:175], v13, s[8:11], s85 offen offset:1024 sc1
 s_mul_i32 s85, s4, 49152
 s_add_u32 s85, s85, s60
 s_add_u32 s85, s85, 32768
 buffer_load_dwordx4 v[176:179], v13, s[8:11], s85 offen offset:0 sc1
 buffer_load_dwordx4 v[180:183], v13, s[8:11], s85 offen offset:1024 sc1
 s_waitcnt vmcnt(4)
 v_lshlrev_b32 v208, 16, v160
 v_and_b32 v209, s89, v160
 v_add_f32 v192, v192, v208
 v_add_f32 v193, v193, v209
 v_lshlrev_b32 v210, 16, v161
 v_and_b32 v211, s89, v161
 v_add_f32 v194, v194, v210
 v_add_f32 v195, v195, v211
 v_lshlrev_b32 v208, 16, v162
 v_and_b32 v209, s89, v162
 v_add_f32 v196, v196, v208
 v_add_f32 v197, v197, v209
 v_lshlrev_b32 v210, 16, v163
 v_and_b32 v211, s89, v163
 v_add_f32 v198, v198, v210
 v_add_f32 v199, v199, v211
 v_lshlrev_b32 v208, 16, v164
 v_and_b32 v209, s89, v164
 v_add_f32 v200, v200, v208
 v_add_f32 v201, v201, v209
 v_lshlrev_b32 v210, 16, v165
 v_and_b32 v211, s89, v165
 v_add_f32 v202, v202, v210
 v_add_f32 v203, v203, v211
 v_lshlrev_b32 v208, 16, v166
 v_and_b32 v209, s89, v166
 v_add_f32 v204, v204, v208
 v_add_f32 v205, v205, v209
 v_lshlrev_b32 v210, 16, v167
 v_and_b32 v211, s89, v167
 v_add_f32 v206, v206, v210
 v_add_f32 v207, v207, v211
 s_waitcnt vmcnt(2)
 v_lshlrev_b32 v208, 16, v168
 v_and_b32 v209, s89, v168
 v_add_f32 v192, v192, v208
 v_add_f32 v193, v193, v209
 v_lshlrev_b32 v210, 16, v169
 v_and_b32 v211, s89, v169
 v_add_f32 v194, v194, v210
 v_add_f32 v195, v195, v211
 v_lshlrev_b32 v208, 16, v170
 v_and_b32 v209, s89, v170
 v_add_f32 v196, v196, v208
 v_add_f32 v197, v197, v209
 v_lshlrev_b32 v210, 16, v171
 v_and_b32 v211, s89, v171
 v_add_f32 v198, v198, v210
 v_add_f32 v199, v199, v211
 v_lshlrev_b32 v208, 16, v172
 v_and_b32 v209, s89, v172
 v_add_f32 v200, v200, v208
 v_add_f32 v201, v201, v209
 v_lshlrev_b32 v210, 16, v173
 v_and_b32 v211, s89, v173
 v_add_f32 v202, v202, v210
 v_add_f32 v203, v203, v211
 v_lshlrev_b32 v208, 16, v174
 v_and_b32 v209, s89, v174
 v_add_f32 v204, v204, v208
 v_add_f32 v205, v205, v209
 v_lshlrev_b32 v210, 16, v175
 v_and_b32 v211, s89, v175
 v_add_f32 v206, v206, v210
 v_add_f32 v207, v207, v211
 s_waitcnt vmcnt(0)
 v_lshlrev_b32 v208, 16, v176
 v_and_b32 v209, s89, v176
 v_add_f32 v192, v192, v208
 v_add_f32 v193, v193, v209
 v_lshlrev_b32 v210, 16, v177
 v_and_b32 v211, s89, v177
 v_add_f32 v194, v194, v210
 v_add_f32 v195, v195, v211
 v_lshlrev_b32 v208, 16, v178
 v_and_b32 v209, s89, v178
 v_add_f32 v196, v196, v208
 v_add_f32 v197, v197, v209
 v_lshlrev_b32 v210, 16, v179
 v_and_b32 v211, s89, v179
 v_add_f32 v198, v198, v210
 v_add_f32 v199, v199, v211
 v_lshlrev_b32 v208, 16, v180
 v_and_b32 v209, s89, v180
 v_add_f32 v200, v200, v208
 v_add_f32 v201, v201, v209
 v_lshlrev_b32 v210, 16, v181
 v_and_b32 v211, s89, v181
 v_add_f32 v202, v202, v210
 v_add_f32 v203, v203, v211
 v_lshlrev_b32 v208, 16, v182
 v_and_b32 v209, s89, v182
 v_add_f32 v204, v204, v208
 v_add_f32 v205, v205, v209
 v_lshlrev_b32 v210, 16, v183
 v_and_b32 v211, s89, v183
 v_add_f32 v206, v206, v210
 v_add_f32 v207, v207, v211
 v_add_f32 v96, v96, v192
 v_add_f32 v97, v97, v193
 v_add_f32 v98, v98, v194
 v_add_f32 v99, v99, v195
 v_add_f32 v100, v100, v196
 v_add_f32 v101, v101, v197
 v_add_f32 v102, v102, v198
 v_add_f32 v103, v103, v199
 v_cvt_pk_bf16_f32 v96, v96, v97
 v_cvt_pk_bf16_f32 v97, v98, v99
 v_cvt_pk_bf16_f32 v98, v100, v101
 v_cvt_pk_bf16_f32 v99, v102, v103
 s_nop 0
 v_permlane16_swap_b32 v96, v98
 v_permlane16_swap_b32 v97, v99
 buffer_store_dwordx4 v[96:99], v94, s[28:31], s61 offen
 v_add_f32 v112, v112, v200
 v_add_f32 v113, v113, v201
 v_add_f32 v114, v114, v202
 v_add_f32 v115, v115, v203
 v_add_f32 v116, v116, v204
 v_add_f32 v117, v117, v205
 v_add_f32 v118, v118, v206
 v_add_f32 v119, v119, v207
 v_cvt_pk_bf16_f32 v112, v112, v113
 v_cvt_pk_bf16_f32 v113, v114, v115
 v_cvt_pk_bf16_f32 v114, v116, v117
 v_cvt_pk_bf16_f32 v115, v118, v119
 s_nop 0
 v_permlane16_swap_b32 v112, v114
 v_permlane16_swap_b32 v113, v115
 buffer_store_dwordx4 v[112:115], v94, s[28:31], s66 offen
 s_endpgm
L0_x:
 s_load_dwordx2 s[8:9], s[0:1], 80
 s_load_dwordx2 s[12:13], s[0:1], 72
 s_load_dwordx2 s[20:21], s[0:1], 24
 s_load_dwordx2 s[24:25], s[0:1], 56
 s_load_dwordx2 s[28:29], s[0:1], 64
 s_and_b32 s94, s2, 7
 s_and_b32 s6, s93, 3
 s_lshr_b32 s98, s4, 1
 s_and_b32 s99, s4, 1
 s_mov_b32 s10, 268435456
 s_mov_b32 s11, 0x20000
 s_mov_b32 s14, 256
 s_mov_b32 s15, 0x20000
 s_mov_b32 s22, 2097152
 s_mov_b32 s23, 0x20000
 s_mov_b32 s26, 7340032
 s_mov_b32 s27, 0x20000
 s_mov_b32 s30, 4194304
 s_mov_b32 s31, 0x20000
 s_add_u32 s54, s52, 32768
 s_add_u32 s55, s52, 36864
 s_movk_i32 s85, -480
 v_mad_i32_i24 v10, v16, s85, v0
 s_waitcnt lgkmcnt(0)
 s_mov_b32 s88, 0xffff0000
 s_waitcnt vmcnt(11)
 v_lshlrev_b32 v112, 16, v96
 v_and_b32 v113, s88, v96
 v_lshlrev_b32 v114, 16, v97
 v_and_b32 v115, s88, v97
 v_lshlrev_b32 v116, 16, v98
 v_and_b32 v117, s88, v98
 v_lshlrev_b32 v118, 16, v99
 v_and_b32 v119, s88, v99
 s_waitcnt vmcnt(10)
 v_lshlrev_b32 v120, 16, v100
 v_and_b32 v121, s88, v100
 v_lshlrev_b32 v122, 16, v101
 v_and_b32 v123, s88, v101
 v_lshlrev_b32 v124, 16, v102
 v_and_b32 v125, s88, v102
 v_lshlrev_b32 v126, 16, v103
 v_and_b32 v127, s88, v103
 v_pk_add_f32 v[144:145], v[112:113], v[120:121]
 v_pk_add_f32 v[146:147], v[114:115], v[122:123]
 v_pk_add_f32 v[148:149], v[116:117], v[124:125]
 v_pk_add_f32 v[150:151], v[118:119], v[126:127]
 s_waitcnt vmcnt(9)
 v_lshlrev_b32 v128, 16, v104
 v_and_b32 v129, s88, v104
 v_lshlrev_b32 v130, 16, v105
 v_and_b32 v131, s88, v105
 v_lshlrev_b32 v132, 16, v106
 v_and_b32 v133, s88, v106
 v_lshlrev_b32 v134, 16, v107
 v_and_b32 v135, s88, v107
 v_pk_add_f32 v[144:145], v[144:145], v[128:129]
 v_pk_add_f32 v[146:147], v[146:147], v[130:131]
 v_pk_add_f32 v[148:149], v[148:149], v[132:133]
 v_pk_add_f32 v[150:151], v[150:151], v[134:135]
 s_waitcnt vmcnt(8)
 v_lshlrev_b32 v136, 16, v108
 v_and_b32 v137, s88, v108
 v_lshlrev_b32 v138, 16, v109
 v_and_b32 v139, s88, v109
 v_lshlrev_b32 v140, 16, v110
 v_and_b32 v141, s88, v110
 v_lshlrev_b32 v142, 16, v111
 v_and_b32 v143, s88, v111
 v_pk_add_f32 v[144:145], v[144:145], v[136:137]
 v_pk_add_f32 v[146:147], v[146:147], v[138:139]
 v_pk_add_f32 v[148:149], v[148:149], v[140:141]
 v_pk_add_f32 v[150:151], v[150:151], v[142:143]
 v_pk_add_f32 v[144:145], v[144:145], v[146:147]
 v_pk_add_f32 v[148:149], v[148:149], v[150:151]
 v_pk_add_f32 v[144:145], v[144:145], v[148:149]
 v_add_f32 v144, v144, v145
 v_mov_b32 v145, v144
 s_nop 1
 v_permlane16_swap_b32 v144, v145
 v_add_f32 v144, v144, v145
 s_nop 1
 v_add_f32_dpp v144, v144, v144 row_ror:8 row_mask:0xf bank_mask:0xf
 s_nop 1
 v_add_f32_dpp v144, v144, v144 row_ror:4 row_mask:0xf bank_mask:0xf
 s_nop 1
 v_add_f32_dpp v144, v144, v144 row_ror:2 row_mask:0xf bank_mask:0xf
 s_nop 1
 v_add_f32_dpp v144, v144, v144 row_ror:1 row_mask:0xf bank_mask:0xf
 v_mul_f32 v144, 0xba800000, v144
 v_pk_add_f32 v[112:113], v[112:113], v[144:145] op_sel_hi:[1,0]
 v_pk_add_f32 v[114:115], v[114:115], v[144:145] op_sel_hi:[1,0]
 v_pk_add_f32 v[116:117], v[116:117], v[144:145] op_sel_hi:[1,0]
 v_pk_add_f32 v[118:119], v[118:119], v[144:145] op_sel_hi:[1,0]
 v_pk_add_f32 v[120:121], v[120:121], v[144:145] op_sel_hi:[1,0]
 v_pk_add_f32 v[122:123], v[122:123], v[144:145] op_sel_hi:[1,0]
 v_pk_add_f32 v[124:125], v[124:125], v[144:145] op_sel_hi:[1,0]
 v_pk_add_f32 v[126:127], v[126:127], v[144:145] op_sel_hi:[1,0]
 v_pk_add_f32 v[128:129], v[128:129], v[144:145] op_sel_hi:[1,0]
 v_pk_add_f32 v[130:131], v[130:131], v[144:145] op_sel_hi:[1,0]
 v_pk_add_f32 v[132:133], v[132:133], v[144:145] op_sel_hi:[1,0]
 v_pk_add_f32 v[134:135], v[134:135], v[144:145] op_sel_hi:[1,0]
 v_pk_add_f32 v[136:137], v[136:137], v[144:145] op_sel_hi:[1,0]
 v_pk_add_f32 v[138:139], v[138:139], v[144:145] op_sel_hi:[1,0]
 v_pk_add_f32 v[140:141], v[140:141], v[144:145] op_sel_hi:[1,0]
 v_pk_add_f32 v[142:143], v[142:143], v[144:145] op_sel_hi:[1,0]
 v_pk_mul_f32 v[152:153], v[112:113], v[112:113]
 v_pk_mul_f32 v[154:155], v[114:115], v[114:115]
 v_pk_mul_f32 v[156:157], v[116:117], v[116:117]
 v_pk_mul_f32 v[158:159], v[118:119], v[118:119]
 v_pk_fma_f32 v[152:153], v[120:121], v[120:121], v[152:153]
 v_pk_fma_f32 v[154:155], v[122:123], v[122:123], v[154:155]
 v_pk_fma_f32 v[156:157], v[124:125], v[124:125], v[156:157]
 v_pk_fma_f32 v[158:159], v[126:127], v[126:127], v[158:159]
 v_pk_fma_f32 v[152:153], v[128:129], v[128:129], v[152:153]
 v_pk_fma_f32 v[154:155], v[130:131], v[130:131], v[154:155]
 v_pk_fma_f32 v[156:157], v[132:133], v[132:133], v[156:157]
 v_pk_fma_f32 v[158:159], v[134:135], v[134:135], v[158:159]
 v_pk_fma_f32 v[152:153], v[136:137], v[136:137], v[152:153]
 v_pk_fma_f32 v[154:155], v[138:139], v[138:139], v[154:155]
 v_pk_fma_f32 v[156:157], v[140:141], v[140:141], v[156:157]
 v_pk_fma_f32 v[158:159], v[142:143], v[142:143], v[158:159]
 v_pk_add_f32 v[152:153], v[152:153], v[154:155]
 v_pk_add_f32 v[156:157], v[156:157], v[158:159]
 v_pk_add_f32 v[152:153], v[152:153], v[156:157]
 v_add_f32 v152, v152, v153
 v_mov_b32 v153, v152
 s_nop 1
 v_permlane16_swap_b32 v152, v153
 v_add_f32 v152, v152, v153
 s_nop 1
 v_add_f32_dpp v152, v152, v152 row_ror:8 row_mask:0xf bank_mask:0xf
 s_nop 1
 v_add_f32_dpp v152, v152, v152 row_ror:4 row_mask:0xf bank_mask:0xf
 s_nop 1
 v_add_f32_dpp v152, v152, v152 row_ror:2 row_mask:0xf bank_mask:0xf
 s_nop 1
 v_add_f32_dpp v152, v152, v152 row_ror:1 row_mask:0xf bank_mask:0xf
 v_mov_b32 v115, 0x3727c5ac
 v_fmac_f32 v115, 0x3a800000, v152
 v_rsq_f32 v117, v115
 s_mov_b32 vcc_lo, 1
 s_mov_b32 vcc_hi, 1
 v_and_b32 v145, s88, v144
 v_sub_f32 v144, v144, v145
 v_cvt_pk_bf16_f32 v112, v145, v145
 v_cvt_pk_bf16_f32 v113, v144, v144
 s_lshr_b32 s88, s97, 6
 s_add_u32 s88, s88, 39976960
 v_mul_f32 v116, 0xc0135761, v117
 v_mul_f32 v152, v117, v117
 v_cndmask_b32 v113, v117, v113, vcc
 v_mul_f32 v152, 0x3d372713, v152
 v_cndmask_b32 v112, v116, v112, vcc
 v_mul_f32 v114, v152, v116
 s_mov_b32 exec_lo, 3
 s_mov_b32 exec_hi, 3
 buffer_store_dwordx4 v[112:115], v10, s[8:11], s88 offen sc1
 s_mov_b64 exec, -1
 s_cmp_lg_u32 s7, 0
 s_cbranch_scc1 L0_xt1
 s_load_dwordx2 s[32:33], s[0:1], 56
 s_mov_b32 s34, 0
 s_mov_b32 s35, 0x20000
 v_lshlrev_b32 v15, 7, v1
 v_mov_b32 v16, 1073741824
 v_cmp_gt_u32 vcc, 32, v1
 s_nop 1
 v_cndmask_b32 v21, v16, v15, vcc
 s_mul_i32 s73, s2, 28672
 s_mov_b32 s78, 0
 s_add_u32 s79, s73, 24576
 s_branch L0_xt3
 s_load_dwordx2 s[32:33], s[0:1], 0
 s_mov_b32 s34, 4194304
 s_mov_b32 s35, 0x20000
 s_lshl3_add_u32 s87, s83, s5
 v_lshlrev_b32 v15, 11, v1
 v_mov_b32 v16, 1073741824
 v_cmp_gt_u32 vcc, 32, v1
 s_nop 1
 v_cndmask_b32 v21, v16, v15, vcc
 s_lshl_b32 s73, s87, 16
 s_mov_b32 s78, 128
 s_add_u32 s79, s73, 1920
 s_branch L0_xt3
L0_xt1:
 s_cmp_lg_u32 s7, 1
 s_cbranch_scc1 L0_xt2
 s_load_dwordx2 s[32:33], s[0:1], 8
 s_mov_b32 s34, 6291456
 s_mov_b32 s35, 0x20000
 v_lshrrev_b32 v14, 2, v1
 v_and_b32 v15, 3, v1
 v_lshlrev_b32 v15, 7, v15
 v_lshl_add_u32 v15, v14, 11, v15
 v_mov_b32 v16, 1073741824
 v_cmp_gt_u32 vcc, 6, v14
 s_nop 1
 v_cndmask_b32 v21, v16, v15, vcc
 s_mul_i32 s87, s93, 12288
 s_lshl_b32 s88, s4, 9
 s_add_u32 s73, s87, s88
 s_mov_b32 s78, 393216
 s_add_u32 s79, s73, 5898240
 s_branch L0_xt6
L0_xt2:
 s_cmp_eq_u32 s7, 2
 s_cbranch_scc1 L0_xt4
 s_load_dwordx2 s[32:33], s[0:1], 48
 s_branch L0_xt5
L0_xt4:
 s_load_dwordx2 s[32:33], s[0:1], 40
L0_xt5:
 s_mov_b32 s34, 7340032
 s_mov_b32 s35, 0x20000
 v_lshrrev_b32 v14, 1, v1
 v_and_b32 v15, 1, v1
 v_mul_u32_u24 v15, 7168, v15
 v_lshl_add_u32 v15, v14, 7, v15
 v_mov_b32 v16, 1073741824
 v_cmp_gt_u32 vcc, 14, v14
 s_nop 1
 v_cndmask_b32 v21, v16, v15, vcc
 s_mul_i32 s87, s93, 14336
 s_mul_i32 s88, s4, 1792
 s_add_u32 s73, s87, s88
 s_mov_b32 s78, 458752
 s_add_u32 s79, s73, 6881280
L0_xt6:
 s_sub_u32 s87, 0, s78
 s_bitcmp1_b32 s2, 0
 s_cselect_b32 s73, s79, s73
 s_cselect_b32 s78, s87, s78
 s_mov_b32 s79, -1
L0_xt3:
 v_lshrrev_b32 v14, 4, v1
 v_lshrrev_b32 v15, 2, v1
 v_and_b32 v16, 3, v1
 v_and_b32 v17, 15, v1
 v_and_b32 v18, 7, v1
 v_xor_b32 v18, v14, v18
 s_and_b32 s85, s2, 1
 s_lshl_b32 s85, s85, 2
 v_xor_b32 v18, s85, v18
 s_lshl_b32 s85, s7, 13
 v_lshlrev_b32 v17, 7, v17
 v_add_u32 v17, s85, v17
 v_lshl_add_u32 v2, v18, 4, v17
 v_xor_b32 v18, 4, v18
 v_lshl_add_u32 v3, v18, 4, v17
 v_mul_u32_u24 v17, 192, v15
 v_lshl_add_u32 v17, v16, 3, v17
 v_add_u32 v17, 65536, v17
 v_and_b32 v18, 1, v14
 v_lshl_add_u32 v4, v18, 5, v17
 v_xor_b32 v18, 1, v18
 v_lshl_add_u32 v5, v18, 5, v17
 v_mul_u32_u24 v17, 224, v15
 v_lshl_add_u32 v17, v16, 3, v17
 v_add_u32 v6, 90112, v17
 v_bfe_u32 v17, v1, 1, 3
 v_lshrrev_b32 v18, 5, v1
 v_cmp_eq_u32 vcc, v17, v18
 v_mov_b32 v17, 0x3e803e80
 s_nop 0
 v_cndmask_b32 v12, 0, v17, vcc
 v_cndmask_b32 v13, 0, v17, vcc
 v_cndmask_b32 v14, 0, v17, vcc
 v_cndmask_b32 v15, 0, v17, vcc
 v_and_b32 v17, 1, v1
 v_mul_u32_u24 v17, 0xaaaa, v17
 v_add_u32 v20, 0x4444, v17
 v_mov_b32 v16, 0
 v_mov_b32 v17, 0
 v_mov_b32 v18, 0
 v_mov_b32 v19, 0
 s_waitcnt lgkmcnt(0)
 s_mul_i32 s87, s78, 1
 s_add_u32 s73, s73, s87
 buffer_load_dword v22, v21, s[32:35], s73 offen sc1
 s_add_u32 s73, s73, s78
 s_min_u32 s73, s73, s79
 s_and_b32 s89, s83, 3
 s_sub_u32 s89, 7, s89
 s_cmp_lt_u32 s7, 2
 s_cselect_b32 s86, s89, 0
 s_cselect_b32 s87, 0, s89
 s_waitcnt vmcnt(2)
 s_barrier
 ds_read_b128 v[64:67], v2 offset:0
 ds_read_b64_tr_b16 v[24:25], v4 offset:0
 ds_read_b64_tr_b16 v[26:27], v4 offset:3072
 ds_read_b128 v[68:71], v2 offset:2048
 ds_read_b128 v[72:75], v2 offset:4096
 ds_read_b128 v[76:79], v2 offset:6144
 ds_read_b64_tr_b16 v[28:29], v5 offset:0
 ds_read_b64_tr_b16 v[30:31], v5 offset:3072
 ds_read_b64_tr_b16 v[32:33], v6 offset:96
 ds_read_b64_tr_b16 v[34:35], v6 offset:3680
 ds_read_b64_tr_b16 v[36:37], v6 offset:7264
 ds_read_b64_tr_b16 v[38:39], v6 offset:10848
 ds_read_b64_tr_b16 v[40:41], v6 offset:128
 ds_read_b64_tr_b16 v[42:43], v6 offset:3712
 s_waitcnt lgkmcnt(0)
 s_mov_b32 s84, 7
 v_mfma_f32_16x16x32_bf16 v[96:99], v[24:27], v[64:67], 0
 ds_read_b64_tr_b16 v[44:45], v6 offset:7296
 v_mfma_f32_16x16x32_bf16 v[100:103], v[24:27], v[68:71], 0
 ds_read_b64_tr_b16 v[46:47], v6 offset:10880
 v_mfma_f32_16x16x32_bf16 v[104:107], v[24:27], v[72:75], 0
 ds_read_b64_tr_b16 v[48:49], v6 offset:160
 v_mfma_f32_16x16x32_bf16 v[108:111], v[24:27], v[76:79], 0
 ds_read_b64_tr_b16 v[50:51], v6 offset:3744
 v_mfma_f32_16x16x32_bf16 v[124:127], v[28:31], v[76:79], 0
 ds_read_b64_tr_b16 v[52:53], v6 offset:7328
 s_cmp_eq_u32 s84, s86
 s_cbranch_scc1 Lcs_106
Lcb_105:
 s_mov_b32 m0, s54
 v_mfma_f32_16x16x32_bf16 v[120:123], v[28:31], v[72:75], 0
 ds_read_b64_tr_b16 v[54:55], v6 offset:10912
 buffer_load_dwordx4 v7, s[16:19], s72 offen offset:0 lds
 s_add_u32 s72, s72, 0x3c00
 v_mfma_f32_16x16x32_bf16 v[116:119], v[28:31], v[68:71], 0
 ds_read_b64_tr_b16 v[56:57], v6 offset:192
 v_mfma_f32_16x16x32_bf16 v[112:115], v[28:31], v[64:67], 0
 ds_read_b64_tr_b16 v[58:59], v6 offset:3776
 buffer_load_dwordx4 v7, s[16:19], s72 offen offset:1024 lds
 s_add_u32 s72, s72, 0x3c00
 v_mfma_f32_16x16x32_bf16 v[128:131], v[32:35], v[64:67], 0
 ds_read_b64_tr_b16 v[60:61], v6 offset:7360
 v_mfma_f32_16x16x32_bf16 v[132:135], v[32:35], v[68:71], 0
 ds_read_b64_tr_b16 v[62:63], v6 offset:10944
 buffer_load_dwordx4 v7, s[16:19], s72 offen offset:2048 lds
 s_add_u32 s72, s72, 0x3c00
 v_mfma_f32_16x16x32_bf16 v[136:139], v[32:35], v[72:75], 0
 v_mfma_f32_16x16x32_bf16 v[140:143], v[32:35], v[76:79], 0
 buffer_load_dwordx4 v7, s[16:19], s72 offen offset:3072 lds
 s_add_u32 s72, s72, 0x4c00
 v_mfma_f32_16x16x32_bf16 v[156:159], v[36:39], v[76:79], 0
 s_mov_b32 m0, s55
 v_mfma_f32_16x16x32_bf16 v[152:155], v[36:39], v[72:75], 0
 buffer_load_dwordx4 v7, s[16:19], s72 offen offset:0 lds
 s_add_u32 s72, s72, 0x3c00
 v_mfma_f32_16x16x32_bf16 v[148:151], v[36:39], v[68:71], 0
 v_mfma_f32_16x16x32_bf16 v[144:147], v[36:39], v[64:67], 0
 buffer_load_dwordx4 v7, s[16:19], s72 offen offset:1024 lds
 s_add_u32 s72, s72, 0x3c00
 v_mfma_f32_16x16x32_bf16 v[160:163], v[40:43], v[64:67], 0
 v_mfma_f32_16x16x32_bf16 v[164:167], v[40:43], v[68:71], 0
 buffer_load_dwordx4 v7, s[16:19], s72 offen offset:2048 lds
 s_add_u32 s72, s72, 0x3c00
 v_mfma_f32_16x16x32_bf16 v[168:171], v[40:43], v[72:75], 0
 v_mfma_f32_16x16x32_bf16 v[172:175], v[40:43], v[76:79], 0
 buffer_load_dwordx4 v7, s[16:19], s72 offen offset:3072 lds
 s_add_u32 s72, s72, s77
 s_waitcnt lgkmcnt(0)
 s_barrier
 s_setprio 1
 v_mfma_f32_16x16x32_bf16 v[188:191], v[44:47], v[76:79], 0
 ds_read_b128 v[80:83], v3 offset:0
 buffer_load_dword v22, v21, s[32:35], s73 offen sc1
 s_add_u32 s73, s73, s78
 s_min_u32 s73, s73, s79
 v_mfma_f32_16x16x32_bf16 v[184:187], v[44:47], v[72:75], 0
 ds_read_b64_tr_b16 v[24:25], v4 offset:6144
 v_mfma_f32_16x16x32_bf16 v[180:183], v[44:47], v[68:71], 0
 ds_read_b64_tr_b16 v[26:27], v4 offset:9216
 v_mfma_f32_16x16x32_bf16 v[176:179], v[44:47], v[64:67], 0
 ds_read_b128 v[84:87], v3 offset:2048
 v_mfma_f32_16x16x32_bf16 v[192:195], v[48:51], v[64:67], 0
 ds_read_b128 v[88:91], v3 offset:4096
 s_cmp_eq_u32 s84, s87
 s_cbranch_scc1 Lcs_109
Lcb_108:
 v_mfma_f32_16x16x32_bf16 v[196:199], v[48:51], v[68:71], 0
 ds_read_b128 v[92:95], v3 offset:6144
 v_mfma_f32_16x16x32_bf16 v[200:203], v[48:51], v[72:75], 0
 ds_read_b64_tr_b16 v[28:29], v5 offset:6144
 v_mfma_f32_16x16x32_bf16 v[204:207], v[48:51], v[76:79], 0
 ds_read_b64_tr_b16 v[30:31], v5 offset:9216
 v_mfma_f32_16x16x32_bf16 v[220:223], v[52:55], v[76:79], 0
 ds_read_b64_tr_b16 v[32:33], v6 offset:14432
 v_mfma_f32_16x16x32_bf16 v[216:219], v[52:55], v[72:75], 0
 ds_read_b64_tr_b16 v[34:35], v6 offset:18016
 v_mfma_f32_16x16x32_bf16 v[212:215], v[52:55], v[68:71], 0
 ds_read_b64_tr_b16 v[36:37], v6 offset:21600
 v_mfma_f32_16x16x32_bf16 v[208:211], v[52:55], v[64:67], 0
 ds_read_b64_tr_b16 v[38:39], v6 offset:25184
 v_mfma_f32_16x16x32_bf16 v[224:227], v[56:59], v[64:67], 0
 ds_read_b64_tr_b16 v[40:41], v6 offset:14464
 v_mfma_f32_16x16x32_bf16 v[228:231], v[56:59], v[68:71], 0
 ds_read_b64_tr_b16 v[42:43], v6 offset:18048
 v_mfma_f32_16x16x32_bf16 v[232:235], v[56:59], v[72:75], 0
 v_mfma_f32_16x16x32_bf16 v[236:239], v[56:59], v[76:79], 0
 v_mfma_f32_16x16x32_bf16 v[252:255], v[60:63], v[76:79], 0
 v_mfma_f32_16x16x32_bf16 v[248:251], v[60:63], v[72:75], 0
 v_mfma_f32_16x16x32_bf16 v[244:247], v[60:63], v[68:71], 0
 s_setprio 0
 v_mfma_f32_16x16x32_bf16 v[240:243], v[60:63], v[64:67], 0
 s_waitcnt lgkmcnt(0)
 v_mfma_f32_16x16x32_bf16 v[96:99], v[24:27], v[80:83], v[96:99]
 ds_read_b64_tr_b16 v[44:45], v6 offset:21632
 v_mfma_f32_16x16x32_bf16 v[100:103], v[24:27], v[84:87], v[100:103]
 ds_read_b64_tr_b16 v[46:47], v6 offset:25216
 v_mfma_f32_16x16x32_bf16 v[104:107], v[24:27], v[88:91], v[104:107]
 ds_read_b64_tr_b16 v[48:49], v6 offset:14496
 v_mfma_f32_16x16x32_bf16 v[108:111], v[24:27], v[92:95], v[108:111]
 ds_read_b64_tr_b16 v[50:51], v6 offset:18080
 v_mfma_f32_16x16x32_bf16 v[124:127], v[28:31], v[92:95], v[124:127]
 ds_read_b64_tr_b16 v[52:53], v6 offset:21664
 s_cmp_eq_u32 s84, s86
 s_cbranch_scc1 Lcs_112
Lcb_111:
 v_mfma_f32_16x16x32_bf16 v[120:123], v[28:31], v[88:91], v[120:123]
 ds_read_b64_tr_b16 v[54:55], v6 offset:25248
 v_mfma_f32_16x16x32_bf16 v[116:119], v[28:31], v[84:87], v[116:119]
 ds_read_b64_tr_b16 v[56:57], v6 offset:14528
 v_mfma_f32_16x16x32_bf16 v[112:115], v[28:31], v[80:83], v[112:115]
 ds_read_b64_tr_b16 v[58:59], v6 offset:18112
 v_mfma_f32_16x16x32_bf16 v[128:131], v[32:35], v[80:83], v[128:131]
 ds_read_b64_tr_b16 v[60:61], v6 offset:21696
 v_mfma_f32_16x16x32_bf16 v[132:135], v[32:35], v[84:87], v[132:135]
 ds_read_b64_tr_b16 v[62:63], v6 offset:25280
 v_mfma_f32_16x16x32_bf16 v[136:139], v[32:35], v[88:91], v[136:139]
 v_mfma_f32_16x16x32_bf16 v[140:143], v[32:35], v[92:95], v[140:143]
 v_mfma_f32_16x16x32_bf16 v[156:159], v[36:39], v[92:95], v[156:159]
 v_mfma_f32_16x16x32_bf16 v[152:155], v[36:39], v[88:91], v[152:155]
 v_mfma_f32_16x16x32_bf16 v[148:151], v[36:39], v[84:87], v[148:151]
 v_mfma_f32_16x16x32_bf16 v[144:147], v[36:39], v[80:83], v[144:147]
 v_mfma_f32_16x16x32_bf16 v[160:163], v[40:43], v[80:83], v[160:163]
 v_mfma_f32_16x16x32_bf16 v[164:167], v[40:43], v[84:87], v[164:167]
 v_mfma_f32_16x16x32_bf16 v[168:171], v[40:43], v[88:91], v[168:171]
 v_mfma_f32_16x16x32_bf16 v[172:175], v[40:43], v[92:95], v[172:175]
 s_waitcnt vmcnt(1) lgkmcnt(0)
 s_barrier
 s_setprio 1
 v_mfma_f32_16x16x32_bf16 v[188:191], v[44:47], v[92:95], v[188:191]
 ds_read_b128 v[64:67], v2 offset:32768
 v_mfma_f32_16x16x32_bf16 v[184:187], v[44:47], v[88:91], v[184:187]
 ds_read_b64_tr_b16 v[24:25], v4 offset:12288
 v_mfma_f32_16x16x32_bf16 v[180:183], v[44:47], v[84:87], v[180:183]
 ds_read_b64_tr_b16 v[26:27], v4 offset:15360
 v_mfma_f32_16x16x32_bf16 v[176:179], v[44:47], v[80:83], v[176:179]
 ds_read_b128 v[68:71], v2 offset:34816
 v_mfma_f32_16x16x32_bf16 v[192:195], v[48:51], v[80:83], v[192:195]
 ds_read_b128 v[72:75], v2 offset:36864
 s_cmp_eq_u32 s84, s87
 s_cbranch_scc1 Lcs_115
Lcb_114:
 v_mfma_f32_16x16x32_bf16 v[196:199], v[48:51], v[84:87], v[196:199]
 ds_read_b128 v[76:79], v2 offset:38912
 v_mfma_f32_16x16x32_bf16 v[200:203], v[48:51], v[88:91], v[200:203]
 ds_read_b64_tr_b16 v[28:29], v5 offset:12288
 v_mfma_f32_16x16x32_bf16 v[204:207], v[48:51], v[92:95], v[204:207]
 ds_read_b64_tr_b16 v[30:31], v5 offset:15360
 v_mfma_f32_16x16x32_bf16 v[220:223], v[52:55], v[92:95], v[220:223]
 ds_read_b64_tr_b16 v[32:33], v6 offset:28768
 v_mfma_f32_16x16x32_bf16 v[216:219], v[52:55], v[88:91], v[216:219]
 ds_read_b64_tr_b16 v[34:35], v6 offset:32352
 v_mfma_f32_16x16x32_bf16 v[212:215], v[52:55], v[84:87], v[212:215]
 ds_read_b64_tr_b16 v[36:37], v6 offset:35936
 v_mfma_f32_16x16x32_bf16 v[208:211], v[52:55], v[80:83], v[208:211]
 ds_read_b64_tr_b16 v[38:39], v6 offset:39520
 s_mov_b32 m0, s52
 v_mfma_f32_16x16x32_bf16 v[224:227], v[56:59], v[80:83], v[224:227]
 ds_read_b64_tr_b16 v[40:41], v6 offset:28800
 buffer_load_dwordx4 v7, s[16:19], s72 offen offset:0 lds
 s_add_u32 s72, s72, 0x3c00
 v_mfma_f32_16x16x32_bf16 v[228:231], v[56:59], v[84:87], v[228:231]
 ds_read_b64_tr_b16 v[42:43], v6 offset:32384
 v_mfma_f32_16x16x32_bf16 v[232:235], v[56:59], v[88:91], v[232:235]
 buffer_load_dwordx4 v7, s[16:19], s72 offen offset:1024 lds
 s_add_u32 s72, s72, 0x3c00
 v_mfma_f32_16x16x32_bf16 v[236:239], v[56:59], v[92:95], v[236:239]
 v_mfma_f32_16x16x32_bf16 v[252:255], v[60:63], v[92:95], v[252:255]
 buffer_load_dwordx4 v7, s[16:19], s72 offen offset:2048 lds
 s_add_u32 s72, s72, 0x3c00
 v_mfma_f32_16x16x32_bf16 v[248:251], v[60:63], v[88:91], v[248:251]
 v_mfma_f32_16x16x32_bf16 v[244:247], v[60:63], v[84:87], v[244:247]
 buffer_load_dwordx4 v7, s[16:19], s72 offen offset:3072 lds
 s_add_u32 s72, s72, 0x4c00
 s_setprio 0
 v_mfma_f32_16x16x32_bf16 v[240:243], v[60:63], v[80:83], v[240:243]
 s_waitcnt lgkmcnt(0)
 v_mfma_f32_16x16x32_bf16 v[96:99], v[24:27], v[64:67], v[96:99]
 ds_read_b64_tr_b16 v[44:45], v6 offset:35968
 v_mfma_f32_16x16x32_bf16 v[100:103], v[24:27], v[68:71], v[100:103]
 ds_read_b64_tr_b16 v[46:47], v6 offset:39552
 v_mfma_f32_16x16x32_bf16 v[104:107], v[24:27], v[72:75], v[104:107]
 ds_read_b64_tr_b16 v[48:49], v6 offset:28832
 v_mfma_f32_16x16x32_bf16 v[108:111], v[24:27], v[76:79], v[108:111]
 ds_read_b64_tr_b16 v[50:51], v6 offset:32416
 v_mfma_f32_16x16x32_bf16 v[124:127], v[28:31], v[76:79], v[124:127]
 ds_read_b64_tr_b16 v[52:53], v6 offset:36000
 s_cmp_eq_u32 s84, s86
 s_cbranch_scc1 Lcs_118
Lcb_117:
 v_mfma_f32_16x16x32_bf16 v[120:123], v[28:31], v[72:75], v[120:123]
 ds_read_b64_tr_b16 v[54:55], v6 offset:39584
 v_mfma_f32_16x16x32_bf16 v[116:119], v[28:31], v[68:71], v[116:119]
 ds_read_b64_tr_b16 v[56:57], v6 offset:28864
 v_mfma_f32_16x16x32_bf16 v[112:115], v[28:31], v[64:67], v[112:115]
 ds_read_b64_tr_b16 v[58:59], v6 offset:32448
 s_mov_b32 m0, s53
 v_mfma_f32_16x16x32_bf16 v[128:131], v[32:35], v[64:67], v[128:131]
 ds_read_b64_tr_b16 v[60:61], v6 offset:36032
 buffer_load_dwordx4 v7, s[16:19], s72 offen offset:0 lds
 s_add_u32 s72, s72, 0x3c00
 v_mfma_f32_16x16x32_bf16 v[132:135], v[32:35], v[68:71], v[132:135]
 ds_read_b64_tr_b16 v[62:63], v6 offset:39616
 v_mfma_f32_16x16x32_bf16 v[136:139], v[32:35], v[72:75], v[136:139]
 buffer_load_dwordx4 v7, s[16:19], s72 offen offset:1024 lds
 s_add_u32 s72, s72, 0x3c00
 v_mfma_f32_16x16x32_bf16 v[140:143], v[32:35], v[76:79], v[140:143]
 v_mfma_f32_16x16x32_bf16 v[156:159], v[36:39], v[76:79], v[156:159]
 buffer_load_dwordx4 v7, s[16:19], s72 offen offset:2048 lds
 s_add_u32 s72, s72, 0x3c00
 v_mfma_f32_16x16x32_bf16 v[152:155], v[36:39], v[72:75], v[152:155]
 v_mfma_f32_16x16x32_bf16 v[148:151], v[36:39], v[68:71], v[148:151]
 buffer_load_dwordx4 v7, s[16:19], s72 offen offset:3072 lds
 s_add_u32 s72, s72, s77
 v_mfma_f32_16x16x32_bf16 v[144:147], v[36:39], v[64:67], v[144:147]
 v_mfma_f32_16x16x32_bf16 v[160:163], v[40:43], v[64:67], v[160:163]
 v_mfma_f32_16x16x32_bf16 v[164:167], v[40:43], v[68:71], v[164:167]
 v_mfma_f32_16x16x32_bf16 v[168:171], v[40:43], v[72:75], v[168:171]
 v_mfma_f32_16x16x32_bf16 v[172:175], v[40:43], v[76:79], v[172:175]
 s_waitcnt lgkmcnt(0)
 s_barrier
 s_setprio 1
 v_mfma_f32_16x16x32_bf16 v[188:191], v[44:47], v[76:79], v[188:191]
 ds_read_b128 v[80:83], v3 offset:32768
 buffer_load_dword v22, v21, s[32:35], s73 offen sc1
 s_add_u32 s73, s73, s78
 s_min_u32 s73, s73, s79
 v_mfma_f32_16x16x32_bf16 v[184:187], v[44:47], v[72:75], v[184:187]
 ds_read_b64_tr_b16 v[24:25], v4 offset:18432
 v_mfma_f32_16x16x32_bf16 v[180:183], v[44:47], v[68:71], v[180:183]
 ds_read_b64_tr_b16 v[26:27], v4 offset:21504
 v_mfma_f32_16x16x32_bf16 v[176:179], v[44:47], v[64:67], v[176:179]
 ds_read_b128 v[84:87], v3 offset:34816
 v_mfma_f32_16x16x32_bf16 v[192:195], v[48:51], v[64:67], v[192:195]
 ds_read_b128 v[88:91], v3 offset:36864
 s_cmp_eq_u32 s84, s87
 s_cbranch_scc1 Lcs_121
Lcb_120:
 v_mfma_f32_16x16x32_bf16 v[196:199], v[48:51], v[68:71], v[196:199]
 ds_read_b128 v[92:95], v3 offset:38912
 v_mfma_f32_16x16x32_bf16 v[200:203], v[48:51], v[72:75], v[200:203]
 ds_read_b64_tr_b16 v[28:29], v5 offset:18432
 v_mfma_f32_16x16x32_bf16 v[204:207], v[48:51], v[76:79], v[204:207]
 ds_read_b64_tr_b16 v[30:31], v5 offset:21504
 v_mfma_f32_16x16x32_bf16 v[220:223], v[52:55], v[76:79], v[220:223]
 ds_read_b64_tr_b16 v[32:33], v6 offset:43104
 v_mfma_f32_16x16x32_bf16 v[216:219], v[52:55], v[72:75], v[216:219]
 ds_read_b64_tr_b16 v[34:35], v6 offset:46688
 v_mfma_f32_16x16x32_bf16 v[212:215], v[52:55], v[68:71], v[212:215]
 ds_read_b64_tr_b16 v[36:37], v6 offset:50272
 v_mfma_f32_16x16x32_bf16 v[208:211], v[52:55], v[64:67], v[208:211]
 ds_read_b64_tr_b16 v[38:39], v6 offset:53856
 v_mfma_f32_16x16x32_bf16 v[224:227], v[56:59], v[64:67], v[224:227]
 ds_read_b64_tr_b16 v[40:41], v6 offset:43136
 v_mfma_f32_16x16x32_bf16 v[228:231], v[56:59], v[68:71], v[228:231]
 ds_read_b64_tr_b16 v[42:43], v6 offset:46720
 v_mfma_f32_16x16x32_bf16 v[232:235], v[56:59], v[72:75], v[232:235]
 v_mfma_f32_16x16x32_bf16 v[236:239], v[56:59], v[76:79], v[236:239]
 v_mfma_f32_16x16x32_bf16 v[252:255], v[60:63], v[76:79], v[252:255]
 v_mfma_f32_16x16x32_bf16 v[248:251], v[60:63], v[72:75], v[248:251]
 v_mfma_f32_16x16x32_bf16 v[244:247], v[60:63], v[68:71], v[244:247]
 s_setprio 0
 v_mfma_f32_16x16x32_bf16 v[240:243], v[60:63], v[64:67], v[240:243]
 s_waitcnt lgkmcnt(0)
 v_mfma_f32_16x16x32_bf16 v[96:99], v[24:27], v[80:83], v[96:99]
 ds_read_b64_tr_b16 v[44:45], v6 offset:50304
 v_mfma_f32_16x16x32_bf16 v[100:103], v[24:27], v[84:87], v[100:103]
 ds_read_b64_tr_b16 v[46:47], v6 offset:53888
 v_mfma_f32_16x16x32_bf16 v[104:107], v[24:27], v[88:91], v[104:107]
 ds_read_b64_tr_b16 v[48:49], v6 offset:43168
 v_mfma_f32_16x16x32_bf16 v[108:111], v[24:27], v[92:95], v[108:111]
 ds_read_b64_tr_b16 v[50:51], v6 offset:46752
 v_mfma_f32_16x16x32_bf16 v[124:127], v[28:31], v[92:95], v[124:127]
 ds_read_b64_tr_b16 v[52:53], v6 offset:50336
 s_cmp_eq_u32 s84, s86
 s_cbranch_scc1 Lcs_124
Lcb_123:
 v_mfma_f32_16x16x32_bf16 v[120:123], v[28:31], v[88:91], v[120:123]
 ds_read_b64_tr_b16 v[54:55], v6 offset:53920
 v_mfma_f32_16x16x32_bf16 v[116:119], v[28:31], v[84:87], v[116:119]
 ds_read_b64_tr_b16 v[56:57], v6 offset:43200
 v_mfma_f32_16x16x32_bf16 v[112:115], v[28:31], v[80:83], v[112:115]
 ds_read_b64_tr_b16 v[58:59], v6 offset:46784
 v_mfma_f32_16x16x32_bf16 v[128:131], v[32:35], v[80:83], v[128:131]
 ds_read_b64_tr_b16 v[60:61], v6 offset:50368
 v_mfma_f32_16x16x32_bf16 v[132:135], v[32:35], v[84:87], v[132:135]
 ds_read_b64_tr_b16 v[62:63], v6 offset:53952
 v_mfma_f32_16x16x32_bf16 v[136:139], v[32:35], v[88:91], v[136:139]
 v_mfma_f32_16x16x32_bf16 v[140:143], v[32:35], v[92:95], v[140:143]
 v_mfma_f32_16x16x32_bf16 v[156:159], v[36:39], v[92:95], v[156:159]
 v_mfma_f32_16x16x32_bf16 v[152:155], v[36:39], v[88:91], v[152:155]
 v_mfma_f32_16x16x32_bf16 v[148:151], v[36:39], v[84:87], v[148:151]
 v_mfma_f32_16x16x32_bf16 v[144:147], v[36:39], v[80:83], v[144:147]
 v_mfma_f32_16x16x32_bf16 v[160:163], v[40:43], v[80:83], v[160:163]
 v_mfma_f32_16x16x32_bf16 v[164:167], v[40:43], v[84:87], v[164:167]
 v_mfma_f32_16x16x32_bf16 v[168:171], v[40:43], v[88:91], v[168:171]
 v_mfma_f32_16x16x32_bf16 v[172:175], v[40:43], v[92:95], v[172:175]
 s_waitcnt vmcnt(1) lgkmcnt(0)
 s_barrier
 s_setprio 1
 v_mfma_f32_16x16x32_bf16 v[188:191], v[44:47], v[92:95], v[188:191]
 ds_read_b128 v[64:67], v2 offset:0
 v_mfma_f32_16x16x32_bf16 v[184:187], v[44:47], v[88:91], v[184:187]
 ds_read_b64_tr_b16 v[24:25], v4 offset:0
 v_mfma_f32_16x16x32_bf16 v[180:183], v[44:47], v[84:87], v[180:183]
 ds_read_b64_tr_b16 v[26:27], v4 offset:3072
 v_mfma_f32_16x16x32_bf16 v[176:179], v[44:47], v[80:83], v[176:179]
 ds_read_b128 v[68:71], v2 offset:2048
 v_mfma_f32_16x16x32_bf16 v[192:195], v[48:51], v[80:83], v[192:195]
 ds_read_b128 v[72:75], v2 offset:4096
 s_cmp_eq_u32 s84, s87
 s_cbranch_scc1 Lcs_127
Lcb_126:
 v_mfma_f32_16x16x32_bf16 v[196:199], v[48:51], v[84:87], v[196:199]
 ds_read_b128 v[76:79], v2 offset:6144
 v_mfma_f32_16x16x32_bf16 v[200:203], v[48:51], v[88:91], v[200:203]
 ds_read_b64_tr_b16 v[28:29], v5 offset:0
 v_mfma_f32_16x16x32_bf16 v[204:207], v[48:51], v[92:95], v[204:207]
 ds_read_b64_tr_b16 v[30:31], v5 offset:3072
 v_mfma_f32_16x16x32_bf16 v[220:223], v[52:55], v[92:95], v[220:223]
 ds_read_b64_tr_b16 v[32:33], v6 offset:96
 v_mfma_f32_16x16x32_bf16 v[216:219], v[52:55], v[88:91], v[216:219]
 ds_read_b64_tr_b16 v[34:35], v6 offset:3680
 v_mfma_f32_16x16x32_bf16 v[212:215], v[52:55], v[84:87], v[212:215]
 ds_read_b64_tr_b16 v[36:37], v6 offset:7264
 v_mfma_f32_16x16x32_bf16 v[208:211], v[52:55], v[80:83], v[208:211]
 ds_read_b64_tr_b16 v[38:39], v6 offset:10848
 s_mov_b32 m0, s54
 v_mfma_f32_16x16x32_bf16 v[224:227], v[56:59], v[80:83], v[224:227]
 ds_read_b64_tr_b16 v[40:41], v6 offset:128
 buffer_load_dwordx4 v7, s[16:19], s72 offen offset:0 lds
 s_add_u32 s72, s72, 0x3c00
 v_mfma_f32_16x16x32_bf16 v[228:231], v[56:59], v[84:87], v[228:231]
 ds_read_b64_tr_b16 v[42:43], v6 offset:3712
 v_mfma_f32_16x16x32_bf16 v[232:235], v[56:59], v[88:91], v[232:235]
 buffer_load_dwordx4 v7, s[16:19], s72 offen offset:1024 lds
 s_add_u32 s72, s72, 0x3c00
 v_mfma_f32_16x16x32_bf16 v[236:239], v[56:59], v[92:95], v[236:239]
 v_mfma_f32_16x16x32_bf16 v[252:255], v[60:63], v[92:95], v[252:255]
 buffer_load_dwordx4 v7, s[16:19], s72 offen offset:2048 lds
 s_add_u32 s72, s72, 0x3c00
 s_cmp_eq_u32 s84, s89
 s_cbranch_scc1 Lrp_129
Lrq_130:
 v_mfma_f32_16x16x32_bf16 v[248:251], v[60:63], v[88:91], v[248:251]
 v_mfma_f32_16x16x32_bf16 v[244:247], v[60:63], v[84:87], v[244:247]
 buffer_load_dwordx4 v7, s[16:19], s72 offen offset:3072 lds
 s_add_u32 s72, s72, 0x4c00
 s_setprio 0
 v_mfma_f32_16x16x32_bf16 v[240:243], v[60:63], v[80:83], v[240:243]
 s_waitcnt lgkmcnt(0)
 s_mov_b32 s84, 6
L1_loop1:
 v_mfma_f32_16x16x32_bf16 v[96:99], v[24:27], v[64:67], v[96:99]
 ds_read_b64_tr_b16 v[44:45], v6 offset:7296
 v_mfma_f32_16x16x32_bf16 v[100:103], v[24:27], v[68:71], v[100:103]
 ds_read_b64_tr_b16 v[46:47], v6 offset:10880
 v_mfma_f32_16x16x32_bf16 v[104:107], v[24:27], v[72:75], v[104:107]
 ds_read_b64_tr_b16 v[48:49], v6 offset:160
 v_mfma_f32_16x16x32_bf16 v[108:111], v[24:27], v[76:79], v[108:111]
 ds_read_b64_tr_b16 v[50:51], v6 offset:3744
 v_mfma_f32_16x16x32_bf16 v[124:127], v[28:31], v[76:79], v[124:127]
 ds_read_b64_tr_b16 v[52:53], v6 offset:7328
 s_cmp_eq_u32 s84, s86
 s_cbranch_scc1 Lcs_132
Lcb_131:
 v_mfma_f32_16x16x32_bf16 v[120:123], v[28:31], v[72:75], v[120:123]
 ds_read_b64_tr_b16 v[54:55], v6 offset:10912
 v_mfma_f32_16x16x32_bf16 v[116:119], v[28:31], v[68:71], v[116:119]
 ds_read_b64_tr_b16 v[56:57], v6 offset:192
 v_mfma_f32_16x16x32_bf16 v[112:115], v[28:31], v[64:67], v[112:115]
 ds_read_b64_tr_b16 v[58:59], v6 offset:3776
 s_mov_b32 m0, s55
 v_mfma_f32_16x16x32_bf16 v[128:131], v[32:35], v[64:67], v[128:131]
 ds_read_b64_tr_b16 v[60:61], v6 offset:7360
 buffer_load_dwordx4 v7, s[16:19], s72 offen offset:0 lds
 s_add_u32 s72, s72, 0x3c00
 v_mfma_f32_16x16x32_bf16 v[132:135], v[32:35], v[68:71], v[132:135]
 ds_read_b64_tr_b16 v[62:63], v6 offset:10944
 v_mfma_f32_16x16x32_bf16 v[136:139], v[32:35], v[72:75], v[136:139]
 buffer_load_dwordx4 v7, s[16:19], s72 offen offset:1024 lds
 s_add_u32 s72, s72, 0x3c00
 v_mfma_f32_16x16x32_bf16 v[140:143], v[32:35], v[76:79], v[140:143]
 v_mfma_f32_16x16x32_bf16 v[156:159], v[36:39], v[76:79], v[156:159]
 buffer_load_dwordx4 v7, s[16:19], s72 offen offset:2048 lds
 s_add_u32 s72, s72, 0x3c00
 v_mfma_f32_16x16x32_bf16 v[152:155], v[36:39], v[72:75], v[152:155]
 v_mfma_f32_16x16x32_bf16 v[148:151], v[36:39], v[68:71], v[148:151]
 buffer_load_dwordx4 v7, s[16:19], s72 offen offset:3072 lds
 s_add_u32 s72, s72, s77
 v_mfma_f32_16x16x32_bf16 v[144:147], v[36:39], v[64:67], v[144:147]
 v_mfma_f32_16x16x32_bf16 v[160:163], v[40:43], v[64:67], v[160:163]
 v_mfma_f32_16x16x32_bf16 v[164:167], v[40:43], v[68:71], v[164:167]
 v_mfma_f32_16x16x32_bf16 v[168:171], v[40:43], v[72:75], v[168:171]
 v_mfma_f32_16x16x32_bf16 v[172:175], v[40:43], v[76:79], v[172:175]
 s_waitcnt lgkmcnt(0)
 s_barrier
 s_setprio 1
 v_mfma_f32_16x16x32_bf16 v[188:191], v[44:47], v[76:79], v[188:191]
 ds_read_b128 v[80:83], v3 offset:0
 buffer_load_dword v22, v21, s[32:35], s73 offen sc1
 s_add_u32 s73, s73, s78
 s_min_u32 s73, s73, s79
 v_mfma_f32_16x16x32_bf16 v[184:187], v[44:47], v[72:75], v[184:187]
 ds_read_b64_tr_b16 v[24:25], v4 offset:6144
 v_mfma_f32_16x16x32_bf16 v[180:183], v[44:47], v[68:71], v[180:183]
 ds_read_b64_tr_b16 v[26:27], v4 offset:9216
 v_mfma_f32_16x16x32_bf16 v[176:179], v[44:47], v[64:67], v[176:179]
 ds_read_b128 v[84:87], v3 offset:2048
 v_mfma_f32_16x16x32_bf16 v[192:195], v[48:51], v[64:67], v[192:195]
 ds_read_b128 v[88:91], v3 offset:4096
 s_cmp_eq_u32 s84, s87
 s_cbranch_scc1 Lcs_135
Lcb_134:
 v_mfma_f32_16x16x32_bf16 v[196:199], v[48:51], v[68:71], v[196:199]
 ds_read_b128 v[92:95], v3 offset:6144
 v_mfma_f32_16x16x32_bf16 v[200:203], v[48:51], v[72:75], v[200:203]
 ds_read_b64_tr_b16 v[28:29], v5 offset:6144
 v_mfma_f32_16x16x32_bf16 v[204:207], v[48:51], v[76:79], v[204:207]
 ds_read_b64_tr_b16 v[30:31], v5 offset:9216
 v_mfma_f32_16x16x32_bf16 v[220:223], v[52:55], v[76:79], v[220:223]
 ds_read_b64_tr_b16 v[32:33], v6 offset:14432
 v_mfma_f32_16x16x32_bf16 v[216:219], v[52:55], v[72:75], v[216:219]
 ds_read_b64_tr_b16 v[34:35], v6 offset:18016
 v_mfma_f32_16x16x32_bf16 v[212:215], v[52:55], v[68:71], v[212:215]
 ds_read_b64_tr_b16 v[36:37], v6 offset:21600
 v_mfma_f32_16x16x32_bf16 v[208:211], v[52:55], v[64:67], v[208:211]
 ds_read_b64_tr_b16 v[38:39], v6 offset:25184
 v_mfma_f32_16x16x32_bf16 v[224:227], v[56:59], v[64:67], v[224:227]
 ds_read_b64_tr_b16 v[40:41], v6 offset:14464
 v_mfma_f32_16x16x32_bf16 v[228:231], v[56:59], v[68:71], v[228:231]
 ds_read_b64_tr_b16 v[42:43], v6 offset:18048
 v_mfma_f32_16x16x32_bf16 v[232:235], v[56:59], v[72:75], v[232:235]
 v_mfma_f32_16x16x32_bf16 v[236:239], v[56:59], v[76:79], v[236:239]
 v_mfma_f32_16x16x32_bf16 v[252:255], v[60:63], v[76:79], v[252:255]
 v_mfma_f32_16x16x32_bf16 v[248:251], v[60:63], v[72:75], v[248:251]
 v_mfma_f32_16x16x32_bf16 v[244:247], v[60:63], v[68:71], v[244:247]
 s_setprio 0
 v_mfma_f32_16x16x32_bf16 v[240:243], v[60:63], v[64:67], v[240:243]
 s_waitcnt lgkmcnt(0)
 v_mfma_f32_16x16x32_bf16 v[96:99], v[24:27], v[80:83], v[96:99]
 ds_read_b64_tr_b16 v[44:45], v6 offset:21632
 v_mfma_f32_16x16x32_bf16 v[100:103], v[24:27], v[84:87], v[100:103]
 ds_read_b64_tr_b16 v[46:47], v6 offset:25216
 v_mfma_f32_16x16x32_bf16 v[104:107], v[24:27], v[88:91], v[104:107]
 ds_read_b64_tr_b16 v[48:49], v6 offset:14496
 v_mfma_f32_16x16x32_bf16 v[108:111], v[24:27], v[92:95], v[108:111]
 ds_read_b64_tr_b16 v[50:51], v6 offset:18080
 v_mfma_f32_16x16x32_bf16 v[124:127], v[28:31], v[92:95], v[124:127]
 ds_read_b64_tr_b16 v[52:53], v6 offset:21664
 s_cmp_eq_u32 s84, s86
 s_cbranch_scc1 Lcs_138
Lcb_137:
 v_mfma_f32_16x16x32_bf16 v[120:123], v[28:31], v[88:91], v[120:123]
 ds_read_b64_tr_b16 v[54:55], v6 offset:25248
 v_mfma_f32_16x16x32_bf16 v[116:119], v[28:31], v[84:87], v[116:119]
 ds_read_b64_tr_b16 v[56:57], v6 offset:14528
 v_mfma_f32_16x16x32_bf16 v[112:115], v[28:31], v[80:83], v[112:115]
 ds_read_b64_tr_b16 v[58:59], v6 offset:18112
 v_mfma_f32_16x16x32_bf16 v[128:131], v[32:35], v[80:83], v[128:131]
 ds_read_b64_tr_b16 v[60:61], v6 offset:21696
 v_mfma_f32_16x16x32_bf16 v[132:135], v[32:35], v[84:87], v[132:135]
 ds_read_b64_tr_b16 v[62:63], v6 offset:25280
 v_mfma_f32_16x16x32_bf16 v[136:139], v[32:35], v[88:91], v[136:139]
 v_mfma_f32_16x16x32_bf16 v[140:143], v[32:35], v[92:95], v[140:143]
 v_mfma_f32_16x16x32_bf16 v[156:159], v[36:39], v[92:95], v[156:159]
 v_mfma_f32_16x16x32_bf16 v[152:155], v[36:39], v[88:91], v[152:155]
 v_mfma_f32_16x16x32_bf16 v[148:151], v[36:39], v[84:87], v[148:151]
 v_mfma_f32_16x16x32_bf16 v[144:147], v[36:39], v[80:83], v[144:147]
 v_mfma_f32_16x16x32_bf16 v[160:163], v[40:43], v[80:83], v[160:163]
 v_mfma_f32_16x16x32_bf16 v[164:167], v[40:43], v[84:87], v[164:167]
 v_mfma_f32_16x16x32_bf16 v[168:171], v[40:43], v[88:91], v[168:171]
 v_mfma_f32_16x16x32_bf16 v[172:175], v[40:43], v[92:95], v[172:175]
 s_waitcnt vmcnt(1) lgkmcnt(0)
 s_barrier
 s_setprio 1
 v_mfma_f32_16x16x32_bf16 v[188:191], v[44:47], v[92:95], v[188:191]
 ds_read_b128 v[64:67], v2 offset:32768
 v_mfma_f32_16x16x32_bf16 v[184:187], v[44:47], v[88:91], v[184:187]
 ds_read_b64_tr_b16 v[24:25], v4 offset:12288
 v_mfma_f32_16x16x32_bf16 v[180:183], v[44:47], v[84:87], v[180:183]
 ds_read_b64_tr_b16 v[26:27], v4 offset:15360
 v_mfma_f32_16x16x32_bf16 v[176:179], v[44:47], v[80:83], v[176:179]
 ds_read_b128 v[68:71], v2 offset:34816
 v_mfma_f32_16x16x32_bf16 v[192:195], v[48:51], v[80:83], v[192:195]
 ds_read_b128 v[72:75], v2 offset:36864
 s_cmp_eq_u32 s84, s87
 s_cbranch_scc1 Lcs_141
Lcb_140:
 v_mfma_f32_16x16x32_bf16 v[196:199], v[48:51], v[84:87], v[196:199]
 ds_read_b128 v[76:79], v2 offset:38912
 v_mfma_f32_16x16x32_bf16 v[200:203], v[48:51], v[88:91], v[200:203]
 ds_read_b64_tr_b16 v[28:29], v5 offset:12288
 v_mfma_f32_16x16x32_bf16 v[204:207], v[48:51], v[92:95], v[204:207]
 ds_read_b64_tr_b16 v[30:31], v5 offset:15360
 v_mfma_f32_16x16x32_bf16 v[220:223], v[52:55], v[92:95], v[220:223]
 ds_read_b64_tr_b16 v[32:33], v6 offset:28768
 v_mfma_f32_16x16x32_bf16 v[216:219], v[52:55], v[88:91], v[216:219]
 ds_read_b64_tr_b16 v[34:35], v6 offset:32352
 v_mfma_f32_16x16x32_bf16 v[212:215], v[52:55], v[84:87], v[212:215]
 ds_read_b64_tr_b16 v[36:37], v6 offset:35936
 v_mfma_f32_16x16x32_bf16 v[208:211], v[52:55], v[80:83], v[208:211]
 ds_read_b64_tr_b16 v[38:39], v6 offset:39520
 s_mov_b32 m0, s52
 v_mfma_f32_16x16x32_bf16 v[224:227], v[56:59], v[80:83], v[224:227]
 ds_read_b64_tr_b16 v[40:41], v6 offset:28800
 buffer_load_dwordx4 v7, s[16:19], s72 offen offset:0 lds
 s_add_u32 s72, s72, 0x3c00
 v_mfma_f32_16x16x32_bf16 v[228:231], v[56:59], v[84:87], v[228:231]
 ds_read_b64_tr_b16 v[42:43], v6 offset:32384
 v_mfma_f32_16x16x32_bf16 v[232:235], v[56:59], v[88:91], v[232:235]
 buffer_load_dwordx4 v7, s[16:19], s72 offen offset:1024 lds
 s_add_u32 s72, s72, 0x3c00
 v_mfma_f32_16x16x32_bf16 v[236:239], v[56:59], v[92:95], v[236:239]
 v_mfma_f32_16x16x32_bf16 v[252:255], v[60:63], v[92:95], v[252:255]
 buffer_load_dwordx4 v7, s[16:19], s72 offen offset:2048 lds
 s_add_u32 s72, s72, 0x3c00
 v_mfma_f32_16x16x32_bf16 v[248:251], v[60:63], v[88:91], v[248:251]
 v_mfma_f32_16x16x32_bf16 v[244:247], v[60:63], v[84:87], v[244:247]
 buffer_load_dwordx4 v7, s[16:19], s72 offen offset:3072 lds
 s_add_u32 s72, s72, 0x4c00
 s_setprio 0
 v_mfma_f32_16x16x32_bf16 v[240:243], v[60:63], v[80:83], v[240:243]
 s_waitcnt lgkmcnt(0)
 v_mfma_f32_16x16x32_bf16 v[96:99], v[24:27], v[64:67], v[96:99]
 ds_read_b64_tr_b16 v[44:45], v6 offset:35968
 v_mfma_f32_16x16x32_bf16 v[100:103], v[24:27], v[68:71], v[100:103]
 ds_read_b64_tr_b16 v[46:47], v6 offset:39552
 s_cmp_eq_u32 s84, 4
 s_cbranch_scc1 Lrp_143
Lrq_144:
 v_mfma_f32_16x16x32_bf16 v[104:107], v[24:27], v[72:75], v[104:107]
 ds_read_b64_tr_b16 v[48:49], v6 offset:28832
 v_mfma_f32_16x16x32_bf16 v[108:111], v[24:27], v[76:79], v[108:111]
 ds_read_b64_tr_b16 v[50:51], v6 offset:32416
 v_mfma_f32_16x16x32_bf16 v[124:127], v[28:31], v[76:79], v[124:127]
 ds_read_b64_tr_b16 v[52:53], v6 offset:36000
 s_cmp_eq_u32 s84, s86
 s_cbranch_scc1 Lcs_146
Lcb_145:
 v_mfma_f32_16x16x32_bf16 v[120:123], v[28:31], v[72:75], v[120:123]
 ds_read_b64_tr_b16 v[54:55], v6 offset:39584
 v_mfma_f32_16x16x32_bf16 v[116:119], v[28:31], v[68:71], v[116:119]
 ds_read_b64_tr_b16 v[56:57], v6 offset:28864
 v_mfma_f32_16x16x32_bf16 v[112:115], v[28:31], v[64:67], v[112:115]
 ds_read_b64_tr_b16 v[58:59], v6 offset:32448
 s_mov_b32 m0, s53
 v_mfma_f32_16x16x32_bf16 v[128:131], v[32:35], v[64:67], v[128:131]
 ds_read_b64_tr_b16 v[60:61], v6 offset:36032
 buffer_load_dwordx4 v7, s[16:19], s72 offen offset:0 lds
 s_add_u32 s72, s72, 0x3c00
 v_mfma_f32_16x16x32_bf16 v[132:135], v[32:35], v[68:71], v[132:135]
 ds_read_b64_tr_b16 v[62:63], v6 offset:39616
 v_mfma_f32_16x16x32_bf16 v[136:139], v[32:35], v[72:75], v[136:139]
 buffer_load_dwordx4 v7, s[16:19], s72 offen offset:1024 lds
 s_add_u32 s72, s72, 0x3c00
 v_mfma_f32_16x16x32_bf16 v[140:143], v[32:35], v[76:79], v[140:143]
 v_mfma_f32_16x16x32_bf16 v[156:159], v[36:39], v[76:79], v[156:159]
 buffer_load_dwordx4 v7, s[16:19], s72 offen offset:2048 lds
 s_add_u32 s72, s72, 0x3c00
 v_mfma_f32_16x16x32_bf16 v[152:155], v[36:39], v[72:75], v[152:155]
 v_mfma_f32_16x16x32_bf16 v[148:151], v[36:39], v[68:71], v[148:151]
 buffer_load_dwordx4 v7, s[16:19], s72 offen offset:3072 lds
 s_add_u32 s72, s72, s77
 v_mfma_f32_16x16x32_bf16 v[144:147], v[36:39], v[64:67], v[144:147]
 v_mfma_f32_16x16x32_bf16 v[160:163], v[40:43], v[64:67], v[160:163]
 v_mfma_f32_16x16x32_bf16 v[164:167], v[40:43], v[68:71], v[164:167]
 v_mfma_f32_16x16x32_bf16 v[168:171], v[40:43], v[72:75], v[168:171]
 v_mfma_f32_16x16x32_bf16 v[172:175], v[40:43], v[76:79], v[172:175]
 s_waitcnt lgkmcnt(0)
 s_barrier
 s_setprio 1
 v_mfma_f32_16x16x32_bf16 v[188:191], v[44:47], v[76:79], v[188:191]
 ds_read_b128 v[80:83], v3 offset:32768
 buffer_load_dword v22, v21, s[32:35], s73 offen sc1
 s_add_u32 s73, s73, s78
 s_min_u32 s73, s73, s79
 v_mfma_f32_16x16x32_bf16 v[184:187], v[44:47], v[72:75], v[184:187]
 ds_read_b64_tr_b16 v[24:25], v4 offset:18432
 v_mfma_f32_16x16x32_bf16 v[180:183], v[44:47], v[68:71], v[180:183]
 ds_read_b64_tr_b16 v[26:27], v4 offset:21504
 v_mfma_f32_16x16x32_bf16 v[176:179], v[44:47], v[64:67], v[176:179]
 ds_read_b128 v[84:87], v3 offset:34816
 v_mfma_f32_16x16x32_bf16 v[192:195], v[48:51], v[64:67], v[192:195]
 ds_read_b128 v[88:91], v3 offset:36864
 s_cmp_eq_u32 s84, s87
 s_cbranch_scc1 Lcs_149
Lcb_148:
 v_mfma_f32_16x16x32_bf16 v[196:199], v[48:51], v[68:71], v[196:199]
 ds_read_b128 v[92:95], v3 offset:38912
 v_mfma_f32_16x16x32_bf16 v[200:203], v[48:51], v[72:75], v[200:203]
 ds_read_b64_tr_b16 v[28:29], v5 offset:18432
 v_mfma_f32_16x16x32_bf16 v[204:207], v[48:51], v[76:79], v[204:207]
 ds_read_b64_tr_b16 v[30:31], v5 offset:21504
 v_mfma_f32_16x16x32_bf16 v[220:223], v[52:55], v[76:79], v[220:223]
 ds_read_b64_tr_b16 v[32:33], v6 offset:43104
 v_mfma_f32_16x16x32_bf16 v[216:219], v[52:55], v[72:75], v[216:219]
 ds_read_b64_tr_b16 v[34:35], v6 offset:46688
 v_mfma_f32_16x16x32_bf16 v[212:215], v[52:55], v[68:71], v[212:215]
 ds_read_b64_tr_b16 v[36:37], v6 offset:50272
 v_mfma_f32_16x16x32_bf16 v[208:211], v[52:55], v[64:67], v[208:211]
 ds_read_b64_tr_b16 v[38:39], v6 offset:53856
 v_mfma_f32_16x16x32_bf16 v[224:227], v[56:59], v[64:67], v[224:227]
 ds_read_b64_tr_b16 v[40:41], v6 offset:43136
 v_mfma_f32_16x16x32_bf16 v[228:231], v[56:59], v[68:71], v[228:231]
 ds_read_b64_tr_b16 v[42:43], v6 offset:46720
 v_mfma_f32_16x16x32_bf16 v[232:235], v[56:59], v[72:75], v[232:235]
 v_mfma_f32_16x16x32_bf16 v[236:239], v[56:59], v[76:79], v[236:239]
 v_mfma_f32_16x16x32_bf16 v[252:255], v[60:63], v[76:79], v[252:255]
 v_mfma_f32_16x16x32_bf16 v[248:251], v[60:63], v[72:75], v[248:251]
 v_mfma_f32_16x16x32_bf16 v[244:247], v[60:63], v[68:71], v[244:247]
 s_setprio 0
 v_mfma_f32_16x16x32_bf16 v[240:243], v[60:63], v[64:67], v[240:243]
 s_waitcnt lgkmcnt(0)
 v_mfma_f32_16x16x32_bf16 v[96:99], v[24:27], v[80:83], v[96:99]
 ds_read_b64_tr_b16 v[44:45], v6 offset:50304
 v_mfma_f32_16x16x32_bf16 v[100:103], v[24:27], v[84:87], v[100:103]
 ds_read_b64_tr_b16 v[46:47], v6 offset:53888
 v_mfma_f32_16x16x32_bf16 v[104:107], v[24:27], v[88:91], v[104:107]
 ds_read_b64_tr_b16 v[48:49], v6 offset:43168
 v_mfma_f32_16x16x32_bf16 v[108:111], v[24:27], v[92:95], v[108:111]
 ds_read_b64_tr_b16 v[50:51], v6 offset:46752
 v_mfma_f32_16x16x32_bf16 v[124:127], v[28:31], v[92:95], v[124:127]
 ds_read_b64_tr_b16 v[52:53], v6 offset:50336
 s_cmp_eq_u32 s84, s86
 s_cbranch_scc1 Lcs_152
Lcb_151:
 v_mfma_f32_16x16x32_bf16 v[120:123], v[28:31], v[88:91], v[120:123]
 ds_read_b64_tr_b16 v[54:55], v6 offset:53920
 v_mfma_f32_16x16x32_bf16 v[116:119], v[28:31], v[84:87], v[116:119]
 ds_read_b64_tr_b16 v[56:57], v6 offset:43200
 v_mfma_f32_16x16x32_bf16 v[112:115], v[28:31], v[80:83], v[112:115]
 ds_read_b64_tr_b16 v[58:59], v6 offset:46784
 v_mfma_f32_16x16x32_bf16 v[128:131], v[32:35], v[80:83], v[128:131]
 ds_read_b64_tr_b16 v[60:61], v6 offset:50368
 v_mfma_f32_16x16x32_bf16 v[132:135], v[32:35], v[84:87], v[132:135]
 ds_read_b64_tr_b16 v[62:63], v6 offset:53952
 v_mfma_f32_16x16x32_bf16 v[136:139], v[32:35], v[88:91], v[136:139]
 v_mfma_f32_16x16x32_bf16 v[140:143], v[32:35], v[92:95], v[140:143]
 v_mfma_f32_16x16x32_bf16 v[156:159], v[36:39], v[92:95], v[156:159]
 v_mfma_f32_16x16x32_bf16 v[152:155], v[36:39], v[88:91], v[152:155]
 v_mfma_f32_16x16x32_bf16 v[148:151], v[36:39], v[84:87], v[148:151]
 v_mfma_f32_16x16x32_bf16 v[144:147], v[36:39], v[80:83], v[144:147]
 v_mfma_f32_16x16x32_bf16 v[160:163], v[40:43], v[80:83], v[160:163]
 v_mfma_f32_16x16x32_bf16 v[164:167], v[40:43], v[84:87], v[164:167]
 v_mfma_f32_16x16x32_bf16 v[168:171], v[40:43], v[88:91], v[168:171]
 v_mfma_f32_16x16x32_bf16 v[172:175], v[40:43], v[92:95], v[172:175]
 s_waitcnt vmcnt(1) lgkmcnt(0)
 s_barrier
 s_setprio 1
 v_mfma_f32_16x16x32_bf16 v[188:191], v[44:47], v[92:95], v[188:191]
 ds_read_b128 v[64:67], v2 offset:0
 v_mfma_f32_16x16x32_bf16 v[184:187], v[44:47], v[88:91], v[184:187]
 ds_read_b64_tr_b16 v[24:25], v4 offset:0
 v_mfma_f32_16x16x32_bf16 v[180:183], v[44:47], v[84:87], v[180:183]
 ds_read_b64_tr_b16 v[26:27], v4 offset:3072
 v_mfma_f32_16x16x32_bf16 v[176:179], v[44:47], v[80:83], v[176:179]
 ds_read_b128 v[68:71], v2 offset:2048
 v_mfma_f32_16x16x32_bf16 v[192:195], v[48:51], v[80:83], v[192:195]
 ds_read_b128 v[72:75], v2 offset:4096
 s_cmp_eq_u32 s84, s87
 s_cbranch_scc1 Lcs_155
Lcb_154:
 v_mfma_f32_16x16x32_bf16 v[196:199], v[48:51], v[84:87], v[196:199]
 ds_read_b128 v[76:79], v2 offset:6144
 v_mfma_f32_16x16x32_bf16 v[200:203], v[48:51], v[88:91], v[200:203]
 ds_read_b64_tr_b16 v[28:29], v5 offset:0
 v_mfma_f32_16x16x32_bf16 v[204:207], v[48:51], v[92:95], v[204:207]
 ds_read_b64_tr_b16 v[30:31], v5 offset:3072
 v_mfma_f32_16x16x32_bf16 v[220:223], v[52:55], v[92:95], v[220:223]
 ds_read_b64_tr_b16 v[32:33], v6 offset:96
 v_mfma_f32_16x16x32_bf16 v[216:219], v[52:55], v[88:91], v[216:219]
 ds_read_b64_tr_b16 v[34:35], v6 offset:3680
 v_mfma_f32_16x16x32_bf16 v[212:215], v[52:55], v[84:87], v[212:215]
 ds_read_b64_tr_b16 v[36:37], v6 offset:7264
 v_mfma_f32_16x16x32_bf16 v[208:211], v[52:55], v[80:83], v[208:211]
 ds_read_b64_tr_b16 v[38:39], v6 offset:10848
 s_mov_b32 m0, s54
 v_mfma_f32_16x16x32_bf16 v[224:227], v[56:59], v[80:83], v[224:227]
 ds_read_b64_tr_b16 v[40:41], v6 offset:128
 buffer_load_dwordx4 v7, s[16:19], s72 offen offset:0 lds
 s_add_u32 s72, s72, 0x3c00
 v_mfma_f32_16x16x32_bf16 v[228:231], v[56:59], v[84:87], v[228:231]
 ds_read_b64_tr_b16 v[42:43], v6 offset:3712
 v_mfma_f32_16x16x32_bf16 v[232:235], v[56:59], v[88:91], v[232:235]
 buffer_load_dwordx4 v7, s[16:19], s72 offen offset:1024 lds
 s_add_u32 s72, s72, 0x3c00
 v_mfma_f32_16x16x32_bf16 v[236:239], v[56:59], v[92:95], v[236:239]
 v_mfma_f32_16x16x32_bf16 v[252:255], v[60:63], v[92:95], v[252:255]
 buffer_load_dwordx4 v7, s[16:19], s72 offen offset:2048 lds
 s_add_u32 s72, s72, 0x3c00
 s_cmp_eq_u32 s84, s89
 s_cbranch_scc1 Lrp_157
Lrq_158:
 v_mfma_f32_16x16x32_bf16 v[248:251], v[60:63], v[88:91], v[248:251]
 v_mfma_f32_16x16x32_bf16 v[244:247], v[60:63], v[84:87], v[244:247]
 buffer_load_dwordx4 v7, s[16:19], s72 offen offset:3072 lds
 s_add_u32 s72, s72, 0x4c00
 s_setprio 0
 v_mfma_f32_16x16x32_bf16 v[240:243], v[60:63], v[80:83], v[240:243]
 s_waitcnt lgkmcnt(0)
 s_sub_u32 s84, s84, 1
 s_cmp_lg_u32 s84, 0
 s_cbranch_scc1 L1_loop1
L1_last1:
 v_mfma_f32_16x16x32_bf16 v[96:99], v[24:27], v[64:67], v[96:99]
 ds_read_b64_tr_b16 v[44:45], v6 offset:7296
 v_lshlrev_b32 v21, 7, v1
 v_mov_b32 v22, 1073741824
 v_cmp_gt_u32 vcc, 48, v1
 s_nop 1
 v_cndmask_b32 v8, v22, v21, vcc
 v_mfma_f32_16x16x32_bf16 v[100:103], v[24:27], v[68:71], v[100:103]
 ds_read_b64_tr_b16 v[46:47], v6 offset:10880
 s_lshr_b32 s85, s93, 2
 s_lshl3_add_u32 s85, s4, s85
 s_mul_i32 s85, s85, 229376
 s_lshl2_add_u32 s86, s6, s7
 v_mfma_f32_16x16x32_bf16 v[104:107], v[24:27], v[72:75], v[104:107]
 ds_read_b64_tr_b16 v[48:49], v6 offset:160
 s_mul_i32 s86, s86, 6144
 s_add_u32 s91, s85, s86
 v_lshlrev_b32 v9, 5, v1
 s_lshl_b32 s90, s7, 11
 v_mfma_f32_16x16x32_bf16 v[108:111], v[24:27], v[76:79], v[108:111]
 ds_read_b64_tr_b16 v[50:51], v6 offset:3744
 s_add_u32 s90, s90, 90112
 s_mov_b32 s65, 0x07060302
 v_mfma_f32_16x16x32_bf16 v[124:127], v[28:31], v[76:79], v[124:127]
 ds_read_b64_tr_b16 v[52:53], v6 offset:7328
 v_mfma_f32_16x16x32_bf16 v[120:123], v[28:31], v[72:75], v[120:123]
 ds_read_b64_tr_b16 v[54:55], v6 offset:10912
 v_mfma_f32_16x16x32_bf16 v[116:119], v[28:31], v[68:71], v[116:119]
 ds_read_b64_tr_b16 v[56:57], v6 offset:192
 v_mfma_f32_16x16x32_bf16 v[112:115], v[28:31], v[64:67], v[112:115]
 ds_read_b64_tr_b16 v[58:59], v6 offset:3776
 s_mov_b32 m0, s55
 v_mfma_f32_16x16x32_bf16 v[128:131], v[32:35], v[64:67], v[128:131]
 ds_read_b64_tr_b16 v[60:61], v6 offset:7360
 buffer_load_dwordx4 v7, s[16:19], s72 offen offset:0 lds
 s_add_u32 s72, s72, 0x3c00
 v_mfma_f32_16x16x32_bf16 v[132:135], v[32:35], v[68:71], v[132:135]
 ds_read_b64_tr_b16 v[62:63], v6 offset:10944
 v_mfma_f32_16x16x32_bf16 v[136:139], v[32:35], v[72:75], v[136:139]
 buffer_load_dwordx4 v7, s[16:19], s72 offen offset:1024 lds
 s_add_u32 s72, s72, 0x3c00
 v_mfma_f32_16x16x32_bf16 v[140:143], v[32:35], v[76:79], v[140:143]
 v_mfma_f32_16x16x32_bf16 v[156:159], v[36:39], v[76:79], v[156:159]
 buffer_load_dwordx4 v7, s[16:19], s72 offen offset:2048 lds
 s_add_u32 s72, s72, 0x3c00
 v_mfma_f32_16x16x32_bf16 v[152:155], v[36:39], v[72:75], v[152:155]
 v_mfma_f32_16x16x32_bf16 v[148:151], v[36:39], v[68:71], v[148:151]
 buffer_load_dwordx4 v7, s[16:19], s72 offen offset:3072 lds
 s_add_u32 s72, s72, s77
 v_mfma_f32_16x16x32_bf16 v[144:147], v[36:39], v[64:67], v[144:147]
 v_mfma_f32_16x16x32_bf16 v[160:163], v[40:43], v[64:67], v[160:163]
 v_mfma_f32_16x16x32_bf16 v[164:167], v[40:43], v[68:71], v[164:167]
 v_mfma_f32_16x16x32_bf16 v[168:171], v[40:43], v[72:75], v[168:171]
 v_mfma_f32_16x16x32_bf16 v[172:175], v[40:43], v[76:79], v[172:175]
 s_waitcnt vmcnt(8) lgkmcnt(0)
 s_barrier
 s_setprio 1
 v_mfma_f32_16x16x32_bf16 v[188:191], v[44:47], v[76:79], v[188:191]
 ds_read_b128 v[80:83], v3 offset:0
 v_mfma_f32_16x16x32_bf16 v[184:187], v[44:47], v[72:75], v[184:187]
 ds_read_b64_tr_b16 v[24:25], v4 offset:6144
 v_mfma_f32_16x16x32_bf16 v[180:183], v[44:47], v[68:71], v[180:183]
 ds_read_b64_tr_b16 v[26:27], v4 offset:9216
 v_mfma_f32_16x16x32_bf16 v[176:179], v[44:47], v[64:67], v[176:179]
 ds_read_b128 v[84:87], v3 offset:2048
 v_mfma_f32_16x16x32_bf16 v[192:195], v[48:51], v[64:67], v[192:195]
 ds_read_b128 v[88:91], v3 offset:4096
 v_mfma_f32_16x16x32_bf16 v[196:199], v[48:51], v[68:71], v[196:199]
 ds_read_b128 v[92:95], v3 offset:6144
 s_lshl3_add_u32 s89, s82, s3
 s_lshl_b32 s89, s89, 11
 v_mfma_f32_16x16x32_bf16 v[200:203], v[48:51], v[72:75], v[200:203]
 ds_read_b64_tr_b16 v[28:29], v5 offset:6144
 buffer_load_dwordx2 v[12:13], v20, s[8:11], s89 offen offset:0 sc1
 v_mfma_f32_16x16x32_bf16 v[204:207], v[48:51], v[76:79], v[204:207]
 ds_read_b64_tr_b16 v[30:31], v5 offset:9216
 v_mfma_f32_16x16x32_bf16 v[220:223], v[52:55], v[76:79], v[220:223]
 ds_read_b64_tr_b16 v[32:33], v6 offset:14432
 buffer_load_dwordx2 v[14:15], v20, s[8:11], s89 offen offset:512 sc1
 v_mfma_f32_16x16x32_bf16 v[216:219], v[52:55], v[72:75], v[216:219]
 ds_read_b64_tr_b16 v[34:35], v6 offset:18016
 v_mfma_f32_16x16x32_bf16 v[212:215], v[52:55], v[68:71], v[212:215]
 ds_read_b64_tr_b16 v[36:37], v6 offset:21600
 buffer_load_dwordx2 v[16:17], v20, s[8:11], s89 offen offset:1024 sc1
 v_mfma_f32_16x16x32_bf16 v[208:211], v[52:55], v[64:67], v[208:211]
 ds_read_b64_tr_b16 v[38:39], v6 offset:25184
 v_mfma_f32_16x16x32_bf16 v[224:227], v[56:59], v[64:67], v[224:227]
 ds_read_b64_tr_b16 v[40:41], v6 offset:14464
 buffer_load_dwordx2 v[18:19], v20, s[8:11], s89 offen offset:1536 sc1
 v_mfma_f32_16x16x32_bf16 v[228:231], v[56:59], v[68:71], v[228:231]
 ds_read_b64_tr_b16 v[42:43], v6 offset:18048
 s_mov_b32 m0, s90
 s_lshl2_add_u32 s85, s83, s7
 s_lshl_b32 s85, s85, 11
 s_add_u32 s85, s85, 39976960
 v_mfma_f32_16x16x32_bf16 v[232:235], v[56:59], v[72:75], v[232:235]
 buffer_load_dwordx4 v0, s[8:11], s85 offen sc1 lds
 v_mfma_f32_16x16x32_bf16 v[236:239], v[56:59], v[76:79], v[236:239]
 v_mfma_f32_16x16x32_bf16 v[252:255], v[60:63], v[76:79], v[252:255]
 buffer_load_dwordx4 v0, s[8:11], s85 offen offset:1024 sc1 lds
 s_lshl_b32 s86, s7, 12
 s_add_u32 s85, s85, 20
 v_mfma_f32_16x16x32_bf16 v[248:251], v[60:63], v[72:75], v[248:251]
 s_add_u32 m0, s86, 149504
 v_mfma_f32_16x16x32_bf16 v[244:247], v[60:63], v[68:71], v[244:247]
 buffer_load_dword v9, s[8:11], s85 offen sc1 lds
 s_setprio 0
 v_mfma_f32_16x16x32_bf16 v[240:243], v[60:63], v[64:67], v[240:243]
 s_waitcnt lgkmcnt(0)
 v_mfma_f32_16x16x32_bf16 v[96:99], v[24:27], v[80:83], v[96:99]
 ds_read_b64_tr_b16 v[44:45], v6 offset:21632
 s_mul_i32 s49, s4, 1835008
 s_lshl_b32 s85, s5, 8
 s_add_u32 s49, s49, s85
 v_mfma_f32_16x16x32_bf16 v[100:103], v[24:27], v[84:87], v[100:103]
 ds_read_b64_tr_b16 v[46:47], v6 offset:25216
 s_lshl_b32 s48, s4, 3
 s_add_u32 s48, s48, s83
 s_mul_i32 s48, s48, 458752
 v_mfma_f32_16x16x32_bf16 v[104:107], v[24:27], v[88:91], v[104:107]
 ds_read_b64_tr_b16 v[48:49], v6 offset:14496
 s_add_u32 s48, s48, 4194304
 s_lshr_b32 s86, s5, 2
 s_add_u32 s54, s6, s86
 v_mfma_f32_16x16x32_bf16 v[108:111], v[24:27], v[92:95], v[108:111]
 ds_read_b64_tr_b16 v[50:51], v6 offset:18080
 s_add_u32 s54, s54, 3
 s_and_b32 s54, s54, 3
 s_mov_b32 s85, s5
 v_mfma_f32_16x16x32_bf16 v[124:127], v[28:31], v[92:95], v[124:127]
 ds_read_b64_tr_b16 v[52:53], v6 offset:21664
 s_mul_i32 s32, s85, 229376
 s_add_u32 s32, s32, s49
 s_mul_i32 s40, s85, 49152
 v_mfma_f32_16x16x32_bf16 v[120:123], v[28:31], v[88:91], v[120:123]
 ds_read_b64_tr_b16 v[54:55], v6 offset:25248
 s_add_u32 s40, s40, s48
 s_add_u32 s85, s54, 1
 s_and_b32 s85, s85, 3
 v_mfma_f32_16x16x32_bf16 v[116:119], v[28:31], v[84:87], v[116:119]
 ds_read_b64_tr_b16 v[56:57], v6 offset:14528
 s_or_b32 s85, s85, 4
 s_mul_i32 s33, s85, 229376
 s_add_u32 s33, s33, s49
 v_mfma_f32_16x16x32_bf16 v[112:115], v[28:31], v[80:83], v[112:115]
 ds_read_b64_tr_b16 v[58:59], v6 offset:18112
 s_mul_i32 s41, s85, 49152
 s_add_u32 s41, s41, s48
 s_add_u32 s85, s54, 2
 v_mfma_f32_16x16x32_bf16 v[128:131], v[32:35], v[80:83], v[128:131]
 ds_read_b64_tr_b16 v[60:61], v6 offset:21696
 s_and_b32 s85, s85, 3
 s_mul_i32 s34, s85, 229376
 s_add_u32 s34, s34, s49
 v_mfma_f32_16x16x32_bf16 v[132:135], v[32:35], v[84:87], v[132:135]
 ds_read_b64_tr_b16 v[62:63], v6 offset:25280
 s_mul_i32 s42, s85, 49152
 s_add_u32 s42, s42, s48
 s_add_u32 s85, s54, 2
 v_mfma_f32_16x16x32_bf16 v[136:139], v[32:35], v[88:91], v[136:139]
 s_and_b32 s85, s85, 3
 s_or_b32 s85, s85, 4
 s_mul_i32 s35, s85, 229376
 v_mfma_f32_16x16x32_bf16 v[140:143], v[32:35], v[92:95], v[140:143]
 s_add_u32 s35, s35, s49
 s_mul_i32 s43, s85, 49152
 s_add_u32 s43, s43, s48
 v_mfma_f32_16x16x32_bf16 v[156:159], v[36:39], v[92:95], v[156:159]
 s_add_u32 s85, s54, 3
 s_and_b32 s85, s85, 3
 s_mul_i32 s36, s85, 229376
 v_mfma_f32_16x16x32_bf16 v[152:155], v[36:39], v[88:91], v[152:155]
 s_add_u32 s36, s36, s49
 s_mul_i32 s44, s85, 49152
 s_add_u32 s44, s44, s48
 v_mfma_f32_16x16x32_bf16 v[148:151], v[36:39], v[84:87], v[148:151]
 s_add_u32 s85, s54, 3
 s_and_b32 s85, s85, 3
 s_or_b32 s85, s85, 4
 v_mfma_f32_16x16x32_bf16 v[144:147], v[36:39], v[80:83], v[144:147]
 s_mul_i32 s37, s85, 229376
 s_add_u32 s37, s37, s49
 s_mul_i32 s45, s85, 49152
 v_mfma_f32_16x16x32_bf16 v[160:163], v[40:43], v[80:83], v[160:163]
 s_add_u32 s45, s45, s48
 s_add_u32 s85, s54, 4
 v_mfma_f32_16x16x32_bf16 v[164:167], v[40:43], v[84:87], v[164:167]
 v_mfma_f32_16x16x32_bf16 v[168:171], v[40:43], v[88:91], v[168:171]
 v_mfma_f32_16x16x32_bf16 v[172:175], v[40:43], v[92:95], v[172:175]
 s_waitcnt vmcnt(7) lgkmcnt(0)
 s_barrier
 s_setprio 1
 v_mfma_f32_16x16x32_bf16 v[188:191], v[44:47], v[92:95], v[188:191]
 ds_read_b128 v[64:67], v2 offset:32768
 s_and_b32 s85, s85, 3
 s_mul_i32 s38, s85, 229376
 v_mfma_f32_16x16x32_bf16 v[184:187], v[44:47], v[88:91], v[184:187]
 ds_read_b64_tr_b16 v[24:25], v4 offset:12288
 s_add_u32 s38, s38, s49
 s_mul_i32 s46, s85, 49152
 v_mfma_f32_16x16x32_bf16 v[180:183], v[44:47], v[84:87], v[180:183]
 ds_read_b64_tr_b16 v[26:27], v4 offset:15360
 s_add_u32 s46, s46, s48
 s_add_u32 s85, s54, s86
 v_mfma_f32_16x16x32_bf16 v[176:179], v[44:47], v[80:83], v[176:179]
 ds_read_b128 v[68:71], v2 offset:34816
 s_and_b32 s85, s85, 3
 s_andn2_b32 s87, 4, s5
 v_mfma_f32_16x16x32_bf16 v[192:195], v[48:51], v[80:83], v[192:195]
 ds_read_b128 v[72:75], v2 offset:36864
 s_or_b32 s85, s85, s87
 s_mul_i32 s39, s85, 229376
 v_mfma_f32_16x16x32_bf16 v[196:199], v[48:51], v[84:87], v[196:199]
 ds_read_b128 v[76:79], v2 offset:38912
 s_add_u32 s39, s39, s49
 s_mul_i32 s47, s85, 49152
 v_mfma_f32_16x16x32_bf16 v[200:203], v[48:51], v[88:91], v[200:203]
 ds_read_b64_tr_b16 v[28:29], v5 offset:12288
 s_add_u32 s47, s47, s48
 s_lshl_b32 s50, s3, 11
 v_mfma_f32_16x16x32_bf16 v[204:207], v[48:51], v[92:95], v[204:207]
 ds_read_b64_tr_b16 v[30:31], v5 offset:15360
 s_lshl_b32 s51, s3, 10
 s_add_u32 s51, s51, 98304
 v_mfma_f32_16x16x32_bf16 v[220:223], v[52:55], v[92:95], v[220:223]
 ds_read_b64_tr_b16 v[32:33], v6 offset:28768
 s_lshl_b32 s85, s3, 2
 v_lshrrev_b32 v9, 4, v1
 v_mfma_f32_16x16x32_bf16 v[216:219], v[52:55], v[88:91], v[216:219]
 ds_read_b64_tr_b16 v[34:35], v6 offset:32352
 v_add_u32 v9, s85, v9
 v_and_b32 v21, 7, v9
 v_mfma_f32_16x16x32_bf16 v[212:215], v[52:55], v[84:87], v[212:215]
 ds_read_b64_tr_b16 v[36:37], v6 offset:35936
 v_lshlrev_b32 v21, 1, v21
 v_and_b32 v22, 15, v1
 v_mfma_f32_16x16x32_bf16 v[208:211], v[52:55], v[80:83], v[208:211]
 ds_read_b64_tr_b16 v[38:39], v6 offset:39520
 v_xor_b32 v21, v21, v22
 v_lshlrev_b32 v9, 11, v9
 v_mfma_f32_16x16x32_bf16 v[224:227], v[56:59], v[80:83], v[224:227]
 ds_read_b64_tr_b16 v[40:41], v6 offset:28800
 v_lshl_add_u32 v10, v21, 4, v9
 v_lshrrev_b32 v22, 3, v21
 v_mfma_f32_16x16x32_bf16 v[228:231], v[56:59], v[84:87], v[228:231]
 ds_read_b64_tr_b16 v[42:43], v6 offset:32384
 v_lshl_add_u32 v9, v22, 16, v9
 v_and_b32 v21, 7, v21
 v_mfma_f32_16x16x32_bf16 v[232:235], v[56:59], v[88:91], v[232:235]
 v_lshl_add_u32 v11, v21, 4, v9
 s_lshr_b32 s87, s3, 2
 v_mfma_f32_16x16x32_bf16 v[236:239], v[56:59], v[92:95], v[236:239]
 v_mfma_f32_16x16x32_bf16 v[252:255], v[60:63], v[92:95], v[252:255]
 v_mfma_f32_16x16x32_bf16 v[248:251], v[60:63], v[88:91], v[248:251]
 v_mfma_f32_16x16x32_bf16 v[244:247], v[60:63], v[84:87], v[244:247]
 s_setprio 0
 v_mfma_f32_16x16x32_bf16 v[240:243], v[60:63], v[80:83], v[240:243]
 s_waitcnt lgkmcnt(0)
 v_mfma_f32_16x16x32_bf16 v[96:99], v[24:27], v[64:67], v[96:99]
 ds_read_b64_tr_b16 v[44:45], v6 offset:35968
 s_xor_b32 s85, s99, 0
 s_lshl_b32 s85, s85, 1
 s_add_u32 s85, s85, s87
 v_mfma_f32_16x16x32_bf16 v[100:103], v[24:27], v[68:71], v[100:103]
 ds_read_b64_tr_b16 v[46:47], v6 offset:39552
 s_lshl1_add_u32 s67, s85, 0
 s_xor_b32 s85, s99, 0
 s_lshl_b32 s85, s85, 1
 v_mfma_f32_16x16x32_bf16 v[104:107], v[24:27], v[72:75], v[104:107]
 ds_read_b64_tr_b16 v[48:49], v6 offset:28832
 s_add_u32 s85, s85, s87
 s_lshl1_add_u32 s68, s85, 1
 s_xor_b32 s85, s99, 1
 v_mfma_f32_16x16x32_bf16 v[108:111], v[24:27], v[76:79], v[108:111]
 ds_read_b64_tr_b16 v[50:51], v6 offset:32416
 s_lshl_b32 s85, s85, 1
 s_add_u32 s85, s85, s87
 s_lshl1_add_u32 s69, s85, 0
 v_mfma_f32_16x16x32_bf16 v[124:127], v[28:31], v[76:79], v[124:127]
 ds_read_b64_tr_b16 v[52:53], v6 offset:36000
 s_xor_b32 s85, s99, 1
 s_lshl_b32 s85, s85, 1
 s_add_u32 s85, s85, s87
 v_mfma_f32_16x16x32_bf16 v[120:123], v[28:31], v[72:75], v[120:123]
 ds_read_b64_tr_b16 v[54:55], v6 offset:39584
 s_lshl1_add_u32 s70, s85, 1
 s_lshl1_add_u32 s58, s5, s99
 s_lshl_b32 s58, s58, 7
 v_mfma_f32_16x16x32_bf16 v[116:119], v[28:31], v[68:71], v[116:119]
 ds_read_b64_tr_b16 v[56:57], v6 offset:28864
 s_lshr_b32 s85, s7, 1
 s_mul_i32 s85, s85, 104
 s_and_b32 s86, s7, 1
 v_mfma_f32_16x16x32_bf16 v[112:115], v[28:31], v[64:67], v[112:115]
 ds_read_b64_tr_b16 v[58:59], v6 offset:32448
 s_lshl2_add_u32 s85, s86, s85
 s_mul_i32 s86, s87, 12
 s_sub_u32 s85, s85, s86
 v_mfma_f32_16x16x32_bf16 v[128:131], v[32:35], v[64:67], v[128:131]
 ds_read_b64_tr_b16 v[60:61], v6 offset:36032
 s_add_u32 s85, s85, 32
 s_lshl_b32 s85, s85, 11
 s_add_u32 s59, s85, s49
 v_mfma_f32_16x16x32_bf16 v[132:135], v[32:35], v[68:71], v[132:135]
 ds_read_b64_tr_b16 v[62:63], v6 offset:39616
 s_xor_b32 s85, s87, s99
 s_lshl_b32 s85, s85, 14
 s_lshl1_add_u32 s86, s7, s98
 v_mfma_f32_16x16x32_bf16 v[136:139], v[32:35], v[72:75], v[136:139]
 s_lshl_b32 s88, s86, 11
 s_add_u32 s85, s85, s88
 s_lshl_b32 s57, s83, 19
 v_mfma_f32_16x16x32_bf16 v[140:143], v[32:35], v[76:79], v[140:143]
 s_add_u32 s57, s57, s85
 s_add_u32 s57, s57, 18874368
 s_add_u32 s56, s48, 393216
 v_mfma_f32_16x16x32_bf16 v[156:159], v[36:39], v[76:79], v[156:159]
 s_lshl_b32 s85, s83, 3
 s_add_u32 s86, s86, s85
 s_lshl_b32 s61, s86, 16
 v_mfma_f32_16x16x32_bf16 v[152:155], v[36:39], v[72:75], v[152:155]
 s_add_u32 s61, s61, s58
 s_lshl_b32 s87, s87, 6
 s_add_u32 s61, s61, s87
 v_mfma_f32_16x16x32_bf16 v[148:151], v[36:39], v[68:71], v[148:151]
 s_add_u32 s66, s61, 32768
 s_lshl_b32 s55, s7, 12
 s_add_u32 s85, s85, s5
 v_mfma_f32_16x16x32_bf16 v[144:147], v[36:39], v[64:67], v[144:147]
 s_mul_i32 s60, s85, 196608
 s_add_u32 s60, s60, 27262976
 v_lshrrev_b32 v21, 2, v1
 v_mfma_f32_16x16x32_bf16 v[160:163], v[40:43], v[64:67], v[160:163]
 v_lshlrev_b32 v21, 6, v21
 v_and_b32 v22, 3, v1
 v_lshl_add_u32 v21, v22, 3, v21
 v_mfma_f32_16x16x32_bf16 v[164:167], v[40:43], v[68:71], v[164:167]
 v_add_u32 v2, 147456, v21
 v_mfma_f32_16x16x32_bf16 v[168:171], v[40:43], v[72:75], v[168:171]
 v_mfma_f32_16x16x32_bf16 v[172:175], v[40:43], v[76:79], v[172:175]
 s_waitcnt vmcnt(0) lgkmcnt(0)
 s_barrier
 s_setprio 1
 v_mfma_f32_16x16x32_bf16 v[188:191], v[44:47], v[76:79], v[188:191]
 ds_read_b128 v[80:83], v3 offset:32768
 v_pk_add_f32 v[12:13], v[12:13], v[14:15]
 v_mfma_f32_16x16x32_bf16 v[184:187], v[44:47], v[72:75], v[184:187]
 ds_read_b64_tr_b16 v[24:25], v4 offset:18432
 v_pk_add_f32 v[16:17], v[16:17], v[18:19]
 v_mfma_f32_16x16x32_bf16 v[180:183], v[44:47], v[68:71], v[180:183]
 ds_read_b64_tr_b16 v[26:27], v4 offset:21504
 s_lshl_b32 s85, s3, 8
 v_mfma_f32_16x16x32_bf16 v[176:179], v[44:47], v[64:67], v[176:179]
 ds_read_b128 v[84:87], v3 offset:34816
 s_add_u32 s85, s85, 65536
 v_mfma_f32_16x16x32_bf16 v[192:195], v[48:51], v[64:67], v[192:195]
 ds_read_b128 v[88:91], v3 offset:36864
 v_pk_add_f32 v[12:13], v[12:13], v[16:17]
 v_mfma_f32_16x16x32_bf16 v[196:199], v[48:51], v[68:71], v[196:199]
 ds_read_b128 v[92:95], v3 offset:38912
 v_lshl_add_u32 v20, v1, 2, s85
 v_mfma_f32_16x16x32_bf16 v[200:203], v[48:51], v[72:75], v[200:203]
 ds_read_b64_tr_b16 v[28:29], v5 offset:18432
 v_permlane32_swap_b32 v12, v13
 v_mfma_f32_16x16x32_bf16 v[204:207], v[48:51], v[76:79], v[204:207]
 ds_read_b64_tr_b16 v[30:31], v5 offset:21504
 v_add_f32 v16, v12, v13
 v_mfma_f32_16x16x32_bf16 v[220:223], v[52:55], v[76:79], v[220:223]
 ds_read_b64_tr_b16 v[32:33], v6 offset:43104
 v_and_b32 v17, 0xffff0000, v16
 v_mfma_f32_16x16x32_bf16 v[216:219], v[52:55], v[72:75], v[216:219]
 ds_read_b64_tr_b16 v[34:35], v6 offset:46688
 v_sub_f32 v16, v16, v17
 v_mfma_f32_16x16x32_bf16 v[212:215], v[52:55], v[68:71], v[212:215]
 ds_read_b64_tr_b16 v[36:37], v6 offset:50272
 v_cvt_pk_bf16_f32 v16, v17, v16
 v_mfma_f32_16x16x32_bf16 v[208:211], v[52:55], v[64:67], v[208:211]
 ds_read_b64_tr_b16 v[38:39], v6 offset:53856
 ds_write_b32 v20, v16
 v_mfma_f32_16x16x32_bf16 v[224:227], v[56:59], v[64:67], v[224:227]
 ds_read_b64_tr_b16 v[40:41], v6 offset:43136
 v_mfma_f32_16x16x32_bf16 v[228:231], v[56:59], v[68:71], v[228:231]
 ds_read_b64_tr_b16 v[42:43], v6 offset:46720
 v_mfma_f32_16x16x32_bf16 v[232:235], v[56:59], v[72:75], v[232:235]
 v_and_b32 v21, 15, v1
 v_mfma_f32_16x16x32_bf16 v[236:239], v[56:59], v[76:79], v[236:239]
 v_lshl_add_u32 v3, v21, 5, s90
 v_mfma_f32_16x16x32_bf16 v[252:255], v[60:63], v[76:79], v[252:255]
 s_mov_b32 s85, 66560
 v_mfma_f32_16x16x32_bf16 v[248:251], v[60:63], v[72:75], v[248:251]
 v_lshl_add_u32 v5, v21, 2, s85
 v_mfma_f32_16x16x32_bf16 v[244:247], v[60:63], v[68:71], v[244:247]
 s_setprio 0
 v_mfma_f32_16x16x32_bf16 v[240:243], v[60:63], v[64:67], v[240:243]
 s_waitcnt lgkmcnt(0)
 v_mfma_f32_16x16x32_bf16 v[96:99], v[24:27], v[80:83], v[96:99]
 ds_read_b64_tr_b16 v[44:45], v6 offset:50304
 v_mfma_f32_16x16x32_bf16 v[100:103], v[24:27], v[84:87], v[100:103]
 ds_read_b64_tr_b16 v[46:47], v6 offset:53888
 v_mfma_f32_16x16x32_bf16 v[104:107], v[24:27], v[88:91], v[104:107]
 ds_read_b64_tr_b16 v[48:49], v6 offset:43168
 v_mfma_f32_16x16x32_bf16 v[108:111], v[24:27], v[92:95], v[108:111]
 ds_read_b64_tr_b16 v[50:51], v6 offset:46752
 v_mfma_f32_16x16x32_bf16 v[124:127], v[28:31], v[92:95], v[124:127]
 ds_read_b64_tr_b16 v[52:53], v6 offset:50336
 v_mfma_f32_16x16x32_bf16 v[120:123], v[28:31], v[88:91], v[120:123]
 ds_read_b64_tr_b16 v[54:55], v6 offset:53920
 v_mfma_f32_16x16x32_bf16 v[116:119], v[28:31], v[84:87], v[116:119]
 ds_read_b64_tr_b16 v[56:57], v6 offset:43200
 ds_read_b64_tr_b16 v[64:65], v2 offset:0
 v_mfma_f32_16x16x32_bf16 v[112:115], v[28:31], v[80:83], v[112:115]
 ds_read_b64_tr_b16 v[58:59], v6 offset:46784
 ds_read_b64_tr_b16 v[66:67], v2 offset:1024
 v_mfma_f32_16x16x32_bf16 v[128:131], v[32:35], v[80:83], v[128:131]
 ds_read_b64_tr_b16 v[60:61], v6 offset:50368
 ds_read_b64_tr_b16 v[68:69], v2 offset:32
 v_mfma_f32_16x16x32_bf16 v[132:135], v[32:35], v[84:87], v[132:135]
 ds_read_b64_tr_b16 v[62:63], v6 offset:53952
 ds_read_b64_tr_b16 v[70:71], v2 offset:1056
 v_mfma_f32_16x16x32_bf16 v[136:139], v[32:35], v[88:91], v[136:139]
 ds_read_b64 v[72:73], v3 offset:0
 v_mfma_f32_16x16x32_bf16 v[140:143], v[32:35], v[92:95], v[140:143]
 ds_read_b64 v[74:75], v3 offset:512
 v_mfma_f32_16x16x32_bf16 v[156:159], v[36:39], v[92:95], v[156:159]
 ds_read_b64 v[76:77], v3 offset:1024
 v_mfma_f32_16x16x32_bf16 v[152:155], v[36:39], v[88:91], v[152:155]
 ds_read_b64 v[78:79], v3 offset:1536
 v_mfma_f32_16x16x32_bf16 v[148:151], v[36:39], v[84:87], v[148:151]
 v_mfma_f32_16x16x32_bf16 v[144:147], v[36:39], v[80:83], v[144:147]
 v_mfma_f32_16x16x32_bf16 v[160:163], v[40:43], v[80:83], v[160:163]
 v_mfma_f32_16x16x32_bf16 v[164:167], v[40:43], v[84:87], v[164:167]
 v_mfma_f32_16x16x32_bf16 v[168:171], v[40:43], v[88:91], v[168:171]
 v_mfma_f32_16x16x32_bf16 v[172:175], v[40:43], v[92:95], v[172:175]
 s_waitcnt vmcnt(0) lgkmcnt(0)
 s_barrier
 v_mfma_f32_16x16x32_bf16 v[188:191], v[44:47], v[92:95], v[188:191]
 ds_read_b128 v[24:27], v3 offset:16
 v_mfma_f32_16x16x32_bf16 v[184:187], v[44:47], v[88:91], v[184:187]
 ds_read_b128 v[28:31], v3 offset:528
 v_mfma_f32_16x16x32_bf16 v[180:183], v[44:47], v[84:87], v[180:183]
 ds_read_b128 v[32:35], v3 offset:1040
 v_mfma_f32_16x16x32_bf16 v[176:179], v[44:47], v[80:83], v[176:179]
 ds_read_b128 v[36:39], v3 offset:1552
 v_mfma_f32_16x16x32_bf16 v[192:195], v[48:51], v[80:83], v[192:195]
 ds_read2_b32 v[40:41], v5 offset0:64 offset1:64
 v_mfma_f32_16x16x32_bf16 v[196:199], v[48:51], v[84:87], v[196:199]
 ds_read2_b32 v[42:43], v5 offset0:208 offset1:208
 v_mfma_f32_16x16x32_bf16 v[200:203], v[48:51], v[88:91], v[200:203]
 ds_read2_b32 v[44:45], v5 offset0:96 offset1:96
 v_mfma_f32_16x16x32_bf16 v[204:207], v[48:51], v[92:95], v[204:207]
 ds_read2_b32 v[46:47], v5 offset0:240 offset1:240
 v_mfma_f32_16x16x32_bf16 v[220:223], v[52:55], v[92:95], v[220:223]
 s_add_u32 m0, s51, 0
 s_add_u32 s63, s32, 0
 v_mfma_f32_16x16x32_bf16 v[216:219], v[52:55], v[88:91], v[216:219]
 buffer_load_dwordx4 v10, s[24:27], s63 offen lds
 ds_read2_b32 v[48:49], v5 offset0:0 offset1:0
 v_mfma_f32_16x16x32_bf16 v[212:215], v[52:55], v[84:87], v[212:215]
 ds_read2_b32 v[50:51], v5 offset0:32 offset1:32
 s_add_u32 m0, s51, 8192
 s_add_u32 s63, s32, 98304
 v_mfma_f32_16x16x32_bf16 v[208:211], v[52:55], v[80:83], v[208:211]
 buffer_load_dwordx4 v10, s[24:27], s63 offen lds
 v_mfma_f32_16x16x32_bf16 v[224:227], v[56:59], v[80:83], v[224:227]
 s_add_u32 m0, s51, 16384
 s_add_u32 s63, s32, 163840
 v_mfma_f32_16x16x32_bf16 v[228:231], v[56:59], v[84:87], v[228:231]
 buffer_load_dwordx4 v10, s[24:27], s63 offen lds
 ds_read2_b32 v[52:53], v5 offset0:128 offset1:128
 v_mfma_f32_16x16x32_bf16 v[232:235], v[56:59], v[88:91], v[232:235]
 ds_read2_b32 v[54:55], v5 offset0:192 offset1:192
 s_add_u32 m0, s51, 24576
 s_add_u32 s63, s33, 98304
 v_mfma_f32_16x16x32_bf16 v[236:239], v[56:59], v[92:95], v[236:239]
 buffer_load_dwordx4 v10, s[24:27], s63 offen lds
 v_mfma_f32_16x16x32_bf16 v[252:255], v[60:63], v[92:95], v[252:255]
 s_add_u32 m0, s51, 32768
 s_add_u32 s63, s33, 163840
 v_mfma_f32_16x16x32_bf16 v[248:251], v[60:63], v[88:91], v[248:251]
 buffer_load_dwordx4 v10, s[24:27], s63 offen lds
 ds_read2_b32 v[56:57], v5 offset0:160 offset1:160
 v_mfma_f32_16x16x32_bf16 v[244:247], v[60:63], v[84:87], v[244:247]
 ds_read2_b32 v[58:59], v5 offset0:224 offset1:224
 s_add_u32 m0, s51, 40960
 s_add_u32 s63, s34, 98304
 v_mfma_f32_16x16x32_bf16 v[240:243], v[60:63], v[80:83], v[240:243]
 buffer_load_dwordx4 v10, s[24:27], s63 offen lds
 s_waitcnt lgkmcnt(4)
L5_p1:
 s_setprio 1
 v_mov_b32 v12, v27
 v_mov_b32 v14, v31
 v_mov_b32 v16, v35
 v_mov_b32 v18, v39
 s_lshl_b32 s85, s7, 12
 v_add_u32 v20, s85, v0
 v_add_u32 v13, s50, v0
 s_xor_b32 s85, s98, 0
 s_lshl_b32 s86, s85, 11
 v_add_u32 v2, s86, v20
 v_add_u32 v4, 0x10000, v2
 s_xor_b32 s85, s98, 1
 s_lshl_b32 s86, s85, 11
 v_add_u32 v3, s86, v20
 v_add_u32 v5, 0x10000, v3
 v_mfma_f32_16x16x16_bf16 v[128:131], v[40:41], v[72:73], v[128:131]
 v_mfma_f32_16x16x16_bf16 v[160:163], v[42:43], v[72:73], v[160:163]
 v_mfma_f32_16x16x16_bf16 v[144:147], v[44:45], v[72:73], v[144:147]
 v_mfma_f32_16x16x16_bf16 v[176:179], v[46:47], v[72:73], v[176:179]
 v_lshrrev_b32 v19, 2, v1
 v_and_b32 v15, 3, v1
 v_lshlrev_b32 v15, 3, v15
 v_lshl_add_u32 v15, v19, 8, v15
 v_add_u32 v15, 98304, v15
 v_and_b32 v19, 7, v19
 v_xor_b32 v6, s67, v19
 v_lshl_add_u32 v6, v6, 5, v15
 v_xor_b32 v7, s68, v19
 v_lshl_add_u32 v7, v7, 5, v15
 v_xor_b32 v8, s69, v19
 v_lshl_add_u32 v8, v8, 5, v15
 v_xor_b32 v9, s70, v19
 v_lshl_add_u32 v9, v9, 5, v15
 s_waitcnt lgkmcnt(0)
 s_lshl2_add_u32 s84, s5, s7
 s_lshl_b32 s84, s84, 12
 v_lshl_add_u32 v94, v1, 7, s84
 s_getpc_b64 s[96:97]
L5_pc:
 s_sub_u32 s96, s96, L5_pc-L5_p0
 s_subb_u32 s97, s97, 0
 v_min_u32 v94, L5_end-L5_p0, v94
 v_mov_b32 v93, s97
 v_add_co_u32 v92, vcc, s96, v94
 s_nop 1
 v_addc_co_u32 v93, vcc, 0, v93, vcc
 s_mov_b32 exec_hi, 0
 global_load_dword v21, v[92:93], off
 s_mov_b32 exec_hi, -1
 s_mul_i32 s85, s5, 49152
 s_add_u32 s85, s85, s48
 s_add_u32 s85, s85, 16384
 v_pk_mul_f32 v[80:81], v[128:129], v[128:129]
 v_pk_mul_f32 v[82:83], v[130:131], v[130:131]
 v_pk_mul_f32 v[84:85], v[160:161], v[160:161]
 v_pk_mul_f32 v[86:87], v[162:163], v[162:163]
 v_pk_fma_f32 v[80:81], v[80:81], v[26:27], v[24:25] op_sel_hi:[1,0,0]
 v_pk_fma_f32 v[82:83], v[82:83], v[26:27], v[24:25] op_sel_hi:[1,0,0]
 v_pk_fma_f32 v[84:85], v[84:85], v[26:27], v[24:25] op_sel_hi:[1,0,0]
 v_pk_fma_f32 v[86:87], v[86:87], v[26:27], v[24:25] op_sel_hi:[1,0,0]
 v_pk_mul_f32 v[80:81], v[80:81], v[128:129]
 v_pk_mul_f32 v[82:83], v[82:83], v[130:131]
 v_pk_mul_f32 v[84:85], v[84:85], v[160:161]
 v_pk_mul_f32 v[86:87], v[86:87], v[162:163]
 v_pk_mul_f32 v[128:129], v[128:129], v[144:145]
 v_pk_mul_f32 v[130:131], v[130:131], v[146:147]
 v_pk_mul_f32 v[160:161], v[160:161], v[176:177]
 v_pk_mul_f32 v[162:163], v[162:163], v[178:179]
 v_mfma_f32_16x16x16_bf16 v[132:135], v[40:41], v[74:75], v[132:135]
 v_exp_f32 v80, v80
 v_exp_f32 v81, v81
 v_mfma_f32_16x16x16_bf16 v[164:167], v[42:43], v[74:75], v[164:167]
 v_exp_f32 v82, v82
 v_exp_f32 v83, v83
 v_mfma_f32_16x16x16_bf16 v[148:151], v[44:45], v[74:75], v[148:151]
 v_exp_f32 v84, v84
 v_exp_f32 v85, v85
 v_exp_f32 v86, v86
 v_exp_f32 v87, v87
 v_pk_fma_f32 v[80:81], v[80:81], v[12:13], v[12:13] op_sel_hi:[1,0,0]
 v_pk_fma_f32 v[82:83], v[82:83], v[12:13], v[12:13] op_sel_hi:[1,0,0]
 v_pk_fma_f32 v[84:85], v[84:85], v[12:13], v[12:13] op_sel_hi:[1,0,0]
 v_pk_fma_f32 v[86:87], v[86:87], v[12:13], v[12:13] op_sel_hi:[1,0,0]
 v_mfma_f32_16x16x16_bf16 v[180:183], v[46:47], v[74:75], v[180:183]
 v_rcp_f32 v80, v80
 v_rcp_f32 v81, v81
 v_mfma_f32_16x16x16_bf16 v[96:99], v[48:49], v[72:73], v[96:99]
 v_rcp_f32 v82, v82
 v_rcp_f32 v83, v83
 v_mfma_f32_16x16x16_bf16 v[112:115], v[50:51], v[72:73], v[112:115]
 v_rcp_f32 v84, v84
 v_rcp_f32 v85, v85
 v_rcp_f32 v86, v86
 v_rcp_f32 v87, v87
 v_pk_mul_f32 v[128:129], v[128:129], v[80:81]
 v_pk_mul_f32 v[130:131], v[130:131], v[82:83]
 v_pk_mul_f32 v[160:161], v[160:161], v[84:85]
 v_pk_mul_f32 v[162:163], v[162:163], v[86:87]
 v_cvt_pk_bf16_f32 v144, v128, v129
 v_cvt_pk_bf16_f32 v145, v130, v131
 v_cvt_pk_bf16_f32 v146, v160, v161
 v_cvt_pk_bf16_f32 v147, v162, v163
 buffer_store_dwordx4 v[144:147], v20, s[8:11], s85 offen offset:0 sc1
 ds_write_b128 v20, v[144:147] offset:16384
 v_pk_mul_f32 v[88:89], v[132:133], v[132:133]
 v_pk_mul_f32 v[90:91], v[134:135], v[134:135]
 v_pk_mul_f32 v[92:93], v[164:165], v[164:165]
 v_pk_mul_f32 v[94:95], v[166:167], v[166:167]
 v_pk_fma_f32 v[88:89], v[88:89], v[30:31], v[28:29] op_sel_hi:[1,0,0]
 v_pk_fma_f32 v[90:91], v[90:91], v[30:31], v[28:29] op_sel_hi:[1,0,0]
 v_pk_fma_f32 v[92:93], v[92:93], v[30:31], v[28:29] op_sel_hi:[1,0,0]
 v_pk_fma_f32 v[94:95], v[94:95], v[30:31], v[28:29] op_sel_hi:[1,0,0]
 v_pk_mul_f32 v[88:89], v[88:89], v[132:133]
 v_pk_mul_f32 v[90:91], v[90:91], v[134:135]
 v_pk_mul_f32 v[92:93], v[92:93], v[164:165]
 v_pk_mul_f32 v[94:95], v[94:95], v[166:167]
 v_pk_mul_f32 v[132:133], v[132:133], v[148:149]
 v_pk_mul_f32 v[134:135], v[134:135], v[150:151]
 v_pk_mul_f32 v[164:165], v[164:165], v[180:181]
 v_pk_mul_f32 v[166:167], v[166:167], v[182:183]
 v_mfma_f32_16x16x16_bf16 v[136:139], v[40:41], v[76:77], v[136:139]
 v_exp_f32 v88, v88
 v_exp_f32 v89, v89
 v_mfma_f32_16x16x16_bf16 v[168:171], v[42:43], v[76:77], v[168:171]
 v_exp_f32 v90, v90
 v_exp_f32 v91, v91
 v_mfma_f32_16x16x16_bf16 v[152:155], v[44:45], v[76:77], v[152:155]
 v_exp_f32 v92, v92
 v_exp_f32 v93, v93
 v_exp_f32 v94, v94
 v_exp_f32 v95, v95
 v_pk_fma_f32 v[88:89], v[88:89], v[14:15], v[14:15] op_sel_hi:[1,0,0]
 v_pk_fma_f32 v[90:91], v[90:91], v[14:15], v[14:15] op_sel_hi:[1,0,0]
 v_pk_fma_f32 v[92:93], v[92:93], v[14:15], v[14:15] op_sel_hi:[1,0,0]
 v_pk_fma_f32 v[94:95], v[94:95], v[14:15], v[14:15] op_sel_hi:[1,0,0]
 v_mfma_f32_16x16x16_bf16 v[184:187], v[46:47], v[76:77], v[184:187]
 v_rcp_f32 v88, v88
 v_rcp_f32 v89, v89
 v_mfma_f32_16x16x16_bf16 v[100:103], v[48:49], v[74:75], v[100:103]
 v_rcp_f32 v90, v90
 v_rcp_f32 v91, v91
 v_mfma_f32_16x16x16_bf16 v[116:119], v[50:51], v[74:75], v[116:119]
 v_rcp_f32 v92, v92
 v_rcp_f32 v93, v93
 v_rcp_f32 v94, v94
 v_rcp_f32 v95, v95
 v_pk_mul_f32 v[132:133], v[132:133], v[88:89]
 v_pk_mul_f32 v[134:135], v[134:135], v[90:91]
 v_pk_mul_f32 v[164:165], v[164:165], v[92:93]
 v_pk_mul_f32 v[166:167], v[166:167], v[94:95]
 v_cvt_pk_bf16_f32 v148, v132, v133
 v_cvt_pk_bf16_f32 v149, v134, v135
 v_cvt_pk_bf16_f32 v150, v164, v165
 v_cvt_pk_bf16_f32 v151, v166, v167
 buffer_store_dwordx4 v[148:151], v20, s[8:11], s85 offen offset:1024 sc1
 ds_write_b128 v20, v[148:151] offset:17408
 v_pk_mul_f32 v[80:81], v[136:137], v[136:137]
 v_pk_mul_f32 v[82:83], v[138:139], v[138:139]
 v_pk_mul_f32 v[84:85], v[168:169], v[168:169]
 v_pk_mul_f32 v[86:87], v[170:171], v[170:171]
 v_pk_fma_f32 v[80:81], v[80:81], v[34:35], v[32:33] op_sel_hi:[1,0,0]
 v_pk_fma_f32 v[82:83], v[82:83], v[34:35], v[32:33] op_sel_hi:[1,0,0]
 v_pk_fma_f32 v[84:85], v[84:85], v[34:35], v[32:33] op_sel_hi:[1,0,0]
 v_pk_fma_f32 v[86:87], v[86:87], v[34:35], v[32:33] op_sel_hi:[1,0,0]
 v_pk_mul_f32 v[80:81], v[80:81], v[136:137]
 v_pk_mul_f32 v[82:83], v[82:83], v[138:139]
 v_pk_mul_f32 v[84:85], v[84:85], v[168:169]
 v_pk_mul_f32 v[86:87], v[86:87], v[170:171]
 v_pk_mul_f32 v[136:137], v[136:137], v[152:153]
 v_pk_mul_f32 v[138:139], v[138:139], v[154:155]
 v_pk_mul_f32 v[168:169], v[168:169], v[184:185]
 v_pk_mul_f32 v[170:171], v[170:171], v[186:187]
 v_mfma_f32_16x16x16_bf16 v[140:143], v[40:41], v[78:79], v[140:143]
 v_exp_f32 v80, v80
 v_exp_f32 v81, v81
 v_mfma_f32_16x16x16_bf16 v[172:175], v[42:43], v[78:79], v[172:175]
 v_exp_f32 v82, v82
 v_exp_f32 v83, v83
 v_mfma_f32_16x16x16_bf16 v[156:159], v[44:45], v[78:79], v[156:159]
 v_exp_f32 v84, v84
 v_exp_f32 v85, v85
 v_exp_f32 v86, v86
 v_exp_f32 v87, v87
 v_pk_fma_f32 v[80:81], v[80:81], v[16:17], v[16:17] op_sel_hi:[1,0,0]
 v_pk_fma_f32 v[82:83], v[82:83], v[16:17], v[16:17] op_sel_hi:[1,0,0]
 v_pk_fma_f32 v[84:85], v[84:85], v[16:17], v[16:17] op_sel_hi:[1,0,0]
 v_pk_fma_f32 v[86:87], v[86:87], v[16:17], v[16:17] op_sel_hi:[1,0,0]
 v_mfma_f32_16x16x16_bf16 v[188:191], v[46:47], v[78:79], v[188:191]
 v_rcp_f32 v80, v80
 v_rcp_f32 v81, v81
 v_mfma_f32_16x16x16_bf16 v[104:107], v[48:49], v[76:77], v[104:107]
 v_rcp_f32 v82, v82
 v_rcp_f32 v83, v83
 v_mfma_f32_16x16x16_bf16 v[120:123], v[50:51], v[76:77], v[120:123]
 v_rcp_f32 v84, v84
 v_rcp_f32 v85, v85
 v_rcp_f32 v86, v86
 v_rcp_f32 v87, v87
 v_pk_mul_f32 v[136:137], v[136:137], v[80:81]
 v_pk_mul_f32 v[138:139], v[138:139], v[82:83]
 v_pk_mul_f32 v[168:169], v[168:169], v[84:85]
 v_pk_mul_f32 v[170:171], v[170:171], v[86:87]
 v_cvt_pk_bf16_f32 v152, v136, v137
 v_cvt_pk_bf16_f32 v153, v138, v139
 v_cvt_pk_bf16_f32 v154, v168, v169
 v_cvt_pk_bf16_f32 v155, v170, v171
 buffer_store_dwordx4 v[152:155], v20, s[8:11], s85 offen offset:2048 sc1
 ds_write_b128 v20, v[152:155] offset:18432
 v_pk_mul_f32 v[88:89], v[140:141], v[140:141]
 v_pk_mul_f32 v[90:91], v[142:143], v[142:143]
 v_pk_mul_f32 v[92:93], v[172:173], v[172:173]
 v_pk_mul_f32 v[94:95], v[174:175], v[174:175]
 v_pk_fma_f32 v[88:89], v[88:89], v[38:39], v[36:37] op_sel_hi:[1,0,0]
 v_pk_fma_f32 v[90:91], v[90:91], v[38:39], v[36:37] op_sel_hi:[1,0,0]
 v_pk_fma_f32 v[92:93], v[92:93], v[38:39], v[36:37] op_sel_hi:[1,0,0]
 v_pk_fma_f32 v[94:95], v[94:95], v[38:39], v[36:37] op_sel_hi:[1,0,0]
 v_pk_mul_f32 v[88:89], v[88:89], v[140:141]
 v_pk_mul_f32 v[90:91], v[90:91], v[142:143]
 v_pk_mul_f32 v[92:93], v[92:93], v[172:173]
 v_pk_mul_f32 v[94:95], v[94:95], v[174:175]
 v_pk_mul_f32 v[140:141], v[140:141], v[156:157]
 v_pk_mul_f32 v[142:143], v[142:143], v[158:159]
 v_pk_mul_f32 v[172:173], v[172:173], v[188:189]
 v_pk_mul_f32 v[174:175], v[174:175], v[190:191]
 v_mfma_f32_16x16x16_bf16 v[192:195], v[52:53], v[72:73], v[192:195]
 v_exp_f32 v88, v88
 v_exp_f32 v89, v89
 v_mfma_f32_16x16x16_bf16 v[224:227], v[54:55], v[72:73], v[224:227]
 v_exp_f32 v90, v90
 v_exp_f32 v91, v91
 v_mfma_f32_16x16x16_bf16 v[208:211], v[56:57], v[72:73], v[208:211]
 v_exp_f32 v92, v92
 v_exp_f32 v93, v93
 v_exp_f32 v94, v94
 v_exp_f32 v95, v95
 v_pk_fma_f32 v[88:89], v[88:89], v[18:19], v[18:19] op_sel_hi:[1,0,0]
 v_pk_fma_f32 v[90:91], v[90:91], v[18:19], v[18:19] op_sel_hi:[1,0,0]
 v_pk_fma_f32 v[92:93], v[92:93], v[18:19], v[18:19] op_sel_hi:[1,0,0]
 v_pk_fma_f32 v[94:95], v[94:95], v[18:19], v[18:19] op_sel_hi:[1,0,0]
 v_mfma_f32_16x16x16_bf16 v[240:243], v[58:59], v[72:73], v[240:243]
 v_rcp_f32 v88, v88
 v_rcp_f32 v89, v89
 v_mfma_f32_16x16x16_bf16 v[108:111], v[48:49], v[78:79], v[108:111]
 v_rcp_f32 v90, v90
 v_rcp_f32 v91, v91
 v_mfma_f32_16x16x16_bf16 v[124:127], v[50:51], v[78:79], v[124:127]
 v_rcp_f32 v92, v92
 v_rcp_f32 v93, v93
 v_rcp_f32 v94, v94
 v_rcp_f32 v95, v95
 v_pk_mul_f32 v[140:141], v[140:141], v[88:89]
 v_pk_mul_f32 v[142:143], v[142:143], v[90:91]
 v_pk_mul_f32 v[172:173], v[172:173], v[92:93]
 v_pk_mul_f32 v[174:175], v[174:175], v[94:95]
 v_cvt_pk_bf16_f32 v156, v140, v141
 v_cvt_pk_bf16_f32 v157, v142, v143
 v_cvt_pk_bf16_f32 v158, v172, v173
 v_cvt_pk_bf16_f32 v159, v174, v175
 buffer_store_dwordx4 v[156:159], v20, s[8:11], s85 offen offset:3072 sc1
 ds_write_b128 v20, v[156:159] offset:19456
 s_mul_i32 s85, s5, 49152
 s_add_u32 s85, s85, s48
 s_add_u32 s85, s85, 32768
 v_pk_mul_f32 v[80:81], v[192:193], v[192:193]
 v_pk_mul_f32 v[82:83], v[194:195], v[194:195]
 v_pk_mul_f32 v[84:85], v[224:225], v[224:225]
 v_pk_mul_f32 v[86:87], v[226:227], v[226:227]
 v_pk_fma_f32 v[80:81], v[80:81], v[26:27], v[24:25] op_sel_hi:[1,0,0]
 v_pk_fma_f32 v[82:83], v[82:83], v[26:27], v[24:25] op_sel_hi:[1,0,0]
 v_pk_fma_f32 v[84:85], v[84:85], v[26:27], v[24:25] op_sel_hi:[1,0,0]
 v_pk_fma_f32 v[86:87], v[86:87], v[26:27], v[24:25] op_sel_hi:[1,0,0]
 v_pk_mul_f32 v[80:81], v[80:81], v[192:193]
 v_pk_mul_f32 v[82:83], v[82:83], v[194:195]
 v_pk_mul_f32 v[84:85], v[84:85], v[224:225]
 v_pk_mul_f32 v[86:87], v[86:87], v[226:227]
 v_pk_mul_f32 v[192:193], v[192:193], v[208:209]
 v_pk_mul_f32 v[194:195], v[194:195], v[210:211]
 v_pk_mul_f32 v[224:225], v[224:225], v[240:241]
 v_pk_mul_f32 v[226:227], v[226:227], v[242:243]
 v_mfma_f32_16x16x16_bf16 v[196:199], v[52:53], v[74:75], v[196:199]
 v_exp_f32 v80, v80
 v_exp_f32 v81, v81
 v_exp_f32 v82, v82
 v_mfma_f32_16x16x16_bf16 v[228:231], v[54:55], v[74:75], v[228:231]
 v_exp_f32 v83, v83
 v_exp_f32 v84, v84
 v_exp_f32 v85, v85
 v_exp_f32 v86, v86
 v_exp_f32 v87, v87
 v_pk_fma_f32 v[80:81], v[80:81], v[12:13], v[12:13] op_sel_hi:[1,0,0]
 v_pk_fma_f32 v[82:83], v[82:83], v[12:13], v[12:13] op_sel_hi:[1,0,0]
 v_pk_fma_f32 v[84:85], v[84:85], v[12:13], v[12:13] op_sel_hi:[1,0,0]
 v_pk_fma_f32 v[86:87], v[86:87], v[12:13], v[12:13] op_sel_hi:[1,0,0]
 v_mfma_f32_16x16x16_bf16 v[212:215], v[56:57], v[74:75], v[212:215]
 v_rcp_f32 v80, v80
 v_rcp_f32 v81, v81
 v_rcp_f32 v82, v82
 v_mfma_f32_16x16x16_bf16 v[244:247], v[58:59], v[74:75], v[244:247]
 v_rcp_f32 v83, v83
 v_rcp_f32 v84, v84
 v_rcp_f32 v85, v85
 v_rcp_f32 v86, v86
 v_rcp_f32 v87, v87
 v_pk_mul_f32 v[192:193], v[192:193], v[80:81]
 v_pk_mul_f32 v[194:195], v[194:195], v[82:83]
 v_pk_mul_f32 v[224:225], v[224:225], v[84:85]
 v_pk_mul_f32 v[226:227], v[226:227], v[86:87]
 v_cvt_pk_bf16_f32 v208, v192, v193
 v_cvt_pk_bf16_f32 v209, v194, v195
 v_cvt_pk_bf16_f32 v210, v224, v225
 v_cvt_pk_bf16_f32 v211, v226, v227
 buffer_store_dwordx4 v[208:211], v20, s[8:11], s85 offen offset:0 sc1
 ds_write_b128 v20, v[208:211] offset:32768
 v_pk_mul_f32 v[88:89], v[196:197], v[196:197]
 v_pk_mul_f32 v[90:91], v[198:199], v[198:199]
 v_pk_mul_f32 v[92:93], v[228:229], v[228:229]
 v_pk_mul_f32 v[94:95], v[230:231], v[230:231]
 v_pk_fma_f32 v[88:89], v[88:89], v[30:31], v[28:29] op_sel_hi:[1,0,0]
 v_pk_fma_f32 v[90:91], v[90:91], v[30:31], v[28:29] op_sel_hi:[1,0,0]
 v_pk_fma_f32 v[92:93], v[92:93], v[30:31], v[28:29] op_sel_hi:[1,0,0]
 v_pk_fma_f32 v[94:95], v[94:95], v[30:31], v[28:29] op_sel_hi:[1,0,0]
 v_pk_mul_f32 v[88:89], v[88:89], v[196:197]
 v_pk_mul_f32 v[90:91], v[90:91], v[198:199]
 v_pk_mul_f32 v[92:93], v[92:93], v[228:229]
 v_pk_mul_f32 v[94:95], v[94:95], v[230:231]
 v_pk_mul_f32 v[196:197], v[196:197], v[212:213]
 v_pk_mul_f32 v[198:199], v[198:199], v[214:215]
 v_pk_mul_f32 v[228:229], v[228:229], v[244:245]
 v_pk_mul_f32 v[230:231], v[230:231], v[246:247]
 v_mfma_f32_16x16x16_bf16 v[200:203], v[52:53], v[76:77], v[200:203]
 v_exp_f32 v88, v88
 v_exp_f32 v89, v89
 v_exp_f32 v90, v90
 v_mfma_f32_16x16x16_bf16 v[232:235], v[54:55], v[76:77], v[232:235]
 v_exp_f32 v91, v91
 v_exp_f32 v92, v92
 v_exp_f32 v93, v93
 v_exp_f32 v94, v94
 v_exp_f32 v95, v95
 v_pk_fma_f32 v[88:89], v[88:89], v[14:15], v[14:15] op_sel_hi:[1,0,0]
 v_pk_fma_f32 v[90:91], v[90:91], v[14:15], v[14:15] op_sel_hi:[1,0,0]
 v_pk_fma_f32 v[92:93], v[92:93], v[14:15], v[14:15] op_sel_hi:[1,0,0]
 v_pk_fma_f32 v[94:95], v[94:95], v[14:15], v[14:15] op_sel_hi:[1,0,0]
 v_mfma_f32_16x16x16_bf16 v[216:219], v[56:57], v[76:77], v[216:219]
 v_rcp_f32 v88, v88
 v_rcp_f32 v89, v89
 v_rcp_f32 v90, v90
 v_mfma_f32_16x16x16_bf16 v[248:251], v[58:59], v[76:77], v[248:251]
 v_rcp_f32 v91, v91
 v_rcp_f32 v92, v92
 v_rcp_f32 v93, v93
 v_rcp_f32 v94, v94
 v_rcp_f32 v95, v95
 v_pk_mul_f32 v[196:197], v[196:197], v[88:89]
 v_pk_mul_f32 v[198:199], v[198:199], v[90:91]
 v_pk_mul_f32 v[228:229], v[228:229], v[92:93]
 v_pk_mul_f32 v[230:231], v[230:231], v[94:95]
 v_cvt_pk_bf16_f32 v212, v196, v197
 v_cvt_pk_bf16_f32 v213, v198, v199
 v_cvt_pk_bf16_f32 v214, v228, v229
 v_cvt_pk_bf16_f32 v215, v230, v231
 buffer_store_dwordx4 v[212:215], v20, s[8:11], s85 offen offset:1024 sc1
 ds_write_b128 v20, v[212:215] offset:33792
 v_pk_mul_f32 v[80:81], v[200:201], v[200:201]
 v_pk_mul_f32 v[82:83], v[202:203], v[202:203]
 v_pk_mul_f32 v[84:85], v[232:233], v[232:233]
 v_pk_mul_f32 v[86:87], v[234:235], v[234:235]
 v_pk_fma_f32 v[80:81], v[80:81], v[34:35], v[32:33] op_sel_hi:[1,0,0]
 v_pk_fma_f32 v[82:83], v[82:83], v[34:35], v[32:33] op_sel_hi:[1,0,0]
 v_pk_fma_f32 v[84:85], v[84:85], v[34:35], v[32:33] op_sel_hi:[1,0,0]
 v_pk_fma_f32 v[86:87], v[86:87], v[34:35], v[32:33] op_sel_hi:[1,0,0]
 v_pk_mul_f32 v[80:81], v[80:81], v[200:201]
 v_pk_mul_f32 v[82:83], v[82:83], v[202:203]
 v_pk_mul_f32 v[84:85], v[84:85], v[232:233]
 v_pk_mul_f32 v[86:87], v[86:87], v[234:235]
 v_pk_mul_f32 v[200:201], v[200:201], v[216:217]
 v_pk_mul_f32 v[202:203], v[202:203], v[218:219]
 v_pk_mul_f32 v[232:233], v[232:233], v[248:249]
 v_pk_mul_f32 v[234:235], v[234:235], v[250:251]
 v_mfma_f32_16x16x16_bf16 v[204:207], v[52:53], v[78:79], v[204:207]
 v_exp_f32 v80, v80
 v_exp_f32 v81, v81
 v_exp_f32 v82, v82
 v_mfma_f32_16x16x16_bf16 v[236:239], v[54:55], v[78:79], v[236:239]
 v_exp_f32 v83, v83
 v_exp_f32 v84, v84
 v_exp_f32 v85, v85
 v_exp_f32 v86, v86
 v_exp_f32 v87, v87
 v_pk_fma_f32 v[80:81], v[80:81], v[16:17], v[16:17] op_sel_hi:[1,0,0]
 v_pk_fma_f32 v[82:83], v[82:83], v[16:17], v[16:17] op_sel_hi:[1,0,0]
 v_pk_fma_f32 v[84:85], v[84:85], v[16:17], v[16:17] op_sel_hi:[1,0,0]
 v_pk_fma_f32 v[86:87], v[86:87], v[16:17], v[16:17] op_sel_hi:[1,0,0]
 v_mfma_f32_16x16x16_bf16 v[220:223], v[56:57], v[78:79], v[220:223]
 v_rcp_f32 v80, v80
 v_rcp_f32 v81, v81
 v_rcp_f32 v82, v82
 v_mfma_f32_16x16x16_bf16 v[252:255], v[58:59], v[78:79], v[252:255]
 v_rcp_f32 v83, v83
 v_rcp_f32 v84, v84
 v_rcp_f32 v85, v85
 v_rcp_f32 v86, v86
 v_rcp_f32 v87, v87
 v_pk_mul_f32 v[200:201], v[200:201], v[80:81]
 v_pk_mul_f32 v[202:203], v[202:203], v[82:83]
 v_pk_mul_f32 v[232:233], v[232:233], v[84:85]
 v_pk_mul_f32 v[234:235], v[234:235], v[86:87]
 v_cvt_pk_bf16_f32 v216, v200, v201
 v_cvt_pk_bf16_f32 v217, v202, v203
 v_cvt_pk_bf16_f32 v218, v232, v233
 v_cvt_pk_bf16_f32 v219, v234, v235
 buffer_store_dwordx4 v[216:219], v20, s[8:11], s85 offen offset:2048 sc1
 ds_write_b128 v20, v[216:219] offset:34816
 v_pk_mul_f32 v[88:89], v[204:205], v[204:205]
 v_pk_mul_f32 v[90:91], v[206:207], v[206:207]
 v_pk_mul_f32 v[92:93], v[236:237], v[236:237]
 v_pk_mul_f32 v[94:95], v[238:239], v[238:239]
 v_pk_fma_f32 v[88:89], v[88:89], v[38:39], v[36:37] op_sel_hi:[1,0,0]
 v_pk_fma_f32 v[90:91], v[90:91], v[38:39], v[36:37] op_sel_hi:[1,0,0]
 v_pk_fma_f32 v[92:93], v[92:93], v[38:39], v[36:37] op_sel_hi:[1,0,0]
 v_pk_fma_f32 v[94:95], v[94:95], v[38:39], v[36:37] op_sel_hi:[1,0,0]
 v_pk_mul_f32 v[88:89], v[88:89], v[204:205]
 v_pk_mul_f32 v[90:91], v[90:91], v[206:207]
 v_pk_mul_f32 v[92:93], v[92:93], v[236:237]
 v_pk_mul_f32 v[94:95], v[94:95], v[238:239]
 v_pk_mul_f32 v[204:205], v[204:205], v[220:221]
 v_pk_mul_f32 v[206:207], v[206:207], v[222:223]
 v_pk_mul_f32 v[236:237], v[236:237], v[252:253]
 v_pk_mul_f32 v[238:239], v[238:239], v[254:255]
 v_exp_f32 v88, v88
 v_exp_f32 v89, v89
 v_exp_f32 v90, v90
 v_exp_f32 v91, v91
 v_exp_f32 v92, v92
 v_exp_f32 v93, v93
 v_exp_f32 v94, v94
 v_exp_f32 v95, v95
 v_pk_fma_f32 v[88:89], v[88:89], v[18:19], v[18:19] op_sel_hi:[1,0,0]
 v_pk_fma_f32 v[90:91], v[90:91], v[18:19], v[18:19] op_sel_hi:[1,0,0]
 v_pk_fma_f32 v[92:93], v[92:93], v[18:19], v[18:19] op_sel_hi:[1,0,0]
 v_pk_fma_f32 v[94:95], v[94:95], v[18:19], v[18:19] op_sel_hi:[1,0,0]
 v_rcp_f32 v88, v88
 v_rcp_f32 v89, v89
 v_rcp_f32 v90, v90
 v_rcp_f32 v91, v91
 v_rcp_f32 v92, v92
 v_rcp_f32 v93, v93
 v_rcp_f32 v94, v94
 v_rcp_f32 v95, v95
 v_pk_mul_f32 v[204:205], v[204:205], v[88:89]
 v_pk_mul_f32 v[206:207], v[206:207], v[90:91]
 v_pk_mul_f32 v[236:237], v[236:237], v[92:93]
 v_pk_mul_f32 v[238:239], v[238:239], v[94:95]
 v_cvt_pk_bf16_f32 v220, v204, v205
 v_cvt_pk_bf16_f32 v221, v206, v207
 v_cvt_pk_bf16_f32 v222, v236, v237
 v_cvt_pk_bf16_f32 v223, v238, v239
 buffer_store_dwordx4 v[220:223], v20, s[8:11], s85 offen offset:3072 sc1
 ds_write_b128 v20, v[220:223] offset:35840
 s_setprio 0
 v_cvt_pk_bf16_f32 v40, v96, v97
 v_cvt_pk_bf16_f32 v41, v98, v99
 v_cvt_pk_bf16_f32 v42, v112, v113
 v_cvt_pk_bf16_f32 v43, v114, v115
 v_cvt_pk_bf16_f32 v44, v100, v101
 v_cvt_pk_bf16_f32 v45, v102, v103
 v_cvt_pk_bf16_f32 v46, v116, v117
 v_cvt_pk_bf16_f32 v47, v118, v119
 v_mfma_f32_16x16x32_bf16 v[160:163], v[64:67], v[40:43], 0
 v_mfma_f32_16x16x32_bf16 v[164:167], v[68:71], v[40:43], 0
 v_cvt_pk_bf16_f32 v48, v104, v105
 v_cvt_pk_bf16_f32 v49, v106, v107
 v_cvt_pk_bf16_f32 v50, v120, v121
 v_cvt_pk_bf16_f32 v51, v122, v123
 v_mfma_f32_16x16x32_bf16 v[168:171], v[64:67], v[44:47], 0
 v_mfma_f32_16x16x32_bf16 v[172:175], v[68:71], v[44:47], 0
 v_cvt_pk_bf16_f32 v52, v108, v109
 v_cvt_pk_bf16_f32 v53, v110, v111
 v_cvt_pk_bf16_f32 v54, v124, v125
 v_cvt_pk_bf16_f32 v55, v126, v127
 v_mfma_f32_16x16x32_bf16 v[176:179], v[64:67], v[48:51], 0
 v_mfma_f32_16x16x32_bf16 v[180:183], v[68:71], v[48:51], 0
 v_mul_f32 v12, 0x3fb8aa3b, v25
 v_mul_f32 v14, 0x3fb8aa3b, v29
 v_mul_f32 v16, 0x3fb8aa3b, v33
 v_mul_f32 v18, 0x3fb8aa3b, v37
 v_mfma_f32_16x16x32_bf16 v[184:187], v[64:67], v[52:55], 0
 v_mfma_f32_16x16x32_bf16 v[188:191], v[68:71], v[52:55], 0
 s_lshl2_add_u32 s92, s83, s4
 s_lshl2_add_u32 s92, s92, s7
 s_lshl_b32 s92, s92, 7
 s_add_u32 s92, s92, 39911425
 s_lshl1_add_u32 s92, s54, s92
 s_lshr_b32 s91, s5, 2
 s_sub_u32 s92, s92, s91
 v_mov_b32 v91, 1
 s_waitcnt vmcnt(0)
 buffer_store_byte v91, off, s[8:11], s92 sc1
 s_waitcnt vmcnt(15) lgkmcnt(0)
 s_barrier
 ds_read_b128 v[40:43], v2 offset:0
 ds_read_b64_tr_b16 v[24:25], v6 offset:0
 ds_read_b64_tr_b16 v[26:27], v6 offset:4096
 ds_read_b64_tr_b16 v[28:29], v7 offset:0
 ds_read_b64_tr_b16 v[30:31], v7 offset:4096
 ds_read_b128 v[44:47], v2 offset:1024
 ds_read_b64_tr_b16 v[32:33], v8 offset:0
 ds_read_b64_tr_b16 v[34:35], v8 offset:4096
 ds_read_b128 v[48:51], v3 offset:0
 ds_read_b64_tr_b16 v[36:37], v9 offset:0
 ds_read_b64_tr_b16 v[38:39], v9 offset:4096
 ds_read_b128 v[52:55], v3 offset:1024
 ds_read_b32 v90, v0
 ds_read_b32 v90, v0
 s_lshl2_add_u32 s64, s83, s4
 s_lshl2_add_u32 s64, s64, s7
 s_lshl_b32 s64, s64, 7
 s_add_u32 s64, s64, 39911424
 s_add_u32 s74, s54, 1
 s_lshl_b32 s74, s74, 4
 s_buffer_load_dwordx2 s[72:73], s[8:11], s64 glc
 v_max3_f32 v240, v160, v161, v162
 v_max3_f32 v241, -v160, -v161, -v162
 v_max3_f32 v242, v168, v169, v170
 v_max3_f32 v243, -v168, -v169, -v170
 v_max3_f32 v244, v176, v177, v178
 v_max3_f32 v245, -v176, -v177, -v178
 v_max3_f32 v246, v184, v185, v186
 v_max3_f32 v247, -v184, -v185, -v186
 v_max3_f32 v240, v240, v163, v164
 v_max3_f32 v241, v241, -v163, -v164
 v_max3_f32 v242, v242, v171, v172
 v_max3_f32 v243, v243, -v171, -v172
 v_max3_f32 v244, v244, v179, v180
 v_max3_f32 v245, v245, -v179, -v180
 v_max3_f32 v246, v246, v187, v188
 v_max3_f32 v247, v247, -v187, -v188
 v_max3_f32 v240, v240, v165, v166
 v_max3_f32 v241, v241, -v165, -v166
 v_max3_f32 v242, v242, v173, v174
 v_max3_f32 v243, v243, -v173, -v174
 v_max3_f32 v244, v244, v181, v182
 v_max3_f32 v245, v245, -v181, -v182
 v_max3_f32 v246, v246, v189, v190
 v_max3_f32 v247, v247, -v189, -v190
 v_max_f32 v240, v240, v167
 v_max_f32_e64 v241, v241, -v167
 v_max_f32 v242, v242, v175
 v_max_f32_e64 v243, v243, -v175
 v_max_f32 v244, v244, v183
 v_max_f32_e64 v245, v245, -v183
 v_max_f32 v246, v246, v191
 v_max_f32_e64 v247, v247, -v191
 v_permlane32_swap_b32 v240, v244
 v_permlane32_swap_b32 v241, v245
 s_waitcnt vmcnt(14) lgkmcnt(2)
 s_barrier
 v_mfma_f32_16x16x32_bf16 v[96:99], v[24:27], v[40:43], 0
 ds_read_b128 v[72:75], v2 offset:16384
 v_mfma_f32_16x16x32_bf16 v[100:103], v[28:31], v[40:43], 0
 ds_read_b64_tr_b16 v[56:57], v6 offset:8192
 v_mfma_f32_16x16x32_bf16 v[104:107], v[32:35], v[40:43], 0
 ds_read_b64_tr_b16 v[58:59], v6 offset:12288
 v_mfma_f32_16x16x32_bf16 v[108:111], v[36:39], v[40:43], 0
 ds_read_b64_tr_b16 v[60:61], v7 offset:8192
 v_mfma_f32_16x16x32_bf16 v[124:127], v[36:39], v[44:47], 0
 ds_read_b64_tr_b16 v[62:63], v7 offset:12288
 s_waitcnt lgkmcnt(0)
 s_lshr_b64 s[72:73], s[72:73], s74
 s_and_b32 s72, s72, 0xffff
 s_cmp_eq_u32 s72, 0x101
 s_cbranch_scc0 Lsp_159
Lok_160:
 s_add_u32 m0, s55, 49152
 s_add_u32 s62, s41, 16384
 v_mfma_f32_16x16x32_bf16 v[120:123], v[32:35], v[44:47], 0
 ds_read_b128 v[76:79], v2 offset:17408
 buffer_load_dwordx4 v20, s[8:11], s62 offen offset:0 sc1 lds
 v_mfma_f32_16x16x32_bf16 v[116:119], v[28:31], v[44:47], 0
 ds_read_b64_tr_b16 v[64:65], v8 offset:8192
 buffer_load_dwordx4 v20, s[8:11], s62 offen offset:1024 sc1 lds
 v_mfma_f32_16x16x32_bf16 v[112:115], v[24:27], v[44:47], 0
 ds_read_b64_tr_b16 v[66:67], v8 offset:12288
 buffer_load_dwordx4 v20, s[8:11], s62 offen offset:2048 sc1 lds
 v_mfma_f32_16x16x32_bf16 v[128:131], v[24:27], v[48:51], 0
 ds_read_b128 v[80:83], v3 offset:16384
 v_mfma_f32_16x16x32_bf16 v[132:135], v[28:31], v[48:51], 0
 ds_read_b64_tr_b16 v[68:69], v9 offset:8192
 buffer_load_dwordx4 v20, s[8:11], s62 offen offset:3072 sc1 lds
 s_add_u32 m0, s55, 65536
 s_add_u32 s62, s41, 32768
 v_mfma_f32_16x16x32_bf16 v[136:139], v[32:35], v[48:51], 0
 ds_read_b64_tr_b16 v[70:71], v9 offset:12288
 buffer_load_dwordx4 v20, s[8:11], s62 offen offset:0 sc1 lds
 v_mfma_f32_16x16x32_bf16 v[140:143], v[36:39], v[48:51], 0
 ds_read_b128 v[84:87], v3 offset:17408
 buffer_load_dwordx4 v20, s[8:11], s62 offen offset:1024 sc1 lds
 v_mfma_f32_16x16x32_bf16 v[156:159], v[36:39], v[52:55], 0
 v_mfma_f32_16x16x32_bf16 v[152:155], v[32:35], v[52:55], 0
 buffer_load_dwordx4 v20, s[8:11], s62 offen offset:2048 sc1 lds
 v_mfma_f32_16x16x32_bf16 v[148:151], v[28:31], v[52:55], 0
 buffer_load_dwordx4 v20, s[8:11], s62 offen offset:3072 sc1 lds
 v_mfma_f32_16x16x32_bf16 v[144:147], v[24:27], v[52:55], 0
 s_waitcnt vmcnt(21) lgkmcnt(0)
 s_barrier
 v_mfma_f32_16x16x32_bf16 v[96:99], v[56:59], v[72:75], v[96:99]
 ds_read_b128 v[40:43], v2 offset:32768
 s_buffer_load_dwordx2 s[72:73], s[8:11], s64 glc
 v_mfma_f32_16x16x32_bf16 v[100:103], v[60:63], v[72:75], v[100:103]
 ds_read_b64_tr_b16 v[24:25], v6 offset:16384
 v_mfma_f32_16x16x32_bf16 v[104:107], v[64:67], v[72:75], v[104:107]
 ds_read_b64_tr_b16 v[26:27], v6 offset:20480
 s_add_u32 m0, s55, 81920
 s_add_u32 s62, s42, 16384
 v_mfma_f32_16x16x32_bf16 v[108:111], v[68:71], v[72:75], v[108:111]
 ds_read_b64_tr_b16 v[28:29], v7 offset:16384
 buffer_load_dwordx4 v20, s[8:11], s62 offen offset:0 sc1 lds
 v_mfma_f32_16x16x32_bf16 v[124:127], v[68:71], v[76:79], v[124:127]
 ds_read_b64_tr_b16 v[30:31], v7 offset:20480
 v_mfma_f32_16x16x32_bf16 v[120:123], v[64:67], v[76:79], v[120:123]
 ds_read_b128 v[44:47], v2 offset:33792
 v_mfma_f32_16x16x32_bf16 v[116:119], v[60:63], v[76:79], v[116:119]
 ds_read_b64_tr_b16 v[32:33], v8 offset:16384
 v_mfma_f32_16x16x32_bf16 v[112:115], v[56:59], v[76:79], v[112:115]
 ds_read_b64_tr_b16 v[34:35], v8 offset:20480
 buffer_load_dwordx4 v20, s[8:11], s62 offen offset:1024 sc1 lds
 v_mfma_f32_16x16x32_bf16 v[128:131], v[56:59], v[80:83], v[128:131]
 ds_read_b128 v[48:51], v3 offset:32768
 v_mfma_f32_16x16x32_bf16 v[132:135], v[60:63], v[80:83], v[132:135]
 ds_read_b64_tr_b16 v[36:37], v9 offset:16384
 v_mfma_f32_16x16x32_bf16 v[136:139], v[64:67], v[80:83], v[136:139]
 ds_read_b64_tr_b16 v[38:39], v9 offset:20480
 buffer_load_dwordx4 v20, s[8:11], s62 offen offset:2048 sc1 lds
 v_mfma_f32_16x16x32_bf16 v[140:143], v[68:71], v[80:83], v[140:143]
 ds_read_b128 v[52:55], v3 offset:33792
 ds_read_b32 v90, v0
 ds_read_b32 v90, v0
 v_mfma_f32_16x16x32_bf16 v[156:159], v[68:71], v[84:87], v[156:159]
 v_mfma_f32_16x16x32_bf16 v[152:155], v[64:67], v[84:87], v[152:155]
 v_mfma_f32_16x16x32_bf16 v[148:151], v[60:63], v[84:87], v[148:151]
 buffer_load_dwordx4 v20, s[8:11], s62 offen offset:3072 sc1 lds
 v_mfma_f32_16x16x32_bf16 v[144:147], v[56:59], v[84:87], v[144:147]
 s_waitcnt vmcnt(8) lgkmcnt(2)
 s_barrier
 v_mfma_f32_16x16x32_bf16 v[96:99], v[24:27], v[40:43], v[96:99]
 ds_read_b128 v[72:75], v2 offset:49152
 v_mfma_f32_16x16x32_bf16 v[100:103], v[28:31], v[40:43], v[100:103]
 ds_read_b64_tr_b16 v[56:57], v6 offset:24576
 v_mfma_f32_16x16x32_bf16 v[104:107], v[32:35], v[40:43], v[104:107]
 ds_read_b64_tr_b16 v[58:59], v6 offset:28672
 s_add_u32 m0, s50, 32768
 s_add_u32 s62, s42, 32768
 v_mfma_f32_16x16x32_bf16 v[108:111], v[36:39], v[40:43], v[108:111]
 ds_read_b64_tr_b16 v[60:61], v7 offset:24576
 buffer_load_dwordx4 v13, s[8:11], s62 offen offset:0 sc1 lds
 v_mfma_f32_16x16x32_bf16 v[124:127], v[36:39], v[44:47], v[124:127]
 ds_read_b64_tr_b16 v[62:63], v7 offset:28672
 v_mfma_f32_16x16x32_bf16 v[120:123], v[32:35], v[44:47], v[120:123]
 ds_read_b128 v[76:79], v2 offset:50176
 v_mfma_f32_16x16x32_bf16 v[116:119], v[28:31], v[44:47], v[116:119]
 ds_read_b64_tr_b16 v[64:65], v8 offset:24576
 v_mfma_f32_16x16x32_bf16 v[112:115], v[24:27], v[44:47], v[112:115]
 ds_read_b64_tr_b16 v[66:67], v8 offset:28672
 buffer_load_dwordx4 v13, s[8:11], s62 offen offset:1024 sc1 lds
 v_mfma_f32_16x16x32_bf16 v[128:131], v[24:27], v[48:51], v[128:131]
 ds_read_b128 v[80:83], v3 offset:49152
 v_mfma_f32_16x16x32_bf16 v[132:135], v[28:31], v[48:51], v[132:135]
 ds_read_b64_tr_b16 v[68:69], v9 offset:24576
 s_add_u32 m0, s51, 0
 s_add_u32 s63, s34, 163840
 v_mfma_f32_16x16x32_bf16 v[136:139], v[32:35], v[48:51], v[136:139]
 ds_read_b64_tr_b16 v[70:71], v9 offset:28672
 buffer_load_dwordx4 v10, s[24:27], s63 offen lds
 v_mfma_f32_16x16x32_bf16 v[140:143], v[36:39], v[48:51], v[140:143]
 ds_read_b128 v[84:87], v3 offset:50176
 v_mfma_f32_16x16x32_bf16 v[156:159], v[36:39], v[52:55], v[156:159]
 v_mfma_f32_16x16x32_bf16 v[152:155], v[32:35], v[52:55], v[152:155]
 s_add_u32 m0, s51, 8192
 s_add_u32 s63, s35, 98304
 v_mfma_f32_16x16x32_bf16 v[148:151], v[28:31], v[52:55], v[148:151]
 buffer_load_dwordx4 v10, s[24:27], s63 offen lds
 v_mfma_f32_16x16x32_bf16 v[144:147], v[24:27], v[52:55], v[144:147]
 s_waitcnt lgkmcnt(0)
 s_and_b32 s72, s72, s73
 s_cmp_eq_u32 s72, 0x1010101
 s_cbranch_scc0 Lsp_162
Lok_163:
 s_waitcnt vmcnt(8) lgkmcnt(0)
 s_barrier
 v_mfma_f32_16x16x32_bf16 v[96:99], v[56:59], v[72:75], v[96:99]
 ds_read_b128 v[40:43], v4 offset:0
 v_mfma_f32_16x16x32_bf16 v[100:103], v[60:63], v[72:75], v[100:103]
 ds_read_b64_tr_b16 v[24:25], v6 offset:32768
 v_mfma_f32_16x16x32_bf16 v[104:107], v[64:67], v[72:75], v[104:107]
 ds_read_b64_tr_b16 v[26:27], v6 offset:36864
 s_add_u32 m0, s50, 49152
 s_add_u32 s62, s43, 16384
 v_mfma_f32_16x16x32_bf16 v[108:111], v[68:71], v[72:75], v[108:111]
 ds_read_b64_tr_b16 v[28:29], v7 offset:32768
 buffer_load_dwordx4 v13, s[8:11], s62 offen offset:0 sc1 lds
 v_mfma_f32_16x16x32_bf16 v[124:127], v[68:71], v[76:79], v[124:127]
 ds_read_b64_tr_b16 v[30:31], v7 offset:36864
 v_mfma_f32_16x16x32_bf16 v[120:123], v[64:67], v[76:79], v[120:123]
 ds_read_b128 v[44:47], v4 offset:1024
 v_mfma_f32_16x16x32_bf16 v[116:119], v[60:63], v[76:79], v[116:119]
 ds_read_b64_tr_b16 v[32:33], v8 offset:32768
 v_mfma_f32_16x16x32_bf16 v[112:115], v[56:59], v[76:79], v[112:115]
 ds_read_b64_tr_b16 v[34:35], v8 offset:36864
 buffer_load_dwordx4 v13, s[8:11], s62 offen offset:1024 sc1 lds
 v_mfma_f32_16x16x32_bf16 v[128:131], v[56:59], v[80:83], v[128:131]
 ds_read_b128 v[48:51], v5 offset:0
 v_mfma_f32_16x16x32_bf16 v[132:135], v[60:63], v[80:83], v[132:135]
 ds_read_b64_tr_b16 v[36:37], v9 offset:32768
 s_add_u32 m0, s51, 16384
 s_add_u32 s63, s35, 163840
 v_mfma_f32_16x16x32_bf16 v[136:139], v[64:67], v[80:83], v[136:139]
 ds_read_b64_tr_b16 v[38:39], v9 offset:36864
 buffer_load_dwordx4 v10, s[24:27], s63 offen lds
 v_mfma_f32_16x16x32_bf16 v[140:143], v[68:71], v[80:83], v[140:143]
 ds_read_b128 v[52:55], v5 offset:1024
 v_mfma_f32_16x16x32_bf16 v[156:159], v[68:71], v[84:87], v[156:159]
 v_mfma_f32_16x16x32_bf16 v[152:155], v[64:67], v[84:87], v[152:155]
 s_add_u32 m0, s51, 24576
 s_add_u32 s63, s36, 98304
 v_mfma_f32_16x16x32_bf16 v[148:151], v[60:63], v[84:87], v[148:151]
 buffer_load_dwordx4 v10, s[24:27], s63 offen lds
 v_mfma_f32_16x16x32_bf16 v[144:147], v[56:59], v[84:87], v[144:147]
 s_waitcnt vmcnt(8) lgkmcnt(0)
 s_barrier
 v_mfma_f32_16x16x32_bf16 v[96:99], v[24:27], v[40:43], v[96:99]
 ds_read_b128 v[72:75], v4 offset:16384
 v_lshrrev_b32 v88, 4, v1
 v_mfma_f32_16x16x32_bf16 v[100:103], v[28:31], v[40:43], v[100:103]
 ds_read_b64_tr_b16 v[56:57], v6 offset:40960
 v_mfma_f32_16x16x32_bf16 v[104:107], v[32:35], v[40:43], v[104:107]
 ds_read_b64_tr_b16 v[58:59], v6 offset:45056
 v_xor_b32 v88, v88, v1
 v_mfma_f32_16x16x32_bf16 v[108:111], v[36:39], v[40:43], v[108:111]
 ds_read_b64_tr_b16 v[60:61], v7 offset:40960
 s_add_u32 m0, s50, 65536
 s_add_u32 s62, s43, 32768
 v_mfma_f32_16x16x32_bf16 v[124:127], v[36:39], v[44:47], v[124:127]
 ds_read_b64_tr_b16 v[62:63], v7 offset:45056
 buffer_load_dwordx4 v13, s[8:11], s62 offen offset:0 sc1 lds
 v_and_b32 v88, 3, v88
 v_mfma_f32_16x16x32_bf16 v[120:123], v[32:35], v[44:47], v[120:123]
 ds_read_b128 v[76:79], v4 offset:17408
 v_mfma_f32_16x16x32_bf16 v[116:119], v[28:31], v[44:47], v[116:119]
 ds_read_b64_tr_b16 v[64:65], v8 offset:40960
 v_and_b32 v89, 60, v1
 v_mfma_f32_16x16x32_bf16 v[112:115], v[24:27], v[44:47], v[112:115]
 ds_read_b64_tr_b16 v[66:67], v8 offset:45056
 v_mfma_f32_16x16x32_bf16 v[128:131], v[24:27], v[48:51], v[128:131]
 ds_read_b128 v[80:83], v5 offset:16384
 v_mfma_f32_16x16x32_bf16 v[132:135], v[28:31], v[48:51], v[132:135]
 ds_read_b64_tr_b16 v[68:69], v9 offset:40960
 buffer_load_dwordx4 v13, s[8:11], s62 offen offset:1024 sc1 lds
 v_or_b32 v89, v89, v88
 v_mfma_f32_16x16x32_bf16 v[136:139], v[32:35], v[48:51], v[136:139]
 ds_read_b64_tr_b16 v[70:71], v9 offset:45056
 v_mfma_f32_16x16x32_bf16 v[140:143], v[36:39], v[48:51], v[140:143]
 ds_read_b128 v[84:87], v5 offset:17408
 s_lshl_b32 s85, s7, 9
 v_lshl_add_u32 v89, v89, 3, s85
 v_mfma_f32_16x16x32_bf16 v[156:159], v[36:39], v[52:55], v[156:159]
 s_add_u32 m0, s51, 32768
 s_add_u32 s63, s36, 163840
 v_mfma_f32_16x16x32_bf16 v[152:155], v[32:35], v[52:55], v[152:155]
 buffer_load_dwordx4 v10, s[24:27], s63 offen lds
 v_add_u32 v88, 149504, v0
 v_mfma_f32_16x16x32_bf16 v[148:151], v[28:31], v[52:55], v[148:151]
 v_mfma_f32_16x16x32_bf16 v[144:147], v[24:27], v[52:55], v[144:147]
 s_waitcnt vmcnt(8) lgkmcnt(0)
 s_barrier
 v_mfma_f32_16x16x32_bf16 v[96:99], v[56:59], v[72:75], v[96:99]
 ds_read_b128 v[40:43], v2 offset:32768
 s_setprio 1
 ds_read_b64_tr_b16 v[208:209], v89 offset:0
 ds_read_b64_tr_b16 v[210:211], v89 offset:2048
 v_mfma_f32_16x16x32_bf16 v[100:103], v[60:63], v[72:75], v[100:103]
 ds_read_b64_tr_b16 v[24:25], v6 offset:0
 ds_read_b128 v[192:195], v88 offset:0
 ds_read_b64_tr_b16 v[212:213], v89 offset:4096
 ds_read_b64_tr_b16 v[214:215], v89 offset:6144
 v_mfma_f32_16x16x32_bf16 v[104:107], v[64:67], v[72:75], v[104:107]
 ds_read_b64_tr_b16 v[26:27], v6 offset:4096
 ds_read_b128 v[196:199], v88 offset:1024
 ds_read_b64_tr_b16 v[216:217], v89 offset:8192
 v_mfma_f32_16x16x32_bf16 v[108:111], v[68:71], v[72:75], v[108:111]
 ds_read_b64_tr_b16 v[28:29], v7 offset:0
 ds_read_b64_tr_b16 v[218:219], v89 offset:10240
 ds_read_b128 v[200:203], v88 offset:4096
 ds_read_b64_tr_b16 v[220:221], v89 offset:12288
 s_add_u32 m0, s50, 81920
 s_add_u32 s62, s44, 16384
 v_mfma_f32_16x16x32_bf16 v[124:127], v[68:71], v[76:79], v[124:127]
 ds_read_b64_tr_b16 v[30:31], v7 offset:4096
 buffer_load_dwordx4 v13, s[8:11], s62 offen offset:0 sc1 lds
 ds_read_b64_tr_b16 v[222:223], v89 offset:14336
 ds_read_b128 v[204:207], v88 offset:5120
 v_mfma_f32_16x16x32_bf16 v[120:123], v[64:67], v[76:79], v[120:123]
 ds_read_b128 v[44:47], v2 offset:33792
 ds_read_b64_tr_b16 v[224:225], v89 offset:16384
 ds_read_b64_tr_b16 v[226:227], v89 offset:18432
 s_waitcnt lgkmcnt(15)
 v_mfma_f32_16x16x32_bf16 v[116:119], v[60:63], v[76:79], v[116:119]
 ds_read_b64_tr_b16 v[32:33], v8 offset:0
 v_mfma_f32_16x16x32_bf16 v[248:251], v[208:211], v[192:195], 0
 ds_read_b64_tr_b16 v[228:229], v89 offset:20480
 v_mfma_f32_16x16x32_bf16 v[112:115], v[56:59], v[76:79], v[112:115]
 ds_read_b64_tr_b16 v[34:35], v8 offset:4096
 ds_read_b64_tr_b16 v[230:231], v89 offset:22528
 s_waitcnt lgkmcnt(15)
 v_mfma_f32_16x16x32_bf16 v[248:251], v[212:215], v[196:199], v[248:251]
 v_mfma_f32_16x16x32_bf16 v[128:131], v[56:59], v[80:83], v[128:131]
 ds_read_b128 v[48:51], v3 offset:32768
 ds_read_b128 v[192:195], v88 offset:8192
 ds_read_b64_tr_b16 v[232:233], v89 offset:24576
 ds_read_b64_tr_b16 v[234:235], v89 offset:26624
 v_mfma_f32_16x16x32_bf16 v[132:135], v[60:63], v[80:83], v[132:135]
 ds_read_b64_tr_b16 v[36:37], v9 offset:0
 buffer_load_dwordx4 v13, s[8:11], s62 offen offset:1024 sc1 lds
 s_waitcnt lgkmcnt(15)
 v_mfma_f32_16x16x32_bf16 v[248:251], v[216:219], v[200:203], v[248:251]
 v_mfma_f32_16x16x32_bf16 v[136:139], v[64:67], v[80:83], v[136:139]
 ds_read_b64_tr_b16 v[38:39], v9 offset:4096
 ds_read_b128 v[196:199], v88 offset:9216
 ds_read_b64_tr_b16 v[236:237], v89 offset:28672
 ds_read_b64_tr_b16 v[238:239], v89 offset:30720
 v_mfma_f32_16x16x32_bf16 v[140:143], v[68:71], v[80:83], v[140:143]
 ds_read_b128 v[52:55], v3 offset:33792
 s_waitcnt lgkmcnt(15)
 v_mfma_f32_16x16x32_bf16 v[248:251], v[220:223], v[204:207], v[248:251]
 v_mfma_f32_16x16x32_bf16 v[156:159], v[68:71], v[84:87], v[156:159]
 ds_read_b128 v[200:203], v88 offset:12288
 s_waitcnt lgkmcnt(9)
 v_mfma_f32_16x16x32_bf16 v[248:251], v[224:227], v[192:195], v[248:251]
 s_add_u32 m0, s51, 40960
 s_add_u32 s63, s37, 98304
 v_mfma_f32_16x16x32_bf16 v[152:155], v[64:67], v[84:87], v[152:155]
 buffer_load_dwordx4 v10, s[24:27], s63 offen lds
 ds_read_b128 v[204:207], v88 offset:13312
 s_waitcnt lgkmcnt(5)
 v_mfma_f32_16x16x32_bf16 v[148:151], v[60:63], v[84:87], v[148:151]
 v_mfma_f32_16x16x32_bf16 v[248:251], v[228:231], v[196:199], v[248:251]
 s_waitcnt lgkmcnt(1)
 v_mfma_f32_16x16x32_bf16 v[248:251], v[232:235], v[200:203], v[248:251]
 v_mfma_f32_16x16x32_bf16 v[144:147], v[56:59], v[84:87], v[144:147]
 s_waitcnt lgkmcnt(0)
 v_mfma_f32_16x16x32_bf16 v[248:251], v[236:239], v[204:207], v[248:251]
 s_waitcnt vmcnt(8) lgkmcnt(0)
 s_barrier
 v_mfma_f32_16x16x32_bf16 v[96:99], v[24:27], v[40:43], v[96:99]
 ds_read_b128 v[72:75], v2 offset:49152
 s_lshl3_add_u32 s85, s82, s83
 s_mul_i32 s85, s85, 8448
 s_add_u32 s85, s85, 23068672
 v_mfma_f32_16x16x32_bf16 v[100:103], v[28:31], v[40:43], v[100:103]
 ds_read_b64_tr_b16 v[56:57], v6 offset:8192
 s_lshl_b32 s86, s3, 10
 s_add_u32 s86, s86, s85
 v_mfma_f32_16x16x32_bf16 v[104:107], v[32:35], v[40:43], v[104:107]
 ds_read_b64_tr_b16 v[58:59], v6 offset:12288
 buffer_store_dwordx4 v[248:251], v0, s[8:11], s86 offen sc1
 v_permlane32_swap_b32 v242, v246
 v_permlane32_swap_b32 v243, v247
 v_mfma_f32_16x16x32_bf16 v[108:111], v[36:39], v[40:43], v[108:111]
 ds_read_b64_tr_b16 v[60:61], v7 offset:8192
 v_max_f32 v240, v240, v244
 v_max_f32 v241, v241, v245
 s_add_u32 m0, s50, 0
 s_add_u32 s62, s44, 32768
 v_mfma_f32_16x16x32_bf16 v[124:127], v[36:39], v[44:47], v[124:127]
 ds_read_b64_tr_b16 v[62:63], v7 offset:12288
 buffer_load_dwordx4 v13, s[8:11], s62 offen offset:0 sc1 lds
 v_max_f32 v242, v242, v246
 v_max_f32 v243, v243, v247
 s_nop 0
 v_permlane16_swap_b32 v240, v242
 v_mfma_f32_16x16x32_bf16 v[120:123], v[32:35], v[44:47], v[120:123]
 ds_read_b128 v[76:79], v2 offset:50176
 v_permlane16_swap_b32 v241, v243
 v_max_f32 v240, v240, v242
 v_mfma_f32_16x16x32_bf16 v[116:119], v[28:31], v[44:47], v[116:119]
 ds_read_b64_tr_b16 v[64:65], v8 offset:8192
 v_max_f32 v241, v241, v243
 v_mov_b32 v242, v240
 v_mov_b32 v243, v241
 v_mfma_f32_16x16x32_bf16 v[112:115], v[24:27], v[44:47], v[112:115]
 ds_read_b64_tr_b16 v[66:67], v8 offset:12288
 v_permlane16_swap_b32 v240, v242
 v_permlane16_swap_b32 v241, v243
 v_mfma_f32_16x16x32_bf16 v[128:131], v[24:27], v[48:51], v[128:131]
 ds_read_b128 v[80:83], v3 offset:49152
 v_mov_b32 v244, v240
 v_mov_b32 v245, v241
 v_mov_b32 v246, v242
 v_mfma_f32_16x16x32_bf16 v[132:135], v[28:31], v[48:51], v[132:135]
 ds_read_b64_tr_b16 v[68:69], v9 offset:8192
 buffer_load_dwordx4 v13, s[8:11], s62 offen offset:1024 sc1 lds
 v_mov_b32 v247, v243
 v_permlane32_swap_b32 v240, v244
 v_mfma_f32_16x16x32_bf16 v[136:139], v[32:35], v[48:51], v[136:139]
 ds_read_b64_tr_b16 v[70:71], v9 offset:12288
 v_permlane32_swap_b32 v241, v245
 v_permlane32_swap_b32 v242, v246
 v_permlane32_swap_b32 v243, v247
 v_mfma_f32_16x16x32_bf16 v[140:143], v[36:39], v[48:51], v[140:143]
 ds_read_b128 v[84:87], v3 offset:50176
 v_mul_f32_e64 v240, v240, -v12
 v_mul_f32_e64 v241, v241, -v12
 v_mfma_f32_16x16x32_bf16 v[156:159], v[36:39], v[52:55], v[156:159]
 v_mul_f32_e64 v242, v242, -v14
 v_mul_f32_e64 v243, v243, -v14
 v_mul_f32_e64 v244, v244, -v16
 s_add_u32 m0, s50, 16384
 s_add_u32 s62, s45, 16384
 v_mfma_f32_16x16x32_bf16 v[152:155], v[32:35], v[52:55], v[152:155]
 buffer_load_dwordx4 v13, s[8:11], s62 offen offset:0 sc1 lds
 v_mul_f32_e64 v245, v245, -v16
 v_mul_f32_e64 v246, v246, -v18
 v_mfma_f32_16x16x32_bf16 v[148:151], v[28:31], v[52:55], v[148:151]
 v_mul_f32_e64 v247, v247, -v18
 v_fma_f32 v208, v160, v12, v240
 v_fma_f32 v160, v160, -v12, v241
 v_mfma_f32_16x16x32_bf16 v[144:147], v[24:27], v[52:55], v[144:147]
 v_fma_f32 v209, v161, v12, v240
 v_fma_f32 v161, v161, -v12, v241
 s_waitcnt vmcnt(8) lgkmcnt(0)
 s_barrier
 v_mfma_f32_16x16x32_bf16 v[96:99], v[56:59], v[72:75], v[96:99]
 ds_read_b128 v[40:43], v4 offset:0
 v_fma_f32 v210, v162, v12, v240
 v_fma_f32 v162, v162, -v12, v241
 v_fma_f32 v211, v163, v12, v240
 v_mfma_f32_16x16x32_bf16 v[100:103], v[60:63], v[72:75], v[100:103]
 ds_read_b64_tr_b16 v[24:25], v6 offset:16384
 v_fma_f32 v163, v163, -v12, v241
 v_fma_f32 v212, v164, v12, v240
 v_fma_f32 v164, v164, -v12, v241
 v_mfma_f32_16x16x32_bf16 v[104:107], v[64:67], v[72:75], v[104:107]
 ds_read_b64_tr_b16 v[26:27], v6 offset:20480
 v_fma_f32 v213, v165, v12, v240
 v_fma_f32 v165, v165, -v12, v241
 v_fma_f32 v214, v166, v12, v240
 v_mfma_f32_16x16x32_bf16 v[108:111], v[68:71], v[72:75], v[108:111]
 ds_read_b64_tr_b16 v[28:29], v7 offset:16384
 buffer_load_dwordx4 v13, s[8:11], s62 offen offset:1024 sc1 lds
 v_fma_f32 v166, v166, -v12, v241
 v_fma_f32 v215, v167, v12, v240
 v_fma_f32 v167, v167, -v12, v241
 v_mfma_f32_16x16x32_bf16 v[124:127], v[68:71], v[76:79], v[124:127]
 ds_read_b64_tr_b16 v[30:31], v7 offset:20480
 v_exp_f32 v208, v208
 v_fma_f32 v216, v168, v14, v242
 v_fma_f32 v168, v168, -v14, v243
 v_mfma_f32_16x16x32_bf16 v[120:123], v[64:67], v[76:79], v[120:123]
 ds_read_b128 v[44:47], v4 offset:1024
 v_exp_f32 v160, v160
 v_fma_f32 v217, v169, v14, v242
 v_mfma_f32_16x16x32_bf16 v[116:119], v[60:63], v[76:79], v[116:119]
 ds_read_b64_tr_b16 v[32:33], v8 offset:16384
 v_fma_f32 v169, v169, -v14, v243
 v_exp_f32 v209, v209
 s_lshl3_add_u32 s92, s82, s3
 s_add_u32 m0, s50, 32768
 s_add_u32 s62, s45, 32768
 v_mfma_f32_16x16x32_bf16 v[112:115], v[56:59], v[76:79], v[112:115]
 ds_read_b64_tr_b16 v[34:35], v8 offset:20480
 buffer_load_dwordx4 v13, s[8:11], s62 offen offset:0 sc1 lds
 s_lshl_b32 s92, s92, 7
 s_add_u32 s92, s92, 39878656
 s_add_u32 s92, s92, s83
 v_mfma_f32_16x16x32_bf16 v[128:131], v[56:59], v[80:83], v[128:131]
 ds_read_b128 v[48:51], v5 offset:0
 v_mov_b32 v91, 1
 s_waitcnt vmcnt(5)
 buffer_store_byte v91, off, s[8:11], s92 sc1
 v_mfma_f32_16x16x32_bf16 v[132:135], v[60:63], v[80:83], v[132:135]
 ds_read_b64_tr_b16 v[36:37], v9 offset:16384
 v_fma_f32 v218, v170, v14, v242
 v_fma_f32 v170, v170, -v14, v243
 v_exp_f32 v161, v161
 v_mfma_f32_16x16x32_bf16 v[136:139], v[64:67], v[80:83], v[136:139]
 ds_read_b64_tr_b16 v[38:39], v9 offset:20480
 buffer_load_dwordx4 v13, s[8:11], s62 offen offset:1024 sc1 lds
 v_fma_f32 v219, v171, v14, v242
 v_fma_f32 v171, v171, -v14, v243
 v_mfma_f32_16x16x32_bf16 v[140:143], v[68:71], v[80:83], v[140:143]
 ds_read_b128 v[52:55], v5 offset:1024
 v_exp_f32 v210, v210
 v_fma_f32 v220, v172, v14, v242
 v_fma_f32 v172, v172, -v14, v243
 v_mfma_f32_16x16x32_bf16 v[156:159], v[68:71], v[84:87], v[156:159]
 v_exp_f32 v162, v162
 s_lshl_b32 s85, s7, 11
 v_add_u32 v15, s85, v0
 v_mfma_f32_16x16x32_bf16 v[152:155], v[64:67], v[84:87], v[152:155]
 v_add_u32 v17, 0x10000, v15
 s_lshl_b32 s65, s4, 11
 s_add_u32 s65, s65, s5
 s_lshl_b32 s65, s65, 8
 s_lshl2_add_u32 s54, s83, s4
 s_lshl_b32 s54, s54, 17
 s_add_u32 s54, s54, 18874368
 s_add_u32 m0, s51, 0
 s_add_u32 s63, s37, 163840
 v_mfma_f32_16x16x32_bf16 v[148:151], v[60:63], v[84:87], v[148:151]
 buffer_load_dwordx4 v10, s[24:27], s63 offen lds
 s_lshl_b32 s71, s83, 5
 s_add_u32 s71, s71, s82
 s_lshl_b32 s71, s71, 5
 v_mfma_f32_16x16x32_bf16 v[144:147], v[56:59], v[84:87], v[144:147]
 s_add_u32 s71, s71, s3
 s_lshl2_add_u32 s71, s71, 39845888
 s_waitcnt vmcnt(10) lgkmcnt(0)
 s_barrier
 v_mfma_f32_16x16x32_bf16 v[96:99], v[24:27], v[40:43], v[96:99]
 ds_read_b128 v[72:75], v4 offset:16384
 v_fma_f32 v221, v173, v14, v242
 v_fma_f32 v173, v173, -v14, v243
 v_mfma_f32_16x16x32_bf16 v[100:103], v[28:31], v[40:43], v[100:103]
 ds_read_b64_tr_b16 v[56:57], v6 offset:24576
 v_exp_f32 v211, v211
 v_mfma_f32_16x16x32_bf16 v[104:107], v[32:35], v[40:43], v[104:107]
 ds_read_b64_tr_b16 v[58:59], v6 offset:28672
 v_fma_f32 v222, v174, v14, v242
 v_fma_f32 v174, v174, -v14, v243
 s_add_u32 m0, s50, 49152
 s_add_u32 s62, s46, 16384
 v_mfma_f32_16x16x32_bf16 v[108:111], v[36:39], v[40:43], v[108:111]
 ds_read_b64_tr_b16 v[60:61], v7 offset:24576
 buffer_load_dwordx4 v13, s[8:11], s62 offen offset:0 sc1 lds
 v_exp_f32 v163, v163
 v_mfma_f32_16x16x32_bf16 v[124:127], v[36:39], v[44:47], v[124:127]
 ds_read_b64_tr_b16 v[62:63], v7 offset:28672
 v_fma_f32 v223, v175, v14, v242
 v_mfma_f32_16x16x32_bf16 v[120:123], v[32:35], v[44:47], v[120:123]
 ds_read_b128 v[76:79], v4 offset:17408
 v_fma_f32 v175, v175, -v14, v243
 v_exp_f32 v212, v212
 v_mfma_f32_16x16x32_bf16 v[116:119], v[28:31], v[44:47], v[116:119]
 ds_read_b64_tr_b16 v[64:65], v8 offset:24576
 v_exp_f32 v164, v164
 v_mfma_f32_16x16x32_bf16 v[112:115], v[24:27], v[44:47], v[112:115]
 ds_read_b64_tr_b16 v[66:67], v8 offset:28672
 buffer_load_dwordx4 v13, s[8:11], s62 offen offset:1024 sc1 lds
 v_exp_f32 v213, v213
 v_mfma_f32_16x16x32_bf16 v[128:131], v[24:27], v[48:51], v[128:131]
 ds_read_b128 v[80:83], v5 offset:16384
 v_exp_f32 v165, v165
 v_exp_f32 v214, v214
 v_mfma_f32_16x16x32_bf16 v[132:135], v[28:31], v[48:51], v[132:135]
 ds_read_b64_tr_b16 v[68:69], v9 offset:24576
 v_exp_f32 v166, v166
 s_add_u32 m0, s51, 8192
 s_add_u32 s63, s38, 98304
 v_mfma_f32_16x16x32_bf16 v[136:139], v[32:35], v[48:51], v[136:139]
 ds_read_b64_tr_b16 v[70:71], v9 offset:28672
 buffer_load_dwordx4 v10, s[24:27], s63 offen lds
 v_exp_f32 v215, v215
 v_exp_f32 v167, v167
 v_mfma_f32_16x16x32_bf16 v[140:143], v[36:39], v[48:51], v[140:143]
 ds_read_b128 v[84:87], v5 offset:17408
 v_exp_f32 v216, v216
 v_mfma_f32_16x16x32_bf16 v[156:159], v[36:39], v[52:55], v[156:159]
 v_fma_f32 v224, v176, v16, v244
 v_mfma_f32_16x16x32_bf16 v[152:155], v[32:35], v[52:55], v[152:155]
 v_fma_f32 v176, v176, -v16, v245
 v_exp_f32 v168, v168
 s_add_u32 m0, s50, 65536
 s_add_u32 s62, s46, 32768
 v_mfma_f32_16x16x32_bf16 v[148:151], v[28:31], v[52:55], v[148:151]
 buffer_load_dwordx4 v13, s[8:11], s62 offen offset:0 sc1 lds
 v_fma_f32 v225, v177, v16, v244
 v_mfma_f32_16x16x32_bf16 v[144:147], v[24:27], v[52:55], v[144:147]
 v_fma_f32 v177, v177, -v16, v245
 s_waitcnt vmcnt(10) lgkmcnt(0)
 s_barrier
 v_mfma_f32_16x16x32_bf16 v[96:99], v[56:59], v[72:75], v[96:99]
 ds_read_b128 v[40:43], v2 offset:0
 v_exp_f32 v217, v217
 v_fma_f32 v226, v178, v16, v244
 v_mfma_f32_16x16x32_bf16 v[100:103], v[60:63], v[72:75], v[100:103]
 ds_read_b64_tr_b16 v[24:25], v6 offset:32768
 v_fma_f32 v178, v178, -v16, v245
 v_exp_f32 v169, v169
 v_mfma_f32_16x16x32_bf16 v[104:107], v[64:67], v[72:75], v[104:107]
 ds_read_b64_tr_b16 v[26:27], v6 offset:36864
 v_fma_f32 v227, v179, v16, v244
 v_fma_f32 v179, v179, -v16, v245
 v_mfma_f32_16x16x32_bf16 v[108:111], v[68:71], v[72:75], v[108:111]
 ds_read_b64_tr_b16 v[28:29], v7 offset:32768
 buffer_load_dwordx4 v13, s[8:11], s62 offen offset:1024 sc1 lds
 v_exp_f32 v218, v218
 v_fma_f32 v228, v180, v16, v244
 v_mfma_f32_16x16x32_bf16 v[124:127], v[68:71], v[76:79], v[124:127]
 ds_read_b64_tr_b16 v[30:31], v7 offset:36864
 v_fma_f32 v180, v180, -v16, v245
 v_exp_f32 v170, v170
 v_mfma_f32_16x16x32_bf16 v[120:123], v[64:67], v[76:79], v[120:123]
 ds_read_b128 v[44:47], v2 offset:1024
 v_fma_f32 v229, v181, v16, v244
 v_fma_f32 v181, v181, -v16, v245
 v_mfma_f32_16x16x32_bf16 v[116:119], v[60:63], v[76:79], v[116:119]
 ds_read_b64_tr_b16 v[32:33], v8 offset:32768
 s_lshl3_add_u32 s64, s82, s3
 s_add_u32 m0, s51, 16384
 s_add_u32 s63, s38, 163840
 v_mfma_f32_16x16x32_bf16 v[112:115], v[56:59], v[76:79], v[112:115]
 ds_read_b64_tr_b16 v[34:35], v8 offset:36864
 buffer_load_dwordx4 v10, s[24:27], s63 offen lds
 s_lshl_b32 s64, s64, 7
 v_mfma_f32_16x16x32_bf16 v[128:131], v[56:59], v[80:83], v[128:131]
 ds_read_b128 v[48:51], v3 offset:0
 s_add_u32 s64, s64, 39878656
 s_buffer_load_dwordx2 s[72:73], s[8:11], s64 glc
 v_mfma_f32_16x16x32_bf16 v[132:135], v[60:63], v[80:83], v[132:135]
 ds_read_b64_tr_b16 v[36:37], v9 offset:32768
 v_exp_f32 v219, v219
 v_fma_f32 v230, v182, v16, v244
 s_add_u32 m0, s50, 81920
 s_add_u32 s62, s47, 16384
 v_mfma_f32_16x16x32_bf16 v[136:139], v[64:67], v[80:83], v[136:139]
 ds_read_b64_tr_b16 v[38:39], v9 offset:36864
 buffer_load_dwordx4 v13, s[8:11], s62 offen offset:0 sc1 lds
 v_fma_f32 v182, v182, -v16, v245
 v_exp_f32 v171, v171
 v_mfma_f32_16x16x32_bf16 v[140:143], v[68:71], v[80:83], v[140:143]
 ds_read_b128 v[52:55], v3 offset:1024
 ds_read_b32 v90, v0
 ds_read_b32 v90, v0
 v_fma_f32 v231, v183, v16, v244
 v_fma_f32 v183, v183, -v16, v245
 v_mfma_f32_16x16x32_bf16 v[156:159], v[68:71], v[84:87], v[156:159]
 v_exp_f32 v220, v220
 v_cvt_pk_bf16_f32 v208, v208, v209
 v_mfma_f32_16x16x32_bf16 v[152:155], v[64:67], v[84:87], v[152:155]
 v_cvt_pk_bf16_f32 v209, v210, v211
 v_exp_f32 v172, v172
 v_mfma_f32_16x16x32_bf16 v[148:151], v[60:63], v[84:87], v[148:151]
 buffer_load_dwordx4 v13, s[8:11], s62 offen offset:1024 sc1 lds
 v_cvt_pk_bf16_f32 v210, v212, v213
 v_cvt_pk_bf16_f32 v211, v214, v215
 v_mfma_f32_16x16x32_bf16 v[144:147], v[56:59], v[84:87], v[144:147]
 v_exp_f32 v221, v221
 s_waitcnt vmcnt(12) lgkmcnt(2)
 s_barrier
 v_mfma_f32_16x16x32_bf16 v[96:99], v[24:27], v[40:43], v[96:99]
 ds_read_b128 v[72:75], v2 offset:16384
 v_cvt_pk_bf16_f32 v160, v160, v161
 v_cvt_pk_bf16_f32 v161, v162, v163
 v_mfma_f32_16x16x32_bf16 v[100:103], v[28:31], v[40:43], v[100:103]
 ds_read_b64_tr_b16 v[56:57], v6 offset:40960
 v_exp_f32 v173, v173
 v_mfma_f32_16x16x32_bf16 v[104:107], v[32:35], v[40:43], v[104:107]
 ds_read_b64_tr_b16 v[58:59], v6 offset:45056
 v_cvt_pk_bf16_f32 v162, v164, v165
 v_cvt_pk_bf16_f32 v163, v166, v167
 s_add_u32 m0, s51, 24576
 s_add_u32 s63, s39, 98304
 v_mfma_f32_16x16x32_bf16 v[108:111], v[36:39], v[40:43], v[108:111]
 ds_read_b64_tr_b16 v[60:61], v7 offset:40960
 buffer_load_dwordx4 v10, s[24:27], s63 offen lds
 v_exp_f32 v222, v222
 v_mfma_f32_16x16x32_bf16 v[124:127], v[36:39], v[44:47], v[124:127]
 ds_read_b64_tr_b16 v[62:63], v7 offset:45056
 v_exp_f32 v174, v174
 v_exp_f32 v223, v223
 v_mfma_f32_16x16x32_bf16 v[120:123], v[32:35], v[44:47], v[120:123]
 ds_read_b128 v[76:79], v2 offset:17408
 v_exp_f32 v175, v175
 v_mfma_f32_16x16x32_bf16 v[116:119], v[28:31], v[44:47], v[116:119]
 ds_read_b64_tr_b16 v[64:65], v8 offset:40960
 v_exp_f32 v224, v224
 v_fma_f32 v232, v184, v18, v246
 s_add_u32 m0, s50, 0
 s_add_u32 s62, s47, 32768
 v_mfma_f32_16x16x32_bf16 v[112:115], v[24:27], v[44:47], v[112:115]
 ds_read_b64_tr_b16 v[66:67], v8 offset:45056
 buffer_load_dwordx4 v13, s[8:11], s62 offen offset:0 sc1 lds
 v_fma_f32 v184, v184, -v18, v247
 v_mfma_f32_16x16x32_bf16 v[128:131], v[24:27], v[48:51], v[128:131]
 ds_read_b128 v[80:83], v3 offset:16384
 v_exp_f32 v176, v176
 v_fma_f32 v233, v185, v18, v246
 v_mfma_f32_16x16x32_bf16 v[132:135], v[28:31], v[48:51], v[132:135]
 ds_read_b64_tr_b16 v[68:69], v9 offset:40960
 v_fma_f32 v185, v185, -v18, v247
 v_mfma_f32_16x16x32_bf16 v[136:139], v[32:35], v[48:51], v[136:139]
 ds_read_b64_tr_b16 v[70:71], v9 offset:45056
 buffer_load_dwordx4 v13, s[8:11], s62 offen offset:1024 sc1 lds
 v_exp_f32 v225, v225
 v_fma_f32 v234, v186, v18, v246
 v_mfma_f32_16x16x32_bf16 v[140:143], v[36:39], v[48:51], v[140:143]
 ds_read_b128 v[84:87], v3 offset:17408
 v_fma_f32 v186, v186, -v18, v247
 v_mfma_f32_16x16x32_bf16 v[156:159], v[36:39], v[52:55], v[156:159]
 v_exp_f32 v177, v177
 v_fma_f32 v235, v187, v18, v246
 v_mfma_f32_16x16x32_bf16 v[152:155], v[32:35], v[52:55], v[152:155]
 v_fma_f32 v187, v187, -v18, v247
 s_add_u32 m0, s51, 32768
 s_add_u32 s63, s39, 163840
 v_mfma_f32_16x16x32_bf16 v[148:151], v[28:31], v[52:55], v[148:151]
 buffer_load_dwordx4 v10, s[24:27], s63 offen lds
 v_exp_f32 v226, v226
 v_fma_f32 v236, v188, v18, v246
 v_mfma_f32_16x16x32_bf16 v[144:147], v[24:27], v[52:55], v[144:147]
 s_waitcnt lgkmcnt(0)
 s_and_b32 s72, s72, s73
 s_cmp_eq_u32 s72, 0x1010101
 s_cbranch_scc0 Lsp_165
Lok_166:
 s_waitcnt vmcnt(12) lgkmcnt(0)
 s_barrier
 v_mfma_f32_16x16x32_bf16 v[96:99], v[56:59], v[72:75], v[96:99]
 ds_read_b128 v[40:43], v2 offset:32768
 s_mul_i32 s87, s82, 67584
 s_add_u32 s87, s87, 23068672
 s_lshl_b32 s86, s3, 10
 v_mfma_f32_16x16x32_bf16 v[100:103], v[60:63], v[72:75], v[100:103]
 ds_read_b64_tr_b16 v[24:25], v6 offset:0
 s_add_u32 s87, s87, s86
 s_xor_b32 s86, s83, 4
 s_mul_i32 s86, s86, 8448
 s_add_u32 s86, s86, s87
 v_mfma_f32_16x16x32_bf16 v[104:107], v[64:67], v[72:75], v[104:107]
 ds_read_b64_tr_b16 v[26:27], v6 offset:4096
 buffer_load_dwordx4 v[192:195], v0, s[8:11], s86 offen sc1
 v_fma_f32 v188, v188, -v18, v247
 v_mfma_f32_16x16x32_bf16 v[108:111], v[68:71], v[72:75], v[108:111]
 ds_read_b64_tr_b16 v[28:29], v7 offset:0
 v_exp_f32 v178, v178
 v_fma_f32 v237, v189, v18, v246
 v_fma_f32 v189, v189, -v18, v247
 v_mfma_f32_16x16x32_bf16 v[124:127], v[68:71], v[76:79], v[124:127]
 ds_read_b64_tr_b16 v[30:31], v7 offset:4096
 v_exp_f32 v227, v227
 v_fma_f32 v238, v190, v18, v246
 v_mfma_f32_16x16x32_bf16 v[120:123], v[64:67], v[76:79], v[120:123]
 ds_read_b128 v[44:47], v2 offset:33792
 s_xor_b32 s86, s83, 5
 s_mul_i32 s86, s86, 8448
 s_add_u32 s86, s86, s87
 buffer_load_dwordx4 v[196:199], v0, s[8:11], s86 offen sc1
 v_mfma_f32_16x16x32_bf16 v[116:119], v[60:63], v[76:79], v[116:119]
 ds_read_b64_tr_b16 v[32:33], v8 offset:0
 v_fma_f32 v190, v190, -v18, v247
 v_exp_f32 v179, v179
 v_fma_f32 v239, v191, v18, v246
 v_mfma_f32_16x16x32_bf16 v[112:115], v[56:59], v[76:79], v[112:115]
 ds_read_b64_tr_b16 v[34:35], v8 offset:4096
 v_fma_f32 v191, v191, -v18, v247
 v_exp_f32 v228, v228
 v_mfma_f32_16x16x32_bf16 v[128:131], v[56:59], v[80:83], v[128:131]
 ds_read_b128 v[48:51], v3 offset:32768
 v_cvt_pk_bf16_f32 v216, v216, v217
 s_xor_b32 s86, s83, 6
 s_mul_i32 s86, s86, 8448
 s_add_u32 s86, s86, s87
 v_mfma_f32_16x16x32_bf16 v[132:135], v[60:63], v[80:83], v[132:135]
 ds_read_b64_tr_b16 v[36:37], v9 offset:0
 buffer_load_dwordx4 v[200:203], v0, s[8:11], s86 offen sc1
 v_cvt_pk_bf16_f32 v217, v218, v219
 v_exp_f32 v180, v180
 v_mfma_f32_16x16x32_bf16 v[136:139], v[64:67], v[80:83], v[136:139]
 ds_read_b64_tr_b16 v[38:39], v9 offset:4096
 v_cvt_pk_bf16_f32 v218, v220, v221
 v_cvt_pk_bf16_f32 v219, v222, v223
 v_mfma_f32_16x16x32_bf16 v[140:143], v[68:71], v[80:83], v[140:143]
 ds_read_b128 v[52:55], v3 offset:33792
 v_exp_f32 v229, v229
 v_cvt_pk_bf16_f32 v168, v168, v169
 v_mfma_f32_16x16x32_bf16 v[156:159], v[68:71], v[84:87], v[156:159]
 s_xor_b32 s86, s83, 7
 s_mul_i32 s86, s86, 8448
 s_add_u32 s86, s86, s87
 buffer_load_dwordx4 v[204:207], v0, s[8:11], s86 offen sc1
 v_cvt_pk_bf16_f32 v169, v170, v171
 v_mfma_f32_16x16x32_bf16 v[152:155], v[64:67], v[84:87], v[152:155]
 v_exp_f32 v181, v181
 v_cvt_pk_bf16_f32 v170, v172, v173
 v_mfma_f32_16x16x32_bf16 v[148:151], v[60:63], v[84:87], v[148:151]
 v_cvt_pk_bf16_f32 v171, v174, v175
 v_exp_f32 v230, v230
 v_mfma_f32_16x16x32_bf16 v[144:147], v[56:59], v[84:87], v[144:147]
 v_exp_f32 v182, v182
 v_exp_f32 v231, v231
 s_waitcnt vmcnt(13) lgkmcnt(0)
 s_barrier
 v_mfma_f32_16x16x32_bf16 v[96:99], v[24:27], v[40:43], v[96:99]
 ds_read_b128 v[72:75], v2 offset:49152
 s_xor_b32 s86, s83, 1
 s_mul_i32 s86, s86, 8448
 s_add_u32 s86, s86, s87
 buffer_load_dwordx4 v[252:255], v0, s[8:11], s86 offen sc1
 v_mfma_f32_16x16x32_bf16 v[100:103], v[28:31], v[40:43], v[100:103]
 ds_read_b64_tr_b16 v[56:57], v6 offset:8192
 v_exp_f32 v183, v183
 v_exp_f32 v232, v232
 v_mfma_f32_16x16x32_bf16 v[104:107], v[32:35], v[40:43], v[104:107]
 ds_read_b64_tr_b16 v[58:59], v6 offset:12288
 v_cvt_pk_bf16_f32 v224, v224, v225
 v_cvt_pk_bf16_f32 v225, v226, v227
 v_mfma_f32_16x16x32_bf16 v[108:111], v[36:39], v[40:43], v[108:111]
 ds_read_b64_tr_b16 v[60:61], v7 offset:8192
 v_exp_f32 v184, v184
 v_mfma_f32_16x16x32_bf16 v[124:127], v[36:39], v[44:47], v[124:127]
 ds_read_b64_tr_b16 v[62:63], v7 offset:12288
 v_cvt_pk_bf16_f32 v226, v228, v229
 v_cvt_pk_bf16_f32 v227, v230, v231
 v_mfma_f32_16x16x32_bf16 v[120:123], v[32:35], v[44:47], v[120:123]
 ds_read_b128 v[76:79], v2 offset:50176
 s_xor_b32 s86, s83, 2
 s_mul_i32 s86, s86, 8448
 s_add_u32 s86, s86, s87
 buffer_load_dwordx4 v[212:215], v0, s[8:11], s86 offen sc1
 v_mfma_f32_16x16x32_bf16 v[116:119], v[28:31], v[44:47], v[116:119]
 ds_read_b64_tr_b16 v[64:65], v8 offset:8192
 v_exp_f32 v233, v233
 v_mfma_f32_16x16x32_bf16 v[112:115], v[24:27], v[44:47], v[112:115]
 ds_read_b64_tr_b16 v[66:67], v8 offset:12288
 v_cvt_pk_bf16_f32 v176, v176, v177
 v_cvt_pk_bf16_f32 v177, v178, v179
 v_mfma_f32_16x16x32_bf16 v[128:131], v[24:27], v[48:51], v[128:131]
 ds_read_b128 v[80:83], v3 offset:49152
 v_exp_f32 v185, v185
 v_cvt_pk_bf16_f32 v178, v180, v181
 s_add_u32 m0, s50, 16384
 s_add_u32 s62, s41, 0
 v_mfma_f32_16x16x32_bf16 v[132:135], v[28:31], v[48:51], v[132:135]
 ds_read_b64_tr_b16 v[68:69], v9 offset:8192
 buffer_load_dwordx4 v13, s[8:11], s62 offen offset:0 sc1 lds
 v_cvt_pk_bf16_f32 v179, v182, v183
 v_mfma_f32_16x16x32_bf16 v[136:139], v[32:35], v[48:51], v[136:139]
 ds_read_b64_tr_b16 v[70:71], v9 offset:12288
 v_exp_f32 v234, v234
 s_xor_b32 s86, s83, 3
 s_mul_i32 s86, s86, 8448
 s_add_u32 s86, s86, s87
 v_mfma_f32_16x16x32_bf16 v[140:143], v[36:39], v[48:51], v[140:143]
 ds_read_b128 v[84:87], v3 offset:50176
 buffer_load_dwordx4 v[164:167], v0, s[8:11], s86 offen sc1
 v_exp_f32 v186, v186
 v_mfma_f32_16x16x32_bf16 v[156:159], v[36:39], v[52:55], v[156:159]
 v_exp_f32 v235, v235
 v_mfma_f32_16x16x32_bf16 v[152:155], v[32:35], v[52:55], v[152:155]
 v_exp_f32 v187, v187
 v_exp_f32 v236, v236
 v_mfma_f32_16x16x32_bf16 v[148:151], v[28:31], v[52:55], v[148:151]
 v_exp_f32 v188, v188
 v_exp_f32 v237, v237
 v_mfma_f32_16x16x32_bf16 v[144:147], v[24:27], v[52:55], v[144:147]
 v_exp_f32 v189, v189
 s_waitcnt vmcnt(14) lgkmcnt(0)
 s_barrier
 v_mfma_f32_16x16x32_bf16 v[96:99], v[56:59], v[72:75], v[96:99]
 ds_read_b128 v[40:43], v4 offset:0
 v_exp_f32 v238, v238
 v_mfma_f32_16x16x32_bf16 v[100:103], v[60:63], v[72:75], v[100:103]
 ds_read_b64_tr_b16 v[24:25], v6 offset:16384
 v_exp_f32 v190, v190
 v_mfma_f32_16x16x32_bf16 v[104:107], v[64:67], v[72:75], v[104:107]
 ds_read_b64_tr_b16 v[26:27], v6 offset:20480
 v_exp_f32 v239, v239
 v_mfma_f32_16x16x32_bf16 v[108:111], v[68:71], v[72:75], v[108:111]
 ds_read_b64_tr_b16 v[28:29], v7 offset:16384
 buffer_load_dwordx4 v13, s[8:11], s62 offen offset:1024 sc1 lds
 v_mfma_f32_16x16x32_bf16 v[124:127], v[68:71], v[76:79], v[124:127]
 ds_read_b64_tr_b16 v[30:31], v7 offset:20480
 v_exp_f32 v191, v191
 v_mfma_f32_16x16x32_bf16 v[120:123], v[64:67], v[76:79], v[120:123]
 ds_read_b128 v[44:47], v4 offset:1024
 v_cvt_pk_bf16_f32 v232, v232, v233
 v_mfma_f32_16x16x32_bf16 v[116:119], v[60:63], v[76:79], v[116:119]
 ds_read_b64_tr_b16 v[32:33], v8 offset:16384
 v_cvt_pk_bf16_f32 v233, v234, v235
 s_add_u32 m0, s51, 40960
 s_add_u32 s63, s33, 0
 v_mfma_f32_16x16x32_bf16 v[112:115], v[56:59], v[76:79], v[112:115]
 ds_read_b64_tr_b16 v[34:35], v8 offset:20480
 buffer_load_dwordx4 v10, s[24:27], s63 offen lds
 v_mfma_f32_16x16x32_bf16 v[128:131], v[56:59], v[80:83], v[128:131]
 ds_read_b128 v[48:51], v5 offset:0
 v_cvt_pk_bf16_f32 v234, v236, v237
 v_mfma_f32_16x16x32_bf16 v[132:135], v[60:63], v[80:83], v[132:135]
 ds_read_b64_tr_b16 v[36:37], v9 offset:16384
 v_cvt_pk_bf16_f32 v235, v238, v239
 s_add_u32 m0, s50, 32768
 s_add_u32 s62, s42, 0
 v_mfma_f32_16x16x32_bf16 v[136:139], v[64:67], v[80:83], v[136:139]
 ds_read_b64_tr_b16 v[38:39], v9 offset:20480
 buffer_load_dwordx4 v13, s[8:11], s62 offen offset:0 sc1 lds
 v_cvt_pk_bf16_f32 v184, v184, v185
 v_mfma_f32_16x16x32_bf16 v[140:143], v[68:71], v[80:83], v[140:143]
 ds_read_b128 v[52:55], v5 offset:1024
 v_mfma_f32_16x16x32_bf16 v[156:159], v[68:71], v[84:87], v[156:159]
 v_cvt_pk_bf16_f32 v185, v186, v187
 v_mfma_f32_16x16x32_bf16 v[152:155], v[64:67], v[84:87], v[152:155]
 v_cvt_pk_bf16_f32 v186, v188, v189
 v_mfma_f32_16x16x32_bf16 v[148:151], v[60:63], v[84:87], v[148:151]
 buffer_load_dwordx4 v13, s[8:11], s62 offen offset:1024 sc1 lds
 v_cvt_pk_bf16_f32 v187, v190, v191
 v_mfma_f32_16x16x32_bf16 v[144:147], v[56:59], v[84:87], v[144:147]
 s_waitcnt vmcnt(15) lgkmcnt(0)
 s_barrier
 v_mfma_f32_16x16x32_bf16 v[96:99], v[24:27], v[40:43], v[96:99]
 ds_read_b128 v[72:75], v4 offset:16384
 s_waitcnt vmcnt(11)
 v_add_f32 v192, v192, v248
 v_mfma_f32_16x16x32_bf16 v[100:103], v[28:31], v[40:43], v[100:103]
 ds_read_b64_tr_b16 v[56:57], v6 offset:24576
 v_add_f32 v193, v193, v249
 v_mfma_f32_16x16x32_bf16 v[104:107], v[32:35], v[40:43], v[104:107]
 ds_read_b64_tr_b16 v[58:59], v6 offset:28672
 v_add_f32 v194, v194, v250
 s_add_u32 m0, s51, 0
 s_add_u32 s63, s34, 0
 v_mfma_f32_16x16x32_bf16 v[108:111], v[36:39], v[40:43], v[108:111]
 ds_read_b64_tr_b16 v[60:61], v7 offset:24576
 buffer_load_dwordx4 v10, s[24:27], s63 offen lds
 v_add_f32 v195, v195, v251
 v_mfma_f32_16x16x32_bf16 v[124:127], v[36:39], v[44:47], v[124:127]
 ds_read_b64_tr_b16 v[62:63], v7 offset:28672
 s_waitcnt vmcnt(10)
 v_mfma_f32_16x16x32_bf16 v[120:123], v[32:35], v[44:47], v[120:123]
 ds_read_b128 v[76:79], v4 offset:17408
 v_add_f32 v196, v196, v200
 v_add_f32 v197, v197, v201
 v_mfma_f32_16x16x32_bf16 v[116:119], v[28:31], v[44:47], v[116:119]
 ds_read_b64_tr_b16 v[64:65], v8 offset:24576
 v_add_f32 v198, v198, v202
 s_add_u32 m0, s50, 49152
 s_add_u32 s62, s43, 0
 v_mfma_f32_16x16x32_bf16 v[112:115], v[24:27], v[44:47], v[112:115]
 ds_read_b64_tr_b16 v[66:67], v8 offset:28672
 buffer_load_dwordx4 v13, s[8:11], s62 offen offset:0 sc1 lds
 v_add_f32 v199, v199, v203
 v_mfma_f32_16x16x32_bf16 v[128:131], v[24:27], v[48:51], v[128:131]
 ds_read_b128 v[80:83], v5 offset:16384
 s_waitcnt vmcnt(10)
 v_mfma_f32_16x16x32_bf16 v[132:135], v[28:31], v[48:51], v[132:135]
 ds_read_b64_tr_b16 v[68:69], v9 offset:24576
 v_add_f32 v192, v192, v204
 v_mfma_f32_16x16x32_bf16 v[136:139], v[32:35], v[48:51], v[136:139]
 ds_read_b64_tr_b16 v[70:71], v9 offset:28672
 buffer_load_dwordx4 v13, s[8:11], s62 offen offset:1024 sc1 lds
 v_add_f32 v193, v193, v205
 v_add_f32 v194, v194, v206
 v_mfma_f32_16x16x32_bf16 v[140:143], v[36:39], v[48:51], v[140:143]
 ds_read_b128 v[84:87], v5 offset:17408
 v_add_f32 v195, v195, v207
 v_mfma_f32_16x16x32_bf16 v[156:159], v[36:39], v[52:55], v[156:159]
 v_add_f32 v192, v192, v196
 v_mfma_f32_16x16x32_bf16 v[152:155], v[32:35], v[52:55], v[152:155]
 v_add_f32 v193, v193, v197
 s_add_u32 m0, s51, 8192
 s_add_u32 s63, s35, 0
 v_mfma_f32_16x16x32_bf16 v[148:151], v[28:31], v[52:55], v[148:151]
 buffer_load_dwordx4 v10, s[24:27], s63 offen lds
 v_add_f32 v194, v194, v198
 v_mfma_f32_16x16x32_bf16 v[144:147], v[24:27], v[52:55], v[144:147]
 v_add_f32 v195, v195, v199
 s_waitcnt vmcnt(16) lgkmcnt(0)
 s_barrier
 v_mfma_f32_16x16x32_bf16 v[96:99], v[56:59], v[72:75], v[96:99]
 ds_read_b128 v[40:43], v2 offset:0
 s_waitcnt vmcnt(10)
 v_add_f32 v252, v252, v212
 v_mfma_f32_16x16x32_bf16 v[100:103], v[60:63], v[72:75], v[100:103]
 ds_read_b64_tr_b16 v[24:25], v6 offset:32768
 v_add_f32 v253, v253, v213
 v_add_f32 v254, v254, v214
 v_mfma_f32_16x16x32_bf16 v[104:107], v[64:67], v[72:75], v[104:107]
 ds_read_b64_tr_b16 v[26:27], v6 offset:36864
 v_add_f32 v255, v255, v215
 s_waitcnt vmcnt(8)
 s_add_u32 m0, s50, 65536
 s_add_u32 s62, s44, 0
 v_mfma_f32_16x16x32_bf16 v[108:111], v[68:71], v[72:75], v[108:111]
 ds_read_b64_tr_b16 v[28:29], v7 offset:32768
 buffer_load_dwordx4 v13, s[8:11], s62 offen offset:0 sc1 lds
 v_add_f32 v192, v192, v164
 v_add_f32 v193, v193, v165
 v_mfma_f32_16x16x32_bf16 v[124:127], v[68:71], v[76:79], v[124:127]
 ds_read_b64_tr_b16 v[30:31], v7 offset:36864
 v_add_f32 v194, v194, v166
 v_add_f32 v195, v195, v167
 v_mfma_f32_16x16x32_bf16 v[120:123], v[64:67], v[76:79], v[120:123]
 ds_read_b128 v[44:47], v2 offset:1024
 v_add_f32 v192, v192, v252
 v_mfma_f32_16x16x32_bf16 v[116:119], v[60:63], v[76:79], v[116:119]
 ds_read_b64_tr_b16 v[32:33], v8 offset:32768
 v_add_f32 v193, v193, v253
 v_add_f32 v194, v194, v254
 v_mfma_f32_16x16x32_bf16 v[112:115], v[56:59], v[76:79], v[112:115]
 ds_read_b64_tr_b16 v[34:35], v8 offset:36864
 buffer_load_dwordx4 v13, s[8:11], s62 offen offset:1024 sc1 lds
 v_add_f32 v195, v195, v255
 s_lshr_b32 s85, s7, 1
 s_lshl_b32 s85, s85, 11
 s_and_b32 s86, s7, 1
 s_lshl3_add_u32 s85, s86, s85
 s_add_u32 s85, s85, 150528
 v_add_u32 v94, s85, v0
 v_mfma_f32_16x16x32_bf16 v[128:131], v[56:59], v[80:83], v[128:131]
 ds_read_b128 v[48:51], v3 offset:0
 v_cvt_pk_bf16_f32 v192, v192, v193
 v_cvt_pk_bf16_f32 v193, v194, v195
 v_mfma_f32_16x16x32_bf16 v[132:135], v[60:63], v[80:83], v[132:135]
 ds_read_b64_tr_b16 v[36:37], v9 offset:32768
 ds_write_b64 v94, v[192:193]
 v_and_b32 v95, 31, v1
 s_add_u32 m0, s51, 16384
 s_add_u32 s63, s36, 0
 v_mfma_f32_16x16x32_bf16 v[136:139], v[64:67], v[80:83], v[136:139]
 ds_read_b64_tr_b16 v[38:39], v9 offset:36864
 buffer_load_dwordx4 v10, s[24:27], s63 offen lds
 v_lshlrev_b32 v95, 2, v95
 v_mfma_f32_16x16x32_bf16 v[140:143], v[68:71], v[80:83], v[140:143]
 ds_read_b128 v[52:55], v3 offset:1024
 v_add_u32 v95, 153728, v95
 v_mov_b32 v92, 0x3f803f80
 v_mfma_f32_16x16x32_bf16 v[156:159], v[68:71], v[84:87], v[156:159]
 ds_write_b32 v95, v92
 v_add_u32 v94, 149504, v0
 v_mfma_f32_16x16x32_bf16 v[152:155], v[64:67], v[84:87], v[152:155]
 v_lshrrev_b32 v95, 4, v1
 v_lshlrev_b32 v95, 3, v95
 s_add_u32 m0, s50, 81920
 s_add_u32 s62, s45, 0
 v_mfma_f32_16x16x32_bf16 v[148:151], v[60:63], v[84:87], v[148:151]
 buffer_load_dwordx4 v13, s[8:11], s62 offen offset:0 sc1 lds
 v_and_b32 v92, 1, v1
 v_lshl_add_u32 v95, v92, 7, v95
 v_mfma_f32_16x16x32_bf16 v[144:147], v[56:59], v[84:87], v[144:147]
 v_add_u32 v95, 153600, v95
 s_waitcnt vmcnt(10) lgkmcnt(0)
 s_barrier
 v_mfma_f32_16x16x32_bf16 v[96:99], v[24:27], v[40:43], v[96:99]
 ds_read_b128 v[72:75], v2 offset:16384
 ds_read_b64 v[240:241], v95 offset:0
 ds_read_b64 v[242:243], v95 offset:32
 ds_read_b64 v[244:245], v95 offset:64
 v_mfma_f32_16x16x32_bf16 v[100:103], v[28:31], v[40:43], v[100:103]
 ds_read_b64_tr_b16 v[56:57], v6 offset:40960
 ds_read_b64 v[246:247], v95 offset:96
 ds_read_b128 v[192:195], v94 offset:0
 v_mfma_f32_16x16x32_bf16 v[104:107], v[32:35], v[40:43], v[104:107]
 ds_read_b64_tr_b16 v[58:59], v6 offset:45056
 ds_read_b128 v[196:199], v94 offset:1024
 ds_read_b128 v[200:203], v94 offset:2048
 v_mfma_f32_16x16x32_bf16 v[108:111], v[36:39], v[40:43], v[108:111]
 ds_read_b64_tr_b16 v[60:61], v7 offset:40960
 buffer_load_dwordx4 v13, s[8:11], s62 offen offset:1024 sc1 lds
 ds_read_b128 v[204:207], v94 offset:3072
 s_lshl_b32 s88, s83, 5
 v_mfma_f32_16x16x32_bf16 v[124:127], v[36:39], v[44:47], v[124:127]
 ds_read_b64_tr_b16 v[62:63], v7 offset:45056
 s_add_u32 s88, s88, s82
 s_lshl_b32 s88, s88, 14
 v_mfma_f32_16x16x32_bf16 v[120:123], v[32:35], v[44:47], v[120:123]
 ds_read_b128 v[76:79], v2 offset:17408
 s_add_u32 s88, s88, 18874368
 v_mov_b32 v92, 0x358637bd
 s_waitcnt lgkmcnt(8)
 v_mfma_f32_16x16x32_bf16 v[116:119], v[28:31], v[44:47], v[116:119]
 ds_read_b64_tr_b16 v[64:65], v8 offset:40960
 v_mfma_f32_16x16x32_bf16 v[212:215], v[240:243], v[208:211], 0
 v_mfma_f32_16x16x32_bf16 v[164:167], v[244:247], v[160:163], 0
 s_add_u32 m0, s51, 24576
 s_add_u32 s63, s37, 0
 v_mfma_f32_16x16x32_bf16 v[112:115], v[24:27], v[44:47], v[112:115]
 ds_read_b64_tr_b16 v[66:67], v8 offset:45056
 buffer_load_dwordx4 v10, s[24:27], s63 offen lds
 v_mfma_f32_16x16x32_bf16 v[220:223], v[240:243], v[216:219], 0
 v_mfma_f32_16x16x32_bf16 v[172:175], v[244:247], v[168:171], 0
 v_mfma_f32_16x16x32_bf16 v[128:131], v[24:27], v[48:51], v[128:131]
 ds_read_b128 v[80:83], v3 offset:16384
 v_mfma_f32_16x16x32_bf16 v[228:231], v[240:243], v[224:227], 0
 v_mfma_f32_16x16x32_bf16 v[180:183], v[244:247], v[176:179], 0
 v_mfma_f32_16x16x32_bf16 v[132:135], v[28:31], v[48:51], v[132:135]
 ds_read_b64_tr_b16 v[68:69], v9 offset:40960
 v_mfma_f32_16x16x32_bf16 v[236:239], v[240:243], v[232:235], 0
 v_mfma_f32_16x16x32_bf16 v[188:191], v[244:247], v[184:187], 0
 s_add_u32 m0, s50, 0
 s_add_u32 s62, s46, 0
 v_mfma_f32_16x16x32_bf16 v[136:139], v[32:35], v[48:51], v[136:139]
 ds_read_b64_tr_b16 v[70:71], v9 offset:45056
 buffer_load_dwordx4 v13, s[8:11], s62 offen offset:0 sc1 lds
 v_rcp_f32 v248, v213
 v_rcp_f32 v249, v165
 v_rcp_f32 v250, v221
 v_mfma_f32_16x16x32_bf16 v[140:143], v[36:39], v[48:51], v[140:143]
 ds_read_b128 v[84:87], v3 offset:17408
 v_rcp_f32 v251, v173
 v_rcp_f32 v252, v229
 v_mfma_f32_16x16x32_bf16 v[156:159], v[36:39], v[52:55], v[156:159]
 v_rcp_f32 v253, v181
 v_rcp_f32 v254, v237
 v_mfma_f32_16x16x32_bf16 v[152:155], v[32:35], v[52:55], v[152:155]
 v_rcp_f32 v255, v189
 v_fma_f32 v212, v212, v248, v92
 v_mfma_f32_16x16x32_bf16 v[148:151], v[28:31], v[52:55], v[148:151]
 buffer_load_dwordx4 v13, s[8:11], s62 offen offset:1024 sc1 lds
 v_fma_f32 v220, v220, v250, v92
 v_fma_f32 v228, v228, v252, v92
 v_mfma_f32_16x16x32_bf16 v[144:147], v[24:27], v[52:55], v[144:147]
 v_fma_f32 v236, v236, v254, v92
 v_fma_f32 v212, v164, v249, v212
 s_waitcnt vmcnt(11) lgkmcnt(0)
 s_barrier
 v_mfma_f32_16x16x32_bf16 v[96:99], v[56:59], v[72:75], v[96:99]
 ds_read_b128 v[40:43], v2 offset:32768
 v_fma_f32 v220, v172, v251, v220
 v_fma_f32 v228, v180, v253, v228
 v_mfma_f32_16x16x32_bf16 v[100:103], v[60:63], v[72:75], v[100:103]
 ds_read_b64_tr_b16 v[24:25], v6 offset:0
 v_fma_f32 v236, v188, v255, v236
 v_rcp_f32 v212, v212
 v_mfma_f32_16x16x32_bf16 v[104:107], v[64:67], v[72:75], v[104:107]
 ds_read_b64_tr_b16 v[26:27], v6 offset:4096
 v_rcp_f32 v220, v220
 s_add_u32 m0, s51, 32768
 s_add_u32 s63, s38, 0
 v_mfma_f32_16x16x32_bf16 v[108:111], v[68:71], v[72:75], v[108:111]
 ds_read_b64_tr_b16 v[28:29], v7 offset:0
 buffer_load_dwordx4 v10, s[24:27], s63 offen lds
 v_rcp_f32 v228, v228
 v_rcp_f32 v236, v236
 v_mfma_f32_16x16x32_bf16 v[124:127], v[68:71], v[76:79], v[124:127]
 ds_read_b64_tr_b16 v[30:31], v7 offset:4096
 v_mul_f32 v248, v248, v212
 v_mfma_f32_16x16x32_bf16 v[120:123], v[64:67], v[76:79], v[120:123]
 ds_read_b128 v[44:47], v2 offset:33792
 v_mul_f32 v249, v249, v212
 v_mul_f32 v250, v250, v220
 v_mfma_f32_16x16x32_bf16 v[116:119], v[60:63], v[76:79], v[116:119]
 ds_read_b64_tr_b16 v[32:33], v8 offset:0
 v_mul_f32 v251, v251, v220
 s_add_u32 m0, s50, 16384
 s_add_u32 s62, s47, 0
 v_mfma_f32_16x16x32_bf16 v[112:115], v[56:59], v[76:79], v[112:115]
 ds_read_b64_tr_b16 v[34:35], v8 offset:4096
 buffer_load_dwordx4 v13, s[8:11], s62 offen offset:0 sc1 lds
 v_mul_f32 v252, v252, v228
 v_mul_f32 v253, v253, v228
 v_mfma_f32_16x16x32_bf16 v[128:131], v[56:59], v[80:83], v[128:131]
 ds_read_b128 v[48:51], v3 offset:32768
 v_mul_f32 v254, v254, v236
 v_mul_f32 v255, v255, v236
 v_mfma_f32_16x16x32_bf16 v[132:135], v[60:63], v[80:83], v[132:135]
 ds_read_b64_tr_b16 v[36:37], v9 offset:0
 v_mfma_f32_16x16x32_bf16 v[136:139], v[64:67], v[80:83], v[136:139]
 ds_read_b64_tr_b16 v[38:39], v9 offset:4096
 buffer_load_dwordx4 v13, s[8:11], s62 offen offset:1024 sc1 lds
 v_mfma_f32_16x16x32_bf16 v[212:215], v[192:195], v[208:211], 0
 v_mfma_f32_16x16x32_bf16 v[220:223], v[196:199], v[208:211], 0
 v_mfma_f32_16x16x32_bf16 v[140:143], v[68:71], v[80:83], v[140:143]
 ds_read_b128 v[52:55], v3 offset:33792
 v_mfma_f32_16x16x32_bf16 v[228:231], v[200:203], v[160:163], 0
 v_mfma_f32_16x16x32_bf16 v[156:159], v[68:71], v[84:87], v[156:159]
 v_mfma_f32_16x16x32_bf16 v[236:239], v[204:207], v[160:163], 0
 v_mfma_f32_16x16x32_bf16 v[164:167], v[192:195], v[216:219], 0
 v_mfma_f32_16x16x32_bf16 v[152:155], v[64:67], v[84:87], v[152:155]
 v_mfma_f32_16x16x32_bf16 v[172:175], v[196:199], v[216:219], 0
 s_add_u32 m0, s51, 40960
 s_add_u32 s63, s39, 0
 v_mfma_f32_16x16x32_bf16 v[148:151], v[60:63], v[84:87], v[148:151]
 buffer_load_dwordx4 v10, s[24:27], s63 offen lds
 v_mfma_f32_16x16x32_bf16 v[180:183], v[200:203], v[168:171], 0
 v_mfma_f32_16x16x32_bf16 v[188:191], v[204:207], v[168:171], 0
 v_mfma_f32_16x16x32_bf16 v[144:147], v[56:59], v[84:87], v[144:147]
 v_mfma_f32_16x16x32_bf16 v[208:211], v[192:195], v[224:227], 0
 s_waitcnt vmcnt(12) lgkmcnt(0)
 s_barrier
 v_mfma_f32_16x16x32_bf16 v[96:99], v[24:27], v[40:43], v[96:99]
 ds_read_b128 v[72:75], v2 offset:49152
 v_mul_f32 v212, v212, v248
 v_mul_f32 v213, v213, v248
 v_mul_f32 v214, v214, v248
 v_mfma_f32_16x16x32_bf16 v[100:103], v[28:31], v[40:43], v[100:103]
 ds_read_b64_tr_b16 v[56:57], v6 offset:8192
 v_mul_f32 v215, v215, v248
 v_mfma_f32_16x16x32_bf16 v[160:163], v[196:199], v[224:227], 0
 v_mul_f32 v220, v220, v248
 v_mfma_f32_16x16x32_bf16 v[104:107], v[32:35], v[40:43], v[104:107]
 ds_read_b64_tr_b16 v[58:59], v6 offset:12288
 v_mul_f32 v221, v221, v248
 v_mfma_f32_16x16x32_bf16 v[108:111], v[36:39], v[40:43], v[108:111]
 ds_read_b64_tr_b16 v[60:61], v7 offset:8192
 s_andn2_b32 s64, s2, 7
 s_lshl4_add_u32 s64, s64, 39960576
 s_buffer_load_dwordx8 s[72:79], s[8:11], s64 glc
 s_add_u32 m0, s50, 32768
 s_add_u32 s62, s6, 0
 s_and_b32 s62, s62, 3
 s_mul_i32 s62, s62, 16384
 s_add_u32 s62, s62, s56
 v_mfma_f32_16x16x32_bf16 v[124:127], v[36:39], v[44:47], v[124:127]
 ds_read_b64_tr_b16 v[62:63], v7 offset:12288
 buffer_load_dwordx4 v13, s[8:11], s62 offen offset:0 sc1 lds
 v_mul_f32 v222, v222, v248
 v_mul_f32 v223, v223, v248
 v_mfma_f32_16x16x32_bf16 v[120:123], v[32:35], v[44:47], v[120:123]
 ds_read_b128 v[76:79], v2 offset:50176
 v_mfma_f32_16x16x32_bf16 v[240:243], v[200:203], v[176:179], 0
 v_fma_f32 v212, v228, v249, v212
 v_fma_f32 v213, v229, v249, v213
 v_mfma_f32_16x16x32_bf16 v[116:119], v[28:31], v[44:47], v[116:119]
 ds_read_b64_tr_b16 v[64:65], v8 offset:8192
 v_fma_f32 v214, v230, v249, v214
 v_fma_f32 v215, v231, v249, v215
 v_mfma_f32_16x16x32_bf16 v[112:115], v[24:27], v[44:47], v[112:115]
 ds_read_b64_tr_b16 v[66:67], v8 offset:12288
 v_mfma_f32_16x16x32_bf16 v[244:247], v[204:207], v[176:179], 0
 v_fma_f32 v220, v236, v249, v220
 v_fma_f32 v221, v237, v249, v221
 v_mfma_f32_16x16x32_bf16 v[128:131], v[24:27], v[48:51], v[128:131]
 ds_read_b128 v[80:83], v3 offset:49152
 v_fma_f32 v222, v238, v249, v222
 v_fma_f32 v223, v239, v249, v223
 v_cvt_pk_bf16_f32 v212, v212, v213
 v_mfma_f32_16x16x32_bf16 v[132:135], v[28:31], v[48:51], v[132:135]
 ds_read_b64_tr_b16 v[68:69], v9 offset:8192
 buffer_load_dwordx4 v13, s[8:11], s62 offen offset:1024 sc1 lds
 v_cvt_pk_bf16_f32 v213, v214, v215
 v_cvt_pk_bf16_f32 v214, v220, v221
 v_mfma_f32_16x16x32_bf16 v[136:139], v[32:35], v[48:51], v[136:139]
 ds_read_b64_tr_b16 v[70:71], v9 offset:12288
 v_cvt_pk_bf16_f32 v215, v222, v223
 buffer_store_dwordx4 v[212:215], v20, s[8:11], s88 offen offset:0 sc1
 v_mfma_f32_16x16x32_bf16 v[216:219], v[192:195], v[232:235], 0
 v_mfma_f32_16x16x32_bf16 v[140:143], v[36:39], v[48:51], v[140:143]
 ds_read_b128 v[84:87], v3 offset:50176
 ds_read_b32 v90, v0
 ds_read_b32 v90, v0
 v_mul_f32 v164, v164, v250
 v_mul_f32 v165, v165, v250
 v_mfma_f32_16x16x32_bf16 v[156:159], v[36:39], v[52:55], v[156:159]
 v_mul_f32 v166, v166, v250
 v_mul_f32 v167, v167, v250
 v_mfma_f32_16x16x32_bf16 v[168:171], v[196:199], v[232:235], 0
 s_add_u32 m0, s51, 0
 s_add_u32 s63, s6, 0
 s_and_b32 s63, s63, 3
 s_mul_i32 s63, s63, 458752
 s_add_u32 s63, s63, s59
 v_mfma_f32_16x16x32_bf16 v[152:155], v[32:35], v[52:55], v[152:155]
 buffer_load_dwordx4 v10, s[24:27], s63 offen lds
 v_mul_f32 v172, v172, v250
 v_mul_f32 v173, v173, v250
 v_mfma_f32_16x16x32_bf16 v[148:151], v[28:31], v[52:55], v[148:151]
 v_mul_f32 v174, v174, v250
 v_mul_f32 v175, v175, v250
 v_mfma_f32_16x16x32_bf16 v[224:227], v[200:203], v[184:187], 0
 v_mfma_f32_16x16x32_bf16 v[144:147], v[24:27], v[52:55], v[144:147]
 v_fma_f32 v164, v180, v251, v164
 v_fma_f32 v165, v181, v251, v165
 s_waitcnt vmcnt(13) lgkmcnt(2)
 s_barrier
 v_mfma_f32_16x16x32_bf16 v[96:99], v[56:59], v[72:75], v[96:99]
 ds_read_b128 v[40:43], v4 offset:0
 v_fma_f32 v166, v182, v251, v166
 v_fma_f32 v167, v183, v251, v167
 v_mfma_f32_16x16x32_bf16 v[176:179], v[204:207], v[184:187], 0
 v_fma_f32 v172, v188, v251, v172
 v_mfma_f32_16x16x32_bf16 v[100:103], v[60:63], v[72:75], v[100:103]
 ds_read_b64_tr_b16 v[24:25], v6 offset:16384
 v_fma_f32 v173, v189, v251, v173
 v_fma_f32 v174, v190, v251, v174
 v_fma_f32 v175, v191, v251, v175
 v_mfma_f32_16x16x32_bf16 v[104:107], v[64:67], v[72:75], v[104:107]
 ds_read_b64_tr_b16 v[26:27], v6 offset:20480
 v_cvt_pk_bf16_f32 v164, v164, v165
 v_cvt_pk_bf16_f32 v165, v166, v167
 v_cvt_pk_bf16_f32 v166, v172, v173
 v_cvt_pk_bf16_f32 v167, v174, v175
 v_mfma_f32_16x16x32_bf16 v[108:111], v[68:71], v[72:75], v[108:111]
 ds_read_b64_tr_b16 v[28:29], v7 offset:16384
 buffer_store_dwordx4 v[164:167], v20, s[8:11], s88 offen offset:1024 sc1
 v_mul_f32 v208, v208, v252
 v_mul_f32 v209, v209, v252
 v_mfma_f32_16x16x32_bf16 v[124:127], v[68:71], v[76:79], v[124:127]
 ds_read_b64_tr_b16 v[30:31], v7 offset:20480
 v_mul_f32 v210, v210, v252
 v_mul_f32 v211, v211, v252
 v_mul_f32 v160, v160, v252
 v_mul_f32 v161, v161, v252
 v_mfma_f32_16x16x32_bf16 v[120:123], v[64:67], v[76:79], v[120:123]
 ds_read_b128 v[44:47], v4 offset:1024
 v_mul_f32 v162, v162, v252
 v_mul_f32 v163, v163, v252
 v_fma_f32 v208, v240, v253, v208
 v_mfma_f32_16x16x32_bf16 v[116:119], v[60:63], v[76:79], v[116:119]
 ds_read_b64_tr_b16 v[32:33], v8 offset:16384
 v_fma_f32 v209, v241, v253, v209
 v_fma_f32 v210, v242, v253, v210
 v_fma_f32 v211, v243, v253, v211
 v_fma_f32 v160, v244, v253, v160
 v_mfma_f32_16x16x32_bf16 v[112:115], v[56:59], v[76:79], v[112:115]
 ds_read_b64_tr_b16 v[34:35], v8 offset:20480
 v_fma_f32 v161, v245, v253, v161
 v_fma_f32 v162, v246, v253, v162
 v_fma_f32 v163, v247, v253, v163
 v_mfma_f32_16x16x32_bf16 v[128:131], v[56:59], v[80:83], v[128:131]
 ds_read_b128 v[48:51], v5 offset:0
 v_cvt_pk_bf16_f32 v208, v208, v209
 v_cvt_pk_bf16_f32 v209, v210, v211
 v_cvt_pk_bf16_f32 v210, v160, v161
 s_add_u32 m0, s50, 49152
 s_add_u32 s62, s6, 1
 s_and_b32 s62, s62, 3
 s_mul_i32 s62, s62, 16384
 s_add_u32 s62, s62, s56
 v_mfma_f32_16x16x32_bf16 v[132:135], v[60:63], v[80:83], v[132:135]
 ds_read_b64_tr_b16 v[36:37], v9 offset:16384
 buffer_load_dwordx4 v13, s[8:11], s62 offen offset:0 sc1 lds
 v_cvt_pk_bf16_f32 v211, v162, v163
 buffer_store_dwordx4 v[208:211], v20, s[8:11], s88 offen offset:2048 sc1
 v_mul_f32 v216, v216, v254
 v_mul_f32 v217, v217, v254
 v_mfma_f32_16x16x32_bf16 v[136:139], v[64:67], v[80:83], v[136:139]
 ds_read_b64_tr_b16 v[38:39], v9 offset:20480
 v_mul_f32 v218, v218, v254
 v_mul_f32 v219, v219, v254
 v_mul_f32 v168, v168, v254
 v_mfma_f32_16x16x32_bf16 v[140:143], v[68:71], v[80:83], v[140:143]
 ds_read_b128 v[52:55], v5 offset:1024
 v_mul_f32 v169, v169, v254
 v_mul_f32 v170, v170, v254
 v_mul_f32 v171, v171, v254
 v_fma_f32 v216, v224, v255, v216
 v_mfma_f32_16x16x32_bf16 v[156:159], v[68:71], v[84:87], v[156:159]
 v_fma_f32 v217, v225, v255, v217
 v_fma_f32 v218, v226, v255, v218
 v_fma_f32 v219, v227, v255, v219
 v_mfma_f32_16x16x32_bf16 v[152:155], v[64:67], v[84:87], v[152:155]
 v_fma_f32 v168, v176, v255, v168
 v_fma_f32 v169, v177, v255, v169
 v_fma_f32 v170, v178, v255, v170
 v_fma_f32 v171, v179, v255, v171
 v_mfma_f32_16x16x32_bf16 v[148:151], v[60:63], v[84:87], v[148:151]
 v_cvt_pk_bf16_f32 v216, v216, v217
 v_cvt_pk_bf16_f32 v217, v218, v219
 v_cvt_pk_bf16_f32 v218, v168, v169
 v_mfma_f32_16x16x32_bf16 v[144:147], v[56:59], v[84:87], v[144:147]
 v_cvt_pk_bf16_f32 v219, v170, v171
 s_waitcnt lgkmcnt(0)
 s_and_b64 s[96:97], s[72:73], s[74:75]
 s_and_b64 s[80:81], s[76:77], s[78:79]
 s_and_b64 s[96:97], s[96:97], s[80:81]
 s_bitcmp1_b32 s2, 0
 s_cselect_b32 s96, s97, s96
 s_bitcmp1_b32 s96, 0
 s_cbranch_scc0 Lsp_168
Lok_169:
 buffer_store_dwordx4 v[216:219], v20, s[8:11], s88 offen offset:3072 sc1
 s_waitcnt vmcnt(14) lgkmcnt(0)
 s_barrier
 v_mfma_f32_16x16x32_bf16 v[96:99], v[24:27], v[40:43], v[96:99]
 ds_read_b128 v[72:75], v4 offset:16384
 s_bitcmp1_b32 s2, 0
 s_cselect_b32 s72, s73, s72
 s_cselect_b32 s74, s75, s74
 s_cselect_b32 s76, s77, s76
 s_cselect_b32 s78, s79, s78
 s_sub_u32 s78, s78, s72
 s_sub_u32 s76, s76, s72
 v_mfma_f32_16x16x32_bf16 v[100:103], v[28:31], v[40:43], v[100:103]
 ds_read_b64_tr_b16 v[56:57], v6 offset:24576
 s_sub_u32 s74, s74, s72
 s_sub_u32 s72, s72, s72
 v_mfma_f32_16x16x32_bf16 v[104:107], v[32:35], v[40:43], v[104:107]
 ds_read_b64_tr_b16 v[58:59], v6 offset:28672
 s_lshl2_add_u32 s72, s72, 0
 s_lshl2_add_u32 s74, s74, 1
 s_lshl2_add_u32 s76, s76, 2
 v_mfma_f32_16x16x32_bf16 v[108:111], v[36:39], v[40:43], v[108:111]
 ds_read_b64_tr_b16 v[60:61], v7 offset:24576
 buffer_load_dwordx4 v13, s[8:11], s62 offen offset:1024 sc1 lds
 s_lshl2_add_u32 s78, s78, 3
 s_min_i32 s73, s72, s74
 v_mfma_f32_16x16x32_bf16 v[124:127], v[36:39], v[44:47], v[124:127]
 ds_read_b64_tr_b16 v[62:63], v7 offset:28672
 s_max_i32 s74, s72, s74
 s_min_i32 s72, s76, s78
 s_max_i32 s78, s76, s78
 v_mfma_f32_16x16x32_bf16 v[120:123], v[32:35], v[44:47], v[120:123]
 ds_read_b128 v[76:79], v4 offset:17408
 s_min_i32 s76, s73, s72
 s_max_i32 s72, s73, s72
 v_mfma_f32_16x16x32_bf16 v[116:119], v[28:31], v[44:47], v[116:119]
 ds_read_b64_tr_b16 v[64:65], v8 offset:24576
 s_min_i32 s73, s74, s78
 s_max_i32 s78, s74, s78
 s_min_i32 s74, s73, s72
 s_add_u32 m0, s51, 8192
 s_add_u32 s63, s6, 1
 s_and_b32 s63, s63, 3
 s_mul_i32 s63, s63, 458752
 s_add_u32 s63, s63, s59
 v_mfma_f32_16x16x32_bf16 v[112:115], v[24:27], v[44:47], v[112:115]
 ds_read_b64_tr_b16 v[66:67], v8 offset:28672
 buffer_load_dwordx4 v10, s[24:27], s63 offen lds
 s_max_i32 s72, s73, s72
 s_mov_b32 s80, 0x08080808
 v_mfma_f32_16x16x32_bf16 v[128:131], v[24:27], v[48:51], v[128:131]
 ds_read_b128 v[80:83], v5 offset:16384
 s_sub_u32 s73, s72, 240
 s_add_u32 s75, s74, 240
 s_sub_u32 s84, s78, 240
 v_mfma_f32_16x16x32_bf16 v[132:135], v[28:31], v[48:51], v[132:135]
 ds_read_b64_tr_b16 v[68:69], v9 offset:24576
 s_add_u32 s96, s76, 240
 s_max_i32 s77, s84, s72
 s_add_u32 m0, s50, 65536
 s_add_u32 s62, s6, 2
 s_and_b32 s62, s62, 3
 s_mul_i32 s62, s62, 16384
 s_add_u32 s62, s62, s56
 v_mfma_f32_16x16x32_bf16 v[136:139], v[32:35], v[48:51], v[136:139]
 ds_read_b64_tr_b16 v[70:71], v9 offset:28672
 buffer_load_dwordx4 v13, s[8:11], s62 offen offset:0 sc1 lds
 s_min_i32 s72, s84, s72
 s_min_i32 s79, s96, s74
 s_max_i32 s74, s96, s74
 v_mfma_f32_16x16x32_bf16 v[140:143], v[36:39], v[48:51], v[140:143]
 ds_read_b128 v[84:87], v5 offset:17408
 s_lshl_b32 s76, s76, 3
 s_lshl_b32 s76, 4, s76
 v_mfma_f32_16x16x32_bf16 v[156:159], v[36:39], v[52:55], v[156:159]
 s_sub_u32 s80, s80, s76
 s_lshl_b32 s79, s79, 3
 s_lshl_b32 s79, 4, s79
 v_mfma_f32_16x16x32_bf16 v[152:155], v[32:35], v[52:55], v[152:155]
 s_sub_u32 s80, s80, s79
 s_sub_u32 s84, s78, s74
 v_mfma_f32_16x16x32_bf16 v[148:151], v[28:31], v[52:55], v[148:151]
 buffer_load_dwordx4 v13, s[8:11], s62 offen offset:1024 sc1 lds
 s_cmp_gt_i32 s84, 288
 s_cselect_b32 s96, 4, 0
 s_lshl_b32 s78, s78, 3
 s_lshl_b32 s78, s96, s78
 v_mfma_f32_16x16x32_bf16 v[144:147], v[24:27], v[52:55], v[144:147]
 s_add_u32 s80, s80, s78
 s_lshl_b32 s74, s74, 3
 s_waitcnt vmcnt(15) lgkmcnt(0)
 s_barrier
 v_mfma_f32_16x16x32_bf16 v[96:99], v[56:59], v[72:75], v[96:99]
 ds_read_b128 v[40:43], v2 offset:0
 s_lshl_b32 s74, s96, s74
 s_sub_u32 s80, s80, s74
 s_sub_u32 s84, s77, s75
 s_cmp_gt_i32 s84, 288
 s_cselect_b32 s96, 4, 0
 v_mfma_f32_16x16x32_bf16 v[100:103], v[60:63], v[72:75], v[100:103]
 ds_read_b64_tr_b16 v[24:25], v6 offset:32768
 s_lshl_b32 s77, s77, 3
 s_lshl_b32 s77, s96, s77
 s_add_u32 s80, s80, s77
 v_mfma_f32_16x16x32_bf16 v[104:107], v[64:67], v[72:75], v[104:107]
 ds_read_b64_tr_b16 v[26:27], v6 offset:36864
 s_lshl_b32 s75, s75, 3
 s_lshl_b32 s75, s96, s75
 s_sub_u32 s80, s80, s75
 s_add_u32 m0, s51, 16384
 s_add_u32 s63, s6, 2
 s_and_b32 s63, s63, 3
 s_mul_i32 s63, s63, 458752
 s_add_u32 s63, s63, s59
 v_mfma_f32_16x16x32_bf16 v[108:111], v[68:71], v[72:75], v[108:111]
 ds_read_b64_tr_b16 v[28:29], v7 offset:32768
 buffer_load_dwordx4 v10, s[24:27], s63 offen lds
 s_xor_b32 s84, s4, 1
 s_lshl3_add_u32 s84, s84, 0x80000
 s_bfe_u32 s84, s80, s84
 v_mfma_f32_16x16x32_bf16 v[124:127], v[68:71], v[76:79], v[124:127]
 ds_read_b64_tr_b16 v[30:31], v7 offset:36864
 s_sub_u32 s96, 16, s84
 s_lshr_b32 s52, 0x7654, s96
 s_mov_b32 s81, s84
 v_mfma_f32_16x16x32_bf16 v[120:123], v[64:67], v[76:79], v[120:123]
 ds_read_b128 v[44:47], v2 offset:1024
 s_xor_b32 s84, s4, 2
 s_lshl3_add_u32 s84, s84, 0x80000
 v_mfma_f32_16x16x32_bf16 v[116:119], v[60:63], v[76:79], v[116:119]
 ds_read_b64_tr_b16 v[32:33], v8 offset:32768
 s_bfe_u32 s84, s80, s84
 s_sub_u32 s96, 16, s84
 s_lshr_b32 s96, 0xba98, s96
 s_lshl2_add_u32 s92, s83, s4
 s_add_u32 m0, s50, 81920
 s_add_u32 s62, s6, 3
 s_and_b32 s62, s62, 3
 s_mul_i32 s62, s62, 16384
 s_add_u32 s62, s62, s56
 v_mfma_f32_16x16x32_bf16 v[112:115], v[56:59], v[76:79], v[112:115]
 ds_read_b64_tr_b16 v[34:35], v8 offset:36864
 buffer_load_dwordx4 v13, s[8:11], s62 offen offset:0 sc1 lds
 s_lshl2_add_u32 s92, s92, s7
 s_lshl_b32 s92, s92, 7
 s_add_u32 s92, s92, 39927808
 s_add_u32 s92, s92, s5
 v_mfma_f32_16x16x32_bf16 v[128:131], v[56:59], v[80:83], v[128:131]
 ds_read_b128 v[48:51], v3 offset:0
 v_mov_b32 v91, 1
 s_waitcnt vmcnt(6)
 buffer_store_byte v91, off, s[8:11], s92 sc1
 v_mfma_f32_16x16x32_bf16 v[132:135], v[60:63], v[80:83], v[132:135]
 ds_read_b64_tr_b16 v[36:37], v9 offset:32768
 s_lshl_b32 s96, s96, s81
 s_or_b32 s52, s52, s96
 s_add_u32 s81, s81, s84
 v_mfma_f32_16x16x32_bf16 v[136:139], v[64:67], v[80:83], v[136:139]
 ds_read_b64_tr_b16 v[38:39], v9 offset:36864
 buffer_load_dwordx4 v13, s[8:11], s62 offen offset:1024 sc1 lds
 s_xor_b32 s84, s4, 3
 s_lshl3_add_u32 s84, s84, 0x80000
 s_bfe_u32 s84, s80, s84
 v_mfma_f32_16x16x32_bf16 v[140:143], v[68:71], v[80:83], v[140:143]
 ds_read_b128 v[52:55], v3 offset:1024
 s_sub_u32 s96, 16, s84
 s_lshr_b32 s96, 0xfedc, s96
 s_lshl_b32 s96, s96, s81
 v_mfma_f32_16x16x32_bf16 v[156:159], v[68:71], v[84:87], v[156:159]
 s_or_b32 s52, s52, s96
 s_add_u32 s81, s81, s84
 s_mul_i32 s84, s5, s81
 v_mfma_f32_16x16x32_bf16 v[152:155], v[64:67], v[84:87], v[152:155]
 s_lshr_b32 s84, s84, 3
 s_andn2_b32 s84, s84, 3
 s_lshr_b32 s96, s52, s84
 s_add_u32 m0, s51, 24576
 s_add_u32 s63, s6, 3
 s_and_b32 s63, s63, 3
 s_mul_i32 s63, s63, 458752
 s_add_u32 s63, s63, s59
 v_mfma_f32_16x16x32_bf16 v[148:151], v[60:63], v[84:87], v[148:151]
 buffer_load_dwordx4 v10, s[24:27], s63 offen lds
 s_sub_u32 s84, s81, s84
 s_lshl_b32 s52, s52, s84
 s_or_b32 s52, s52, s96
 v_mfma_f32_16x16x32_bf16 v[144:147], v[56:59], v[84:87], v[144:147]
 s_lshl_b32 s84, s6, 2
 s_mul_i32 s96, s4, 0x44444444
L5_f1:
 s_cmp_eq_u32 s81, 12
 s_cbranch_scc1 L5_v13
 s_cmp_eq_u32 s81, 8
 s_cbranch_scc1 L5_v14
 s_cmp_eq_u32 s81, 20
 s_cbranch_scc1 L5_v11
 s_cmp_eq_u32 s81, 24
 s_cbranch_scc1 L5_v10
 s_lshl_b32 s52, s52, 8
 s_lshr_b32 s84, 0x32323232, s84
 s_and_b32 s84, s84, 0xff
 s_or_b32 s52, s52, s84
 s_xor_b32 s52, s52, s96
 s_waitcnt vmcnt(17) lgkmcnt(0)
 s_barrier
 v_mfma_f32_16x16x32_bf16 v[96:99], v[24:27], v[40:43], v[96:99]
 ds_read_b128 v[72:75], v2 offset:16384
 v_mfma_f32_16x16x32_bf16 v[100:103], v[28:31], v[40:43], v[100:103]
 ds_read_b64_tr_b16 v[56:57], v6 offset:40960
 v_mfma_f32_16x16x32_bf16 v[104:107], v[32:35], v[40:43], v[104:107]
 ds_read_b64_tr_b16 v[58:59], v6 offset:45056
 v_mfma_f32_16x16x32_bf16 v[108:111], v[36:39], v[40:43], v[108:111]
 ds_read_b64_tr_b16 v[60:61], v7 offset:40960
 v_mfma_f32_16x16x32_bf16 v[124:127], v[36:39], v[44:47], v[124:127]
 ds_read_b64_tr_b16 v[62:63], v7 offset:45056
 v_mfma_f32_16x16x32_bf16 v[120:123], v[32:35], v[44:47], v[120:123]
 ds_read_b128 v[76:79], v2 offset:17408
 v_mfma_f32_16x16x32_bf16 v[116:119], v[28:31], v[44:47], v[116:119]
 ds_read_b64_tr_b16 v[64:65], v8 offset:40960
 v_mfma_f32_16x16x32_bf16 v[112:115], v[24:27], v[44:47], v[112:115]
 ds_read_b64_tr_b16 v[66:67], v8 offset:45056
 v_mfma_f32_16x16x32_bf16 v[128:131], v[24:27], v[48:51], v[128:131]
 ds_read_b128 v[80:83], v3 offset:16384
 s_add_u32 m0, s51, 32768
 s_add_u32 s63, s6, 0
 s_and_b32 s63, s63, 3
 s_mul_i32 s63, s63, 65536
 s_add_u32 s63, s63, s65
 v_mfma_f32_16x16x32_bf16 v[132:135], v[28:31], v[48:51], v[132:135]
 ds_read_b64_tr_b16 v[68:69], v9 offset:40960
 buffer_load_dwordx4 v10, s[20:23], s63 offen lds
 v_mfma_f32_16x16x32_bf16 v[136:139], v[32:35], v[48:51], v[136:139]
 ds_read_b64_tr_b16 v[70:71], v9 offset:45056
 v_mfma_f32_16x16x32_bf16 v[140:143], v[36:39], v[48:51], v[140:143]
 ds_read_b128 v[84:87], v3 offset:17408
 v_mfma_f32_16x16x32_bf16 v[156:159], v[36:39], v[52:55], v[156:159]
 v_mfma_f32_16x16x32_bf16 v[152:155], v[32:35], v[52:55], v[152:155]
 v_mfma_f32_16x16x32_bf16 v[148:151], v[28:31], v[52:55], v[148:151]
 v_mfma_f32_16x16x32_bf16 v[144:147], v[24:27], v[52:55], v[144:147]
 s_waitcnt vmcnt(14) lgkmcnt(0)
 s_barrier
 v_mfma_f32_16x16x32_bf16 v[96:99], v[56:59], v[72:75], v[96:99]
 ds_read_b128 v[40:43], v2 offset:32768
 v_and_b32 v94, 15, v1
 v_mfma_f32_16x16x32_bf16 v[100:103], v[60:63], v[72:75], v[100:103]
 ds_read_b64_tr_b16 v[24:25], v6 offset:0
 v_mfma_f32_16x16x32_bf16 v[104:107], v[64:67], v[72:75], v[104:107]
 ds_read_b64_tr_b16 v[26:27], v6 offset:4096
 v_lshlrev_b32 v94, 11, v94
 v_mfma_f32_16x16x32_bf16 v[108:111], v[68:71], v[72:75], v[108:111]
 ds_read_b64_tr_b16 v[28:29], v7 offset:0
 v_mfma_f32_16x16x32_bf16 v[124:127], v[68:71], v[76:79], v[124:127]
 ds_read_b64_tr_b16 v[30:31], v7 offset:4096
 v_bfe_u32 v92, v1, 4, 1
 v_mfma_f32_16x16x32_bf16 v[120:123], v[64:67], v[76:79], v[120:123]
 ds_read_b128 v[44:47], v2 offset:33792
 v_mfma_f32_16x16x32_bf16 v[116:119], v[60:63], v[76:79], v[116:119]
 ds_read_b64_tr_b16 v[32:33], v8 offset:0
 v_lshl_add_u32 v94, v92, 5, v94
 v_mfma_f32_16x16x32_bf16 v[112:115], v[56:59], v[76:79], v[112:115]
 ds_read_b64_tr_b16 v[34:35], v8 offset:4096
 v_mfma_f32_16x16x32_bf16 v[128:131], v[56:59], v[80:83], v[128:131]
 ds_read_b128 v[48:51], v3 offset:32768
 v_lshrrev_b32 v92, 5, v1
 s_add_u32 m0, s51, 40960
 s_add_u32 s63, s6, 1
 s_and_b32 s63, s63, 3
 s_mul_i32 s63, s63, 65536
 s_add_u32 s63, s63, s65
 v_mfma_f32_16x16x32_bf16 v[132:135], v[60:63], v[80:83], v[132:135]
 ds_read_b64_tr_b16 v[36:37], v9 offset:0
 buffer_load_dwordx4 v10, s[20:23], s63 offen lds
 v_mfma_f32_16x16x32_bf16 v[136:139], v[64:67], v[80:83], v[136:139]
 ds_read_b64_tr_b16 v[38:39], v9 offset:4096
 v_lshl_add_u32 v94, v92, 4, v94
 v_mfma_f32_16x16x32_bf16 v[140:143], v[68:71], v[80:83], v[140:143]
 ds_read_b128 v[52:55], v3 offset:33792
 v_mfma_f32_16x16x32_bf16 v[156:159], v[68:71], v[84:87], v[156:159]
 buffer_load_dwordx4 v[184:187], v94, s[16:19], s61 offen
 v_mfma_f32_16x16x32_bf16 v[152:155], v[64:67], v[84:87], v[152:155]
 v_mfma_f32_16x16x32_bf16 v[148:151], v[60:63], v[84:87], v[148:151]
 buffer_load_dwordx4 v[188:191], v94, s[16:19], s66 offen
 v_mfma_f32_16x16x32_bf16 v[144:147], v[56:59], v[84:87], v[144:147]
 s_waitcnt vmcnt(11) lgkmcnt(0)
 s_barrier
 v_mfma_f32_16x16x32_bf16 v[96:99], v[24:27], v[40:43], v[96:99]
 ds_read_b128 v[72:75], v2 offset:49152
 v_mfma_f32_16x16x32_bf16 v[100:103], v[28:31], v[40:43], v[100:103]
 ds_read_b64_tr_b16 v[56:57], v6 offset:8192
 v_mfma_f32_16x16x32_bf16 v[104:107], v[32:35], v[40:43], v[104:107]
 ds_read_b64_tr_b16 v[58:59], v6 offset:12288
 v_mfma_f32_16x16x32_bf16 v[108:111], v[36:39], v[40:43], v[108:111]
 ds_read_b64_tr_b16 v[60:61], v7 offset:8192
 v_mfma_f32_16x16x32_bf16 v[124:127], v[36:39], v[44:47], v[124:127]
 ds_read_b64_tr_b16 v[62:63], v7 offset:12288
 v_mfma_f32_16x16x32_bf16 v[120:123], v[32:35], v[44:47], v[120:123]
 ds_read_b128 v[76:79], v2 offset:50176
 v_mfma_f32_16x16x32_bf16 v[116:119], v[28:31], v[44:47], v[116:119]
 ds_read_b64_tr_b16 v[64:65], v8 offset:8192
 v_mfma_f32_16x16x32_bf16 v[112:115], v[24:27], v[44:47], v[112:115]
 ds_read_b64_tr_b16 v[66:67], v8 offset:12288
 v_mfma_f32_16x16x32_bf16 v[128:131], v[24:27], v[48:51], v[128:131]
 ds_read_b128 v[80:83], v3 offset:49152
 s_add_u32 m0, s51, 0
 s_add_u32 s63, s6, 2
 s_and_b32 s63, s63, 3
 s_mul_i32 s63, s63, 65536
 s_add_u32 s63, s63, s65
 v_mfma_f32_16x16x32_bf16 v[132:135], v[28:31], v[48:51], v[132:135]
 ds_read_b64_tr_b16 v[68:69], v9 offset:8192
 buffer_load_dwordx4 v10, s[20:23], s63 offen lds
 v_mfma_f32_16x16x32_bf16 v[136:139], v[32:35], v[48:51], v[136:139]
 ds_read_b64_tr_b16 v[70:71], v9 offset:12288
 v_mfma_f32_16x16x32_bf16 v[140:143], v[36:39], v[48:51], v[140:143]
 ds_read_b128 v[84:87], v3 offset:50176
 v_mfma_f32_16x16x32_bf16 v[156:159], v[36:39], v[52:55], v[156:159]
 v_mfma_f32_16x16x32_bf16 v[152:155], v[32:35], v[52:55], v[152:155]
 v_mfma_f32_16x16x32_bf16 v[148:151], v[28:31], v[52:55], v[148:151]
 v_mfma_f32_16x16x32_bf16 v[144:147], v[24:27], v[52:55], v[144:147]
 s_waitcnt vmcnt(9) lgkmcnt(0)
 s_barrier
 v_mfma_f32_16x16x32_bf16 v[96:99], v[56:59], v[72:75], v[96:99]
 ds_read_b128 v[40:43], v4 offset:0
 v_mfma_f32_16x16x32_bf16 v[100:103], v[60:63], v[72:75], v[100:103]
 ds_read_b64_tr_b16 v[24:25], v6 offset:16384
 v_mfma_f32_16x16x32_bf16 v[104:107], v[64:67], v[72:75], v[104:107]
 ds_read_b64_tr_b16 v[26:27], v6 offset:20480
 s_add_u32 m0, s50, 0
 s_add_u32 s62, s6, 0
 s_and_b32 s62, s62, 3
 s_mul_i32 s62, s62, 16384
 s_add_u32 s62, s62, s54
 v_mfma_f32_16x16x32_bf16 v[108:111], v[68:71], v[72:75], v[108:111]
 ds_read_b64_tr_b16 v[28:29], v7 offset:16384
 buffer_load_dwordx4 v13, s[8:11], s62 offen offset:0 sc1 lds
 v_mfma_f32_16x16x32_bf16 v[124:127], v[68:71], v[76:79], v[124:127]
 ds_read_b64_tr_b16 v[30:31], v7 offset:20480
 v_mfma_f32_16x16x32_bf16 v[120:123], v[64:67], v[76:79], v[120:123]
 ds_read_b128 v[44:47], v4 offset:1024
 buffer_load_dwordx4 v13, s[8:11], s62 offen offset:1024 sc1 lds
 v_mfma_f32_16x16x32_bf16 v[116:119], v[60:63], v[76:79], v[116:119]
 ds_read_b64_tr_b16 v[32:33], v8 offset:16384
 s_add_u32 m0, s50, 16384
 s_add_u32 s62, s6, 1
 s_and_b32 s62, s62, 3
 s_mul_i32 s62, s62, 16384
 s_add_u32 s62, s62, s54
 v_mfma_f32_16x16x32_bf16 v[112:115], v[56:59], v[76:79], v[112:115]
 ds_read_b64_tr_b16 v[34:35], v8 offset:20480
 buffer_load_dwordx4 v13, s[8:11], s62 offen offset:0 sc1 lds
 v_mfma_f32_16x16x32_bf16 v[128:131], v[56:59], v[80:83], v[128:131]
 ds_read_b128 v[48:51], v5 offset:0
 v_mfma_f32_16x16x32_bf16 v[132:135], v[60:63], v[80:83], v[132:135]
 ds_read_b64_tr_b16 v[36:37], v9 offset:16384
 v_mfma_f32_16x16x32_bf16 v[136:139], v[64:67], v[80:83], v[136:139]
 ds_read_b64_tr_b16 v[38:39], v9 offset:20480
 buffer_load_dwordx4 v13, s[8:11], s62 offen offset:1024 sc1 lds
 v_mfma_f32_16x16x32_bf16 v[140:143], v[68:71], v[80:83], v[140:143]
 ds_read_b128 v[52:55], v5 offset:1024
 s_add_u32 m0, s50, 32768
 s_add_u32 s62, s6, 2
 s_and_b32 s62, s62, 3
 s_mul_i32 s62, s62, 16384
 s_add_u32 s62, s62, s54
 v_mfma_f32_16x16x32_bf16 v[156:159], v[68:71], v[84:87], v[156:159]
 buffer_load_dwordx4 v13, s[8:11], s62 offen offset:0 sc1 lds
 v_mfma_f32_16x16x32_bf16 v[152:155], v[64:67], v[84:87], v[152:155]
 v_mfma_f32_16x16x32_bf16 v[148:151], v[60:63], v[84:87], v[148:151]
 buffer_load_dwordx4 v13, s[8:11], s62 offen offset:1024 sc1 lds
 v_mfma_f32_16x16x32_bf16 v[144:147], v[56:59], v[84:87], v[144:147]
 s_waitcnt vmcnt(11) lgkmcnt(0)
 s_barrier
 v_mfma_f32_16x16x32_bf16 v[96:99], v[24:27], v[40:43], v[96:99]
 ds_read_b128 v[72:75], v4 offset:16384
 s_mov_b32 s89, 0xffff0000
 s_waitcnt vmcnt(7)
 v_mfma_f32_16x16x32_bf16 v[100:103], v[28:31], v[40:43], v[100:103]
 ds_read_b64_tr_b16 v[56:57], v6 offset:24576
 v_permlane16_swap_b32 v184, v186
 v_permlane16_swap_b32 v185, v187
 v_mfma_f32_16x16x32_bf16 v[104:107], v[32:35], v[40:43], v[104:107]
 ds_read_b64_tr_b16 v[58:59], v6 offset:28672
 v_permlane16_swap_b32 v188, v190
 v_permlane16_swap_b32 v189, v191
 s_add_u32 m0, s50, 49152
 s_add_u32 s62, s6, 3
 s_and_b32 s62, s62, 3
 s_mul_i32 s62, s62, 16384
 s_add_u32 s62, s62, s54
 v_mfma_f32_16x16x32_bf16 v[108:111], v[36:39], v[40:43], v[108:111]
 ds_read_b64_tr_b16 v[60:61], v7 offset:24576
 buffer_load_dwordx4 v13, s[8:11], s62 offen offset:0 sc1 lds
 v_lshlrev_b32 v192, 16, v184
 v_mfma_f32_16x16x32_bf16 v[124:127], v[36:39], v[44:47], v[124:127]
 ds_read_b64_tr_b16 v[62:63], v7 offset:28672
 v_and_b32 v193, s89, v184
 v_lshlrev_b32 v194, 16, v185
 v_mfma_f32_16x16x32_bf16 v[120:123], v[32:35], v[44:47], v[120:123]
 ds_read_b128 v[76:79], v4 offset:17408
 buffer_load_dwordx4 v13, s[8:11], s62 offen offset:1024 sc1 lds
 v_and_b32 v195, s89, v185
 v_lshlrev_b32 v196, 16, v186
 v_mfma_f32_16x16x32_bf16 v[116:119], v[28:31], v[44:47], v[116:119]
 ds_read_b64_tr_b16 v[64:65], v8 offset:24576
 s_add_u32 m0, s51, 8192
 s_add_u32 s63, s6, 3
 s_and_b32 s63, s63, 3
 s_mul_i32 s63, s63, 65536
 s_add_u32 s63, s63, s65
 v_mfma_f32_16x16x32_bf16 v[112:115], v[24:27], v[44:47], v[112:115]
 ds_read_b64_tr_b16 v[66:67], v8 offset:28672
 buffer_load_dwordx4 v10, s[20:23], s63 offen lds
 s_lshl4_add_u32 s64, s83, s7
 s_lshl_b32 s64, s64, 7
 v_mfma_f32_16x16x32_bf16 v[128:131], v[24:27], v[48:51], v[128:131]
 ds_read_b128 v[80:83], v5 offset:16384
 s_add_u32 s64, s64, 39927808
 s_buffer_load_dwordx2 s[72:73], s[8:11], s64 offset:0 glc
 s_buffer_load_dwordx2 s[74:75], s[8:11], s64 offset:512 glc
 s_buffer_load_dwordx2 s[76:77], s[8:11], s64 offset:1024 glc
 s_buffer_load_dwordx2 s[78:79], s[8:11], s64 offset:1536 glc
 v_mfma_f32_16x16x32_bf16 v[132:135], v[28:31], v[48:51], v[132:135]
 ds_read_b64_tr_b16 v[68:69], v9 offset:24576
 v_and_b32 v197, s89, v186
 s_add_u32 m0, s50, 65536
 s_bfe_u32 s62, s52, 0x40000
 s_lshl_b32 s62, s62, 15
 s_add_u32 s62, s62, s57
 v_mfma_f32_16x16x32_bf16 v[136:139], v[32:35], v[48:51], v[136:139]
 ds_read_b64_tr_b16 v[70:71], v9 offset:28672
 buffer_load_dwordx4 v0, s[8:11], s62 offen offset:0 sc1 lds
 v_lshlrev_b32 v198, 16, v187
 v_and_b32 v199, s89, v187
 v_mfma_f32_16x16x32_bf16 v[140:143], v[36:39], v[48:51], v[140:143]
 ds_read_b128 v[84:87], v5 offset:17408
 ds_read_b32 v90, v0
 ds_read_b32 v90, v0
 ds_read_b32 v90, v0
 ds_read_b32 v90, v0
 ds_read_b32 v90, v0
 ds_read_b32 v90, v0
 ds_read_b32 v90, v0
 ds_read_b32 v90, v0
 v_lshlrev_b32 v200, 16, v188
 v_and_b32 v201, s89, v188
 v_mfma_f32_16x16x32_bf16 v[156:159], v[36:39], v[52:55], v[156:159]
 buffer_load_dwordx4 v0, s[8:11], s62 offen offset:1024 sc1 lds
 v_lshlrev_b32 v202, 16, v189
 v_mfma_f32_16x16x32_bf16 v[152:155], v[32:35], v[52:55], v[152:155]
 v_and_b32 v203, s89, v189
 v_lshlrev_b32 v204, 16, v190
 s_add_u32 m0, s51, 16384
 s_bfe_u32 s63, s52, 0x40000
 s_lshl_b32 s63, s63, 17
 s_add_u32 s63, s63, s58
 v_mfma_f32_16x16x32_bf16 v[148:151], v[28:31], v[52:55], v[148:151]
 buffer_load_dwordx4 v11, s[20:23], s63 offen lds
 v_and_b32 v205, s89, v190
 v_lshlrev_b32 v206, 16, v191
 v_mfma_f32_16x16x32_bf16 v[144:147], v[24:27], v[52:55], v[144:147]
 v_and_b32 v207, s89, v191
 s_waitcnt vmcnt(10) lgkmcnt(8)
 s_barrier
 v_mfma_f32_16x16x32_bf16 v[96:99], v[56:59], v[72:75], v[96:99]
 ds_read_b128 v[40:43], v2 offset:0
 v_mfma_f32_16x16x32_bf16 v[100:103], v[60:63], v[72:75], v[100:103]
 ds_read_b64_tr_b16 v[24:25], v6 offset:32768
 v_mfma_f32_16x16x32_bf16 v[104:107], v[64:67], v[72:75], v[104:107]
 ds_read_b64_tr_b16 v[26:27], v6 offset:36864
 v_mfma_f32_16x16x32_bf16 v[108:111], v[68:71], v[72:75], v[108:111]
 ds_read_b64_tr_b16 v[28:29], v7 offset:32768
 s_add_u32 m0, s50, 81920
 s_bfe_u32 s62, s52, 0x40004
 s_lshl_b32 s62, s62, 15
 s_add_u32 s62, s62, s57
 v_mfma_f32_16x16x32_bf16 v[124:127], v[68:71], v[76:79], v[124:127]
 ds_read_b64_tr_b16 v[30:31], v7 offset:36864
 buffer_load_dwordx4 v0, s[8:11], s62 offen offset:0 sc1 lds
 v_mfma_f32_16x16x32_bf16 v[120:123], v[64:67], v[76:79], v[120:123]
 ds_read_b128 v[44:47], v2 offset:1024
 v_mfma_f32_16x16x32_bf16 v[116:119], v[60:63], v[76:79], v[116:119]
 ds_read_b64_tr_b16 v[32:33], v8 offset:32768
 v_mfma_f32_16x16x32_bf16 v[112:115], v[56:59], v[76:79], v[112:115]
 ds_read_b64_tr_b16 v[34:35], v8 offset:36864
 v_mfma_f32_16x16x32_bf16 v[128:131], v[56:59], v[80:83], v[128:131]
 ds_read_b128 v[48:51], v3 offset:0
 v_mfma_f32_16x16x32_bf16 v[132:135], v[60:63], v[80:83], v[132:135]
 ds_read_b64_tr_b16 v[36:37], v9 offset:32768
 buffer_load_dwordx4 v0, s[8:11], s62 offen offset:1024 sc1 lds
 v_mfma_f32_16x16x32_bf16 v[136:139], v[64:67], v[80:83], v[136:139]
 ds_read_b64_tr_b16 v[38:39], v9 offset:36864
 v_mfma_f32_16x16x32_bf16 v[140:143], v[68:71], v[80:83], v[140:143]
 ds_read_b128 v[52:55], v3 offset:1024
 v_mfma_f32_16x16x32_bf16 v[156:159], v[68:71], v[84:87], v[156:159]
 s_add_u32 m0, s51, 24576
 s_bfe_u32 s63, s52, 0x40004
 s_lshl_b32 s63, s63, 17
 s_add_u32 s63, s63, s58
 v_mfma_f32_16x16x32_bf16 v[152:155], v[64:67], v[84:87], v[152:155]
 buffer_load_dwordx4 v11, s[20:23], s63 offen lds
 v_mfma_f32_16x16x32_bf16 v[148:151], v[60:63], v[84:87], v[148:151]
 v_mfma_f32_16x16x32_bf16 v[144:147], v[56:59], v[84:87], v[144:147]
 s_waitcnt lgkmcnt(0)
 s_and_b64 s[72:73], s[72:73], s[74:75]
 s_and_b64 s[76:77], s[76:77], s[78:79]
 s_and_b64 s[72:73], s[72:73], s[76:77]
 s_and_b32 s72, s72, s73
 s_cmp_eq_u32 s72, 0x1010101
 s_cbranch_scc0 Lsp_171
Lok_172:
 s_waitcnt vmcnt(11) lgkmcnt(0)
 s_barrier
 v_mfma_f32_16x16x32_bf16 v[96:99], v[24:27], v[40:43], v[96:99]
 ds_read_b128 v[72:75], v2 offset:16384
 v_mfma_f32_16x16x32_bf16 v[100:103], v[28:31], v[40:43], v[100:103]
 ds_read_b64_tr_b16 v[56:57], v6 offset:40960
 v_mfma_f32_16x16x32_bf16 v[104:107], v[32:35], v[40:43], v[104:107]
 ds_read_b64_tr_b16 v[58:59], v6 offset:45056
 v_mfma_f32_16x16x32_bf16 v[108:111], v[36:39], v[40:43], v[108:111]
 ds_read_b64_tr_b16 v[60:61], v7 offset:40960
 s_add_u32 m0, s50, 0
 s_bfe_u32 s62, s52, 0x40008
 s_lshl_b32 s62, s62, 15
 s_add_u32 s62, s62, s57
 v_mfma_f32_16x16x32_bf16 v[124:127], v[36:39], v[44:47], v[124:127]
 ds_read_b64_tr_b16 v[62:63], v7 offset:45056
 buffer_load_dwordx4 v0, s[8:11], s62 offen offset:0 sc1 lds
 v_mfma_f32_16x16x32_bf16 v[120:123], v[32:35], v[44:47], v[120:123]
 ds_read_b128 v[76:79], v2 offset:17408
 v_mfma_f32_16x16x32_bf16 v[116:119], v[28:31], v[44:47], v[116:119]
 ds_read_b64_tr_b16 v[64:65], v8 offset:40960
 v_mfma_f32_16x16x32_bf16 v[112:115], v[24:27], v[44:47], v[112:115]
 ds_read_b64_tr_b16 v[66:67], v8 offset:45056
 v_mfma_f32_16x16x32_bf16 v[128:131], v[24:27], v[48:51], v[128:131]
 ds_read_b128 v[80:83], v3 offset:16384
 v_mfma_f32_16x16x32_bf16 v[132:135], v[28:31], v[48:51], v[132:135]
 ds_read_b64_tr_b16 v[68:69], v9 offset:40960
 buffer_load_dwordx4 v0, s[8:11], s62 offen offset:1024 sc1 lds
 v_mfma_f32_16x16x32_bf16 v[136:139], v[32:35], v[48:51], v[136:139]
 ds_read_b64_tr_b16 v[70:71], v9 offset:45056
 v_mfma_f32_16x16x32_bf16 v[140:143], v[36:39], v[48:51], v[140:143]
 ds_read_b128 v[84:87], v3 offset:17408
 v_mfma_f32_16x16x32_bf16 v[156:159], v[36:39], v[52:55], v[156:159]
 s_add_u32 m0, s51, 32768
 s_bfe_u32 s63, s52, 0x40008
 s_lshl_b32 s63, s63, 17
 s_add_u32 s63, s63, s58
 v_mfma_f32_16x16x32_bf16 v[152:155], v[32:35], v[52:55], v[152:155]
 buffer_load_dwordx4 v11, s[20:23], s63 offen lds
 v_mfma_f32_16x16x32_bf16 v[148:151], v[28:31], v[52:55], v[148:151]
 v_mfma_f32_16x16x32_bf16 v[144:147], v[24:27], v[52:55], v[144:147]
 s_waitcnt vmcnt(12) lgkmcnt(0)
 s_barrier
 v_mfma_f32_16x16x32_bf16 v[96:99], v[56:59], v[72:75], v[96:99]
 ds_read_b128 v[40:43], v2 offset:32768
 v_mfma_f32_16x16x32_bf16 v[100:103], v[60:63], v[72:75], v[100:103]
 ds_read_b64_tr_b16 v[24:25], v6 offset:0
 v_mfma_f32_16x16x32_bf16 v[104:107], v[64:67], v[72:75], v[104:107]
 ds_read_b64_tr_b16 v[26:27], v6 offset:4096
 v_mfma_f32_16x16x32_bf16 v[108:111], v[68:71], v[72:75], v[108:111]
 ds_read_b64_tr_b16 v[28:29], v7 offset:0
 s_add_u32 m0, s50, 16384
 s_bfe_u32 s62, s52, 0x4000c
 s_lshl_b32 s62, s62, 15
 s_add_u32 s62, s62, s57
 v_mfma_f32_16x16x32_bf16 v[124:127], v[68:71], v[76:79], v[124:127]
 ds_read_b64_tr_b16 v[30:31], v7 offset:4096
 buffer_load_dwordx4 v0, s[8:11], s62 offen offset:0 sc1 lds
 v_mfma_f32_16x16x32_bf16 v[120:123], v[64:67], v[76:79], v[120:123]
 ds_read_b128 v[44:47], v2 offset:33792
 v_mfma_f32_16x16x32_bf16 v[116:119], v[60:63], v[76:79], v[116:119]
 ds_read_b64_tr_b16 v[32:33], v8 offset:0
 v_mfma_f32_16x16x32_bf16 v[112:115], v[56:59], v[76:79], v[112:115]
 ds_read_b64_tr_b16 v[34:35], v8 offset:4096
 v_mfma_f32_16x16x32_bf16 v[128:131], v[56:59], v[80:83], v[128:131]
 ds_read_b128 v[48:51], v3 offset:32768
 v_mfma_f32_16x16x32_bf16 v[132:135], v[60:63], v[80:83], v[132:135]
 ds_read_b64_tr_b16 v[36:37], v9 offset:0
 buffer_load_dwordx4 v0, s[8:11], s62 offen offset:1024 sc1 lds
 v_mfma_f32_16x16x32_bf16 v[136:139], v[64:67], v[80:83], v[136:139]
 ds_read_b64_tr_b16 v[38:39], v9 offset:4096
 v_mfma_f32_16x16x32_bf16 v[140:143], v[68:71], v[80:83], v[140:143]
 ds_read_b128 v[52:55], v3 offset:33792
 v_mfma_f32_16x16x32_bf16 v[156:159], v[68:71], v[84:87], v[156:159]
 s_add_u32 m0, s51, 40960
 s_bfe_u32 s63, s52, 0x4000c
 s_lshl_b32 s63, s63, 17
 s_add_u32 s63, s63, s58
 v_mfma_f32_16x16x32_bf16 v[152:155], v[64:67], v[84:87], v[152:155]
 buffer_load_dwordx4 v11, s[20:23], s63 offen lds
 v_mfma_f32_16x16x32_bf16 v[148:151], v[60:63], v[84:87], v[148:151]
 v_mfma_f32_16x16x32_bf16 v[144:147], v[56:59], v[84:87], v[144:147]
 s_waitcnt vmcnt(12) lgkmcnt(0)
 s_barrier
 v_mfma_f32_16x16x32_bf16 v[96:99], v[24:27], v[40:43], v[96:99]
 ds_read_b128 v[72:75], v2 offset:49152
 v_mfma_f32_16x16x32_bf16 v[100:103], v[28:31], v[40:43], v[100:103]
 ds_read_b64_tr_b16 v[56:57], v6 offset:8192
 v_mfma_f32_16x16x32_bf16 v[104:107], v[32:35], v[40:43], v[104:107]
 ds_read_b64_tr_b16 v[58:59], v6 offset:12288
 v_mfma_f32_16x16x32_bf16 v[108:111], v[36:39], v[40:43], v[108:111]
 ds_read_b64_tr_b16 v[60:61], v7 offset:8192
 s_add_u32 m0, s50, 32768
 s_bfe_u32 s62, s52, 0x40010
 s_lshl_b32 s62, s62, 15
 s_add_u32 s62, s62, s57
 v_mfma_f32_16x16x32_bf16 v[124:127], v[36:39], v[44:47], v[124:127]
 ds_read_b64_tr_b16 v[62:63], v7 offset:12288
 buffer_load_dwordx4 v0, s[8:11], s62 offen offset:0 sc1 lds
 v_mfma_f32_16x16x32_bf16 v[120:123], v[32:35], v[44:47], v[120:123]
 ds_read_b128 v[76:79], v2 offset:50176
 v_mfma_f32_16x16x32_bf16 v[116:119], v[28:31], v[44:47], v[116:119]
 ds_read_b64_tr_b16 v[64:65], v8 offset:8192
 v_mfma_f32_16x16x32_bf16 v[112:115], v[24:27], v[44:47], v[112:115]
 ds_read_b64_tr_b16 v[66:67], v8 offset:12288
 v_mfma_f32_16x16x32_bf16 v[128:131], v[24:27], v[48:51], v[128:131]
 ds_read_b128 v[80:83], v3 offset:49152
 v_mfma_f32_16x16x32_bf16 v[132:135], v[28:31], v[48:51], v[132:135]
 ds_read_b64_tr_b16 v[68:69], v9 offset:8192
 buffer_load_dwordx4 v0, s[8:11], s62 offen offset:1024 sc1 lds
 v_mfma_f32_16x16x32_bf16 v[136:139], v[32:35], v[48:51], v[136:139]
 ds_read_b64_tr_b16 v[70:71], v9 offset:12288
 v_mfma_f32_16x16x32_bf16 v[140:143], v[36:39], v[48:51], v[140:143]
 ds_read_b128 v[84:87], v3 offset:50176
 v_mfma_f32_16x16x32_bf16 v[156:159], v[36:39], v[52:55], v[156:159]
 s_add_u32 m0, s51, 0
 s_bfe_u32 s63, s52, 0x40010
 s_lshl_b32 s63, s63, 17
 s_add_u32 s63, s63, s58
 v_mfma_f32_16x16x32_bf16 v[152:155], v[32:35], v[52:55], v[152:155]
 buffer_load_dwordx4 v11, s[20:23], s63 offen lds
 v_mfma_f32_16x16x32_bf16 v[148:151], v[28:31], v[52:55], v[148:151]
 v_mfma_f32_16x16x32_bf16 v[144:147], v[24:27], v[52:55], v[144:147]
 s_waitcnt vmcnt(12) lgkmcnt(0)
 s_barrier
 v_mfma_f32_16x16x32_bf16 v[96:99], v[56:59], v[72:75], v[96:99]
 ds_read_b128 v[40:43], v17 offset:0
 v_mfma_f32_16x16x32_bf16 v[100:103], v[60:63], v[72:75], v[100:103]
 ds_read_b64_tr_b16 v[24:25], v6 offset:16384
 v_mfma_f32_16x16x32_bf16 v[104:107], v[64:67], v[72:75], v[104:107]
 ds_read_b64_tr_b16 v[26:27], v6 offset:20480
 v_mfma_f32_16x16x32_bf16 v[108:111], v[68:71], v[72:75], v[108:111]
 ds_read_b64_tr_b16 v[28:29], v7 offset:16384
 s_add_u32 m0, s50, 49152
 s_bfe_u32 s62, s52, 0x40014
 s_lshl_b32 s62, s62, 15
 s_add_u32 s62, s62, s57
 v_mfma_f32_16x16x32_bf16 v[124:127], v[68:71], v[76:79], v[124:127]
 ds_read_b64_tr_b16 v[30:31], v7 offset:20480
 buffer_load_dwordx4 v0, s[8:11], s62 offen offset:0 sc1 lds
 v_mfma_f32_16x16x32_bf16 v[120:123], v[64:67], v[76:79], v[120:123]
 ds_read_b128 v[44:47], v17 offset:1024
 v_mfma_f32_16x16x32_bf16 v[116:119], v[60:63], v[76:79], v[116:119]
 ds_read_b64_tr_b16 v[32:33], v8 offset:16384
 v_mfma_f32_16x16x32_bf16 v[112:115], v[56:59], v[76:79], v[112:115]
 ds_read_b64_tr_b16 v[34:35], v8 offset:20480
 v_mfma_f32_16x16x32_bf16 v[128:131], v[56:59], v[80:83], v[128:131]
 ds_read_b128 v[48:51], v17 offset:8192
 v_mfma_f32_16x16x32_bf16 v[132:135], v[60:63], v[80:83], v[132:135]
 ds_read_b64_tr_b16 v[36:37], v9 offset:16384
 buffer_load_dwordx4 v0, s[8:11], s62 offen offset:1024 sc1 lds
 v_mfma_f32_16x16x32_bf16 v[136:139], v[64:67], v[80:83], v[136:139]
 ds_read_b64_tr_b16 v[38:39], v9 offset:20480
 v_mfma_f32_16x16x32_bf16 v[140:143], v[68:71], v[80:83], v[140:143]
 ds_read_b128 v[52:55], v17 offset:9216
 v_mfma_f32_16x16x32_bf16 v[156:159], v[68:71], v[84:87], v[156:159]
 s_add_u32 m0, s51, 8192
 s_bfe_u32 s63, s52, 0x40014
 s_lshl_b32 s63, s63, 17
 s_add_u32 s63, s63, s58
 v_mfma_f32_16x16x32_bf16 v[152:155], v[64:67], v[84:87], v[152:155]
 buffer_load_dwordx4 v11, s[20:23], s63 offen lds
 v_mfma_f32_16x16x32_bf16 v[148:151], v[60:63], v[84:87], v[148:151]
 v_mfma_f32_16x16x32_bf16 v[144:147], v[56:59], v[84:87], v[144:147]
 s_waitcnt vmcnt(12) lgkmcnt(0)
 s_barrier
 v_mfma_f32_16x16x32_bf16 v[96:99], v[24:27], v[40:43], v[96:99]
 ds_read_b128 v[72:75], v17 offset:16384
 ds_read_b64_tr_b16 v[56:57], v6 offset:24576
 v_cvt_pk_bf16_f32 v104, v104, v105
 v_cvt_pk_bf16_f32 v105, v106, v107
 v_cvt_pk_bf16_f32 v106, v108, v109
 v_cvt_pk_bf16_f32 v107, v110, v111
 s_xor_b32 s85, s4, 1
 s_mul_i32 s85, s85, 49152
 s_add_u32 s85, s85, s60
 v_mfma_f32_16x16x32_bf16 v[100:103], v[28:31], v[40:43], v[100:103]
 ds_read_b64_tr_b16 v[58:59], v6 offset:28672
 ds_read_b64_tr_b16 v[60:61], v7 offset:24576
 buffer_store_dwordx4 v[104:107], v13, s[8:11], s85 offen offset:0 sc1
 v_cvt_pk_bf16_f32 v120, v120, v121
 v_cvt_pk_bf16_f32 v121, v122, v123
 v_cvt_pk_bf16_f32 v122, v124, v125
 v_cvt_pk_bf16_f32 v123, v126, v127
 s_xor_b32 s85, s4, 1
 v_mfma_f32_16x16x32_bf16 v[116:119], v[28:31], v[44:47], v[116:119]
 ds_read_b64_tr_b16 v[62:63], v7 offset:28672
 ds_read_b128 v[76:79], v17 offset:17408
 s_mul_i32 s85, s85, 49152
 s_add_u32 s85, s85, s60
 buffer_store_dwordx4 v[120:123], v13, s[8:11], s85 offen offset:1024 sc1
 v_cvt_pk_bf16_f32 v128, v128, v129
 v_cvt_pk_bf16_f32 v129, v130, v131
 v_cvt_pk_bf16_f32 v130, v132, v133
 v_cvt_pk_bf16_f32 v131, v134, v135
 v_mfma_f32_16x16x32_bf16 v[112:115], v[24:27], v[44:47], v[112:115]
 ds_read_b64_tr_b16 v[64:65], v8 offset:24576
 ds_read_b64_tr_b16 v[66:67], v8 offset:28672
 s_xor_b32 s85, s4, 2
 s_mul_i32 s85, s85, 49152
 s_add_u32 s85, s85, s60
 s_add_u32 s85, s85, 16384
 buffer_store_dwordx4 v[128:131], v13, s[8:11], s85 offen offset:0 sc1
 v_cvt_pk_bf16_f32 v144, v144, v145
 v_mfma_f32_16x16x32_bf16 v[96:99], v[32:35], v[48:51], v[96:99]
 ds_read_b128 v[80:83], v17 offset:24576
 ds_read_b64_tr_b16 v[68:69], v9 offset:24576
 v_cvt_pk_bf16_f32 v145, v146, v147
 v_cvt_pk_bf16_f32 v146, v148, v149
 v_cvt_pk_bf16_f32 v147, v150, v151
 s_xor_b32 s85, s4, 2
 s_mul_i32 s85, s85, 49152
 s_add_u32 s85, s85, s60
 s_add_u32 s85, s85, 16384
 v_mfma_f32_16x16x32_bf16 v[100:103], v[36:39], v[48:51], v[100:103]
 ds_read_b64_tr_b16 v[70:71], v9 offset:28672
 ds_read_b128 v[84:87], v17 offset:25600
 buffer_store_dwordx4 v[144:147], v13, s[8:11], s85 offen offset:1024 sc1
 v_cvt_pk_bf16_f32 v136, v136, v137
 v_cvt_pk_bf16_f32 v137, v138, v139
 v_cvt_pk_bf16_f32 v138, v140, v141
 v_cvt_pk_bf16_f32 v139, v142, v143
 s_xor_b32 s85, s4, 3
 v_mfma_f32_16x16x32_bf16 v[116:119], v[36:39], v[52:55], v[116:119]
 s_mul_i32 s85, s85, 49152
 s_add_u32 s85, s85, s60
 s_add_u32 s85, s85, 32768
 buffer_store_dwordx4 v[136:139], v13, s[8:11], s85 offen offset:0 sc1
 v_cvt_pk_bf16_f32 v152, v152, v153
 v_cvt_pk_bf16_f32 v153, v154, v155
 v_cvt_pk_bf16_f32 v154, v156, v157
 v_mfma_f32_16x16x32_bf16 v[112:115], v[32:35], v[52:55], v[112:115]
 v_cvt_pk_bf16_f32 v155, v158, v159
 s_xor_b32 s85, s4, 3
 s_mul_i32 s85, s85, 49152
 s_add_u32 s85, s85, s60
 s_add_u32 s85, s85, 32768
 buffer_store_dwordx4 v[152:155], v13, s[8:11], s85 offen offset:1024 sc1
 s_waitcnt vmcnt(6) lgkmcnt(0)
 s_barrier
 v_mfma_f32_16x16x32_bf16 v[96:99], v[56:59], v[72:75], v[96:99]
 ds_read_b128 v[40:43], v15 offset:0
 ds_read_b64_tr_b16 v[24:25], v6 offset:32768
 v_mfma_f32_16x16x32_bf16 v[100:103], v[60:63], v[72:75], v[100:103]
 ds_read_b64_tr_b16 v[26:27], v6 offset:36864
 ds_read_b64_tr_b16 v[28:29], v7 offset:32768
 v_mfma_f32_16x16x32_bf16 v[116:119], v[60:63], v[76:79], v[116:119]
 ds_read_b64_tr_b16 v[30:31], v7 offset:36864
 ds_read_b128 v[44:47], v15 offset:1024
 v_mfma_f32_16x16x32_bf16 v[112:115], v[56:59], v[76:79], v[112:115]
 ds_read_b64_tr_b16 v[32:33], v8 offset:32768
 ds_read_b64_tr_b16 v[34:35], v8 offset:36864
 v_mfma_f32_16x16x32_bf16 v[96:99], v[64:67], v[80:83], v[96:99]
 ds_read_b128 v[48:51], v15 offset:8192
 ds_read_b64_tr_b16 v[36:37], v9 offset:32768
 v_mfma_f32_16x16x32_bf16 v[100:103], v[68:71], v[80:83], v[100:103]
 ds_read_b64_tr_b16 v[38:39], v9 offset:36864
 ds_read_b128 v[52:55], v15 offset:9216
 v_mfma_f32_16x16x32_bf16 v[116:119], v[68:71], v[84:87], v[116:119]
 v_mfma_f32_16x16x32_bf16 v[112:115], v[64:67], v[84:87], v[112:115]
 s_waitcnt lgkmcnt(0)
 v_mfma_f32_16x16x32_bf16 v[96:99], v[24:27], v[40:43], v[96:99]
 ds_read_b128 v[72:75], v15 offset:16384
 ds_read_b64_tr_b16 v[56:57], v6 offset:40960
 s_xor_b32 s92, s71, 1024
 v_mov_b32 v91, 1
 v_mfma_f32_16x16x32_bf16 v[100:103], v[28:31], v[40:43], v[100:103]
 ds_read_b64_tr_b16 v[58:59], v6 offset:45056
 ds_read_b64_tr_b16 v[60:61], v7 offset:40960
 s_waitcnt vmcnt(4)
 v_mfma_f32_16x16x32_bf16 v[116:119], v[28:31], v[44:47], v[116:119]
 ds_read_b64_tr_b16 v[62:63], v7 offset:45056
 ds_read_b128 v[76:79], v15 offset:17408
 buffer_store_byte v91, off, s[8:11], s92 sc1
 s_xor_b32 s92, s71, 2048
 v_mfma_f32_16x16x32_bf16 v[112:115], v[24:27], v[44:47], v[112:115]
 ds_read_b64_tr_b16 v[64:65], v8 offset:40960
 ds_read_b64_tr_b16 v[66:67], v8 offset:45056
 v_mov_b32 v91, 1
 v_mfma_f32_16x16x32_bf16 v[96:99], v[32:35], v[48:51], v[96:99]
 ds_read_b128 v[80:83], v15 offset:24576
 ds_read_b64_tr_b16 v[68:69], v9 offset:40960
 s_waitcnt vmcnt(3)
 buffer_store_byte v91, off, s[8:11], s92 offset:1 sc1
 v_mfma_f32_16x16x32_bf16 v[100:103], v[36:39], v[48:51], v[100:103]
 ds_read_b64_tr_b16 v[70:71], v9 offset:45056
 ds_read_b128 v[84:87], v15 offset:25600
 s_xor_b32 s92, s71, 3072
 v_mfma_f32_16x16x32_bf16 v[116:119], v[36:39], v[52:55], v[116:119]
 v_mov_b32 v91, 1
 s_waitcnt vmcnt(2)
 v_mfma_f32_16x16x32_bf16 v[112:115], v[32:35], v[52:55], v[112:115]
 buffer_store_byte v91, off, s[8:11], s92 offset:2 sc1
 s_waitcnt lgkmcnt(0)
 v_mfma_f32_16x16x32_bf16 v[96:99], v[56:59], v[72:75], v[96:99]
 ds_read_b128 v[40:43], v15 offset:32768
 ds_read_b64_tr_b16 v[24:25], v6 offset:0
 v_mfma_f32_16x16x32_bf16 v[100:103], v[60:63], v[72:75], v[100:103]
 ds_read_b64_tr_b16 v[26:27], v6 offset:4096
 ds_read_b64_tr_b16 v[28:29], v7 offset:0
 v_mfma_f32_16x16x32_bf16 v[116:119], v[60:63], v[76:79], v[116:119]
 ds_read_b64_tr_b16 v[30:31], v7 offset:4096
 ds_read_b128 v[44:47], v15 offset:33792
 v_mfma_f32_16x16x32_bf16 v[112:115], v[56:59], v[76:79], v[112:115]
 ds_read_b64_tr_b16 v[32:33], v8 offset:0
 ds_read_b64_tr_b16 v[34:35], v8 offset:4096
 v_mfma_f32_16x16x32_bf16 v[96:99], v[64:67], v[80:83], v[96:99]
 ds_read_b128 v[48:51], v15 offset:40960
 ds_read_b64_tr_b16 v[36:37], v9 offset:0
 v_mfma_f32_16x16x32_bf16 v[100:103], v[68:71], v[80:83], v[100:103]
 ds_read_b64_tr_b16 v[38:39], v9 offset:4096
 ds_read_b128 v[52:55], v15 offset:41984
 v_mfma_f32_16x16x32_bf16 v[116:119], v[68:71], v[84:87], v[116:119]
 v_mfma_f32_16x16x32_bf16 v[112:115], v[64:67], v[84:87], v[112:115]
 s_waitcnt lgkmcnt(0)
 v_mfma_f32_16x16x32_bf16 v[96:99], v[24:27], v[40:43], v[96:99]
 ds_read_b128 v[72:75], v15 offset:49152
 ds_read_b64_tr_b16 v[56:57], v6 offset:8192
 v_mfma_f32_16x16x32_bf16 v[100:103], v[28:31], v[40:43], v[100:103]
 ds_read_b64_tr_b16 v[58:59], v6 offset:12288
 ds_read_b64_tr_b16 v[60:61], v7 offset:8192
 v_mfma_f32_16x16x32_bf16 v[116:119], v[28:31], v[44:47], v[116:119]
 ds_read_b64_tr_b16 v[62:63], v7 offset:12288
 ds_read_b128 v[76:79], v15 offset:50176
 v_mfma_f32_16x16x32_bf16 v[112:115], v[24:27], v[44:47], v[112:115]
 ds_read_b64_tr_b16 v[64:65], v8 offset:8192
 ds_read_b64_tr_b16 v[66:67], v8 offset:12288
 v_mfma_f32_16x16x32_bf16 v[96:99], v[32:35], v[48:51], v[96:99]
 ds_read_b128 v[80:83], v15 offset:57344
 ds_read_b64_tr_b16 v[68:69], v9 offset:8192
 v_mfma_f32_16x16x32_bf16 v[100:103], v[36:39], v[48:51], v[100:103]
 ds_read_b64_tr_b16 v[70:71], v9 offset:12288
 ds_read_b128 v[84:87], v15 offset:58368
 v_mfma_f32_16x16x32_bf16 v[116:119], v[36:39], v[52:55], v[116:119]
 v_mfma_f32_16x16x32_bf16 v[112:115], v[32:35], v[52:55], v[112:115]
 s_waitcnt lgkmcnt(0)
 v_mfma_f32_16x16x32_bf16 v[96:99], v[56:59], v[72:75], v[96:99]
 s_buffer_load_dword s72, s[8:11], s71 glc
 v_mfma_f32_16x16x32_bf16 v[100:103], v[60:63], v[72:75], v[100:103]
 v_mfma_f32_16x16x32_bf16 v[116:119], v[60:63], v[76:79], v[116:119]
 v_mfma_f32_16x16x32_bf16 v[112:115], v[56:59], v[76:79], v[112:115]
 v_mfma_f32_16x16x32_bf16 v[96:99], v[64:67], v[80:83], v[96:99]
 v_mfma_f32_16x16x32_bf16 v[100:103], v[68:71], v[80:83], v[100:103]
 v_mfma_f32_16x16x32_bf16 v[116:119], v[68:71], v[84:87], v[116:119]
 v_mfma_f32_16x16x32_bf16 v[112:115], v[64:67], v[84:87], v[112:115]
 s_waitcnt lgkmcnt(0)
 s_cmp_eq_u32 s72, 0x10101
 s_cbranch_scc0 Lsp_174
Lok_175:
 s_mul_i32 s85, s4, 49152
 s_add_u32 s85, s85, s60
 buffer_load_dwordx4 v[160:163], v13, s[8:11], s85 offen offset:0 sc1
 buffer_load_dwordx4 v[164:167], v13, s[8:11], s85 offen offset:1024 sc1
 s_mul_i32 s85, s4, 49152
 s_add_u32 s85, s85, s60
 s_add_u32 s85, s85, 16384
 buffer_load_dwordx4 v[168:171], v13, s[8:11], s85 offen offset:0 sc1
 buffer_load_dwordx4 v[172:175], v13, s[8:11], s85 offen offset:1024 sc1
 s_mul_i32 s85, s4, 49152
 s_add_u32 s85, s85, s60
 s_add_u32 s85, s85, 32768
 buffer_load_dwordx4 v[176:179], v13, s[8:11], s85 offen offset:0 sc1
 buffer_load_dwordx4 v[180:183], v13, s[8:11], s85 offen offset:1024 sc1
 s_waitcnt vmcnt(4)
 v_lshlrev_b32 v208, 16, v160
 v_and_b32 v209, s89, v160
 v_add_f32 v192, v192, v208
 v_add_f32 v193, v193, v209
 v_lshlrev_b32 v210, 16, v161
 v_and_b32 v211, s89, v161
 v_add_f32 v194, v194, v210
 v_add_f32 v195, v195, v211
 v_lshlrev_b32 v208, 16, v162
 v_and_b32 v209, s89, v162
 v_add_f32 v196, v196, v208
 v_add_f32 v197, v197, v209
 v_lshlrev_b32 v210, 16, v163
 v_and_b32 v211, s89, v163
 v_add_f32 v198, v198, v210
 v_add_f32 v199, v199, v211
 v_lshlrev_b32 v208, 16, v164
 v_and_b32 v209, s89, v164
 v_add_f32 v200, v200, v208
 v_add_f32 v201, v201, v209
 v_lshlrev_b32 v210, 16, v165
 v_and_b32 v211, s89, v165
 v_add_f32 v202, v202, v210
 v_add_f32 v203, v203, v211
 v_lshlrev_b32 v208, 16, v166
 v_and_b32 v209, s89, v166
 v_add_f32 v204, v204, v208
 v_add_f32 v205, v205, v209
 v_lshlrev_b32 v210, 16, v167
 v_and_b32 v211, s89, v167
 v_add_f32 v206, v206, v210
 v_add_f32 v207, v207, v211
 s_waitcnt vmcnt(2)
 v_lshlrev_b32 v208, 16, v168
 v_and_b32 v209, s89, v168
 v_add_f32 v192, v192, v208
 v_add_f32 v193, v193, v209
 v_lshlrev_b32 v210, 16, v169
 v_and_b32 v211, s89, v169
 v_add_f32 v194, v194, v210
 v_add_f32 v195, v195, v211
 v_lshlrev_b32 v208, 16, v170
 v_and_b32 v209, s89, v170
 v_add_f32 v196, v196, v208
 v_add_f32 v197, v197, v209
 v_lshlrev_b32 v210, 16, v171
 v_and_b32 v211, s89, v171
 v_add_f32 v198, v198, v210
 v_add_f32 v199, v199, v211
 v_lshlrev_b32 v208, 16, v172
 v_and_b32 v209, s89, v172
 v_add_f32 v200, v200, v208
 v_add_f32 v201, v201, v209
 v_lshlrev_b32 v210, 16, v173
 v_and_b32 v211, s89, v173
 v_add_f32 v202, v202, v210
 v_add_f32 v203, v203, v211
 v_lshlrev_b32 v208, 16, v174
 v_and_b32 v209, s89, v174
 v_add_f32 v204, v204, v208
 v_add_f32 v205, v205, v209
 v_lshlrev_b32 v210, 16, v175
 v_and_b32 v211, s89, v175
 v_add_f32 v206, v206, v210
 v_add_f32 v207, v207, v211
 s_waitcnt vmcnt(0)
 v_lshlrev_b32 v208, 16, v176
 v_and_b32 v209, s89, v176
 v_add_f32 v192, v192, v208
 v_add_f32 v193, v193, v209
 v_lshlrev_b32 v210, 16, v177
 v_and_b32 v211, s89, v177
 v_add_f32 v194, v194, v210
 v_add_f32 v195, v195, v211
 v_lshlrev_b32 v208, 16, v178
 v_and_b32 v209, s89, v178
 v_add_f32 v196, v196, v208
 v_add_f32 v197, v197, v209
 v_lshlrev_b32 v210, 16, v179
 v_and_b32 v211, s89, v179
 v_add_f32 v198, v198, v210
 v_add_f32 v199, v199, v211
 v_lshlrev_b32 v208, 16, v180
 v_and_b32 v209, s89, v180
 v_add_f32 v200, v200, v208
 v_add_f32 v201, v201, v209
 v_lshlrev_b32 v210, 16, v181
 v_and_b32 v211, s89, v181
 v_add_f32 v202, v202, v210
 v_add_f32 v203, v203, v211
 v_lshlrev_b32 v208, 16, v182
 v_and_b32 v209, s89, v182
 v_add_f32 v204, v204, v208
 v_add_f32 v205, v205, v209
 v_lshlrev_b32 v210, 16, v183
 v_and_b32 v211, s89, v183
 v_add_f32 v206, v206, v210
 v_add_f32 v207, v207, v211
 v_add_f32 v96, v96, v192
 v_add_f32 v97, v97, v193
 v_add_f32 v98, v98, v194
 v_add_f32 v99, v99, v195
 v_add_f32 v100, v100, v196
 v_add_f32 v101, v101, v197
 v_add_f32 v102, v102, v198
 v_add_f32 v103, v103, v199
 v_cvt_pk_bf16_f32 v96, v96, v97
 v_cvt_pk_bf16_f32 v97, v98, v99
 v_cvt_pk_bf16_f32 v98, v100, v101
 v_cvt_pk_bf16_f32 v99, v102, v103
 s_nop 0
 v_permlane16_swap_b32 v96, v98
 v_permlane16_swap_b32 v97, v99
 buffer_store_dwordx4 v[96:99], v94, s[28:31], s61 offen
 v_add_f32 v112, v112, v200
 v_add_f32 v113, v113, v201
 v_add_f32 v114, v114, v202
 v_add_f32 v115, v115, v203
 v_add_f32 v116, v116, v204
 v_add_f32 v117, v117, v205
 v_add_f32 v118, v118, v206
 v_add_f32 v119, v119, v207
 v_cvt_pk_bf16_f32 v112, v112, v113
 v_cvt_pk_bf16_f32 v113, v114, v115
 v_cvt_pk_bf16_f32 v114, v116, v117
 v_cvt_pk_bf16_f32 v115, v118, v119
 s_nop 0
 v_permlane16_swap_b32 v112, v114
 v_permlane16_swap_b32 v113, v115
 buffer_store_dwordx4 v[112:115], v94, s[28:31], s66 offen
L3_end:
L_end:
 s_endpgm
Lcs_2:
 s_bitcmp1_b32 s7, 0
 s_cbranch_scc1 Lcs_3
 v_smfmac_f32_16x16x64_bf16 v[16:19], v[12:15], v[24:31], v20
 s_branch Lcb_1
Lcs_3:
 v_smfmac_f32_16x16x64_bf16 v[16:19], v[12:15], v[32:39], v20
 s_branch Lcb_1
Lcs_5:
 s_bitcmp1_b32 s7, 0
 s_cbranch_scc1 Lcs_6
 v_smfmac_f32_16x16x64_bf16 v[16:19], v[12:15], v[48:55], v20
 v_mov_b32_dpp v12, v12 row_ror:4 row_mask:0xf bank_mask:0xf
 v_mov_b32_dpp v13, v13 row_ror:4 row_mask:0xf bank_mask:0xf
 v_mov_b32_dpp v14, v14 row_ror:4 row_mask:0xf bank_mask:0xf
 v_mov_b32_dpp v15, v15 row_ror:4 row_mask:0xf bank_mask:0xf
 s_nop 1
 v_smfmac_f32_16x16x64_bf16 v[16:19], v[12:15], v[40:47], v20
 s_branch Lcb_4
Lcs_6:
 v_smfmac_f32_16x16x64_bf16 v[16:19], v[12:15], v[56:63], v20
 s_branch Lcb_4
Lcs_8:
 s_bitcmp1_b32 s7, 0
 s_cbranch_scc1 Lcs_9
 v_smfmac_f32_16x16x64_bf16 v[16:19], v[12:15], v[24:31], v20
 s_branch Lcb_7
Lcs_9:
 v_smfmac_f32_16x16x64_bf16 v[16:19], v[12:15], v[32:39], v20
 s_branch Lcb_7
Lcs_11:
 s_bitcmp1_b32 s7, 0
 s_cbranch_scc1 Lcs_12
 v_smfmac_f32_16x16x64_bf16 v[16:19], v[12:15], v[40:47], v20
 v_mov_b32_dpp v12, v12 row_ror:12 row_mask:0xf bank_mask:0xf
 v_mov_b32_dpp v13, v13 row_ror:12 row_mask:0xf bank_mask:0xf
 v_mov_b32_dpp v14, v14 row_ror:12 row_mask:0xf bank_mask:0xf
 v_mov_b32_dpp v15, v15 row_ror:12 row_mask:0xf bank_mask:0xf
 s_nop 1
 v_smfmac_f32_16x16x64_bf16 v[16:19], v[12:15], v[48:55], v20
 s_branch Lcb_10
Lcs_12:
 v_smfmac_f32_16x16x64_bf16 v[16:19], v[12:15], v[56:63], v20
 s_branch Lcb_10
Lcs_14:
 s_bitcmp1_b32 s7, 0
 s_cbranch_scc1 Lcs_15
 v_smfmac_f32_16x16x64_bf16 v[16:19], v[12:15], v[24:31], v20
 s_branch Lcb_13
Lcs_15:
 v_smfmac_f32_16x16x64_bf16 v[16:19], v[12:15], v[32:39], v20
 s_branch Lcb_13
Lcs_17:
 s_bitcmp1_b32 s7, 0
 s_cbranch_scc1 Lcs_18
 v_smfmac_f32_16x16x64_bf16 v[16:19], v[12:15], v[48:55], v20
 v_mov_b32_dpp v12, v12 row_ror:4 row_mask:0xf bank_mask:0xf
 v_mov_b32_dpp v13, v13 row_ror:4 row_mask:0xf bank_mask:0xf
 v_mov_b32_dpp v14, v14 row_ror:4 row_mask:0xf bank_mask:0xf
 v_mov_b32_dpp v15, v15 row_ror:4 row_mask:0xf bank_mask:0xf
 s_nop 1
 v_smfmac_f32_16x16x64_bf16 v[16:19], v[12:15], v[40:47], v20
 s_branch Lcb_16
Lcs_18:
 v_smfmac_f32_16x16x64_bf16 v[16:19], v[12:15], v[56:63], v20
 s_branch Lcb_16
Lcs_20:
 s_bitcmp1_b32 s7, 0
 s_cbranch_scc1 Lcs_21
 v_smfmac_f32_16x16x64_bf16 v[16:19], v[12:15], v[24:31], v20
 s_branch Lcb_19
Lcs_21:
 v_smfmac_f32_16x16x64_bf16 v[16:19], v[12:15], v[32:39], v20
 s_branch Lcb_19
Lcs_23:
 s_bitcmp1_b32 s7, 0
 s_cbranch_scc1 Lcs_24
 v_smfmac_f32_16x16x64_bf16 v[16:19], v[12:15], v[40:47], v20
 v_mov_b32_dpp v12, v12 row_ror:12 row_mask:0xf bank_mask:0xf
 v_mov_b32_dpp v13, v13 row_ror:12 row_mask:0xf bank_mask:0xf
 v_mov_b32_dpp v14, v14 row_ror:12 row_mask:0xf bank_mask:0xf
 v_mov_b32_dpp v15, v15 row_ror:12 row_mask:0xf bank_mask:0xf
 s_nop 1
 v_smfmac_f32_16x16x64_bf16 v[16:19], v[12:15], v[48:55], v20
 s_branch Lcb_22
Lcs_24:
 v_smfmac_f32_16x16x64_bf16 v[16:19], v[12:15], v[56:63], v20
 s_branch Lcb_22
Lrp_25:
 v_add_f32 v16, v16, v17
 v_add_f32 v17, v18, v19
 s_lshl3_add_u32 s85, s82, s3
 s_lshl3_add_u32 s85, s85, s83
 s_lshl_b32 s85, s85, 8
 v_lshlrev_b32 v20, 3, v1
 s_mov_b32 exec_hi, 0
 buffer_store_dwordx2 v[16:17], v20, s[8:11], s85 offen sc1
 s_mov_b32 exec_hi, -1
 s_branch Lrq_26
Ldg_27:
 v_mov_b32 v22, 0
 s_and_b32 s85, s2, 3
 s_lshl_b32 s85, s85, 3
 s_lshl_b32 s85, 1, s85
 v_mov_b32 v21, s85
 s_andn2_b32 s85, s2, 3
 s_mov_b64 exec, 1
 buffer_atomic_or v21, v22, s[12:15], s85 offen sc1
 s_mov_b64 exec, -1
 s_branch Ldb_28
Lcs_30:
 s_bitcmp1_b32 s7, 0
 s_cbranch_scc1 Lcs_31
 v_smfmac_f32_16x16x64_bf16 v[16:19], v[12:15], v[24:31], v20
 s_branch Lcb_29
Lcs_31:
 v_smfmac_f32_16x16x64_bf16 v[16:19], v[12:15], v[32:39], v20
 s_branch Lcb_29
Lcs_33:
 s_bitcmp1_b32 s7, 0
 s_cbranch_scc1 Lcs_34
 v_smfmac_f32_16x16x64_bf16 v[16:19], v[12:15], v[48:55], v20
 v_mov_b32_dpp v12, v12 row_ror:4 row_mask:0xf bank_mask:0xf
 v_mov_b32_dpp v13, v13 row_ror:4 row_mask:0xf bank_mask:0xf
 v_mov_b32_dpp v14, v14 row_ror:4 row_mask:0xf bank_mask:0xf
 v_mov_b32_dpp v15, v15 row_ror:4 row_mask:0xf bank_mask:0xf
 s_nop 1
 v_smfmac_f32_16x16x64_bf16 v[16:19], v[12:15], v[40:47], v20
 s_branch Lcb_32
Lcs_34:
 v_smfmac_f32_16x16x64_bf16 v[16:19], v[12:15], v[56:63], v20
 s_branch Lcb_32
Ldg_35:
 v_mov_b32 v22, 0
 s_and_b32 s85, s2, 3
 s_lshl_b32 s85, s85, 3
 s_lshl_b32 s85, 1, s85
 v_mov_b32 v21, s85
 s_andn2_b32 s85, s2, 3
 s_mov_b64 exec, 1
 buffer_atomic_or v21, v22, s[12:15], s85 offen sc1
 s_mov_b64 exec, -1
 s_branch Ldb_36
Lcs_38:
 s_bitcmp1_b32 s7, 0
 s_cbranch_scc1 Lcs_39
 v_smfmac_f32_16x16x64_bf16 v[16:19], v[12:15], v[24:31], v20
 s_branch Lcb_37
Lcs_39:
 v_smfmac_f32_16x16x64_bf16 v[16:19], v[12:15], v[32:39], v20
 s_branch Lcb_37
Lcs_41:
 s_bitcmp1_b32 s7, 0
 s_cbranch_scc1 Lcs_42
 v_smfmac_f32_16x16x64_bf16 v[16:19], v[12:15], v[40:47], v20
 v_mov_b32_dpp v12, v12 row_ror:12 row_mask:0xf bank_mask:0xf
 v_mov_b32_dpp v13, v13 row_ror:12 row_mask:0xf bank_mask:0xf
 v_mov_b32_dpp v14, v14 row_ror:12 row_mask:0xf bank_mask:0xf
 v_mov_b32_dpp v15, v15 row_ror:12 row_mask:0xf bank_mask:0xf
 s_nop 1
 v_smfmac_f32_16x16x64_bf16 v[16:19], v[12:15], v[48:55], v20
 s_branch Lcb_40
Lcs_42:
 v_smfmac_f32_16x16x64_bf16 v[16:19], v[12:15], v[56:63], v20
 s_branch Lcb_40
Ldp_43:
 v_lshlrev_b32 v22, 2, v1
 buffer_load_dword v21, v22, s[12:15], 0 offen sc1
 s_branch Ldq_44
Ldg_45:
 v_mov_b32 v22, 0
 s_and_b32 s85, s2, 3
 s_lshl_b32 s85, s85, 3
 s_lshl_b32 s85, 1, s85
 v_mov_b32 v21, s85
 s_andn2_b32 s85, s2, 3
 s_mov_b64 exec, 1
 buffer_atomic_or v21, v22, s[12:15], s85 offen sc1
 s_mov_b64 exec, -1
 s_branch Ldb_46
Lcs_48:
 s_bitcmp1_b32 s7, 0
 s_cbranch_scc1 Lcs_49
 v_smfmac_f32_16x16x64_bf16 v[16:19], v[12:15], v[24:31], v20
 s_branch Lcb_47
Lcs_49:
 v_smfmac_f32_16x16x64_bf16 v[16:19], v[12:15], v[32:39], v20
 s_branch Lcb_47
Lcs_51:
 s_bitcmp1_b32 s7, 0
 s_cbranch_scc1 Lcs_52
 v_smfmac_f32_16x16x64_bf16 v[16:19], v[12:15], v[48:55], v20
 v_mov_b32_dpp v12, v12 row_ror:4 row_mask:0xf bank_mask:0xf
 v_mov_b32_dpp v13, v13 row_ror:4 row_mask:0xf bank_mask:0xf
 v_mov_b32_dpp v14, v14 row_ror:4 row_mask:0xf bank_mask:0xf
 v_mov_b32_dpp v15, v15 row_ror:4 row_mask:0xf bank_mask:0xf
 s_nop 1
 v_smfmac_f32_16x16x64_bf16 v[16:19], v[12:15], v[40:47], v20
 s_branch Lcb_50
Lcs_52:
 v_smfmac_f32_16x16x64_bf16 v[16:19], v[12:15], v[56:63], v20
 s_branch Lcb_50
Ldg_53:
 v_mov_b32 v22, 0
 s_and_b32 s85, s2, 3
 s_lshl_b32 s85, s85, 3
 s_lshl_b32 s85, 1, s85
 v_mov_b32 v21, s85
 s_andn2_b32 s85, s2, 3
 s_mov_b64 exec, 1
 buffer_atomic_or v21, v22, s[12:15], s85 offen sc1
 s_mov_b64 exec, -1
 s_branch Ldb_54
Lcs_56:
 s_bitcmp1_b32 s7, 0
 s_cbranch_scc1 Lcs_57
 v_smfmac_f32_16x16x64_bf16 v[16:19], v[12:15], v[24:31], v20
 s_branch Lcb_55
Lcs_57:
 v_smfmac_f32_16x16x64_bf16 v[16:19], v[12:15], v[32:39], v20
 s_branch Lcb_55
Lcs_59:
 s_bitcmp1_b32 s7, 0
 s_cbranch_scc1 Lcs_60
 v_smfmac_f32_16x16x64_bf16 v[16:19], v[12:15], v[40:47], v20
 v_mov_b32_dpp v12, v12 row_ror:12 row_mask:0xf bank_mask:0xf
 v_mov_b32_dpp v13, v13 row_ror:12 row_mask:0xf bank_mask:0xf
 v_mov_b32_dpp v14, v14 row_ror:12 row_mask:0xf bank_mask:0xf
 v_mov_b32_dpp v15, v15 row_ror:12 row_mask:0xf bank_mask:0xf
 s_nop 1
 v_smfmac_f32_16x16x64_bf16 v[16:19], v[12:15], v[48:55], v20
 s_branch Lcb_58
Lcs_60:
 v_smfmac_f32_16x16x64_bf16 v[16:19], v[12:15], v[56:63], v20
 s_branch Lcb_58
Lrp_61:
 v_add_f32 v16, v16, v17
 v_add_f32 v17, v18, v19
 s_lshl3_add_u32 s85, s82, s3
 s_lshl3_add_u32 s85, s85, s83
 s_lshl_b32 s85, s85, 8
 v_lshlrev_b32 v20, 3, v1
 s_mov_b32 exec_hi, 0
 buffer_store_dwordx2 v[16:17], v20, s[8:11], s85 offen sc1
 s_mov_b32 exec_hi, -1
 s_branch Lrq_62
Lsp_63:
 s_mov_b32 s95, 0
Llp_65:
 buffer_load_dword v21, v22, s[12:15], 0 offen sc1
 s_waitcnt vmcnt(0)
 s_add_u32 s95, s95, 1
 v_cmp_ne_u32 vcc, s85, v21
 s_cbranch_vccz Lok_64
 s_cmp_lt_u32 s95, 0x40000
 s_sleep 1
 s_cbranch_scc1 Llp_65
 s_branch Lok_64
Lsp_66:
 s_mov_b32 s95, 0
Llp_68:
 s_buffer_load_dwordx2 s[72:73], s[8:11], s64 glc
 s_waitcnt lgkmcnt(0)
 s_add_u32 s95, s95, 1
 s_and_b32 s72, s72, s73
 s_cmp_eq_u32 s72, 0x1010101
 s_cbranch_scc1 Lok_67
 s_cmp_lt_u32 s95, 0x40000
 s_cbranch_scc1 Llp_68
 s_branch Lok_67
Lsp_69:
 s_mov_b32 s95, 0
Llp_71:
 s_buffer_load_dwordx2 s[72:73], s[8:11], s64 glc
 s_waitcnt lgkmcnt(0)
 s_add_u32 s95, s95, 1
 s_and_b32 s72, s72, s73
 s_cmp_eq_u32 s72, 0x1010101
 s_cbranch_scc1 Lok_70
 s_cmp_lt_u32 s95, 0x40000
 s_cbranch_scc1 Llp_71
 s_branch Lok_70
Lsp_72:
 s_mov_b32 s95, 0
Llp_74:
 s_buffer_load_dwordx8 s[72:79], s[8:11], s64 glc
 s_waitcnt lgkmcnt(0)
 s_add_u32 s95, s95, 1
 s_and_b64 s[96:97], s[72:73], s[74:75]
 s_and_b64 s[80:81], s[76:77], s[78:79]
 s_and_b64 s[96:97], s[96:97], s[80:81]
 s_bitcmp1_b32 s2, 0
 s_cselect_b32 s96, s97, s96
 s_bitcmp1_b32 s96, 0
 s_cbranch_scc1 Lok_73
 s_cmp_lt_u32 s95, 0x40000
 s_cbranch_scc1 Llp_74
 s_branch Lok_73
Lsp_75:
 s_mov_b32 s95, 0
Llp_77:
 s_buffer_load_dwordx2 s[72:73], s[8:11], s64 glc
 s_waitcnt lgkmcnt(0)
 s_add_u32 s95, s95, 1
 s_and_b32 s72, s72, s73
 s_cmp_eq_u32 s72, 0x1010101
 s_cbranch_scc1 Lok_76
 s_cmp_lt_u32 s95, 0x40000
 s_cbranch_scc1 Llp_77
 s_branch Lok_76
Lsp_78:
 s_mov_b32 s95, 0
Llp_80:
 s_buffer_load_dword s72, s[8:11], s71 glc
 s_waitcnt lgkmcnt(0)
 s_add_u32 s95, s95, 1
 s_cmp_eq_u32 s72, 0x10101
 s_cbranch_scc1 Lok_79
 s_cmp_lt_u32 s95, 0x40000
 s_cbranch_scc1 Llp_80
 s_branch Lok_79
Lcs_106:
 s_bitcmp1_b32 s7, 0
 s_cbranch_scc1 Lcs_107
 v_smfmac_f32_16x16x64_bf16 v[16:19], v[12:15], v[24:31], v20
 s_branch Lcb_105
Lcs_107:
 v_smfmac_f32_16x16x64_bf16 v[16:19], v[12:15], v[32:39], v20
 s_branch Lcb_105
Lcs_109:
 s_bitcmp1_b32 s7, 0
 s_cbranch_scc1 Lcs_110
 v_smfmac_f32_16x16x64_bf16 v[16:19], v[12:15], v[48:55], v20
 s_branch Lcb_108
Lcs_110:
 v_smfmac_f32_16x16x64_bf16 v[16:19], v[12:15], v[56:63], v20
 v_mov_b32_dpp v12, v12 row_ror:4 row_mask:0xf bank_mask:0xf
 v_mov_b32_dpp v13, v13 row_ror:4 row_mask:0xf bank_mask:0xf
 v_mov_b32_dpp v14, v14 row_ror:4 row_mask:0xf bank_mask:0xf
 v_mov_b32_dpp v15, v15 row_ror:4 row_mask:0xf bank_mask:0xf
 s_nop 1
 v_smfmac_f32_16x16x64_bf16 v[16:19], v[12:15], v[40:47], v20
 s_branch Lcb_108
Lcs_112:
 s_bitcmp1_b32 s7, 0
 s_cbranch_scc1 Lcs_113
 v_smfmac_f32_16x16x64_bf16 v[16:19], v[12:15], v[24:31], v20
 s_branch Lcb_111
Lcs_113:
 v_smfmac_f32_16x16x64_bf16 v[16:19], v[12:15], v[32:39], v20
 s_branch Lcb_111
Lcs_115:
 s_bitcmp1_b32 s7, 0
 s_cbranch_scc1 Lcs_116
 v_smfmac_f32_16x16x64_bf16 v[16:19], v[12:15], v[48:55], v20
 s_branch Lcb_114
Lcs_116:
 v_smfmac_f32_16x16x64_bf16 v[16:19], v[12:15], v[40:47], v20
 v_mov_b32_dpp v12, v12 row_ror:12 row_mask:0xf bank_mask:0xf
 v_mov_b32_dpp v13, v13 row_ror:12 row_mask:0xf bank_mask:0xf
 v_mov_b32_dpp v14, v14 row_ror:12 row_mask:0xf bank_mask:0xf
 v_mov_b32_dpp v15, v15 row_ror:12 row_mask:0xf bank_mask:0xf
 s_nop 1
 v_smfmac_f32_16x16x64_bf16 v[16:19], v[12:15], v[56:63], v20
 s_branch Lcb_114
Lcs_118:
 s_bitcmp1_b32 s7, 0
 s_cbranch_scc1 Lcs_119
 v_smfmac_f32_16x16x64_bf16 v[16:19], v[12:15], v[24:31], v20
 s_branch Lcb_117
Lcs_119:
 v_smfmac_f32_16x16x64_bf16 v[16:19], v[12:15], v[32:39], v20
 s_branch Lcb_117
Lcs_121:
 s_bitcmp1_b32 s7, 0
 s_cbranch_scc1 Lcs_122
 v_smfmac_f32_16x16x64_bf16 v[16:19], v[12:15], v[48:55], v20
 s_branch Lcb_120
Lcs_122:
 v_smfmac_f32_16x16x64_bf16 v[16:19], v[12:15], v[56:63], v20
 v_mov_b32_dpp v12, v12 row_ror:4 row_mask:0xf bank_mask:0xf
 v_mov_b32_dpp v13, v13 row_ror:4 row_mask:0xf bank_mask:0xf
 v_mov_b32_dpp v14, v14 row_ror:4 row_mask:0xf bank_mask:0xf
 v_mov_b32_dpp v15, v15 row_ror:4 row_mask:0xf bank_mask:0xf
 s_nop 1
 v_smfmac_f32_16x16x64_bf16 v[16:19], v[12:15], v[40:47], v20
 s_branch Lcb_120
Lcs_124:
 s_bitcmp1_b32 s7, 0
 s_cbranch_scc1 Lcs_125
 v_smfmac_f32_16x16x64_bf16 v[16:19], v[12:15], v[24:31], v20
 s_branch Lcb_123
Lcs_125:
 v_smfmac_f32_16x16x64_bf16 v[16:19], v[12:15], v[32:39], v20
 s_branch Lcb_123
Lcs_127:
 s_bitcmp1_b32 s7, 0
 s_cbranch_scc1 Lcs_128
 v_smfmac_f32_16x16x64_bf16 v[16:19], v[12:15], v[48:55], v20
 s_branch Lcb_126
Lcs_128:
 v_smfmac_f32_16x16x64_bf16 v[16:19], v[12:15], v[40:47], v20
 v_mov_b32_dpp v12, v12 row_ror:12 row_mask:0xf bank_mask:0xf
 v_mov_b32_dpp v13, v13 row_ror:12 row_mask:0xf bank_mask:0xf
 v_mov_b32_dpp v14, v14 row_ror:12 row_mask:0xf bank_mask:0xf
 v_mov_b32_dpp v15, v15 row_ror:12 row_mask:0xf bank_mask:0xf
 s_nop 1
 v_smfmac_f32_16x16x64_bf16 v[16:19], v[12:15], v[56:63], v20
 s_branch Lcb_126
Lrp_129:
 v_add_f32 v16, v16, v17
 v_add_f32 v17, v18, v19
 s_lshl3_add_u32 s85, s82, s3
 s_lshl3_add_u32 s85, s85, s83
 s_lshl_b32 s85, s85, 8
 v_lshlrev_b32 v20, 3, v1
 s_mov_b32 exec_hi, 0
 buffer_store_dwordx2 v[16:17], v20, s[8:11], s85 offen sc1
 s_mov_b32 exec_hi, -1
 s_branch Lrq_130
Lcs_132:
 s_bitcmp1_b32 s7, 0
 s_cbranch_scc1 Lcs_133
 v_smfmac_f32_16x16x64_bf16 v[16:19], v[12:15], v[24:31], v20
 s_branch Lcb_131
Lcs_133:
 v_smfmac_f32_16x16x64_bf16 v[16:19], v[12:15], v[32:39], v20
 s_branch Lcb_131
Lcs_135:
 s_bitcmp1_b32 s7, 0
 s_cbranch_scc1 Lcs_136
 v_smfmac_f32_16x16x64_bf16 v[16:19], v[12:15], v[48:55], v20
 s_branch Lcb_134
Lcs_136:
 v_smfmac_f32_16x16x64_bf16 v[16:19], v[12:15], v[56:63], v20
 v_mov_b32_dpp v12, v12 row_ror:4 row_mask:0xf bank_mask:0xf
 v_mov_b32_dpp v13, v13 row_ror:4 row_mask:0xf bank_mask:0xf
 v_mov_b32_dpp v14, v14 row_ror:4 row_mask:0xf bank_mask:0xf
 v_mov_b32_dpp v15, v15 row_ror:4 row_mask:0xf bank_mask:0xf
 s_nop 1
 v_smfmac_f32_16x16x64_bf16 v[16:19], v[12:15], v[40:47], v20
 s_branch Lcb_134
Lcs_138:
 s_bitcmp1_b32 s7, 0
 s_cbranch_scc1 Lcs_139
 v_smfmac_f32_16x16x64_bf16 v[16:19], v[12:15], v[24:31], v20
 s_branch Lcb_137
Lcs_139:
 v_smfmac_f32_16x16x64_bf16 v[16:19], v[12:15], v[32:39], v20
 s_branch Lcb_137
Lcs_141:
 s_bitcmp1_b32 s7, 0
 s_cbranch_scc1 Lcs_142
 v_smfmac_f32_16x16x64_bf16 v[16:19], v[12:15], v[48:55], v20
 s_branch Lcb_140
Lcs_142:
 v_smfmac_f32_16x16x64_bf16 v[16:19], v[12:15], v[40:47], v20
 v_mov_b32_dpp v12, v12 row_ror:12 row_mask:0xf bank_mask:0xf
 v_mov_b32_dpp v13, v13 row_ror:12 row_mask:0xf bank_mask:0xf
 v_mov_b32_dpp v14, v14 row_ror:12 row_mask:0xf bank_mask:0xf
 v_mov_b32_dpp v15, v15 row_ror:12 row_mask:0xf bank_mask:0xf
 s_nop 1
 v_smfmac_f32_16x16x64_bf16 v[16:19], v[12:15], v[56:63], v20
 s_branch Lcb_140
Lrp_143:
 s_cmp_eq_u32 s7, 0
 s_cselect_b32 s34, 7340032, 0
 s_cselect_b32 s78, 4096, 0
 s_branch Lrq_144
Lcs_146:
 s_bitcmp1_b32 s7, 0
 s_cbranch_scc1 Lcs_147
 v_smfmac_f32_16x16x64_bf16 v[16:19], v[12:15], v[24:31], v20
 s_branch Lcb_145
Lcs_147:
 v_smfmac_f32_16x16x64_bf16 v[16:19], v[12:15], v[32:39], v20
 s_branch Lcb_145
Lcs_149:
 s_bitcmp1_b32 s7, 0
 s_cbranch_scc1 Lcs_150
 v_smfmac_f32_16x16x64_bf16 v[16:19], v[12:15], v[48:55], v20
 s_branch Lcb_148
Lcs_150:
 v_smfmac_f32_16x16x64_bf16 v[16:19], v[12:15], v[56:63], v20
 v_mov_b32_dpp v12, v12 row_ror:4 row_mask:0xf bank_mask:0xf
 v_mov_b32_dpp v13, v13 row_ror:4 row_mask:0xf bank_mask:0xf
 v_mov_b32_dpp v14, v14 row_ror:4 row_mask:0xf bank_mask:0xf
 v_mov_b32_dpp v15, v15 row_ror:4 row_mask:0xf bank_mask:0xf
 s_nop 1
 v_smfmac_f32_16x16x64_bf16 v[16:19], v[12:15], v[40:47], v20
 s_branch Lcb_148
Lcs_152:
 s_bitcmp1_b32 s7, 0
 s_cbranch_scc1 Lcs_153
 v_smfmac_f32_16x16x64_bf16 v[16:19], v[12:15], v[24:31], v20
 s_branch Lcb_151
Lcs_153:
 v_smfmac_f32_16x16x64_bf16 v[16:19], v[12:15], v[32:39], v20
 s_branch Lcb_151
Lcs_155:
 s_bitcmp1_b32 s7, 0
 s_cbranch_scc1 Lcs_156
 v_smfmac_f32_16x16x64_bf16 v[16:19], v[12:15], v[48:55], v20
 s_branch Lcb_154
Lcs_156:
 v_smfmac_f32_16x16x64_bf16 v[16:19], v[12:15], v[40:47], v20
 v_mov_b32_dpp v12, v12 row_ror:12 row_mask:0xf bank_mask:0xf
 v_mov_b32_dpp v13, v13 row_ror:12 row_mask:0xf bank_mask:0xf
 v_mov_b32_dpp v14, v14 row_ror:12 row_mask:0xf bank_mask:0xf
 v_mov_b32_dpp v15, v15 row_ror:12 row_mask:0xf bank_mask:0xf
 s_nop 1
 v_smfmac_f32_16x16x64_bf16 v[16:19], v[12:15], v[56:63], v20
 s_branch Lcb_154
Lrp_157:
 v_add_f32 v16, v16, v17
 v_add_f32 v17, v18, v19
 s_lshl3_add_u32 s85, s82, s3
 s_lshl3_add_u32 s85, s85, s83
 s_lshl_b32 s85, s85, 8
 v_lshlrev_b32 v20, 3, v1
 s_mov_b32 exec_hi, 0
 buffer_store_dwordx2 v[16:17], v20, s[8:11], s85 offen sc1
 s_mov_b32 exec_hi, -1
 s_branch Lrq_158
Lsp_159:
 s_mov_b32 s95, 0
Llp_161:
 s_buffer_load_dwordx2 s[72:73], s[8:11], s64 glc
 s_waitcnt lgkmcnt(0)
 s_add_u32 s95, s95, 1
 s_lshr_b64 s[72:73], s[72:73], s74
 s_and_b32 s72, s72, 0xffff
 s_cmp_eq_u32 s72, 0x101
 s_cbranch_scc1 Lok_160
 s_cmp_lt_u32 s95, 0x40000
 s_cbranch_scc1 Llp_161
 s_branch Lok_160
Lsp_162:
 s_mov_b32 s95, 0
Llp_164:
 s_buffer_load_dwordx2 s[72:73], s[8:11], s64 glc
 s_waitcnt lgkmcnt(0)
 s_add_u32 s95, s95, 1
 s_and_b32 s72, s72, s73
 s_cmp_eq_u32 s72, 0x1010101
 s_cbranch_scc1 Lok_163
 s_cmp_lt_u32 s95, 0x40000
 s_cbranch_scc1 Llp_164
 s_branch Lok_163
Lsp_165:
 s_mov_b32 s95, 0
Llp_167:
 s_buffer_load_dwordx2 s[72:73], s[8:11], s64 glc
 s_waitcnt lgkmcnt(0)
 s_add_u32 s95, s95, 1
 s_and_b32 s72, s72, s73
 s_cmp_eq_u32 s72, 0x1010101
 s_cbranch_scc1 Lok_166
 s_cmp_lt_u32 s95, 0x40000
 s_cbranch_scc1 Llp_167
 s_branch Lok_166
Lsp_168:
 s_mov_b32 s95, 0
Llp_170:
 s_buffer_load_dwordx8 s[72:79], s[8:11], s64 glc
 s_waitcnt lgkmcnt(0)
 s_add_u32 s95, s95, 1
 s_and_b64 s[96:97], s[72:73], s[74:75]
 s_and_b64 s[80:81], s[76:77], s[78:79]
 s_and_b64 s[96:97], s[96:97], s[80:81]
 s_bitcmp1_b32 s2, 0
 s_cselect_b32 s96, s97, s96
 s_bitcmp1_b32 s96, 0
 s_cbranch_scc1 Lok_169
 s_cmp_lt_u32 s95, 0x40000
 s_cbranch_scc1 Llp_170
 s_branch Lok_169
Lsp_171:
 s_mov_b32 s95, 0
Llp_173:
 s_buffer_load_dwordx2 s[72:73], s[8:11], s64 offset:0 glc
 s_buffer_load_dwordx2 s[74:75], s[8:11], s64 offset:512 glc
 s_buffer_load_dwordx2 s[76:77], s[8:11], s64 offset:1024 glc
 s_buffer_load_dwordx2 s[78:79], s[8:11], s64 offset:1536 glc
 s_waitcnt lgkmcnt(0)
 s_add_u32 s95, s95, 1
 s_and_b64 s[72:73], s[72:73], s[74:75]
 s_and_b64 s[76:77], s[76:77], s[78:79]
 s_and_b64 s[72:73], s[72:73], s[76:77]
 s_and_b32 s72, s72, s73
 s_cmp_eq_u32 s72, 0x1010101
 s_cbranch_scc1 Lok_172
 s_cmp_lt_u32 s95, 0x40000
 s_cbranch_scc1 Llp_173
 s_branch Lok_172
Lsp_174:
 s_mov_b32 s95, 0
Llp_176:
 s_buffer_load_dword s72, s[8:11], s71 glc
 s_waitcnt lgkmcnt(0)
 s_add_u32 s95, s95, 1
 s_cmp_eq_u32 s72, 0x10101
 s_cbranch_scc1 Lok_175
 s_cmp_lt_u32 s95, 0x40000
 s_cbranch_scc1 Llp_176
 s_branch Lok_175
L_last:
 s_endpgm
L5_v0:
L5_v01:
 s_lshl_b32 s52, s52, 4
 s_lshr_b32 s84, 0x33333333, s84
 s_and_b32 s84, s84, 0xf
 s_or_b32 s52, s52, s84
 s_xor_b32 s52, s52, s96
 s_waitcnt vmcnt(12) lgkmcnt(0)
 s_barrier
 v_mfma_f32_16x16x32_bf16 v[96:99], v[24:27], v[40:43], v[96:99]
 ds_read_b128 v[72:75], v2 offset:16384
 v_mfma_f32_16x16x32_bf16 v[100:103], v[28:31], v[40:43], v[100:103]
 ds_read_b64_tr_b16 v[56:57], v6 offset:40960
 v_mfma_f32_16x16x32_bf16 v[104:107], v[32:35], v[40:43], v[104:107]
 ds_read_b64_tr_b16 v[58:59], v6 offset:45056
 v_mfma_f32_16x16x32_bf16 v[108:111], v[36:39], v[40:43], v[108:111]
 ds_read_b64_tr_b16 v[60:61], v7 offset:40960
 v_mfma_f32_16x16x32_bf16 v[124:127], v[36:39], v[44:47], v[124:127]
 ds_read_b64_tr_b16 v[62:63], v7 offset:45056
 v_mfma_f32_16x16x32_bf16 v[120:123], v[32:35], v[44:47], v[120:123]
 ds_read_b128 v[76:79], v2 offset:17408
 v_mfma_f32_16x16x32_bf16 v[116:119], v[28:31], v[44:47], v[116:119]
 ds_read_b64_tr_b16 v[64:65], v8 offset:40960
 v_mfma_f32_16x16x32_bf16 v[112:115], v[24:27], v[44:47], v[112:115]
 ds_read_b64_tr_b16 v[66:67], v8 offset:45056
 v_mfma_f32_16x16x32_bf16 v[128:131], v[24:27], v[48:51], v[128:131]
 ds_read_b128 v[80:83], v3 offset:16384
 s_add_u32 m0, s51, 32768
 s_lshl_b32 s63, s6, 2
 s_lshr_b32 s63, 0x3210, s63
 s_and_b32 s63, s63, 7
 s_mul_i32 s63, s63, 65536
 s_add_u32 s63, s63, s65
 v_mfma_f32_16x16x32_bf16 v[132:135], v[28:31], v[48:51], v[132:135]
 ds_read_b64_tr_b16 v[68:69], v9 offset:40960
 buffer_load_dwordx4 v10, s[20:23], s63 offen lds
 v_mfma_f32_16x16x32_bf16 v[136:139], v[32:35], v[48:51], v[136:139]
 ds_read_b64_tr_b16 v[70:71], v9 offset:45056
 v_mfma_f32_16x16x32_bf16 v[140:143], v[36:39], v[48:51], v[140:143]
 ds_read_b128 v[84:87], v3 offset:17408
 v_mfma_f32_16x16x32_bf16 v[156:159], v[36:39], v[52:55], v[156:159]
 v_mfma_f32_16x16x32_bf16 v[152:155], v[32:35], v[52:55], v[152:155]
 v_mfma_f32_16x16x32_bf16 v[148:151], v[28:31], v[52:55], v[148:151]
 v_mfma_f32_16x16x32_bf16 v[144:147], v[24:27], v[52:55], v[144:147]
 s_waitcnt vmcnt(10) lgkmcnt(0)
 s_barrier
 v_mfma_f32_16x16x32_bf16 v[96:99], v[56:59], v[72:75], v[96:99]
 ds_read_b128 v[40:43], v2 offset:32768
 v_mfma_f32_16x16x32_bf16 v[100:103], v[60:63], v[72:75], v[100:103]
 ds_read_b64_tr_b16 v[24:25], v6 offset:0
 v_mfma_f32_16x16x32_bf16 v[104:107], v[64:67], v[72:75], v[104:107]
 ds_read_b64_tr_b16 v[26:27], v6 offset:4096
 v_mfma_f32_16x16x32_bf16 v[108:111], v[68:71], v[72:75], v[108:111]
 ds_read_b64_tr_b16 v[28:29], v7 offset:0
 v_mfma_f32_16x16x32_bf16 v[124:127], v[68:71], v[76:79], v[124:127]
 ds_read_b64_tr_b16 v[30:31], v7 offset:4096
 s_lshl2_add_u32 s64, s83, s4
 v_mfma_f32_16x16x32_bf16 v[120:123], v[64:67], v[76:79], v[120:123]
 ds_read_b128 v[44:47], v2 offset:33792
 s_lshl2_add_u32 s64, s64, s7
 s_lshl_b32 s64, s64, 7
 v_mfma_f32_16x16x32_bf16 v[116:119], v[60:63], v[76:79], v[116:119]
 ds_read_b64_tr_b16 v[32:33], v8 offset:0
 s_add_u32 s64, s64, 39927808
 v_mfma_f32_16x16x32_bf16 v[112:115], v[56:59], v[76:79], v[112:115]
 ds_read_b64_tr_b16 v[34:35], v8 offset:4096
 s_buffer_load_dwordx2 s[72:73], s[8:11], s64 glc
 v_mfma_f32_16x16x32_bf16 v[128:131], v[56:59], v[80:83], v[128:131]
 ds_read_b128 v[48:51], v3 offset:32768
 s_add_u32 m0, s51, 40960
 s_lshl_b32 s63, s6, 2
 s_lshr_b32 s63, 0x4321, s63
 s_and_b32 s63, s63, 7
 s_mul_i32 s63, s63, 65536
 s_add_u32 s63, s63, s65
 v_mfma_f32_16x16x32_bf16 v[132:135], v[60:63], v[80:83], v[132:135]
 ds_read_b64_tr_b16 v[36:37], v9 offset:0
 buffer_load_dwordx4 v10, s[20:23], s63 offen lds
 v_mfma_f32_16x16x32_bf16 v[136:139], v[64:67], v[80:83], v[136:139]
 ds_read_b64_tr_b16 v[38:39], v9 offset:4096
 v_mfma_f32_16x16x32_bf16 v[140:143], v[68:71], v[80:83], v[140:143]
 ds_read_b128 v[52:55], v3 offset:33792
 ds_read_b32 v90, v0
 ds_read_b32 v90, v0
 v_mfma_f32_16x16x32_bf16 v[156:159], v[68:71], v[84:87], v[156:159]
 v_mfma_f32_16x16x32_bf16 v[152:155], v[64:67], v[84:87], v[152:155]
 v_mfma_f32_16x16x32_bf16 v[148:151], v[60:63], v[84:87], v[148:151]
 v_mfma_f32_16x16x32_bf16 v[144:147], v[56:59], v[84:87], v[144:147]
 s_waitcnt vmcnt(8) lgkmcnt(2)
 s_barrier
 v_mfma_f32_16x16x32_bf16 v[96:99], v[24:27], v[40:43], v[96:99]
 ds_read_b128 v[72:75], v2 offset:49152
 v_mfma_f32_16x16x32_bf16 v[100:103], v[28:31], v[40:43], v[100:103]
 ds_read_b64_tr_b16 v[56:57], v6 offset:8192
 v_mfma_f32_16x16x32_bf16 v[104:107], v[32:35], v[40:43], v[104:107]
 ds_read_b64_tr_b16 v[58:59], v6 offset:12288
 v_mfma_f32_16x16x32_bf16 v[108:111], v[36:39], v[40:43], v[108:111]
 ds_read_b64_tr_b16 v[60:61], v7 offset:8192
 v_mfma_f32_16x16x32_bf16 v[124:127], v[36:39], v[44:47], v[124:127]
 ds_read_b64_tr_b16 v[62:63], v7 offset:12288
 v_mfma_f32_16x16x32_bf16 v[120:123], v[32:35], v[44:47], v[120:123]
 ds_read_b128 v[76:79], v2 offset:50176
 v_mfma_f32_16x16x32_bf16 v[116:119], v[28:31], v[44:47], v[116:119]
 ds_read_b64_tr_b16 v[64:65], v8 offset:8192
 v_mfma_f32_16x16x32_bf16 v[112:115], v[24:27], v[44:47], v[112:115]
 ds_read_b64_tr_b16 v[66:67], v8 offset:12288
 v_mfma_f32_16x16x32_bf16 v[128:131], v[24:27], v[48:51], v[128:131]
 ds_read_b128 v[80:83], v3 offset:49152
 s_add_u32 m0, s51, 0
 s_lshl_b32 s63, s6, 2
 s_lshr_b32 s63, 0x5432, s63
 s_and_b32 s63, s63, 7
 s_mul_i32 s63, s63, 65536
 s_add_u32 s63, s63, s65
 v_mfma_f32_16x16x32_bf16 v[132:135], v[28:31], v[48:51], v[132:135]
 ds_read_b64_tr_b16 v[68:69], v9 offset:8192
 buffer_load_dwordx4 v10, s[20:23], s63 offen lds
 v_mfma_f32_16x16x32_bf16 v[136:139], v[32:35], v[48:51], v[136:139]
 ds_read_b64_tr_b16 v[70:71], v9 offset:12288
 v_mfma_f32_16x16x32_bf16 v[140:143], v[36:39], v[48:51], v[140:143]
 ds_read_b128 v[84:87], v3 offset:50176
 v_mfma_f32_16x16x32_bf16 v[156:159], v[36:39], v[52:55], v[156:159]
 v_mfma_f32_16x16x32_bf16 v[152:155], v[32:35], v[52:55], v[152:155]
 v_mfma_f32_16x16x32_bf16 v[148:151], v[28:31], v[52:55], v[148:151]
 v_mfma_f32_16x16x32_bf16 v[144:147], v[24:27], v[52:55], v[144:147]
 s_waitcnt lgkmcnt(0)
 s_and_b32 s72, s72, s73
 s_cmp_eq_u32 s72, 0x1010101
 s_cbranch_scc0 Lsp_81
Lok_82:
 s_waitcnt vmcnt(6) lgkmcnt(0)
 s_barrier
 v_mfma_f32_16x16x32_bf16 v[96:99], v[56:59], v[72:75], v[96:99]
 ds_read_b128 v[40:43], v4 offset:0
 v_mfma_f32_16x16x32_bf16 v[100:103], v[60:63], v[72:75], v[100:103]
 ds_read_b64_tr_b16 v[24:25], v6 offset:16384
 v_mfma_f32_16x16x32_bf16 v[104:107], v[64:67], v[72:75], v[104:107]
 ds_read_b64_tr_b16 v[26:27], v6 offset:20480
 s_add_u32 m0, s50, 0
 s_lshl_b32 s62, s6, 2
 s_lshr_b32 s62, 0x3210, s62
 s_and_b32 s62, s62, 7
 s_mul_i32 s62, s62, 16384
 s_add_u32 s62, s62, s54
 v_mfma_f32_16x16x32_bf16 v[108:111], v[68:71], v[72:75], v[108:111]
 ds_read_b64_tr_b16 v[28:29], v7 offset:16384
 buffer_load_dwordx4 v13, s[8:11], s62 offen offset:0 sc1 lds
 v_mfma_f32_16x16x32_bf16 v[124:127], v[68:71], v[76:79], v[124:127]
 ds_read_b64_tr_b16 v[30:31], v7 offset:20480
 v_mfma_f32_16x16x32_bf16 v[120:123], v[64:67], v[76:79], v[120:123]
 ds_read_b128 v[44:47], v4 offset:1024
 buffer_load_dwordx4 v13, s[8:11], s62 offen offset:1024 sc1 lds
 v_mfma_f32_16x16x32_bf16 v[116:119], v[60:63], v[76:79], v[116:119]
 ds_read_b64_tr_b16 v[32:33], v8 offset:16384
 s_add_u32 m0, s50, 16384
 s_lshl_b32 s62, s6, 2
 s_lshr_b32 s62, 0x4321, s62
 s_and_b32 s62, s62, 7
 s_mul_i32 s62, s62, 16384
 s_add_u32 s62, s62, s54
 v_mfma_f32_16x16x32_bf16 v[112:115], v[56:59], v[76:79], v[112:115]
 ds_read_b64_tr_b16 v[34:35], v8 offset:20480
 buffer_load_dwordx4 v13, s[8:11], s62 offen offset:0 sc1 lds
 v_mfma_f32_16x16x32_bf16 v[128:131], v[56:59], v[80:83], v[128:131]
 ds_read_b128 v[48:51], v5 offset:0
 v_mfma_f32_16x16x32_bf16 v[132:135], v[60:63], v[80:83], v[132:135]
 ds_read_b64_tr_b16 v[36:37], v9 offset:16384
 v_mfma_f32_16x16x32_bf16 v[136:139], v[64:67], v[80:83], v[136:139]
 ds_read_b64_tr_b16 v[38:39], v9 offset:20480
 buffer_load_dwordx4 v13, s[8:11], s62 offen offset:1024 sc1 lds
 v_mfma_f32_16x16x32_bf16 v[140:143], v[68:71], v[80:83], v[140:143]
 ds_read_b128 v[52:55], v5 offset:1024
 s_add_u32 m0, s50, 32768
 s_lshl_b32 s62, s6, 2
 s_lshr_b32 s62, 0x5432, s62
 s_and_b32 s62, s62, 7
 s_mul_i32 s62, s62, 16384
 s_add_u32 s62, s62, s54
 v_mfma_f32_16x16x32_bf16 v[156:159], v[68:71], v[84:87], v[156:159]
 buffer_load_dwordx4 v13, s[8:11], s62 offen offset:0 sc1 lds
 v_mfma_f32_16x16x32_bf16 v[152:155], v[64:67], v[84:87], v[152:155]
 v_mfma_f32_16x16x32_bf16 v[148:151], v[60:63], v[84:87], v[148:151]
 buffer_load_dwordx4 v13, s[8:11], s62 offen offset:1024 sc1 lds
 v_mfma_f32_16x16x32_bf16 v[144:147], v[56:59], v[84:87], v[144:147]
 s_waitcnt vmcnt(9) lgkmcnt(0)
 s_barrier
 v_mfma_f32_16x16x32_bf16 v[96:99], v[24:27], v[40:43], v[96:99]
 ds_read_b128 v[72:75], v4 offset:16384
 s_mov_b32 s89, 0xffff0000
 s_waitcnt vmcnt(28)
 v_mfma_f32_16x16x32_bf16 v[100:103], v[28:31], v[40:43], v[100:103]
 ds_read_b64_tr_b16 v[56:57], v6 offset:24576
 v_permlane16_swap_b32 v184, v186
 v_mfma_f32_16x16x32_bf16 v[104:107], v[32:35], v[40:43], v[104:107]
 ds_read_b64_tr_b16 v[58:59], v6 offset:28672
 v_permlane16_swap_b32 v185, v187
 v_permlane16_swap_b32 v188, v190
 s_add_u32 m0, s50, 49152
 s_lshl_b32 s62, s6, 2
 s_lshr_b32 s62, 0x543, s62
 s_and_b32 s62, s62, 7
 s_mul_i32 s62, s62, 16384
 s_add_u32 s62, s62, s54
 v_mfma_f32_16x16x32_bf16 v[108:111], v[36:39], v[40:43], v[108:111]
 ds_read_b64_tr_b16 v[60:61], v7 offset:24576
 buffer_load_dwordx4 v13, s[8:11], s62 offen offset:0 sc1 lds
 v_permlane16_swap_b32 v189, v191
 v_mfma_f32_16x16x32_bf16 v[124:127], v[36:39], v[44:47], v[124:127]
 ds_read_b64_tr_b16 v[62:63], v7 offset:28672
 v_lshlrev_b32 v192, 16, v184
 v_mfma_f32_16x16x32_bf16 v[120:123], v[32:35], v[44:47], v[120:123]
 ds_read_b128 v[76:79], v4 offset:17408
 buffer_load_dwordx4 v13, s[8:11], s62 offen offset:1024 sc1 lds
 v_and_b32 v193, s89, v184
 v_lshlrev_b32 v194, 16, v185
 v_mfma_f32_16x16x32_bf16 v[116:119], v[28:31], v[44:47], v[116:119]
 ds_read_b64_tr_b16 v[64:65], v8 offset:24576
 v_and_b32 v195, s89, v185
 s_add_u32 m0, s51, 8192
 s_lshl_b32 s63, s6, 2
 s_lshr_b32 s63, 0x543, s63
 s_and_b32 s63, s63, 7
 s_mul_i32 s63, s63, 65536
 s_add_u32 s63, s63, s65
 v_mfma_f32_16x16x32_bf16 v[112:115], v[24:27], v[44:47], v[112:115]
 ds_read_b64_tr_b16 v[66:67], v8 offset:28672
 buffer_load_dwordx4 v10, s[20:23], s63 offen lds
 v_lshlrev_b32 v196, 16, v186
 v_mfma_f32_16x16x32_bf16 v[128:131], v[24:27], v[48:51], v[128:131]
 ds_read_b128 v[80:83], v5 offset:16384
 v_and_b32 v197, s89, v186
 v_lshlrev_b32 v198, 16, v187
 v_mfma_f32_16x16x32_bf16 v[132:135], v[28:31], v[48:51], v[132:135]
 ds_read_b64_tr_b16 v[68:69], v9 offset:24576
 v_and_b32 v199, s89, v187
 s_add_u32 m0, s50, 65536
 s_lshl_b32 s62, s6, 2
 s_lshr_b32 s62, 0x1054, s62
 s_and_b32 s62, s62, 7
 s_mul_i32 s62, s62, 16384
 s_add_u32 s62, s62, s54
 v_mfma_f32_16x16x32_bf16 v[136:139], v[32:35], v[48:51], v[136:139]
 ds_read_b64_tr_b16 v[70:71], v9 offset:28672
 buffer_load_dwordx4 v13, s[8:11], s62 offen offset:0 sc1 lds
 v_lshlrev_b32 v200, 16, v188
 v_and_b32 v201, s89, v188
 v_mfma_f32_16x16x32_bf16 v[140:143], v[36:39], v[48:51], v[140:143]
 ds_read_b128 v[84:87], v5 offset:17408
 v_lshlrev_b32 v202, 16, v189
 v_mfma_f32_16x16x32_bf16 v[156:159], v[36:39], v[52:55], v[156:159]
 buffer_load_dwordx4 v13, s[8:11], s62 offen offset:1024 sc1 lds
 v_and_b32 v203, s89, v189
 v_mfma_f32_16x16x32_bf16 v[152:155], v[32:35], v[52:55], v[152:155]
 v_lshlrev_b32 v204, 16, v190
 v_and_b32 v205, s89, v190
 s_add_u32 m0, s51, 16384
 s_lshl_b32 s63, s6, 2
 s_lshr_b32 s63, 0x1054, s63
 s_and_b32 s63, s63, 7
 s_mul_i32 s63, s63, 65536
 s_add_u32 s63, s63, s65
 v_mfma_f32_16x16x32_bf16 v[148:151], v[28:31], v[52:55], v[148:151]
 buffer_load_dwordx4 v10, s[20:23], s63 offen lds
 v_lshlrev_b32 v206, 16, v191
 v_mfma_f32_16x16x32_bf16 v[144:147], v[24:27], v[52:55], v[144:147]
 v_and_b32 v207, s89, v191
 s_waitcnt vmcnt(10) lgkmcnt(0)
 s_barrier
 v_mfma_f32_16x16x32_bf16 v[96:99], v[56:59], v[72:75], v[96:99]
 ds_read_b128 v[40:43], v2 offset:0
 v_mfma_f32_16x16x32_bf16 v[100:103], v[60:63], v[72:75], v[100:103]
 ds_read_b64_tr_b16 v[24:25], v6 offset:32768
 v_mfma_f32_16x16x32_bf16 v[104:107], v[64:67], v[72:75], v[104:107]
 ds_read_b64_tr_b16 v[26:27], v6 offset:36864
 v_mfma_f32_16x16x32_bf16 v[108:111], v[68:71], v[72:75], v[108:111]
 ds_read_b64_tr_b16 v[28:29], v7 offset:32768
 s_add_u32 m0, s50, 81920
 s_lshl_b32 s62, s6, 2
 s_lshr_b32 s62, 0x2105, s62
 s_and_b32 s62, s62, 7
 s_mul_i32 s62, s62, 16384
 s_add_u32 s62, s62, s54
 v_mfma_f32_16x16x32_bf16 v[124:127], v[68:71], v[76:79], v[124:127]
 ds_read_b64_tr_b16 v[30:31], v7 offset:36864
 buffer_load_dwordx4 v13, s[8:11], s62 offen offset:0 sc1 lds
 v_mfma_f32_16x16x32_bf16 v[120:123], v[64:67], v[76:79], v[120:123]
 ds_read_b128 v[44:47], v2 offset:1024
 v_mfma_f32_16x16x32_bf16 v[116:119], v[60:63], v[76:79], v[116:119]
 ds_read_b64_tr_b16 v[32:33], v8 offset:32768
 v_mfma_f32_16x16x32_bf16 v[112:115], v[56:59], v[76:79], v[112:115]
 ds_read_b64_tr_b16 v[34:35], v8 offset:36864
 v_mfma_f32_16x16x32_bf16 v[128:131], v[56:59], v[80:83], v[128:131]
 ds_read_b128 v[48:51], v3 offset:0
 v_mfma_f32_16x16x32_bf16 v[132:135], v[60:63], v[80:83], v[132:135]
 ds_read_b64_tr_b16 v[36:37], v9 offset:32768
 buffer_load_dwordx4 v13, s[8:11], s62 offen offset:1024 sc1 lds
 v_mfma_f32_16x16x32_bf16 v[136:139], v[64:67], v[80:83], v[136:139]
 ds_read_b64_tr_b16 v[38:39], v9 offset:36864
 v_mfma_f32_16x16x32_bf16 v[140:143], v[68:71], v[80:83], v[140:143]
 ds_read_b128 v[52:55], v3 offset:1024
 v_mfma_f32_16x16x32_bf16 v[156:159], v[68:71], v[84:87], v[156:159]
 s_add_u32 m0, s51, 24576
 s_lshl_b32 s63, s6, 2
 s_lshr_b32 s63, 0x2105, s63
 s_and_b32 s63, s63, 7
 s_mul_i32 s63, s63, 65536
 s_add_u32 s63, s63, s65
 v_mfma_f32_16x16x32_bf16 v[152:155], v[64:67], v[84:87], v[152:155]
 buffer_load_dwordx4 v10, s[20:23], s63 offen lds
 v_mfma_f32_16x16x32_bf16 v[148:151], v[60:63], v[84:87], v[148:151]
 v_mfma_f32_16x16x32_bf16 v[144:147], v[56:59], v[84:87], v[144:147]
 s_waitcnt vmcnt(11) lgkmcnt(0)
 s_barrier
 v_mfma_f32_16x16x32_bf16 v[96:99], v[24:27], v[40:43], v[96:99]
 ds_read_b128 v[72:75], v2 offset:16384
 v_mfma_f32_16x16x32_bf16 v[100:103], v[28:31], v[40:43], v[100:103]
 ds_read_b64_tr_b16 v[56:57], v6 offset:40960
 v_mfma_f32_16x16x32_bf16 v[104:107], v[32:35], v[40:43], v[104:107]
 ds_read_b64_tr_b16 v[58:59], v6 offset:45056
 v_mfma_f32_16x16x32_bf16 v[108:111], v[36:39], v[40:43], v[108:111]
 ds_read_b64_tr_b16 v[60:61], v7 offset:40960
 s_add_u32 m0, s50, 0
 s_bfe_u32 s62, s52, 0x40000
 s_lshl_b32 s62, s62, 15
 s_add_u32 s62, s62, s57
 v_mfma_f32_16x16x32_bf16 v[124:127], v[36:39], v[44:47], v[124:127]
 ds_read_b64_tr_b16 v[62:63], v7 offset:45056
 buffer_load_dwordx4 v0, s[8:11], s62 offen offset:0 sc1 lds
 v_mfma_f32_16x16x32_bf16 v[120:123], v[32:35], v[44:47], v[120:123]
 ds_read_b128 v[76:79], v2 offset:17408
 v_mfma_f32_16x16x32_bf16 v[116:119], v[28:31], v[44:47], v[116:119]
 ds_read_b64_tr_b16 v[64:65], v8 offset:40960
 v_mfma_f32_16x16x32_bf16 v[112:115], v[24:27], v[44:47], v[112:115]
 ds_read_b64_tr_b16 v[66:67], v8 offset:45056
 v_mfma_f32_16x16x32_bf16 v[128:131], v[24:27], v[48:51], v[128:131]
 ds_read_b128 v[80:83], v3 offset:16384
 v_mfma_f32_16x16x32_bf16 v[132:135], v[28:31], v[48:51], v[132:135]
 ds_read_b64_tr_b16 v[68:69], v9 offset:40960
 buffer_load_dwordx4 v0, s[8:11], s62 offen offset:1024 sc1 lds
 v_mfma_f32_16x16x32_bf16 v[136:139], v[32:35], v[48:51], v[136:139]
 ds_read_b64_tr_b16 v[70:71], v9 offset:45056
 v_mfma_f32_16x16x32_bf16 v[140:143], v[36:39], v[48:51], v[140:143]
 ds_read_b128 v[84:87], v3 offset:17408
 v_mfma_f32_16x16x32_bf16 v[156:159], v[36:39], v[52:55], v[156:159]
 s_add_u32 m0, s51, 32768
 s_bfe_u32 s63, s52, 0x40000
 s_lshl_b32 s63, s63, 17
 s_add_u32 s63, s63, s58
 v_mfma_f32_16x16x32_bf16 v[152:155], v[32:35], v[52:55], v[152:155]
 buffer_load_dwordx4 v11, s[20:23], s63 offen lds
 v_mfma_f32_16x16x32_bf16 v[148:151], v[28:31], v[52:55], v[148:151]
 v_mfma_f32_16x16x32_bf16 v[144:147], v[24:27], v[52:55], v[144:147]
 s_waitcnt vmcnt(12) lgkmcnt(0)
 s_barrier
 v_mfma_f32_16x16x32_bf16 v[96:99], v[56:59], v[72:75], v[96:99]
 ds_read_b128 v[40:43], v2 offset:32768
 v_mfma_f32_16x16x32_bf16 v[100:103], v[60:63], v[72:75], v[100:103]
 ds_read_b64_tr_b16 v[24:25], v6 offset:0
 v_mfma_f32_16x16x32_bf16 v[104:107], v[64:67], v[72:75], v[104:107]
 ds_read_b64_tr_b16 v[26:27], v6 offset:4096
 v_mfma_f32_16x16x32_bf16 v[108:111], v[68:71], v[72:75], v[108:111]
 ds_read_b64_tr_b16 v[28:29], v7 offset:0
 s_add_u32 m0, s50, 16384
 s_bfe_u32 s62, s52, 0x40004
 s_lshl_b32 s62, s62, 15
 s_add_u32 s62, s62, s57
 v_mfma_f32_16x16x32_bf16 v[124:127], v[68:71], v[76:79], v[124:127]
 ds_read_b64_tr_b16 v[30:31], v7 offset:4096
 buffer_load_dwordx4 v0, s[8:11], s62 offen offset:0 sc1 lds
 v_mfma_f32_16x16x32_bf16 v[120:123], v[64:67], v[76:79], v[120:123]
 ds_read_b128 v[44:47], v2 offset:33792
 v_mfma_f32_16x16x32_bf16 v[116:119], v[60:63], v[76:79], v[116:119]
 ds_read_b64_tr_b16 v[32:33], v8 offset:0
 v_mfma_f32_16x16x32_bf16 v[112:115], v[56:59], v[76:79], v[112:115]
 ds_read_b64_tr_b16 v[34:35], v8 offset:4096
 v_mfma_f32_16x16x32_bf16 v[128:131], v[56:59], v[80:83], v[128:131]
 ds_read_b128 v[48:51], v3 offset:32768
 v_mfma_f32_16x16x32_bf16 v[132:135], v[60:63], v[80:83], v[132:135]
 ds_read_b64_tr_b16 v[36:37], v9 offset:0
 buffer_load_dwordx4 v0, s[8:11], s62 offen offset:1024 sc1 lds
 v_mfma_f32_16x16x32_bf16 v[136:139], v[64:67], v[80:83], v[136:139]
 ds_read_b64_tr_b16 v[38:39], v9 offset:4096
 v_mfma_f32_16x16x32_bf16 v[140:143], v[68:71], v[80:83], v[140:143]
 ds_read_b128 v[52:55], v3 offset:33792
 v_mfma_f32_16x16x32_bf16 v[156:159], v[68:71], v[84:87], v[156:159]
 s_add_u32 m0, s51, 40960
 s_bfe_u32 s63, s52, 0x40004
 s_lshl_b32 s63, s63, 17
 s_add_u32 s63, s63, s58
 v_mfma_f32_16x16x32_bf16 v[152:155], v[64:67], v[84:87], v[152:155]
 buffer_load_dwordx4 v11, s[20:23], s63 offen lds
 v_mfma_f32_16x16x32_bf16 v[148:151], v[60:63], v[84:87], v[148:151]
 v_mfma_f32_16x16x32_bf16 v[144:147], v[56:59], v[84:87], v[144:147]
 s_waitcnt vmcnt(12) lgkmcnt(0)
 s_barrier
 v_mfma_f32_16x16x32_bf16 v[96:99], v[24:27], v[40:43], v[96:99]
 ds_read_b128 v[72:75], v2 offset:49152
 v_mfma_f32_16x16x32_bf16 v[100:103], v[28:31], v[40:43], v[100:103]
 ds_read_b64_tr_b16 v[56:57], v6 offset:8192
 v_mfma_f32_16x16x32_bf16 v[104:107], v[32:35], v[40:43], v[104:107]
 ds_read_b64_tr_b16 v[58:59], v6 offset:12288
 v_mfma_f32_16x16x32_bf16 v[108:111], v[36:39], v[40:43], v[108:111]
 ds_read_b64_tr_b16 v[60:61], v7 offset:8192
 s_add_u32 m0, s50, 32768
 s_bfe_u32 s62, s52, 0x40008
 s_lshl_b32 s62, s62, 15
 s_add_u32 s62, s62, s57
 v_mfma_f32_16x16x32_bf16 v[124:127], v[36:39], v[44:47], v[124:127]
 ds_read_b64_tr_b16 v[62:63], v7 offset:12288
 buffer_load_dwordx4 v0, s[8:11], s62 offen offset:0 sc1 lds
 v_mfma_f32_16x16x32_bf16 v[120:123], v[32:35], v[44:47], v[120:123]
 ds_read_b128 v[76:79], v2 offset:50176
 v_mfma_f32_16x16x32_bf16 v[116:119], v[28:31], v[44:47], v[116:119]
 ds_read_b64_tr_b16 v[64:65], v8 offset:8192
 v_mfma_f32_16x16x32_bf16 v[112:115], v[24:27], v[44:47], v[112:115]
 ds_read_b64_tr_b16 v[66:67], v8 offset:12288
 v_mfma_f32_16x16x32_bf16 v[128:131], v[24:27], v[48:51], v[128:131]
 ds_read_b128 v[80:83], v3 offset:49152
 v_mfma_f32_16x16x32_bf16 v[132:135], v[28:31], v[48:51], v[132:135]
 ds_read_b64_tr_b16 v[68:69], v9 offset:8192
 buffer_load_dwordx4 v0, s[8:11], s62 offen offset:1024 sc1 lds
 v_mfma_f32_16x16x32_bf16 v[136:139], v[32:35], v[48:51], v[136:139]
 ds_read_b64_tr_b16 v[70:71], v9 offset:12288
 v_mfma_f32_16x16x32_bf16 v[140:143], v[36:39], v[48:51], v[140:143]
 ds_read_b128 v[84:87], v3 offset:50176
 v_mfma_f32_16x16x32_bf16 v[156:159], v[36:39], v[52:55], v[156:159]
 s_add_u32 m0, s51, 0
 s_bfe_u32 s63, s52, 0x40008
 s_lshl_b32 s63, s63, 17
 s_add_u32 s63, s63, s58
 v_mfma_f32_16x16x32_bf16 v[152:155], v[32:35], v[52:55], v[152:155]
 buffer_load_dwordx4 v11, s[20:23], s63 offen lds
 v_mfma_f32_16x16x32_bf16 v[148:151], v[28:31], v[52:55], v[148:151]
 v_mfma_f32_16x16x32_bf16 v[144:147], v[24:27], v[52:55], v[144:147]
 s_waitcnt vmcnt(12) lgkmcnt(0)
 s_barrier
 v_mfma_f32_16x16x32_bf16 v[96:99], v[56:59], v[72:75], v[96:99]
 ds_read_b128 v[40:43], v4 offset:0
 v_mfma_f32_16x16x32_bf16 v[100:103], v[60:63], v[72:75], v[100:103]
 ds_read_b64_tr_b16 v[24:25], v6 offset:16384
 v_mfma_f32_16x16x32_bf16 v[104:107], v[64:67], v[72:75], v[104:107]
 ds_read_b64_tr_b16 v[26:27], v6 offset:20480
 v_mfma_f32_16x16x32_bf16 v[108:111], v[68:71], v[72:75], v[108:111]
 ds_read_b64_tr_b16 v[28:29], v7 offset:16384
 s_add_u32 m0, s50, 49152
 s_bfe_u32 s62, s52, 0x4000c
 s_lshl_b32 s62, s62, 15
 s_add_u32 s62, s62, s57
 v_mfma_f32_16x16x32_bf16 v[124:127], v[68:71], v[76:79], v[124:127]
 ds_read_b64_tr_b16 v[30:31], v7 offset:20480
 buffer_load_dwordx4 v0, s[8:11], s62 offen offset:0 sc1 lds
 v_mfma_f32_16x16x32_bf16 v[120:123], v[64:67], v[76:79], v[120:123]
 ds_read_b128 v[44:47], v4 offset:1024
 v_mfma_f32_16x16x32_bf16 v[116:119], v[60:63], v[76:79], v[116:119]
 ds_read_b64_tr_b16 v[32:33], v8 offset:16384
 v_mfma_f32_16x16x32_bf16 v[112:115], v[56:59], v[76:79], v[112:115]
 ds_read_b64_tr_b16 v[34:35], v8 offset:20480
 v_mfma_f32_16x16x32_bf16 v[128:131], v[56:59], v[80:83], v[128:131]
 ds_read_b128 v[48:51], v5 offset:0
 v_mfma_f32_16x16x32_bf16 v[132:135], v[60:63], v[80:83], v[132:135]
 ds_read_b64_tr_b16 v[36:37], v9 offset:16384
 buffer_load_dwordx4 v0, s[8:11], s62 offen offset:1024 sc1 lds
 v_mfma_f32_16x16x32_bf16 v[136:139], v[64:67], v[80:83], v[136:139]
 ds_read_b64_tr_b16 v[38:39], v9 offset:20480
 v_mfma_f32_16x16x32_bf16 v[140:143], v[68:71], v[80:83], v[140:143]
 ds_read_b128 v[52:55], v5 offset:1024
 v_mfma_f32_16x16x32_bf16 v[156:159], v[68:71], v[84:87], v[156:159]
 s_add_u32 m0, s51, 8192
 s_bfe_u32 s63, s52, 0x4000c
 s_lshl_b32 s63, s63, 17
 s_add_u32 s63, s63, s58
 v_mfma_f32_16x16x32_bf16 v[152:155], v[64:67], v[84:87], v[152:155]
 buffer_load_dwordx4 v11, s[20:23], s63 offen lds
 v_mfma_f32_16x16x32_bf16 v[148:151], v[60:63], v[84:87], v[148:151]
 v_mfma_f32_16x16x32_bf16 v[144:147], v[56:59], v[84:87], v[144:147]
 s_waitcnt vmcnt(12) lgkmcnt(0)
 s_barrier
 v_mfma_f32_16x16x32_bf16 v[96:99], v[24:27], v[40:43], v[96:99]
 ds_read_b128 v[72:75], v4 offset:16384
 v_mfma_f32_16x16x32_bf16 v[100:103], v[28:31], v[40:43], v[100:103]
 ds_read_b64_tr_b16 v[56:57], v6 offset:24576
 v_mfma_f32_16x16x32_bf16 v[104:107], v[32:35], v[40:43], v[104:107]
 ds_read_b64_tr_b16 v[58:59], v6 offset:28672
 v_mfma_f32_16x16x32_bf16 v[108:111], v[36:39], v[40:43], v[108:111]
 ds_read_b64_tr_b16 v[60:61], v7 offset:24576
 s_add_u32 m0, s50, 65536
 s_bfe_u32 s62, s52, 0x40010
 s_lshl_b32 s62, s62, 15
 s_add_u32 s62, s62, s57
 v_mfma_f32_16x16x32_bf16 v[124:127], v[36:39], v[44:47], v[124:127]
 ds_read_b64_tr_b16 v[62:63], v7 offset:28672
 buffer_load_dwordx4 v0, s[8:11], s62 offen offset:0 sc1 lds
 v_mfma_f32_16x16x32_bf16 v[120:123], v[32:35], v[44:47], v[120:123]
 ds_read_b128 v[76:79], v4 offset:17408
 v_mfma_f32_16x16x32_bf16 v[116:119], v[28:31], v[44:47], v[116:119]
 ds_read_b64_tr_b16 v[64:65], v8 offset:24576
 v_mfma_f32_16x16x32_bf16 v[112:115], v[24:27], v[44:47], v[112:115]
 ds_read_b64_tr_b16 v[66:67], v8 offset:28672
 v_mfma_f32_16x16x32_bf16 v[128:131], v[24:27], v[48:51], v[128:131]
 ds_read_b128 v[80:83], v5 offset:16384
 v_mfma_f32_16x16x32_bf16 v[132:135], v[28:31], v[48:51], v[132:135]
 ds_read_b64_tr_b16 v[68:69], v9 offset:24576
 buffer_load_dwordx4 v0, s[8:11], s62 offen offset:1024 sc1 lds
 v_mfma_f32_16x16x32_bf16 v[136:139], v[32:35], v[48:51], v[136:139]
 ds_read_b64_tr_b16 v[70:71], v9 offset:28672
 v_mfma_f32_16x16x32_bf16 v[140:143], v[36:39], v[48:51], v[140:143]
 ds_read_b128 v[84:87], v5 offset:17408
 v_mfma_f32_16x16x32_bf16 v[156:159], v[36:39], v[52:55], v[156:159]
 s_add_u32 m0, s51, 16384
 s_bfe_u32 s63, s52, 0x40010
 s_lshl_b32 s63, s63, 17
 s_add_u32 s63, s63, s58
 v_mfma_f32_16x16x32_bf16 v[152:155], v[32:35], v[52:55], v[152:155]
 buffer_load_dwordx4 v11, s[20:23], s63 offen lds
 v_mfma_f32_16x16x32_bf16 v[148:151], v[28:31], v[52:55], v[148:151]
 v_mfma_f32_16x16x32_bf16 v[144:147], v[24:27], v[52:55], v[144:147]
 s_waitcnt vmcnt(12) lgkmcnt(0)
 s_barrier
 v_mfma_f32_16x16x32_bf16 v[96:99], v[56:59], v[72:75], v[96:99]
 ds_read_b128 v[40:43], v15 offset:0
 v_mfma_f32_16x16x32_bf16 v[100:103], v[60:63], v[72:75], v[100:103]
 ds_read_b64_tr_b16 v[24:25], v6 offset:32768
 v_mfma_f32_16x16x32_bf16 v[104:107], v[64:67], v[72:75], v[104:107]
 ds_read_b64_tr_b16 v[26:27], v6 offset:36864
 v_mfma_f32_16x16x32_bf16 v[108:111], v[68:71], v[72:75], v[108:111]
 ds_read_b64_tr_b16 v[28:29], v7 offset:32768
 s_add_u32 m0, s50, 81920
 s_bfe_u32 s62, s52, 0x40014
 s_lshl_b32 s62, s62, 15
 s_add_u32 s62, s62, s57
 v_mfma_f32_16x16x32_bf16 v[124:127], v[68:71], v[76:79], v[124:127]
 ds_read_b64_tr_b16 v[30:31], v7 offset:36864
 buffer_load_dwordx4 v0, s[8:11], s62 offen offset:0 sc1 lds
 v_mfma_f32_16x16x32_bf16 v[120:123], v[64:67], v[76:79], v[120:123]
 ds_read_b128 v[44:47], v15 offset:1024
 v_mfma_f32_16x16x32_bf16 v[116:119], v[60:63], v[76:79], v[116:119]
 ds_read_b64_tr_b16 v[32:33], v8 offset:32768
 v_mfma_f32_16x16x32_bf16 v[112:115], v[56:59], v[76:79], v[112:115]
 ds_read_b64_tr_b16 v[34:35], v8 offset:36864
 v_mfma_f32_16x16x32_bf16 v[128:131], v[56:59], v[80:83], v[128:131]
 ds_read_b128 v[48:51], v15 offset:8192
 v_mfma_f32_16x16x32_bf16 v[132:135], v[60:63], v[80:83], v[132:135]
 ds_read_b64_tr_b16 v[36:37], v9 offset:32768
 buffer_load_dwordx4 v0, s[8:11], s62 offen offset:1024 sc1 lds
 v_mfma_f32_16x16x32_bf16 v[136:139], v[64:67], v[80:83], v[136:139]
 ds_read_b64_tr_b16 v[38:39], v9 offset:36864
 v_mfma_f32_16x16x32_bf16 v[140:143], v[68:71], v[80:83], v[140:143]
 ds_read_b128 v[52:55], v15 offset:9216
 v_mfma_f32_16x16x32_bf16 v[156:159], v[68:71], v[84:87], v[156:159]
 s_add_u32 m0, s51, 24576
 s_bfe_u32 s63, s52, 0x40014
 s_lshl_b32 s63, s63, 17
 s_add_u32 s63, s63, s58
 v_mfma_f32_16x16x32_bf16 v[152:155], v[64:67], v[84:87], v[152:155]
 buffer_load_dwordx4 v11, s[20:23], s63 offen lds
 v_mfma_f32_16x16x32_bf16 v[148:151], v[60:63], v[84:87], v[148:151]
 v_mfma_f32_16x16x32_bf16 v[144:147], v[56:59], v[84:87], v[144:147]
 s_waitcnt vmcnt(12) lgkmcnt(0)
 s_barrier
 v_mfma_f32_16x16x32_bf16 v[96:99], v[24:27], v[40:43], v[96:99]
 ds_read_b128 v[72:75], v15 offset:16384
 ds_read_b64_tr_b16 v[56:57], v6 offset:40960
 v_cvt_pk_bf16_f32 v104, v104, v105
 v_cvt_pk_bf16_f32 v105, v106, v107
 v_cvt_pk_bf16_f32 v106, v108, v109
 v_cvt_pk_bf16_f32 v107, v110, v111
 s_xor_b32 s85, s4, 1
 s_mul_i32 s85, s85, 49152
 s_add_u32 s85, s85, s60
 v_mfma_f32_16x16x32_bf16 v[100:103], v[28:31], v[40:43], v[100:103]
 ds_read_b64_tr_b16 v[58:59], v6 offset:45056
 ds_read_b64_tr_b16 v[60:61], v7 offset:40960
 buffer_store_dwordx4 v[104:107], v13, s[8:11], s85 offen offset:0 sc1
 v_cvt_pk_bf16_f32 v120, v120, v121
 v_cvt_pk_bf16_f32 v121, v122, v123
 v_cvt_pk_bf16_f32 v122, v124, v125
 v_cvt_pk_bf16_f32 v123, v126, v127
 s_xor_b32 s85, s4, 1
 v_mfma_f32_16x16x32_bf16 v[116:119], v[28:31], v[44:47], v[116:119]
 ds_read_b64_tr_b16 v[62:63], v7 offset:45056
 ds_read_b128 v[76:79], v15 offset:17408
 s_mul_i32 s85, s85, 49152
 s_add_u32 s85, s85, s60
 buffer_store_dwordx4 v[120:123], v13, s[8:11], s85 offen offset:1024 sc1
 v_cvt_pk_bf16_f32 v128, v128, v129
 v_cvt_pk_bf16_f32 v129, v130, v131
 v_cvt_pk_bf16_f32 v130, v132, v133
 v_cvt_pk_bf16_f32 v131, v134, v135
 v_mfma_f32_16x16x32_bf16 v[112:115], v[24:27], v[44:47], v[112:115]
 ds_read_b64_tr_b16 v[64:65], v8 offset:40960
 ds_read_b64_tr_b16 v[66:67], v8 offset:45056
 s_xor_b32 s85, s4, 2
 s_mul_i32 s85, s85, 49152
 s_add_u32 s85, s85, s60
 s_add_u32 s85, s85, 16384
 buffer_store_dwordx4 v[128:131], v13, s[8:11], s85 offen offset:0 sc1
 v_cvt_pk_bf16_f32 v144, v144, v145
 v_mfma_f32_16x16x32_bf16 v[96:99], v[32:35], v[48:51], v[96:99]
 ds_read_b128 v[80:83], v15 offset:24576
 ds_read_b64_tr_b16 v[68:69], v9 offset:40960
 v_cvt_pk_bf16_f32 v145, v146, v147
 v_cvt_pk_bf16_f32 v146, v148, v149
 v_cvt_pk_bf16_f32 v147, v150, v151
 s_xor_b32 s85, s4, 2
 s_mul_i32 s85, s85, 49152
 s_add_u32 s85, s85, s60
 s_add_u32 s85, s85, 16384
 v_mfma_f32_16x16x32_bf16 v[100:103], v[36:39], v[48:51], v[100:103]
 ds_read_b64_tr_b16 v[70:71], v9 offset:45056
 ds_read_b128 v[84:87], v15 offset:25600
 buffer_store_dwordx4 v[144:147], v13, s[8:11], s85 offen offset:1024 sc1
 v_cvt_pk_bf16_f32 v136, v136, v137
 v_cvt_pk_bf16_f32 v137, v138, v139
 v_cvt_pk_bf16_f32 v138, v140, v141
 v_cvt_pk_bf16_f32 v139, v142, v143
 s_xor_b32 s85, s4, 3
 v_mfma_f32_16x16x32_bf16 v[116:119], v[36:39], v[52:55], v[116:119]
 s_mul_i32 s85, s85, 49152
 s_add_u32 s85, s85, s60
 s_add_u32 s85, s85, 32768
 buffer_store_dwordx4 v[136:139], v13, s[8:11], s85 offen offset:0 sc1
 v_cvt_pk_bf16_f32 v152, v152, v153
 v_cvt_pk_bf16_f32 v153, v154, v155
 v_cvt_pk_bf16_f32 v154, v156, v157
 v_mfma_f32_16x16x32_bf16 v[112:115], v[32:35], v[52:55], v[112:115]
 v_cvt_pk_bf16_f32 v155, v158, v159
 s_xor_b32 s85, s4, 3
 s_mul_i32 s85, s85, 49152
 s_add_u32 s85, s85, s60
 s_add_u32 s85, s85, 32768
 buffer_store_dwordx4 v[152:155], v13, s[8:11], s85 offen offset:1024 sc1
 s_waitcnt vmcnt(6) lgkmcnt(0)
 s_barrier
 v_mfma_f32_16x16x32_bf16 v[96:99], v[56:59], v[72:75], v[96:99]
 ds_read_b128 v[40:43], v15 offset:32768
 ds_read_b64_tr_b16 v[24:25], v6 offset:0
 v_mfma_f32_16x16x32_bf16 v[100:103], v[60:63], v[72:75], v[100:103]
 ds_read_b64_tr_b16 v[26:27], v6 offset:4096
 ds_read_b64_tr_b16 v[28:29], v7 offset:0
 v_mfma_f32_16x16x32_bf16 v[116:119], v[60:63], v[76:79], v[116:119]
 ds_read_b64_tr_b16 v[30:31], v7 offset:4096
 ds_read_b128 v[44:47], v15 offset:33792
 v_mfma_f32_16x16x32_bf16 v[112:115], v[56:59], v[76:79], v[112:115]
 ds_read_b64_tr_b16 v[32:33], v8 offset:0
 ds_read_b64_tr_b16 v[34:35], v8 offset:4096
 v_mfma_f32_16x16x32_bf16 v[96:99], v[64:67], v[80:83], v[96:99]
 ds_read_b128 v[48:51], v15 offset:40960
 ds_read_b64_tr_b16 v[36:37], v9 offset:0
 v_mfma_f32_16x16x32_bf16 v[100:103], v[68:71], v[80:83], v[100:103]
 ds_read_b64_tr_b16 v[38:39], v9 offset:4096
 ds_read_b128 v[52:55], v15 offset:41984
 v_mfma_f32_16x16x32_bf16 v[116:119], v[68:71], v[84:87], v[116:119]
 v_mfma_f32_16x16x32_bf16 v[112:115], v[64:67], v[84:87], v[112:115]
 s_waitcnt lgkmcnt(0)
 v_mfma_f32_16x16x32_bf16 v[96:99], v[24:27], v[40:43], v[96:99]
 ds_read_b128 v[72:75], v15 offset:49152
 ds_read_b64_tr_b16 v[56:57], v6 offset:8192
 s_xor_b32 s92, s71, 1024
 v_mov_b32 v91, 1
 v_mfma_f32_16x16x32_bf16 v[100:103], v[28:31], v[40:43], v[100:103]
 ds_read_b64_tr_b16 v[58:59], v6 offset:12288
 ds_read_b64_tr_b16 v[60:61], v7 offset:8192
 s_waitcnt vmcnt(4)
 v_mfma_f32_16x16x32_bf16 v[116:119], v[28:31], v[44:47], v[116:119]
 ds_read_b64_tr_b16 v[62:63], v7 offset:12288
 ds_read_b128 v[76:79], v15 offset:50176
 buffer_store_byte v91, off, s[8:11], s92 sc1
 s_xor_b32 s92, s71, 2048
 v_mfma_f32_16x16x32_bf16 v[112:115], v[24:27], v[44:47], v[112:115]
 ds_read_b64_tr_b16 v[64:65], v8 offset:8192
 ds_read_b64_tr_b16 v[66:67], v8 offset:12288
 v_mov_b32 v91, 1
 v_mfma_f32_16x16x32_bf16 v[96:99], v[32:35], v[48:51], v[96:99]
 ds_read_b128 v[80:83], v15 offset:57344
 ds_read_b64_tr_b16 v[68:69], v9 offset:8192
 s_waitcnt vmcnt(3)
 buffer_store_byte v91, off, s[8:11], s92 offset:1 sc1
 v_mfma_f32_16x16x32_bf16 v[100:103], v[36:39], v[48:51], v[100:103]
 ds_read_b64_tr_b16 v[70:71], v9 offset:12288
 ds_read_b128 v[84:87], v15 offset:58368
 s_xor_b32 s92, s71, 3072
 v_mfma_f32_16x16x32_bf16 v[116:119], v[36:39], v[52:55], v[116:119]
 v_mov_b32 v91, 1
 s_waitcnt vmcnt(2)
 v_mfma_f32_16x16x32_bf16 v[112:115], v[32:35], v[52:55], v[112:115]
 buffer_store_byte v91, off, s[8:11], s92 offset:2 sc1
 s_waitcnt lgkmcnt(0)
 v_mfma_f32_16x16x32_bf16 v[96:99], v[56:59], v[72:75], v[96:99]
 ds_read_b128 v[40:43], v17 offset:0
 ds_read_b64_tr_b16 v[24:25], v6 offset:16384
 v_mfma_f32_16x16x32_bf16 v[100:103], v[60:63], v[72:75], v[100:103]
 ds_read_b64_tr_b16 v[26:27], v6 offset:20480
 ds_read_b64_tr_b16 v[28:29], v7 offset:16384
 v_mfma_f32_16x16x32_bf16 v[116:119], v[60:63], v[76:79], v[116:119]
 ds_read_b64_tr_b16 v[30:31], v7 offset:20480
 ds_read_b128 v[44:47], v17 offset:1024
 v_mfma_f32_16x16x32_bf16 v[112:115], v[56:59], v[76:79], v[112:115]
 ds_read_b64_tr_b16 v[32:33], v8 offset:16384
 ds_read_b64_tr_b16 v[34:35], v8 offset:20480
 v_mfma_f32_16x16x32_bf16 v[96:99], v[64:67], v[80:83], v[96:99]
 ds_read_b128 v[48:51], v17 offset:8192
 ds_read_b64_tr_b16 v[36:37], v9 offset:16384
 v_mfma_f32_16x16x32_bf16 v[100:103], v[68:71], v[80:83], v[100:103]
 ds_read_b64_tr_b16 v[38:39], v9 offset:20480
 ds_read_b128 v[52:55], v17 offset:9216
 v_mfma_f32_16x16x32_bf16 v[116:119], v[68:71], v[84:87], v[116:119]
 v_mfma_f32_16x16x32_bf16 v[112:115], v[64:67], v[84:87], v[112:115]
 s_waitcnt lgkmcnt(0)
 v_mfma_f32_16x16x32_bf16 v[96:99], v[24:27], v[40:43], v[96:99]
 ds_read_b128 v[72:75], v17 offset:16384
 ds_read_b64_tr_b16 v[56:57], v6 offset:24576
 v_mfma_f32_16x16x32_bf16 v[100:103], v[28:31], v[40:43], v[100:103]
 ds_read_b64_tr_b16 v[58:59], v6 offset:28672
 ds_read_b64_tr_b16 v[60:61], v7 offset:24576
 v_mfma_f32_16x16x32_bf16 v[116:119], v[28:31], v[44:47], v[116:119]
 ds_read_b64_tr_b16 v[62:63], v7 offset:28672
 ds_read_b128 v[76:79], v17 offset:17408
 v_mfma_f32_16x16x32_bf16 v[112:115], v[24:27], v[44:47], v[112:115]
 ds_read_b64_tr_b16 v[64:65], v8 offset:24576
 ds_read_b64_tr_b16 v[66:67], v8 offset:28672
 v_mfma_f32_16x16x32_bf16 v[96:99], v[32:35], v[48:51], v[96:99]
 ds_read_b128 v[80:83], v17 offset:24576
 ds_read_b64_tr_b16 v[68:69], v9 offset:24576
 v_mfma_f32_16x16x32_bf16 v[100:103], v[36:39], v[48:51], v[100:103]
 ds_read_b64_tr_b16 v[70:71], v9 offset:28672
 ds_read_b128 v[84:87], v17 offset:25600
 v_mfma_f32_16x16x32_bf16 v[116:119], v[36:39], v[52:55], v[116:119]
 v_mfma_f32_16x16x32_bf16 v[112:115], v[32:35], v[52:55], v[112:115]
 s_waitcnt lgkmcnt(0)
 v_mfma_f32_16x16x32_bf16 v[96:99], v[56:59], v[72:75], v[96:99]
 s_buffer_load_dword s72, s[8:11], s71 glc
 v_mfma_f32_16x16x32_bf16 v[100:103], v[60:63], v[72:75], v[100:103]
 v_mfma_f32_16x16x32_bf16 v[116:119], v[60:63], v[76:79], v[116:119]
 v_mfma_f32_16x16x32_bf16 v[112:115], v[56:59], v[76:79], v[112:115]
 v_mfma_f32_16x16x32_bf16 v[96:99], v[64:67], v[80:83], v[96:99]
 v_mfma_f32_16x16x32_bf16 v[100:103], v[68:71], v[80:83], v[100:103]
 v_mfma_f32_16x16x32_bf16 v[116:119], v[68:71], v[84:87], v[116:119]
 v_mfma_f32_16x16x32_bf16 v[112:115], v[64:67], v[84:87], v[112:115]
 s_waitcnt lgkmcnt(0)
 s_cmp_eq_u32 s72, 0x10101
 s_cbranch_scc0 Lsp_84
Lok_85:
 s_mul_i32 s85, s4, 49152
 s_add_u32 s85, s85, s60
 buffer_load_dwordx4 v[160:163], v13, s[8:11], s85 offen offset:0 sc1
 buffer_load_dwordx4 v[164:167], v13, s[8:11], s85 offen offset:1024 sc1
 s_mul_i32 s85, s4, 49152
 s_add_u32 s85, s85, s60
 s_add_u32 s85, s85, 16384
 buffer_load_dwordx4 v[168:171], v13, s[8:11], s85 offen offset:0 sc1
 buffer_load_dwordx4 v[172:175], v13, s[8:11], s85 offen offset:1024 sc1
 s_mul_i32 s85, s4, 49152
 s_add_u32 s85, s85, s60
 s_add_u32 s85, s85, 32768
 buffer_load_dwordx4 v[176:179], v13, s[8:11], s85 offen offset:0 sc1
 buffer_load_dwordx4 v[180:183], v13, s[8:11], s85 offen offset:1024 sc1
 s_waitcnt vmcnt(4)
 v_lshlrev_b32 v208, 16, v160
 v_and_b32 v209, s89, v160
 v_add_f32 v192, v192, v208
 v_add_f32 v193, v193, v209
 v_lshlrev_b32 v210, 16, v161
 v_and_b32 v211, s89, v161
 v_add_f32 v194, v194, v210
 v_add_f32 v195, v195, v211
 v_lshlrev_b32 v208, 16, v162
 v_and_b32 v209, s89, v162
 v_add_f32 v196, v196, v208
 v_add_f32 v197, v197, v209
 v_lshlrev_b32 v210, 16, v163
 v_and_b32 v211, s89, v163
 v_add_f32 v198, v198, v210
 v_add_f32 v199, v199, v211
 v_lshlrev_b32 v208, 16, v164
 v_and_b32 v209, s89, v164
 v_add_f32 v200, v200, v208
 v_add_f32 v201, v201, v209
 v_lshlrev_b32 v210, 16, v165
 v_and_b32 v211, s89, v165
 v_add_f32 v202, v202, v210
 v_add_f32 v203, v203, v211
 v_lshlrev_b32 v208, 16, v166
 v_and_b32 v209, s89, v166
 v_add_f32 v204, v204, v208
 v_add_f32 v205, v205, v209
 v_lshlrev_b32 v210, 16, v167
 v_and_b32 v211, s89, v167
 v_add_f32 v206, v206, v210
 v_add_f32 v207, v207, v211
 s_waitcnt vmcnt(2)
 v_lshlrev_b32 v208, 16, v168
 v_and_b32 v209, s89, v168
 v_add_f32 v192, v192, v208
 v_add_f32 v193, v193, v209
 v_lshlrev_b32 v210, 16, v169
 v_and_b32 v211, s89, v169
 v_add_f32 v194, v194, v210
 v_add_f32 v195, v195, v211
 v_lshlrev_b32 v208, 16, v170
 v_and_b32 v209, s89, v170
 v_add_f32 v196, v196, v208
 v_add_f32 v197, v197, v209
 v_lshlrev_b32 v210, 16, v171
 v_and_b32 v211, s89, v171
 v_add_f32 v198, v198, v210
 v_add_f32 v199, v199, v211
 v_lshlrev_b32 v208, 16, v172
 v_and_b32 v209, s89, v172
 v_add_f32 v200, v200, v208
 v_add_f32 v201, v201, v209
 v_lshlrev_b32 v210, 16, v173
 v_and_b32 v211, s89, v173
 v_add_f32 v202, v202, v210
 v_add_f32 v203, v203, v211
 v_lshlrev_b32 v208, 16, v174
 v_and_b32 v209, s89, v174
 v_add_f32 v204, v204, v208
 v_add_f32 v205, v205, v209
 v_lshlrev_b32 v210, 16, v175
 v_and_b32 v211, s89, v175
 v_add_f32 v206, v206, v210
 v_add_f32 v207, v207, v211
 s_waitcnt vmcnt(0)
 v_lshlrev_b32 v208, 16, v176
 v_and_b32 v209, s89, v176
 v_add_f32 v192, v192, v208
 v_add_f32 v193, v193, v209
 v_lshlrev_b32 v210, 16, v177
 v_and_b32 v211, s89, v177
 v_add_f32 v194, v194, v210
 v_add_f32 v195, v195, v211
 v_lshlrev_b32 v208, 16, v178
 v_and_b32 v209, s89, v178
 v_add_f32 v196, v196, v208
 v_add_f32 v197, v197, v209
 v_lshlrev_b32 v210, 16, v179
 v_and_b32 v211, s89, v179
 v_add_f32 v198, v198, v210
 v_add_f32 v199, v199, v211
 v_lshlrev_b32 v208, 16, v180
 v_and_b32 v209, s89, v180
 v_add_f32 v200, v200, v208
 v_add_f32 v201, v201, v209
 v_lshlrev_b32 v210, 16, v181
 v_and_b32 v211, s89, v181
 v_add_f32 v202, v202, v210
 v_add_f32 v203, v203, v211
 v_lshlrev_b32 v208, 16, v182
 v_and_b32 v209, s89, v182
 v_add_f32 v204, v204, v208
 v_add_f32 v205, v205, v209
 v_lshlrev_b32 v210, 16, v183
 v_and_b32 v211, s89, v183
 v_add_f32 v206, v206, v210
 v_add_f32 v207, v207, v211
 v_add_f32 v96, v96, v192
 v_add_f32 v97, v97, v193
 v_add_f32 v98, v98, v194
 v_add_f32 v99, v99, v195
 v_add_f32 v100, v100, v196
 v_add_f32 v101, v101, v197
 v_add_f32 v102, v102, v198
 v_add_f32 v103, v103, v199
 v_cvt_pk_bf16_f32 v96, v96, v97
 v_cvt_pk_bf16_f32 v97, v98, v99
 v_cvt_pk_bf16_f32 v98, v100, v101
 v_cvt_pk_bf16_f32 v99, v102, v103
 s_nop 0
 v_permlane16_swap_b32 v96, v98
 v_permlane16_swap_b32 v97, v99
 buffer_store_dwordx4 v[96:99], v94, s[28:31], s61 offen
 v_add_f32 v112, v112, v200
 v_add_f32 v113, v113, v201
 v_add_f32 v114, v114, v202
 v_add_f32 v115, v115, v203
 v_add_f32 v116, v116, v204
 v_add_f32 v117, v117, v205
 v_add_f32 v118, v118, v206
 v_add_f32 v119, v119, v207
 v_cvt_pk_bf16_f32 v112, v112, v113
 v_cvt_pk_bf16_f32 v113, v114, v115
 v_cvt_pk_bf16_f32 v114, v116, v117
 v_cvt_pk_bf16_f32 v115, v118, v119
 s_nop 0
 v_permlane16_swap_b32 v112, v114
 v_permlane16_swap_b32 v113, v115
 buffer_store_dwordx4 v[112:115], v94, s[28:31], s66 offen
 s_endpgm
Lsp_81:
 s_mov_b32 s95, 0
Llp_83:
 s_buffer_load_dwordx2 s[72:73], s[8:11], s64 glc
 s_waitcnt lgkmcnt(0)
 s_add_u32 s95, s95, 1
 s_and_b32 s72, s72, s73
 s_cmp_eq_u32 s72, 0x1010101
 s_cbranch_scc1 Lok_82
 s_cmp_lt_u32 s95, 0x40000
 s_cbranch_scc1 Llp_83
 s_branch Lok_82
Lsp_84:
 s_mov_b32 s95, 0
Llp_86:
 s_buffer_load_dword s72, s[8:11], s71 glc
 s_waitcnt lgkmcnt(0)
 s_add_u32 s95, s95, 1
 s_cmp_eq_u32 s72, 0x10101
 s_cbranch_scc1 Lok_85
 s_cmp_lt_u32 s95, 0x40000
 s_cbranch_scc1 Llp_86
 s_branch Lok_85
L5_v03:
 s_lshl_b32 s52, s52, 12
 s_lshr_b32 s84, 0x21321321, s84
 s_and_b32 s84, s84, 0xfff
 s_or_b32 s52, s52, s84
 s_xor_b32 s52, s52, s96
 s_waitcnt vmcnt(12) lgkmcnt(0)
 s_barrier
 v_mfma_f32_16x16x32_bf16 v[96:99], v[24:27], v[40:43], v[96:99]
 ds_read_b128 v[72:75], v2 offset:16384
 v_mfma_f32_16x16x32_bf16 v[100:103], v[28:31], v[40:43], v[100:103]
 ds_read_b64_tr_b16 v[56:57], v6 offset:40960
 v_mfma_f32_16x16x32_bf16 v[104:107], v[32:35], v[40:43], v[104:107]
 ds_read_b64_tr_b16 v[58:59], v6 offset:45056
 v_mfma_f32_16x16x32_bf16 v[108:111], v[36:39], v[40:43], v[108:111]
 ds_read_b64_tr_b16 v[60:61], v7 offset:40960
 v_mfma_f32_16x16x32_bf16 v[124:127], v[36:39], v[44:47], v[124:127]
 ds_read_b64_tr_b16 v[62:63], v7 offset:45056
 v_mfma_f32_16x16x32_bf16 v[120:123], v[32:35], v[44:47], v[120:123]
 ds_read_b128 v[76:79], v2 offset:17408
 v_mfma_f32_16x16x32_bf16 v[116:119], v[28:31], v[44:47], v[116:119]
 ds_read_b64_tr_b16 v[64:65], v8 offset:40960
 v_mfma_f32_16x16x32_bf16 v[112:115], v[24:27], v[44:47], v[112:115]
 ds_read_b64_tr_b16 v[66:67], v8 offset:45056
 v_mfma_f32_16x16x32_bf16 v[128:131], v[24:27], v[48:51], v[128:131]
 ds_read_b128 v[80:83], v3 offset:16384
 s_add_u32 m0, s51, 32768
 s_add_u32 s63, s6, 0
 s_and_b32 s63, s63, 1
 s_mul_i32 s63, s63, 65536
 s_add_u32 s63, s63, s65
 v_mfma_f32_16x16x32_bf16 v[132:135], v[28:31], v[48:51], v[132:135]
 ds_read_b64_tr_b16 v[68:69], v9 offset:40960
 buffer_load_dwordx4 v10, s[20:23], s63 offen lds
 v_mfma_f32_16x16x32_bf16 v[136:139], v[32:35], v[48:51], v[136:139]
 ds_read_b64_tr_b16 v[70:71], v9 offset:45056
 v_mfma_f32_16x16x32_bf16 v[140:143], v[36:39], v[48:51], v[140:143]
 ds_read_b128 v[84:87], v3 offset:17408
 v_mfma_f32_16x16x32_bf16 v[156:159], v[36:39], v[52:55], v[156:159]
 v_mfma_f32_16x16x32_bf16 v[152:155], v[32:35], v[52:55], v[152:155]
 v_mfma_f32_16x16x32_bf16 v[148:151], v[28:31], v[52:55], v[148:151]
 v_mfma_f32_16x16x32_bf16 v[144:147], v[24:27], v[52:55], v[144:147]
 s_waitcnt vmcnt(10) lgkmcnt(0)
 s_barrier
 v_mfma_f32_16x16x32_bf16 v[96:99], v[56:59], v[72:75], v[96:99]
 ds_read_b128 v[40:43], v2 offset:32768
 v_mfma_f32_16x16x32_bf16 v[100:103], v[60:63], v[72:75], v[100:103]
 ds_read_b64_tr_b16 v[24:25], v6 offset:0
 v_mfma_f32_16x16x32_bf16 v[104:107], v[64:67], v[72:75], v[104:107]
 ds_read_b64_tr_b16 v[26:27], v6 offset:4096
 v_mfma_f32_16x16x32_bf16 v[108:111], v[68:71], v[72:75], v[108:111]
 ds_read_b64_tr_b16 v[28:29], v7 offset:0
 v_mfma_f32_16x16x32_bf16 v[124:127], v[68:71], v[76:79], v[124:127]
 ds_read_b64_tr_b16 v[30:31], v7 offset:4096
 s_lshl2_add_u32 s64, s83, s4
 v_mfma_f32_16x16x32_bf16 v[120:123], v[64:67], v[76:79], v[120:123]
 ds_read_b128 v[44:47], v2 offset:33792
 s_lshl2_add_u32 s64, s64, s7
 s_lshl_b32 s64, s64, 7
 v_mfma_f32_16x16x32_bf16 v[116:119], v[60:63], v[76:79], v[116:119]
 ds_read_b64_tr_b16 v[32:33], v8 offset:0
 s_add_u32 s64, s64, 39927808
 v_mfma_f32_16x16x32_bf16 v[112:115], v[56:59], v[76:79], v[112:115]
 ds_read_b64_tr_b16 v[34:35], v8 offset:4096
 s_buffer_load_dwordx2 s[72:73], s[8:11], s64 glc
 v_mfma_f32_16x16x32_bf16 v[128:131], v[56:59], v[80:83], v[128:131]
 ds_read_b128 v[48:51], v3 offset:32768
 s_add_u32 m0, s51, 40960
 s_add_u32 s63, s6, 1
 s_and_b32 s63, s63, 1
 s_mul_i32 s63, s63, 65536
 s_add_u32 s63, s63, s65
 v_mfma_f32_16x16x32_bf16 v[132:135], v[60:63], v[80:83], v[132:135]
 ds_read_b64_tr_b16 v[36:37], v9 offset:0
 buffer_load_dwordx4 v10, s[20:23], s63 offen lds
 v_mfma_f32_16x16x32_bf16 v[136:139], v[64:67], v[80:83], v[136:139]
 ds_read_b64_tr_b16 v[38:39], v9 offset:4096
 v_mfma_f32_16x16x32_bf16 v[140:143], v[68:71], v[80:83], v[140:143]
 ds_read_b128 v[52:55], v3 offset:33792
 ds_read_b32 v90, v0
 ds_read_b32 v90, v0
 v_mfma_f32_16x16x32_bf16 v[156:159], v[68:71], v[84:87], v[156:159]
 v_mfma_f32_16x16x32_bf16 v[152:155], v[64:67], v[84:87], v[152:155]
 v_mfma_f32_16x16x32_bf16 v[148:151], v[60:63], v[84:87], v[148:151]
 v_mfma_f32_16x16x32_bf16 v[144:147], v[56:59], v[84:87], v[144:147]
 s_waitcnt vmcnt(8) lgkmcnt(2)
 s_barrier
 v_mfma_f32_16x16x32_bf16 v[96:99], v[24:27], v[40:43], v[96:99]
 ds_read_b128 v[72:75], v2 offset:49152
 v_mfma_f32_16x16x32_bf16 v[100:103], v[28:31], v[40:43], v[100:103]
 ds_read_b64_tr_b16 v[56:57], v6 offset:8192
 v_mfma_f32_16x16x32_bf16 v[104:107], v[32:35], v[40:43], v[104:107]
 ds_read_b64_tr_b16 v[58:59], v6 offset:12288
 v_mfma_f32_16x16x32_bf16 v[108:111], v[36:39], v[40:43], v[108:111]
 ds_read_b64_tr_b16 v[60:61], v7 offset:8192
 v_mfma_f32_16x16x32_bf16 v[124:127], v[36:39], v[44:47], v[124:127]
 ds_read_b64_tr_b16 v[62:63], v7 offset:12288
 v_mfma_f32_16x16x32_bf16 v[120:123], v[32:35], v[44:47], v[120:123]
 ds_read_b128 v[76:79], v2 offset:50176
 v_mfma_f32_16x16x32_bf16 v[116:119], v[28:31], v[44:47], v[116:119]
 ds_read_b64_tr_b16 v[64:65], v8 offset:8192
 v_mfma_f32_16x16x32_bf16 v[112:115], v[24:27], v[44:47], v[112:115]
 ds_read_b64_tr_b16 v[66:67], v8 offset:12288
 v_mfma_f32_16x16x32_bf16 v[128:131], v[24:27], v[48:51], v[128:131]
 ds_read_b128 v[80:83], v3 offset:49152
 s_add_u32 m0, s51, 0
 s_bfe_u32 s63, s52, 0x40000
 s_lshl_b32 s63, s63, 17
 s_add_u32 s63, s63, s58
 v_mfma_f32_16x16x32_bf16 v[132:135], v[28:31], v[48:51], v[132:135]
 ds_read_b64_tr_b16 v[68:69], v9 offset:8192
 buffer_load_dwordx4 v11, s[20:23], s63 offen lds
 v_mfma_f32_16x16x32_bf16 v[136:139], v[32:35], v[48:51], v[136:139]
 ds_read_b64_tr_b16 v[70:71], v9 offset:12288
 v_mfma_f32_16x16x32_bf16 v[140:143], v[36:39], v[48:51], v[140:143]
 ds_read_b128 v[84:87], v3 offset:50176
 v_mfma_f32_16x16x32_bf16 v[156:159], v[36:39], v[52:55], v[156:159]
 v_mfma_f32_16x16x32_bf16 v[152:155], v[32:35], v[52:55], v[152:155]
 v_mfma_f32_16x16x32_bf16 v[148:151], v[28:31], v[52:55], v[148:151]
 v_mfma_f32_16x16x32_bf16 v[144:147], v[24:27], v[52:55], v[144:147]
 s_waitcnt lgkmcnt(0)
 s_and_b32 s72, s72, s73
 s_cmp_eq_u32 s72, 0x1010101
 s_cbranch_scc0 Lsp_87
Lok_88:
 s_waitcnt vmcnt(6) lgkmcnt(0)
 s_barrier
 v_mfma_f32_16x16x32_bf16 v[96:99], v[56:59], v[72:75], v[96:99]
 ds_read_b128 v[40:43], v4 offset:0
 v_mfma_f32_16x16x32_bf16 v[100:103], v[60:63], v[72:75], v[100:103]
 ds_read_b64_tr_b16 v[24:25], v6 offset:16384
 v_mfma_f32_16x16x32_bf16 v[104:107], v[64:67], v[72:75], v[104:107]
 ds_read_b64_tr_b16 v[26:27], v6 offset:20480
 s_add_u32 m0, s50, 0
 s_add_u32 s62, s6, 0
 s_and_b32 s62, s62, 1
 s_mul_i32 s62, s62, 16384
 s_add_u32 s62, s62, s54
 v_mfma_f32_16x16x32_bf16 v[108:111], v[68:71], v[72:75], v[108:111]
 ds_read_b64_tr_b16 v[28:29], v7 offset:16384
 buffer_load_dwordx4 v13, s[8:11], s62 offen offset:0 sc1 lds
 v_mfma_f32_16x16x32_bf16 v[124:127], v[68:71], v[76:79], v[124:127]
 ds_read_b64_tr_b16 v[30:31], v7 offset:20480
 v_mfma_f32_16x16x32_bf16 v[120:123], v[64:67], v[76:79], v[120:123]
 ds_read_b128 v[44:47], v4 offset:1024
 buffer_load_dwordx4 v13, s[8:11], s62 offen offset:1024 sc1 lds
 v_mfma_f32_16x16x32_bf16 v[116:119], v[60:63], v[76:79], v[116:119]
 ds_read_b64_tr_b16 v[32:33], v8 offset:16384
 s_add_u32 m0, s50, 16384
 s_add_u32 s62, s6, 1
 s_and_b32 s62, s62, 1
 s_mul_i32 s62, s62, 16384
 s_add_u32 s62, s62, s54
 v_mfma_f32_16x16x32_bf16 v[112:115], v[56:59], v[76:79], v[112:115]
 ds_read_b64_tr_b16 v[34:35], v8 offset:20480
 buffer_load_dwordx4 v13, s[8:11], s62 offen offset:0 sc1 lds
 v_mfma_f32_16x16x32_bf16 v[128:131], v[56:59], v[80:83], v[128:131]
 ds_read_b128 v[48:51], v5 offset:0
 v_mfma_f32_16x16x32_bf16 v[132:135], v[60:63], v[80:83], v[132:135]
 ds_read_b64_tr_b16 v[36:37], v9 offset:16384
 v_mfma_f32_16x16x32_bf16 v[136:139], v[64:67], v[80:83], v[136:139]
 ds_read_b64_tr_b16 v[38:39], v9 offset:20480
 buffer_load_dwordx4 v13, s[8:11], s62 offen offset:1024 sc1 lds
 v_mfma_f32_16x16x32_bf16 v[140:143], v[68:71], v[80:83], v[140:143]
 ds_read_b128 v[52:55], v5 offset:1024
 s_add_u32 m0, s50, 32768
 s_bfe_u32 s62, s52, 0x40000
 s_lshl_b32 s62, s62, 15
 s_add_u32 s62, s62, s57
 v_mfma_f32_16x16x32_bf16 v[156:159], v[68:71], v[84:87], v[156:159]
 buffer_load_dwordx4 v0, s[8:11], s62 offen offset:0 sc1 lds
 v_mfma_f32_16x16x32_bf16 v[152:155], v[64:67], v[84:87], v[152:155]
 v_mfma_f32_16x16x32_bf16 v[148:151], v[60:63], v[84:87], v[148:151]
 buffer_load_dwordx4 v0, s[8:11], s62 offen offset:1024 sc1 lds
 v_mfma_f32_16x16x32_bf16 v[144:147], v[56:59], v[84:87], v[144:147]
 s_waitcnt vmcnt(9) lgkmcnt(0)
 s_barrier
 v_mfma_f32_16x16x32_bf16 v[96:99], v[24:27], v[40:43], v[96:99]
 ds_read_b128 v[72:75], v4 offset:16384
 s_mov_b32 s89, 0xffff0000
 s_waitcnt vmcnt(28)
 v_mfma_f32_16x16x32_bf16 v[100:103], v[28:31], v[40:43], v[100:103]
 ds_read_b64_tr_b16 v[56:57], v6 offset:24576
 v_permlane16_swap_b32 v184, v186
 v_mfma_f32_16x16x32_bf16 v[104:107], v[32:35], v[40:43], v[104:107]
 ds_read_b64_tr_b16 v[58:59], v6 offset:28672
 v_permlane16_swap_b32 v185, v187
 v_permlane16_swap_b32 v188, v190
 s_add_u32 m0, s50, 49152
 s_bfe_u32 s62, s52, 0x40004
 s_lshl_b32 s62, s62, 15
 s_add_u32 s62, s62, s57
 v_mfma_f32_16x16x32_bf16 v[108:111], v[36:39], v[40:43], v[108:111]
 ds_read_b64_tr_b16 v[60:61], v7 offset:24576
 buffer_load_dwordx4 v0, s[8:11], s62 offen offset:0 sc1 lds
 v_permlane16_swap_b32 v189, v191
 v_mfma_f32_16x16x32_bf16 v[124:127], v[36:39], v[44:47], v[124:127]
 ds_read_b64_tr_b16 v[62:63], v7 offset:28672
 v_lshlrev_b32 v192, 16, v184
 v_mfma_f32_16x16x32_bf16 v[120:123], v[32:35], v[44:47], v[120:123]
 ds_read_b128 v[76:79], v4 offset:17408
 buffer_load_dwordx4 v0, s[8:11], s62 offen offset:1024 sc1 lds
 v_and_b32 v193, s89, v184
 v_lshlrev_b32 v194, 16, v185
 v_mfma_f32_16x16x32_bf16 v[116:119], v[28:31], v[44:47], v[116:119]
 ds_read_b64_tr_b16 v[64:65], v8 offset:24576
 v_and_b32 v195, s89, v185
 s_add_u32 m0, s51, 8192
 s_bfe_u32 s63, s52, 0x40004
 s_lshl_b32 s63, s63, 17
 s_add_u32 s63, s63, s58
 v_mfma_f32_16x16x32_bf16 v[112:115], v[24:27], v[44:47], v[112:115]
 ds_read_b64_tr_b16 v[66:67], v8 offset:28672
 buffer_load_dwordx4 v11, s[20:23], s63 offen lds
 v_lshlrev_b32 v196, 16, v186
 v_mfma_f32_16x16x32_bf16 v[128:131], v[24:27], v[48:51], v[128:131]
 ds_read_b128 v[80:83], v5 offset:16384
 v_and_b32 v197, s89, v186
 v_lshlrev_b32 v198, 16, v187
 v_mfma_f32_16x16x32_bf16 v[132:135], v[28:31], v[48:51], v[132:135]
 ds_read_b64_tr_b16 v[68:69], v9 offset:24576
 v_and_b32 v199, s89, v187
 s_add_u32 m0, s50, 65536
 s_bfe_u32 s62, s52, 0x40008
 s_lshl_b32 s62, s62, 15
 s_add_u32 s62, s62, s57
 v_mfma_f32_16x16x32_bf16 v[136:139], v[32:35], v[48:51], v[136:139]
 ds_read_b64_tr_b16 v[70:71], v9 offset:28672
 buffer_load_dwordx4 v0, s[8:11], s62 offen offset:0 sc1 lds
 v_lshlrev_b32 v200, 16, v188
 v_and_b32 v201, s89, v188
 v_mfma_f32_16x16x32_bf16 v[140:143], v[36:39], v[48:51], v[140:143]
 ds_read_b128 v[84:87], v5 offset:17408
 v_lshlrev_b32 v202, 16, v189
 v_mfma_f32_16x16x32_bf16 v[156:159], v[36:39], v[52:55], v[156:159]
 buffer_load_dwordx4 v0, s[8:11], s62 offen offset:1024 sc1 lds
 v_and_b32 v203, s89, v189
 v_mfma_f32_16x16x32_bf16 v[152:155], v[32:35], v[52:55], v[152:155]
 v_lshlrev_b32 v204, 16, v190
 v_and_b32 v205, s89, v190
 s_add_u32 m0, s51, 16384
 s_bfe_u32 s63, s52, 0x40008
 s_lshl_b32 s63, s63, 17
 s_add_u32 s63, s63, s58
 v_mfma_f32_16x16x32_bf16 v[148:151], v[28:31], v[52:55], v[148:151]
 buffer_load_dwordx4 v11, s[20:23], s63 offen lds
 v_lshlrev_b32 v206, 16, v191
 v_mfma_f32_16x16x32_bf16 v[144:147], v[24:27], v[52:55], v[144:147]
 v_and_b32 v207, s89, v191
 s_waitcnt vmcnt(10) lgkmcnt(0)
 s_barrier
 v_mfma_f32_16x16x32_bf16 v[96:99], v[56:59], v[72:75], v[96:99]
 ds_read_b128 v[40:43], v2 offset:0
 v_mfma_f32_16x16x32_bf16 v[100:103], v[60:63], v[72:75], v[100:103]
 ds_read_b64_tr_b16 v[24:25], v6 offset:32768
 v_mfma_f32_16x16x32_bf16 v[104:107], v[64:67], v[72:75], v[104:107]
 ds_read_b64_tr_b16 v[26:27], v6 offset:36864
 v_mfma_f32_16x16x32_bf16 v[108:111], v[68:71], v[72:75], v[108:111]
 ds_read_b64_tr_b16 v[28:29], v7 offset:32768
 s_add_u32 m0, s50, 81920
 s_bfe_u32 s62, s52, 0x4000c
 s_lshl_b32 s62, s62, 15
 s_add_u32 s62, s62, s57
 v_mfma_f32_16x16x32_bf16 v[124:127], v[68:71], v[76:79], v[124:127]
 ds_read_b64_tr_b16 v[30:31], v7 offset:36864
 buffer_load_dwordx4 v0, s[8:11], s62 offen offset:0 sc1 lds
 v_mfma_f32_16x16x32_bf16 v[120:123], v[64:67], v[76:79], v[120:123]
 ds_read_b128 v[44:47], v2 offset:1024
 v_mfma_f32_16x16x32_bf16 v[116:119], v[60:63], v[76:79], v[116:119]
 ds_read_b64_tr_b16 v[32:33], v8 offset:32768
 v_mfma_f32_16x16x32_bf16 v[112:115], v[56:59], v[76:79], v[112:115]
 ds_read_b64_tr_b16 v[34:35], v8 offset:36864
 v_mfma_f32_16x16x32_bf16 v[128:131], v[56:59], v[80:83], v[128:131]
 ds_read_b128 v[48:51], v3 offset:0
 v_mfma_f32_16x16x32_bf16 v[132:135], v[60:63], v[80:83], v[132:135]
 ds_read_b64_tr_b16 v[36:37], v9 offset:32768
 buffer_load_dwordx4 v0, s[8:11], s62 offen offset:1024 sc1 lds
 v_mfma_f32_16x16x32_bf16 v[136:139], v[64:67], v[80:83], v[136:139]
 ds_read_b64_tr_b16 v[38:39], v9 offset:36864
 v_mfma_f32_16x16x32_bf16 v[140:143], v[68:71], v[80:83], v[140:143]
 ds_read_b128 v[52:55], v3 offset:1024
 v_mfma_f32_16x16x32_bf16 v[156:159], v[68:71], v[84:87], v[156:159]
 s_add_u32 m0, s51, 24576
 s_bfe_u32 s63, s52, 0x4000c
 s_lshl_b32 s63, s63, 17
 s_add_u32 s63, s63, s58
 v_mfma_f32_16x16x32_bf16 v[152:155], v[64:67], v[84:87], v[152:155]
 buffer_load_dwordx4 v11, s[20:23], s63 offen lds
 v_mfma_f32_16x16x32_bf16 v[148:151], v[60:63], v[84:87], v[148:151]
 v_mfma_f32_16x16x32_bf16 v[144:147], v[56:59], v[84:87], v[144:147]
 s_waitcnt vmcnt(11) lgkmcnt(0)
 s_barrier
 v_mfma_f32_16x16x32_bf16 v[96:99], v[24:27], v[40:43], v[96:99]
 ds_read_b128 v[72:75], v2 offset:16384
 v_mfma_f32_16x16x32_bf16 v[100:103], v[28:31], v[40:43], v[100:103]
 ds_read_b64_tr_b16 v[56:57], v6 offset:40960
 v_mfma_f32_16x16x32_bf16 v[104:107], v[32:35], v[40:43], v[104:107]
 ds_read_b64_tr_b16 v[58:59], v6 offset:45056
 v_mfma_f32_16x16x32_bf16 v[108:111], v[36:39], v[40:43], v[108:111]
 ds_read_b64_tr_b16 v[60:61], v7 offset:40960
 s_add_u32 m0, s50, 0
 s_bfe_u32 s62, s52, 0x40010
 s_lshl_b32 s62, s62, 15
 s_add_u32 s62, s62, s57
 v_mfma_f32_16x16x32_bf16 v[124:127], v[36:39], v[44:47], v[124:127]
 ds_read_b64_tr_b16 v[62:63], v7 offset:45056
 buffer_load_dwordx4 v0, s[8:11], s62 offen offset:0 sc1 lds
 v_mfma_f32_16x16x32_bf16 v[120:123], v[32:35], v[44:47], v[120:123]
 ds_read_b128 v[76:79], v2 offset:17408
 v_mfma_f32_16x16x32_bf16 v[116:119], v[28:31], v[44:47], v[116:119]
 ds_read_b64_tr_b16 v[64:65], v8 offset:40960
 v_mfma_f32_16x16x32_bf16 v[112:115], v[24:27], v[44:47], v[112:115]
 ds_read_b64_tr_b16 v[66:67], v8 offset:45056
 v_mfma_f32_16x16x32_bf16 v[128:131], v[24:27], v[48:51], v[128:131]
 ds_read_b128 v[80:83], v3 offset:16384
 v_mfma_f32_16x16x32_bf16 v[132:135], v[28:31], v[48:51], v[132:135]
 ds_read_b64_tr_b16 v[68:69], v9 offset:40960
 buffer_load_dwordx4 v0, s[8:11], s62 offen offset:1024 sc1 lds
 v_mfma_f32_16x16x32_bf16 v[136:139], v[32:35], v[48:51], v[136:139]
 ds_read_b64_tr_b16 v[70:71], v9 offset:45056
 v_mfma_f32_16x16x32_bf16 v[140:143], v[36:39], v[48:51], v[140:143]
 ds_read_b128 v[84:87], v3 offset:17408
 v_mfma_f32_16x16x32_bf16 v[156:159], v[36:39], v[52:55], v[156:159]
 s_add_u32 m0, s51, 32768
 s_bfe_u32 s63, s52, 0x40010
 s_lshl_b32 s63, s63, 17
 s_add_u32 s63, s63, s58
 v_mfma_f32_16x16x32_bf16 v[152:155], v[32:35], v[52:55], v[152:155]
 buffer_load_dwordx4 v11, s[20:23], s63 offen lds
 v_mfma_f32_16x16x32_bf16 v[148:151], v[28:31], v[52:55], v[148:151]
 v_mfma_f32_16x16x32_bf16 v[144:147], v[24:27], v[52:55], v[144:147]
 s_waitcnt vmcnt(12) lgkmcnt(0)
 s_barrier
 v_mfma_f32_16x16x32_bf16 v[96:99], v[56:59], v[72:75], v[96:99]
 ds_read_b128 v[40:43], v15 offset:32768
 v_mfma_f32_16x16x32_bf16 v[100:103], v[60:63], v[72:75], v[100:103]
 ds_read_b64_tr_b16 v[24:25], v6 offset:0
 v_mfma_f32_16x16x32_bf16 v[104:107], v[64:67], v[72:75], v[104:107]
 ds_read_b64_tr_b16 v[26:27], v6 offset:4096
 v_mfma_f32_16x16x32_bf16 v[108:111], v[68:71], v[72:75], v[108:111]
 ds_read_b64_tr_b16 v[28:29], v7 offset:0
 s_add_u32 m0, s50, 16384
 s_bfe_u32 s62, s52, 0x40014
 s_lshl_b32 s62, s62, 15
 s_add_u32 s62, s62, s57
 v_mfma_f32_16x16x32_bf16 v[124:127], v[68:71], v[76:79], v[124:127]
 ds_read_b64_tr_b16 v[30:31], v7 offset:4096
 buffer_load_dwordx4 v0, s[8:11], s62 offen offset:0 sc1 lds
 v_mfma_f32_16x16x32_bf16 v[120:123], v[64:67], v[76:79], v[120:123]
 ds_read_b128 v[44:47], v15 offset:33792
 v_mfma_f32_16x16x32_bf16 v[116:119], v[60:63], v[76:79], v[116:119]
 ds_read_b64_tr_b16 v[32:33], v8 offset:0
 v_mfma_f32_16x16x32_bf16 v[112:115], v[56:59], v[76:79], v[112:115]
 ds_read_b64_tr_b16 v[34:35], v8 offset:4096
 v_mfma_f32_16x16x32_bf16 v[128:131], v[56:59], v[80:83], v[128:131]
 ds_read_b128 v[48:51], v15 offset:40960
 v_mfma_f32_16x16x32_bf16 v[132:135], v[60:63], v[80:83], v[132:135]
 ds_read_b64_tr_b16 v[36:37], v9 offset:0
 buffer_load_dwordx4 v0, s[8:11], s62 offen offset:1024 sc1 lds
 v_mfma_f32_16x16x32_bf16 v[136:139], v[64:67], v[80:83], v[136:139]
 ds_read_b64_tr_b16 v[38:39], v9 offset:4096
 v_mfma_f32_16x16x32_bf16 v[140:143], v[68:71], v[80:83], v[140:143]
 ds_read_b128 v[52:55], v15 offset:41984
 v_mfma_f32_16x16x32_bf16 v[156:159], v[68:71], v[84:87], v[156:159]
 s_add_u32 m0, s51, 40960
 s_bfe_u32 s63, s52, 0x40014
 s_lshl_b32 s63, s63, 17
 s_add_u32 s63, s63, s58
 v_mfma_f32_16x16x32_bf16 v[152:155], v[64:67], v[84:87], v[152:155]
 buffer_load_dwordx4 v11, s[20:23], s63 offen lds
 v_mfma_f32_16x16x32_bf16 v[148:151], v[60:63], v[84:87], v[148:151]
 v_mfma_f32_16x16x32_bf16 v[144:147], v[56:59], v[84:87], v[144:147]
 s_waitcnt vmcnt(12) lgkmcnt(0)
 s_barrier
 v_mfma_f32_16x16x32_bf16 v[96:99], v[24:27], v[40:43], v[96:99]
 ds_read_b128 v[72:75], v15 offset:49152
 ds_read_b64_tr_b16 v[56:57], v6 offset:8192
 v_cvt_pk_bf16_f32 v104, v104, v105
 v_cvt_pk_bf16_f32 v105, v106, v107
 v_cvt_pk_bf16_f32 v106, v108, v109
 v_cvt_pk_bf16_f32 v107, v110, v111
 s_xor_b32 s85, s4, 1
 s_mul_i32 s85, s85, 49152
 s_add_u32 s85, s85, s60
 v_mfma_f32_16x16x32_bf16 v[100:103], v[28:31], v[40:43], v[100:103]
 ds_read_b64_tr_b16 v[58:59], v6 offset:12288
 ds_read_b64_tr_b16 v[60:61], v7 offset:8192
 buffer_store_dwordx4 v[104:107], v13, s[8:11], s85 offen offset:0 sc1
 v_cvt_pk_bf16_f32 v120, v120, v121
 v_cvt_pk_bf16_f32 v121, v122, v123
 v_cvt_pk_bf16_f32 v122, v124, v125
 v_cvt_pk_bf16_f32 v123, v126, v127
 s_xor_b32 s85, s4, 1
 v_mfma_f32_16x16x32_bf16 v[116:119], v[28:31], v[44:47], v[116:119]
 ds_read_b64_tr_b16 v[62:63], v7 offset:12288
 ds_read_b128 v[76:79], v15 offset:50176
 s_mul_i32 s85, s85, 49152
 s_add_u32 s85, s85, s60
 buffer_store_dwordx4 v[120:123], v13, s[8:11], s85 offen offset:1024 sc1
 v_cvt_pk_bf16_f32 v128, v128, v129
 v_cvt_pk_bf16_f32 v129, v130, v131
 v_cvt_pk_bf16_f32 v130, v132, v133
 v_cvt_pk_bf16_f32 v131, v134, v135
 v_mfma_f32_16x16x32_bf16 v[112:115], v[24:27], v[44:47], v[112:115]
 ds_read_b64_tr_b16 v[64:65], v8 offset:8192
 ds_read_b64_tr_b16 v[66:67], v8 offset:12288
 s_xor_b32 s85, s4, 2
 s_mul_i32 s85, s85, 49152
 s_add_u32 s85, s85, s60
 s_add_u32 s85, s85, 16384
 buffer_store_dwordx4 v[128:131], v13, s[8:11], s85 offen offset:0 sc1
 v_cvt_pk_bf16_f32 v144, v144, v145
 v_mfma_f32_16x16x32_bf16 v[96:99], v[32:35], v[48:51], v[96:99]
 ds_read_b128 v[80:83], v15 offset:57344
 ds_read_b64_tr_b16 v[68:69], v9 offset:8192
 v_cvt_pk_bf16_f32 v145, v146, v147
 v_cvt_pk_bf16_f32 v146, v148, v149
 v_cvt_pk_bf16_f32 v147, v150, v151
 s_xor_b32 s85, s4, 2
 s_mul_i32 s85, s85, 49152
 s_add_u32 s85, s85, s60
 s_add_u32 s85, s85, 16384
 v_mfma_f32_16x16x32_bf16 v[100:103], v[36:39], v[48:51], v[100:103]
 ds_read_b64_tr_b16 v[70:71], v9 offset:12288
 ds_read_b128 v[84:87], v15 offset:58368
 buffer_store_dwordx4 v[144:147], v13, s[8:11], s85 offen offset:1024 sc1
 v_cvt_pk_bf16_f32 v136, v136, v137
 v_cvt_pk_bf16_f32 v137, v138, v139
 v_cvt_pk_bf16_f32 v138, v140, v141
 v_cvt_pk_bf16_f32 v139, v142, v143
 s_xor_b32 s85, s4, 3
 v_mfma_f32_16x16x32_bf16 v[116:119], v[36:39], v[52:55], v[116:119]
 s_mul_i32 s85, s85, 49152
 s_add_u32 s85, s85, s60
 s_add_u32 s85, s85, 32768
 buffer_store_dwordx4 v[136:139], v13, s[8:11], s85 offen offset:0 sc1
 v_cvt_pk_bf16_f32 v152, v152, v153
 v_cvt_pk_bf16_f32 v153, v154, v155
 v_cvt_pk_bf16_f32 v154, v156, v157
 v_mfma_f32_16x16x32_bf16 v[112:115], v[32:35], v[52:55], v[112:115]
 v_cvt_pk_bf16_f32 v155, v158, v159
 s_xor_b32 s85, s4, 3
 s_mul_i32 s85, s85, 49152
 s_add_u32 s85, s85, s60
 s_add_u32 s85, s85, 32768
 buffer_store_dwordx4 v[152:155], v13, s[8:11], s85 offen offset:1024 sc1
 s_waitcnt vmcnt(6) lgkmcnt(0)
 s_barrier
 v_mfma_f32_16x16x32_bf16 v[96:99], v[56:59], v[72:75], v[96:99]
 ds_read_b128 v[40:43], v17 offset:0
 ds_read_b64_tr_b16 v[24:25], v6 offset:16384
 v_mfma_f32_16x16x32_bf16 v[100:103], v[60:63], v[72:75], v[100:103]
 ds_read_b64_tr_b16 v[26:27], v6 offset:20480
 ds_read_b64_tr_b16 v[28:29], v7 offset:16384
 v_mfma_f32_16x16x32_bf16 v[116:119], v[60:63], v[76:79], v[116:119]
 ds_read_b64_tr_b16 v[30:31], v7 offset:20480
 ds_read_b128 v[44:47], v17 offset:1024
 v_mfma_f32_16x16x32_bf16 v[112:115], v[56:59], v[76:79], v[112:115]
 ds_read_b64_tr_b16 v[32:33], v8 offset:16384
 ds_read_b64_tr_b16 v[34:35], v8 offset:20480
 v_mfma_f32_16x16x32_bf16 v[96:99], v[64:67], v[80:83], v[96:99]
 ds_read_b128 v[48:51], v17 offset:8192
 ds_read_b64_tr_b16 v[36:37], v9 offset:16384
 v_mfma_f32_16x16x32_bf16 v[100:103], v[68:71], v[80:83], v[100:103]
 ds_read_b64_tr_b16 v[38:39], v9 offset:20480
 ds_read_b128 v[52:55], v17 offset:9216
 v_mfma_f32_16x16x32_bf16 v[116:119], v[68:71], v[84:87], v[116:119]
 v_mfma_f32_16x16x32_bf16 v[112:115], v[64:67], v[84:87], v[112:115]
 s_waitcnt lgkmcnt(0)
 v_mfma_f32_16x16x32_bf16 v[96:99], v[24:27], v[40:43], v[96:99]
 ds_read_b128 v[72:75], v17 offset:16384
 ds_read_b64_tr_b16 v[56:57], v6 offset:24576
 s_xor_b32 s92, s71, 1024
 v_mov_b32 v91, 1
 v_mfma_f32_16x16x32_bf16 v[100:103], v[28:31], v[40:43], v[100:103]
 ds_read_b64_tr_b16 v[58:59], v6 offset:28672
 ds_read_b64_tr_b16 v[60:61], v7 offset:24576
 s_waitcnt vmcnt(4)
 v_mfma_f32_16x16x32_bf16 v[116:119], v[28:31], v[44:47], v[116:119]
 ds_read_b64_tr_b16 v[62:63], v7 offset:28672
 ds_read_b128 v[76:79], v17 offset:17408
 buffer_store_byte v91, off, s[8:11], s92 sc1
 s_xor_b32 s92, s71, 2048
 v_mfma_f32_16x16x32_bf16 v[112:115], v[24:27], v[44:47], v[112:115]
 ds_read_b64_tr_b16 v[64:65], v8 offset:24576
 ds_read_b64_tr_b16 v[66:67], v8 offset:28672
 v_mov_b32 v91, 1
 v_mfma_f32_16x16x32_bf16 v[96:99], v[32:35], v[48:51], v[96:99]
 ds_read_b128 v[80:83], v17 offset:24576
 ds_read_b64_tr_b16 v[68:69], v9 offset:24576
 s_waitcnt vmcnt(3)
 buffer_store_byte v91, off, s[8:11], s92 offset:1 sc1
 v_mfma_f32_16x16x32_bf16 v[100:103], v[36:39], v[48:51], v[100:103]
 ds_read_b64_tr_b16 v[70:71], v9 offset:28672
 ds_read_b128 v[84:87], v17 offset:25600
 s_xor_b32 s92, s71, 3072
 v_mfma_f32_16x16x32_bf16 v[116:119], v[36:39], v[52:55], v[116:119]
 v_mov_b32 v91, 1
 s_waitcnt vmcnt(2)
 v_mfma_f32_16x16x32_bf16 v[112:115], v[32:35], v[52:55], v[112:115]
 buffer_store_byte v91, off, s[8:11], s92 offset:2 sc1
 s_waitcnt lgkmcnt(0)
 v_mfma_f32_16x16x32_bf16 v[96:99], v[56:59], v[72:75], v[96:99]
 ds_read_b128 v[40:43], v15 offset:0
 ds_read_b64_tr_b16 v[24:25], v6 offset:32768
 v_mfma_f32_16x16x32_bf16 v[100:103], v[60:63], v[72:75], v[100:103]
 ds_read_b64_tr_b16 v[26:27], v6 offset:36864
 ds_read_b64_tr_b16 v[28:29], v7 offset:32768
 v_mfma_f32_16x16x32_bf16 v[116:119], v[60:63], v[76:79], v[116:119]
 ds_read_b64_tr_b16 v[30:31], v7 offset:36864
 ds_read_b128 v[44:47], v15 offset:1024
 v_mfma_f32_16x16x32_bf16 v[112:115], v[56:59], v[76:79], v[112:115]
 ds_read_b64_tr_b16 v[32:33], v8 offset:32768
 ds_read_b64_tr_b16 v[34:35], v8 offset:36864
 v_mfma_f32_16x16x32_bf16 v[96:99], v[64:67], v[80:83], v[96:99]
 ds_read_b128 v[48:51], v15 offset:8192
 ds_read_b64_tr_b16 v[36:37], v9 offset:32768
 v_mfma_f32_16x16x32_bf16 v[100:103], v[68:71], v[80:83], v[100:103]
 ds_read_b64_tr_b16 v[38:39], v9 offset:36864
 ds_read_b128 v[52:55], v15 offset:9216
 v_mfma_f32_16x16x32_bf16 v[116:119], v[68:71], v[84:87], v[116:119]
 v_mfma_f32_16x16x32_bf16 v[112:115], v[64:67], v[84:87], v[112:115]
 s_waitcnt lgkmcnt(0)
 v_mfma_f32_16x16x32_bf16 v[96:99], v[24:27], v[40:43], v[96:99]
 ds_read_b128 v[72:75], v15 offset:16384
 ds_read_b64_tr_b16 v[56:57], v6 offset:40960
 v_mfma_f32_16x16x32_bf16 v[100:103], v[28:31], v[40:43], v[100:103]
 ds_read_b64_tr_b16 v[58:59], v6 offset:45056
 ds_read_b64_tr_b16 v[60:61], v7 offset:40960
 v_mfma_f32_16x16x32_bf16 v[116:119], v[28:31], v[44:47], v[116:119]
 ds_read_b64_tr_b16 v[62:63], v7 offset:45056
 ds_read_b128 v[76:79], v15 offset:17408
 v_mfma_f32_16x16x32_bf16 v[112:115], v[24:27], v[44:47], v[112:115]
 ds_read_b64_tr_b16 v[64:65], v8 offset:40960
 ds_read_b64_tr_b16 v[66:67], v8 offset:45056
 v_mfma_f32_16x16x32_bf16 v[96:99], v[32:35], v[48:51], v[96:99]
 ds_read_b128 v[80:83], v15 offset:24576
 ds_read_b64_tr_b16 v[68:69], v9 offset:40960
 v_mfma_f32_16x16x32_bf16 v[100:103], v[36:39], v[48:51], v[100:103]
 ds_read_b64_tr_b16 v[70:71], v9 offset:45056
 ds_read_b128 v[84:87], v15 offset:25600
 v_mfma_f32_16x16x32_bf16 v[116:119], v[36:39], v[52:55], v[116:119]
 v_mfma_f32_16x16x32_bf16 v[112:115], v[32:35], v[52:55], v[112:115]
 s_waitcnt lgkmcnt(0)
 v_mfma_f32_16x16x32_bf16 v[96:99], v[56:59], v[72:75], v[96:99]
 s_buffer_load_dword s72, s[8:11], s71 glc
 v_mfma_f32_16x16x32_bf16 v[100:103], v[60:63], v[72:75], v[100:103]
 v_mfma_f32_16x16x32_bf16 v[116:119], v[60:63], v[76:79], v[116:119]
 v_mfma_f32_16x16x32_bf16 v[112:115], v[56:59], v[76:79], v[112:115]
 v_mfma_f32_16x16x32_bf16 v[96:99], v[64:67], v[80:83], v[96:99]
 v_mfma_f32_16x16x32_bf16 v[100:103], v[68:71], v[80:83], v[100:103]
 v_mfma_f32_16x16x32_bf16 v[116:119], v[68:71], v[84:87], v[116:119]
 v_mfma_f32_16x16x32_bf16 v[112:115], v[64:67], v[84:87], v[112:115]
 s_waitcnt lgkmcnt(0)
 s_cmp_eq_u32 s72, 0x10101
 s_cbranch_scc0 Lsp_90
Lok_91:
 s_mul_i32 s85, s4, 49152
 s_add_u32 s85, s85, s60
 buffer_load_dwordx4 v[160:163], v13, s[8:11], s85 offen offset:0 sc1
 buffer_load_dwordx4 v[164:167], v13, s[8:11], s85 offen offset:1024 sc1
 s_mul_i32 s85, s4, 49152
 s_add_u32 s85, s85, s60
 s_add_u32 s85, s85, 16384
 buffer_load_dwordx4 v[168:171], v13, s[8:11], s85 offen offset:0 sc1
 buffer_load_dwordx4 v[172:175], v13, s[8:11], s85 offen offset:1024 sc1
 s_mul_i32 s85, s4, 49152
 s_add_u32 s85, s85, s60
 s_add_u32 s85, s85, 32768
 buffer_load_dwordx4 v[176:179], v13, s[8:11], s85 offen offset:0 sc1
 buffer_load_dwordx4 v[180:183], v13, s[8:11], s85 offen offset:1024 sc1
 s_waitcnt vmcnt(4)
 v_lshlrev_b32 v208, 16, v160
 v_and_b32 v209, s89, v160
 v_add_f32 v192, v192, v208
 v_add_f32 v193, v193, v209
 v_lshlrev_b32 v210, 16, v161
 v_and_b32 v211, s89, v161
 v_add_f32 v194, v194, v210
 v_add_f32 v195, v195, v211
 v_lshlrev_b32 v208, 16, v162
 v_and_b32 v209, s89, v162
 v_add_f32 v196, v196, v208
 v_add_f32 v197, v197, v209
 v_lshlrev_b32 v210, 16, v163
 v_and_b32 v211, s89, v163
 v_add_f32 v198, v198, v210
 v_add_f32 v199, v199, v211
 v_lshlrev_b32 v208, 16, v164
 v_and_b32 v209, s89, v164
 v_add_f32 v200, v200, v208
 v_add_f32 v201, v201, v209
 v_lshlrev_b32 v210, 16, v165
 v_and_b32 v211, s89, v165
 v_add_f32 v202, v202, v210
 v_add_f32 v203, v203, v211
 v_lshlrev_b32 v208, 16, v166
 v_and_b32 v209, s89, v166
 v_add_f32 v204, v204, v208
 v_add_f32 v205, v205, v209
 v_lshlrev_b32 v210, 16, v167
 v_and_b32 v211, s89, v167
 v_add_f32 v206, v206, v210
 v_add_f32 v207, v207, v211
 s_waitcnt vmcnt(2)
 v_lshlrev_b32 v208, 16, v168
 v_and_b32 v209, s89, v168
 v_add_f32 v192, v192, v208
 v_add_f32 v193, v193, v209
 v_lshlrev_b32 v210, 16, v169
 v_and_b32 v211, s89, v169
 v_add_f32 v194, v194, v210
 v_add_f32 v195, v195, v211
 v_lshlrev_b32 v208, 16, v170
 v_and_b32 v209, s89, v170
 v_add_f32 v196, v196, v208
 v_add_f32 v197, v197, v209
 v_lshlrev_b32 v210, 16, v171
 v_and_b32 v211, s89, v171
 v_add_f32 v198, v198, v210
 v_add_f32 v199, v199, v211
 v_lshlrev_b32 v208, 16, v172
 v_and_b32 v209, s89, v172
 v_add_f32 v200, v200, v208
 v_add_f32 v201, v201, v209
 v_lshlrev_b32 v210, 16, v173
 v_and_b32 v211, s89, v173
 v_add_f32 v202, v202, v210
 v_add_f32 v203, v203, v211
 v_lshlrev_b32 v208, 16, v174
 v_and_b32 v209, s89, v174
 v_add_f32 v204, v204, v208
 v_add_f32 v205, v205, v209
 v_lshlrev_b32 v210, 16, v175
 v_and_b32 v211, s89, v175
 v_add_f32 v206, v206, v210
 v_add_f32 v207, v207, v211
 s_waitcnt vmcnt(0)
 v_lshlrev_b32 v208, 16, v176
 v_and_b32 v209, s89, v176
 v_add_f32 v192, v192, v208
 v_add_f32 v193, v193, v209
 v_lshlrev_b32 v210, 16, v177
 v_and_b32 v211, s89, v177
 v_add_f32 v194, v194, v210
 v_add_f32 v195, v195, v211
 v_lshlrev_b32 v208, 16, v178
 v_and_b32 v209, s89, v178
 v_add_f32 v196, v196, v208
 v_add_f32 v197, v197, v209
 v_lshlrev_b32 v210, 16, v179
 v_and_b32 v211, s89, v179
 v_add_f32 v198, v198, v210
 v_add_f32 v199, v199, v211
 v_lshlrev_b32 v208, 16, v180
 v_and_b32 v209, s89, v180
 v_add_f32 v200, v200, v208
 v_add_f32 v201, v201, v209
 v_lshlrev_b32 v210, 16, v181
 v_and_b32 v211, s89, v181
 v_add_f32 v202, v202, v210
 v_add_f32 v203, v203, v211
 v_lshlrev_b32 v208, 16, v182
 v_and_b32 v209, s89, v182
 v_add_f32 v204, v204, v208
 v_add_f32 v205, v205, v209
 v_lshlrev_b32 v210, 16, v183
 v_and_b32 v211, s89, v183
 v_add_f32 v206, v206, v210
 v_add_f32 v207, v207, v211
 v_add_f32 v96, v96, v192
 v_add_f32 v97, v97, v193
 v_add_f32 v98, v98, v194
 v_add_f32 v99, v99, v195
 v_add_f32 v100, v100, v196
 v_add_f32 v101, v101, v197
 v_add_f32 v102, v102, v198
 v_add_f32 v103, v103, v199
 v_cvt_pk_bf16_f32 v96, v96, v97
 v_cvt_pk_bf16_f32 v97, v98, v99
 v_cvt_pk_bf16_f32 v98, v100, v101
 v_cvt_pk_bf16_f32 v99, v102, v103
 s_nop 0
 v_permlane16_swap_b32 v96, v98
 v_permlane16_swap_b32 v97, v99
 buffer_store_dwordx4 v[96:99], v94, s[28:31], s61 offen
 v_add_f32 v112, v112, v200
 v_add_f32 v113, v113, v201
 v_add_f32 v114, v114, v202
 v_add_f32 v115, v115, v203
 v_add_f32 v116, v116, v204
 v_add_f32 v117, v117, v205
 v_add_f32 v118, v118, v206
 v_add_f32 v119, v119, v207
 v_cvt_pk_bf16_f32 v112, v112, v113
 v_cvt_pk_bf16_f32 v113, v114, v115
 v_cvt_pk_bf16_f32 v114, v116, v117
 v_cvt_pk_bf16_f32 v115, v118, v119
 s_nop 0
 v_permlane16_swap_b32 v112, v114
 v_permlane16_swap_b32 v113, v115
 buffer_store_dwordx4 v[112:115], v94, s[28:31], s66 offen
 s_endpgm
Lsp_87:
 s_mov_b32 s95, 0
Llp_89:
 s_buffer_load_dwordx2 s[72:73], s[8:11], s64 glc
 s_waitcnt lgkmcnt(0)
 s_add_u32 s95, s95, 1
 s_and_b32 s72, s72, s73
 s_cmp_eq_u32 s72, 0x1010101
 s_cbranch_scc1 Lok_88
 s_cmp_lt_u32 s95, 0x40000
 s_cbranch_scc1 Llp_89
 s_branch Lok_88
Lsp_90:
 s_mov_b32 s95, 0
Llp_92:
 s_buffer_load_dword s72, s[8:11], s71 glc
 s_waitcnt lgkmcnt(0)
 s_add_u32 s95, s95, 1
 s_cmp_eq_u32 s72, 0x10101
 s_cbranch_scc1 Lok_91
 s_cmp_lt_u32 s95, 0x40000
 s_cbranch_scc1 Llp_92
 s_branch Lok_91
L5_v00:
 s_xor_b32 s52, s52, s96
 s_waitcnt vmcnt(12) lgkmcnt(0)
 s_barrier
 v_mfma_f32_16x16x32_bf16 v[96:99], v[24:27], v[40:43], v[96:99]
 ds_read_b128 v[72:75], v2 offset:16384
 v_mfma_f32_16x16x32_bf16 v[100:103], v[28:31], v[40:43], v[100:103]
 ds_read_b64_tr_b16 v[56:57], v6 offset:40960
 v_mfma_f32_16x16x32_bf16 v[104:107], v[32:35], v[40:43], v[104:107]
 ds_read_b64_tr_b16 v[58:59], v6 offset:45056
 v_mfma_f32_16x16x32_bf16 v[108:111], v[36:39], v[40:43], v[108:111]
 ds_read_b64_tr_b16 v[60:61], v7 offset:40960
 v_mfma_f32_16x16x32_bf16 v[124:127], v[36:39], v[44:47], v[124:127]
 ds_read_b64_tr_b16 v[62:63], v7 offset:45056
 v_mfma_f32_16x16x32_bf16 v[120:123], v[32:35], v[44:47], v[120:123]
 ds_read_b128 v[76:79], v2 offset:17408
 v_mfma_f32_16x16x32_bf16 v[116:119], v[28:31], v[44:47], v[116:119]
 ds_read_b64_tr_b16 v[64:65], v8 offset:40960
 v_mfma_f32_16x16x32_bf16 v[112:115], v[24:27], v[44:47], v[112:115]
 ds_read_b64_tr_b16 v[66:67], v8 offset:45056
 v_mfma_f32_16x16x32_bf16 v[128:131], v[24:27], v[48:51], v[128:131]
 ds_read_b128 v[80:83], v3 offset:16384
 s_add_u32 m0, s51, 32768
 s_add_u32 s63, s6, 0
 s_and_b32 s63, s63, 7
 s_mul_i32 s63, s63, 65536
 s_add_u32 s63, s63, s65
 v_mfma_f32_16x16x32_bf16 v[132:135], v[28:31], v[48:51], v[132:135]
 ds_read_b64_tr_b16 v[68:69], v9 offset:40960
 buffer_load_dwordx4 v10, s[20:23], s63 offen lds
 v_mfma_f32_16x16x32_bf16 v[136:139], v[32:35], v[48:51], v[136:139]
 ds_read_b64_tr_b16 v[70:71], v9 offset:45056
 v_mfma_f32_16x16x32_bf16 v[140:143], v[36:39], v[48:51], v[140:143]
 ds_read_b128 v[84:87], v3 offset:17408
 v_mfma_f32_16x16x32_bf16 v[156:159], v[36:39], v[52:55], v[156:159]
 v_mfma_f32_16x16x32_bf16 v[152:155], v[32:35], v[52:55], v[152:155]
 v_mfma_f32_16x16x32_bf16 v[148:151], v[28:31], v[52:55], v[148:151]
 v_mfma_f32_16x16x32_bf16 v[144:147], v[24:27], v[52:55], v[144:147]
 s_waitcnt vmcnt(10) lgkmcnt(0)
 s_barrier
 v_mfma_f32_16x16x32_bf16 v[96:99], v[56:59], v[72:75], v[96:99]
 ds_read_b128 v[40:43], v2 offset:32768
 v_mfma_f32_16x16x32_bf16 v[100:103], v[60:63], v[72:75], v[100:103]
 ds_read_b64_tr_b16 v[24:25], v6 offset:0
 v_mfma_f32_16x16x32_bf16 v[104:107], v[64:67], v[72:75], v[104:107]
 ds_read_b64_tr_b16 v[26:27], v6 offset:4096
 v_mfma_f32_16x16x32_bf16 v[108:111], v[68:71], v[72:75], v[108:111]
 ds_read_b64_tr_b16 v[28:29], v7 offset:0
 v_mfma_f32_16x16x32_bf16 v[124:127], v[68:71], v[76:79], v[124:127]
 ds_read_b64_tr_b16 v[30:31], v7 offset:4096
 s_lshl2_add_u32 s64, s83, s4
 v_mfma_f32_16x16x32_bf16 v[120:123], v[64:67], v[76:79], v[120:123]
 ds_read_b128 v[44:47], v2 offset:33792
 s_lshl2_add_u32 s64, s64, s7
 s_lshl_b32 s64, s64, 7
 v_mfma_f32_16x16x32_bf16 v[116:119], v[60:63], v[76:79], v[116:119]
 ds_read_b64_tr_b16 v[32:33], v8 offset:0
 s_add_u32 s64, s64, 39927808
 v_mfma_f32_16x16x32_bf16 v[112:115], v[56:59], v[76:79], v[112:115]
 ds_read_b64_tr_b16 v[34:35], v8 offset:4096
 s_buffer_load_dwordx2 s[72:73], s[8:11], s64 glc
 v_mfma_f32_16x16x32_bf16 v[128:131], v[56:59], v[80:83], v[128:131]
 ds_read_b128 v[48:51], v3 offset:32768
 s_add_u32 m0, s51, 40960
 s_add_u32 s63, s6, 1
 s_and_b32 s63, s63, 7
 s_mul_i32 s63, s63, 65536
 s_add_u32 s63, s63, s65
 v_mfma_f32_16x16x32_bf16 v[132:135], v[60:63], v[80:83], v[132:135]
 ds_read_b64_tr_b16 v[36:37], v9 offset:0
 buffer_load_dwordx4 v10, s[20:23], s63 offen lds
 v_mfma_f32_16x16x32_bf16 v[136:139], v[64:67], v[80:83], v[136:139]
 ds_read_b64_tr_b16 v[38:39], v9 offset:4096
 v_mfma_f32_16x16x32_bf16 v[140:143], v[68:71], v[80:83], v[140:143]
 ds_read_b128 v[52:55], v3 offset:33792
 ds_read_b32 v90, v0
 ds_read_b32 v90, v0
 v_mfma_f32_16x16x32_bf16 v[156:159], v[68:71], v[84:87], v[156:159]
 v_mfma_f32_16x16x32_bf16 v[152:155], v[64:67], v[84:87], v[152:155]
 v_mfma_f32_16x16x32_bf16 v[148:151], v[60:63], v[84:87], v[148:151]
 v_mfma_f32_16x16x32_bf16 v[144:147], v[56:59], v[84:87], v[144:147]
 s_waitcnt vmcnt(8) lgkmcnt(2)
 s_barrier
 v_mfma_f32_16x16x32_bf16 v[96:99], v[24:27], v[40:43], v[96:99]
 ds_read_b128 v[72:75], v2 offset:49152
 v_mfma_f32_16x16x32_bf16 v[100:103], v[28:31], v[40:43], v[100:103]
 ds_read_b64_tr_b16 v[56:57], v6 offset:8192
 v_mfma_f32_16x16x32_bf16 v[104:107], v[32:35], v[40:43], v[104:107]
 ds_read_b64_tr_b16 v[58:59], v6 offset:12288
 v_mfma_f32_16x16x32_bf16 v[108:111], v[36:39], v[40:43], v[108:111]
 ds_read_b64_tr_b16 v[60:61], v7 offset:8192
 v_mfma_f32_16x16x32_bf16 v[124:127], v[36:39], v[44:47], v[124:127]
 ds_read_b64_tr_b16 v[62:63], v7 offset:12288
 v_mfma_f32_16x16x32_bf16 v[120:123], v[32:35], v[44:47], v[120:123]
 ds_read_b128 v[76:79], v2 offset:50176
 v_mfma_f32_16x16x32_bf16 v[116:119], v[28:31], v[44:47], v[116:119]
 ds_read_b64_tr_b16 v[64:65], v8 offset:8192
 v_mfma_f32_16x16x32_bf16 v[112:115], v[24:27], v[44:47], v[112:115]
 ds_read_b64_tr_b16 v[66:67], v8 offset:12288
 v_mfma_f32_16x16x32_bf16 v[128:131], v[24:27], v[48:51], v[128:131]
 ds_read_b128 v[80:83], v3 offset:49152
 s_add_u32 m0, s51, 0
 s_add_u32 s63, s6, 2
 s_and_b32 s63, s63, 7
 s_mul_i32 s63, s63, 65536
 s_add_u32 s63, s63, s65
 v_mfma_f32_16x16x32_bf16 v[132:135], v[28:31], v[48:51], v[132:135]
 ds_read_b64_tr_b16 v[68:69], v9 offset:8192
 buffer_load_dwordx4 v10, s[20:23], s63 offen lds
 v_mfma_f32_16x16x32_bf16 v[136:139], v[32:35], v[48:51], v[136:139]
 ds_read_b64_tr_b16 v[70:71], v9 offset:12288
 v_mfma_f32_16x16x32_bf16 v[140:143], v[36:39], v[48:51], v[140:143]
 ds_read_b128 v[84:87], v3 offset:50176
 v_mfma_f32_16x16x32_bf16 v[156:159], v[36:39], v[52:55], v[156:159]
 v_mfma_f32_16x16x32_bf16 v[152:155], v[32:35], v[52:55], v[152:155]
 v_mfma_f32_16x16x32_bf16 v[148:151], v[28:31], v[52:55], v[148:151]
 v_mfma_f32_16x16x32_bf16 v[144:147], v[24:27], v[52:55], v[144:147]
 s_waitcnt lgkmcnt(0)
 s_and_b32 s72, s72, s73
 s_cmp_eq_u32 s72, 0x1010101
 s_cbranch_scc0 Lsp_93
Lok_94:
 s_waitcnt vmcnt(6) lgkmcnt(0)
 s_barrier
 v_mfma_f32_16x16x32_bf16 v[96:99], v[56:59], v[72:75], v[96:99]
 ds_read_b128 v[40:43], v4 offset:0
 v_mfma_f32_16x16x32_bf16 v[100:103], v[60:63], v[72:75], v[100:103]
 ds_read_b64_tr_b16 v[24:25], v6 offset:16384
 v_mfma_f32_16x16x32_bf16 v[104:107], v[64:67], v[72:75], v[104:107]
 ds_read_b64_tr_b16 v[26:27], v6 offset:20480
 s_add_u32 m0, s50, 0
 s_add_u32 s62, s6, 0
 s_and_b32 s62, s62, 7
 s_mul_i32 s62, s62, 16384
 s_add_u32 s62, s62, s54
 v_mfma_f32_16x16x32_bf16 v[108:111], v[68:71], v[72:75], v[108:111]
 ds_read_b64_tr_b16 v[28:29], v7 offset:16384
 buffer_load_dwordx4 v13, s[8:11], s62 offen offset:0 sc1 lds
 v_mfma_f32_16x16x32_bf16 v[124:127], v[68:71], v[76:79], v[124:127]
 ds_read_b64_tr_b16 v[30:31], v7 offset:20480
 v_mfma_f32_16x16x32_bf16 v[120:123], v[64:67], v[76:79], v[120:123]
 ds_read_b128 v[44:47], v4 offset:1024
 buffer_load_dwordx4 v13, s[8:11], s62 offen offset:1024 sc1 lds
 v_mfma_f32_16x16x32_bf16 v[116:119], v[60:63], v[76:79], v[116:119]
 ds_read_b64_tr_b16 v[32:33], v8 offset:16384
 s_add_u32 m0, s50, 16384
 s_add_u32 s62, s6, 1
 s_and_b32 s62, s62, 7
 s_mul_i32 s62, s62, 16384
 s_add_u32 s62, s62, s54
 v_mfma_f32_16x16x32_bf16 v[112:115], v[56:59], v[76:79], v[112:115]
 ds_read_b64_tr_b16 v[34:35], v8 offset:20480
 buffer_load_dwordx4 v13, s[8:11], s62 offen offset:0 sc1 lds
 v_mfma_f32_16x16x32_bf16 v[128:131], v[56:59], v[80:83], v[128:131]
 ds_read_b128 v[48:51], v5 offset:0
 v_mfma_f32_16x16x32_bf16 v[132:135], v[60:63], v[80:83], v[132:135]
 ds_read_b64_tr_b16 v[36:37], v9 offset:16384
 v_mfma_f32_16x16x32_bf16 v[136:139], v[64:67], v[80:83], v[136:139]
 ds_read_b64_tr_b16 v[38:39], v9 offset:20480
 buffer_load_dwordx4 v13, s[8:11], s62 offen offset:1024 sc1 lds
 v_mfma_f32_16x16x32_bf16 v[140:143], v[68:71], v[80:83], v[140:143]
 ds_read_b128 v[52:55], v5 offset:1024
 s_add_u32 m0, s50, 32768
 s_add_u32 s62, s6, 2
 s_and_b32 s62, s62, 7
 s_mul_i32 s62, s62, 16384
 s_add_u32 s62, s62, s54
 v_mfma_f32_16x16x32_bf16 v[156:159], v[68:71], v[84:87], v[156:159]
 buffer_load_dwordx4 v13, s[8:11], s62 offen offset:0 sc1 lds
 v_mfma_f32_16x16x32_bf16 v[152:155], v[64:67], v[84:87], v[152:155]
 v_mfma_f32_16x16x32_bf16 v[148:151], v[60:63], v[84:87], v[148:151]
 buffer_load_dwordx4 v13, s[8:11], s62 offen offset:1024 sc1 lds
 v_mfma_f32_16x16x32_bf16 v[144:147], v[56:59], v[84:87], v[144:147]
 s_waitcnt vmcnt(9) lgkmcnt(0)
 s_barrier
 v_mfma_f32_16x16x32_bf16 v[96:99], v[24:27], v[40:43], v[96:99]
 ds_read_b128 v[72:75], v4 offset:16384
 s_mov_b32 s89, 0xffff0000
 s_waitcnt vmcnt(28)
 v_mfma_f32_16x16x32_bf16 v[100:103], v[28:31], v[40:43], v[100:103]
 ds_read_b64_tr_b16 v[56:57], v6 offset:24576
 v_permlane16_swap_b32 v184, v186
 v_mfma_f32_16x16x32_bf16 v[104:107], v[32:35], v[40:43], v[104:107]
 ds_read_b64_tr_b16 v[58:59], v6 offset:28672
 v_permlane16_swap_b32 v185, v187
 v_permlane16_swap_b32 v188, v190
 s_add_u32 m0, s50, 49152
 s_add_u32 s62, s6, 3
 s_and_b32 s62, s62, 7
 s_mul_i32 s62, s62, 16384
 s_add_u32 s62, s62, s54
 v_mfma_f32_16x16x32_bf16 v[108:111], v[36:39], v[40:43], v[108:111]
 ds_read_b64_tr_b16 v[60:61], v7 offset:24576
 buffer_load_dwordx4 v13, s[8:11], s62 offen offset:0 sc1 lds
 v_permlane16_swap_b32 v189, v191
 v_mfma_f32_16x16x32_bf16 v[124:127], v[36:39], v[44:47], v[124:127]
 ds_read_b64_tr_b16 v[62:63], v7 offset:28672
 v_lshlrev_b32 v192, 16, v184
 v_mfma_f32_16x16x32_bf16 v[120:123], v[32:35], v[44:47], v[120:123]
 ds_read_b128 v[76:79], v4 offset:17408
 buffer_load_dwordx4 v13, s[8:11], s62 offen offset:1024 sc1 lds
 v_and_b32 v193, s89, v184
 v_lshlrev_b32 v194, 16, v185
 v_mfma_f32_16x16x32_bf16 v[116:119], v[28:31], v[44:47], v[116:119]
 ds_read_b64_tr_b16 v[64:65], v8 offset:24576
 v_and_b32 v195, s89, v185
 s_add_u32 m0, s51, 8192
 s_add_u32 s63, s6, 3
 s_and_b32 s63, s63, 7
 s_mul_i32 s63, s63, 65536
 s_add_u32 s63, s63, s65
 v_mfma_f32_16x16x32_bf16 v[112:115], v[24:27], v[44:47], v[112:115]
 ds_read_b64_tr_b16 v[66:67], v8 offset:28672
 buffer_load_dwordx4 v10, s[20:23], s63 offen lds
 v_lshlrev_b32 v196, 16, v186
 v_mfma_f32_16x16x32_bf16 v[128:131], v[24:27], v[48:51], v[128:131]
 ds_read_b128 v[80:83], v5 offset:16384
 v_and_b32 v197, s89, v186
 v_lshlrev_b32 v198, 16, v187
 v_mfma_f32_16x16x32_bf16 v[132:135], v[28:31], v[48:51], v[132:135]
 ds_read_b64_tr_b16 v[68:69], v9 offset:24576
 v_and_b32 v199, s89, v187
 s_add_u32 m0, s50, 65536
 s_add_u32 s62, s6, 4
 s_and_b32 s62, s62, 7
 s_mul_i32 s62, s62, 16384
 s_add_u32 s62, s62, s54
 v_mfma_f32_16x16x32_bf16 v[136:139], v[32:35], v[48:51], v[136:139]
 ds_read_b64_tr_b16 v[70:71], v9 offset:28672
 buffer_load_dwordx4 v13, s[8:11], s62 offen offset:0 sc1 lds
 v_lshlrev_b32 v200, 16, v188
 v_and_b32 v201, s89, v188
 v_mfma_f32_16x16x32_bf16 v[140:143], v[36:39], v[48:51], v[140:143]
 ds_read_b128 v[84:87], v5 offset:17408
 v_lshlrev_b32 v202, 16, v189
 v_mfma_f32_16x16x32_bf16 v[156:159], v[36:39], v[52:55], v[156:159]
 buffer_load_dwordx4 v13, s[8:11], s62 offen offset:1024 sc1 lds
 v_and_b32 v203, s89, v189
 v_mfma_f32_16x16x32_bf16 v[152:155], v[32:35], v[52:55], v[152:155]
 v_lshlrev_b32 v204, 16, v190
 v_and_b32 v205, s89, v190
 s_add_u32 m0, s51, 16384
 s_add_u32 s63, s6, 4
 s_and_b32 s63, s63, 7
 s_mul_i32 s63, s63, 65536
 s_add_u32 s63, s63, s65
 v_mfma_f32_16x16x32_bf16 v[148:151], v[28:31], v[52:55], v[148:151]
 buffer_load_dwordx4 v10, s[20:23], s63 offen lds
 v_lshlrev_b32 v206, 16, v191
 v_mfma_f32_16x16x32_bf16 v[144:147], v[24:27], v[52:55], v[144:147]
 v_and_b32 v207, s89, v191
 s_waitcnt vmcnt(10) lgkmcnt(0)
 s_barrier
 v_mfma_f32_16x16x32_bf16 v[96:99], v[56:59], v[72:75], v[96:99]
 ds_read_b128 v[40:43], v2 offset:0
 v_mfma_f32_16x16x32_bf16 v[100:103], v[60:63], v[72:75], v[100:103]
 ds_read_b64_tr_b16 v[24:25], v6 offset:32768
 v_mfma_f32_16x16x32_bf16 v[104:107], v[64:67], v[72:75], v[104:107]
 ds_read_b64_tr_b16 v[26:27], v6 offset:36864
 v_mfma_f32_16x16x32_bf16 v[108:111], v[68:71], v[72:75], v[108:111]
 ds_read_b64_tr_b16 v[28:29], v7 offset:32768
 s_add_u32 m0, s50, 81920
 s_add_u32 s62, s6, 5
 s_and_b32 s62, s62, 7
 s_mul_i32 s62, s62, 16384
 s_add_u32 s62, s62, s54
 v_mfma_f32_16x16x32_bf16 v[124:127], v[68:71], v[76:79], v[124:127]
 ds_read_b64_tr_b16 v[30:31], v7 offset:36864
 buffer_load_dwordx4 v13, s[8:11], s62 offen offset:0 sc1 lds
 v_mfma_f32_16x16x32_bf16 v[120:123], v[64:67], v[76:79], v[120:123]
 ds_read_b128 v[44:47], v2 offset:1024
 v_mfma_f32_16x16x32_bf16 v[116:119], v[60:63], v[76:79], v[116:119]
 ds_read_b64_tr_b16 v[32:33], v8 offset:32768
 v_mfma_f32_16x16x32_bf16 v[112:115], v[56:59], v[76:79], v[112:115]
 ds_read_b64_tr_b16 v[34:35], v8 offset:36864
 v_mfma_f32_16x16x32_bf16 v[128:131], v[56:59], v[80:83], v[128:131]
 ds_read_b128 v[48:51], v3 offset:0
 v_mfma_f32_16x16x32_bf16 v[132:135], v[60:63], v[80:83], v[132:135]
 ds_read_b64_tr_b16 v[36:37], v9 offset:32768
 buffer_load_dwordx4 v13, s[8:11], s62 offen offset:1024 sc1 lds
 v_mfma_f32_16x16x32_bf16 v[136:139], v[64:67], v[80:83], v[136:139]
 ds_read_b64_tr_b16 v[38:39], v9 offset:36864
 v_mfma_f32_16x16x32_bf16 v[140:143], v[68:71], v[80:83], v[140:143]
 ds_read_b128 v[52:55], v3 offset:1024
 v_mfma_f32_16x16x32_bf16 v[156:159], v[68:71], v[84:87], v[156:159]
 s_add_u32 m0, s51, 24576
 s_add_u32 s63, s6, 5
 s_and_b32 s63, s63, 7
 s_mul_i32 s63, s63, 65536
 s_add_u32 s63, s63, s65
 v_mfma_f32_16x16x32_bf16 v[152:155], v[64:67], v[84:87], v[152:155]
 buffer_load_dwordx4 v10, s[20:23], s63 offen lds
 v_mfma_f32_16x16x32_bf16 v[148:151], v[60:63], v[84:87], v[148:151]
 v_mfma_f32_16x16x32_bf16 v[144:147], v[56:59], v[84:87], v[144:147]
 s_waitcnt vmcnt(11) lgkmcnt(0)
 s_barrier
 v_mfma_f32_16x16x32_bf16 v[96:99], v[24:27], v[40:43], v[96:99]
 ds_read_b128 v[72:75], v2 offset:16384
 v_mfma_f32_16x16x32_bf16 v[100:103], v[28:31], v[40:43], v[100:103]
 ds_read_b64_tr_b16 v[56:57], v6 offset:40960
 v_mfma_f32_16x16x32_bf16 v[104:107], v[32:35], v[40:43], v[104:107]
 ds_read_b64_tr_b16 v[58:59], v6 offset:45056
 v_mfma_f32_16x16x32_bf16 v[108:111], v[36:39], v[40:43], v[108:111]
 ds_read_b64_tr_b16 v[60:61], v7 offset:40960
 s_add_u32 m0, s50, 0
 s_add_u32 s62, s6, 6
 s_and_b32 s62, s62, 7
 s_mul_i32 s62, s62, 16384
 s_add_u32 s62, s62, s54
 v_mfma_f32_16x16x32_bf16 v[124:127], v[36:39], v[44:47], v[124:127]
 ds_read_b64_tr_b16 v[62:63], v7 offset:45056
 buffer_load_dwordx4 v13, s[8:11], s62 offen offset:0 sc1 lds
 v_mfma_f32_16x16x32_bf16 v[120:123], v[32:35], v[44:47], v[120:123]
 ds_read_b128 v[76:79], v2 offset:17408
 v_mfma_f32_16x16x32_bf16 v[116:119], v[28:31], v[44:47], v[116:119]
 ds_read_b64_tr_b16 v[64:65], v8 offset:40960
 v_mfma_f32_16x16x32_bf16 v[112:115], v[24:27], v[44:47], v[112:115]
 ds_read_b64_tr_b16 v[66:67], v8 offset:45056
 v_mfma_f32_16x16x32_bf16 v[128:131], v[24:27], v[48:51], v[128:131]
 ds_read_b128 v[80:83], v3 offset:16384
 v_mfma_f32_16x16x32_bf16 v[132:135], v[28:31], v[48:51], v[132:135]
 ds_read_b64_tr_b16 v[68:69], v9 offset:40960
 buffer_load_dwordx4 v13, s[8:11], s62 offen offset:1024 sc1 lds
 v_mfma_f32_16x16x32_bf16 v[136:139], v[32:35], v[48:51], v[136:139]
 ds_read_b64_tr_b16 v[70:71], v9 offset:45056
 v_mfma_f32_16x16x32_bf16 v[140:143], v[36:39], v[48:51], v[140:143]
 ds_read_b128 v[84:87], v3 offset:17408
 v_mfma_f32_16x16x32_bf16 v[156:159], v[36:39], v[52:55], v[156:159]
 s_add_u32 m0, s51, 32768
 s_add_u32 s63, s6, 6
 s_and_b32 s63, s63, 7
 s_mul_i32 s63, s63, 65536
 s_add_u32 s63, s63, s65
 v_mfma_f32_16x16x32_bf16 v[152:155], v[32:35], v[52:55], v[152:155]
 buffer_load_dwordx4 v10, s[20:23], s63 offen lds
 v_mfma_f32_16x16x32_bf16 v[148:151], v[28:31], v[52:55], v[148:151]
 v_mfma_f32_16x16x32_bf16 v[144:147], v[24:27], v[52:55], v[144:147]
 s_waitcnt vmcnt(12) lgkmcnt(0)
 s_barrier
 v_mfma_f32_16x16x32_bf16 v[96:99], v[56:59], v[72:75], v[96:99]
 ds_read_b128 v[40:43], v2 offset:32768
 v_mfma_f32_16x16x32_bf16 v[100:103], v[60:63], v[72:75], v[100:103]
 ds_read_b64_tr_b16 v[24:25], v6 offset:0
 v_mfma_f32_16x16x32_bf16 v[104:107], v[64:67], v[72:75], v[104:107]
 ds_read_b64_tr_b16 v[26:27], v6 offset:4096
 v_mfma_f32_16x16x32_bf16 v[108:111], v[68:71], v[72:75], v[108:111]
 ds_read_b64_tr_b16 v[28:29], v7 offset:0
 s_add_u32 m0, s50, 16384
 s_add_u32 s62, s6, 7
 s_and_b32 s62, s62, 7
 s_mul_i32 s62, s62, 16384
 s_add_u32 s62, s62, s54
 v_mfma_f32_16x16x32_bf16 v[124:127], v[68:71], v[76:79], v[124:127]
 ds_read_b64_tr_b16 v[30:31], v7 offset:4096
 buffer_load_dwordx4 v13, s[8:11], s62 offen offset:0 sc1 lds
 v_mfma_f32_16x16x32_bf16 v[120:123], v[64:67], v[76:79], v[120:123]
 ds_read_b128 v[44:47], v2 offset:33792
 v_mfma_f32_16x16x32_bf16 v[116:119], v[60:63], v[76:79], v[116:119]
 ds_read_b64_tr_b16 v[32:33], v8 offset:0
 v_mfma_f32_16x16x32_bf16 v[112:115], v[56:59], v[76:79], v[112:115]
 ds_read_b64_tr_b16 v[34:35], v8 offset:4096
 v_mfma_f32_16x16x32_bf16 v[128:131], v[56:59], v[80:83], v[128:131]
 ds_read_b128 v[48:51], v3 offset:32768
 v_mfma_f32_16x16x32_bf16 v[132:135], v[60:63], v[80:83], v[132:135]
 ds_read_b64_tr_b16 v[36:37], v9 offset:0
 buffer_load_dwordx4 v13, s[8:11], s62 offen offset:1024 sc1 lds
 v_mfma_f32_16x16x32_bf16 v[136:139], v[64:67], v[80:83], v[136:139]
 ds_read_b64_tr_b16 v[38:39], v9 offset:4096
 v_mfma_f32_16x16x32_bf16 v[140:143], v[68:71], v[80:83], v[140:143]
 ds_read_b128 v[52:55], v3 offset:33792
 v_mfma_f32_16x16x32_bf16 v[156:159], v[68:71], v[84:87], v[156:159]
 s_add_u32 m0, s51, 40960
 s_add_u32 s63, s6, 7
 s_and_b32 s63, s63, 7
 s_mul_i32 s63, s63, 65536
 s_add_u32 s63, s63, s65
 v_mfma_f32_16x16x32_bf16 v[152:155], v[64:67], v[84:87], v[152:155]
 buffer_load_dwordx4 v10, s[20:23], s63 offen lds
 v_mfma_f32_16x16x32_bf16 v[148:151], v[60:63], v[84:87], v[148:151]
 v_mfma_f32_16x16x32_bf16 v[144:147], v[56:59], v[84:87], v[144:147]
 s_waitcnt vmcnt(12) lgkmcnt(0)
 s_barrier
 v_mfma_f32_16x16x32_bf16 v[96:99], v[24:27], v[40:43], v[96:99]
 ds_read_b128 v[72:75], v2 offset:49152
 v_mfma_f32_16x16x32_bf16 v[100:103], v[28:31], v[40:43], v[100:103]
 ds_read_b64_tr_b16 v[56:57], v6 offset:8192
 v_mfma_f32_16x16x32_bf16 v[104:107], v[32:35], v[40:43], v[104:107]
 ds_read_b64_tr_b16 v[58:59], v6 offset:12288
 v_mfma_f32_16x16x32_bf16 v[108:111], v[36:39], v[40:43], v[108:111]
 ds_read_b64_tr_b16 v[60:61], v7 offset:8192
 s_add_u32 m0, s50, 32768
 s_bfe_u32 s62, s52, 0x40000
 s_lshl_b32 s62, s62, 15
 s_add_u32 s62, s62, s57
 v_mfma_f32_16x16x32_bf16 v[124:127], v[36:39], v[44:47], v[124:127]
 ds_read_b64_tr_b16 v[62:63], v7 offset:12288
 buffer_load_dwordx4 v0, s[8:11], s62 offen offset:0 sc1 lds
 v_mfma_f32_16x16x32_bf16 v[120:123], v[32:35], v[44:47], v[120:123]
 ds_read_b128 v[76:79], v2 offset:50176
 v_mfma_f32_16x16x32_bf16 v[116:119], v[28:31], v[44:47], v[116:119]
 ds_read_b64_tr_b16 v[64:65], v8 offset:8192
 v_mfma_f32_16x16x32_bf16 v[112:115], v[24:27], v[44:47], v[112:115]
 ds_read_b64_tr_b16 v[66:67], v8 offset:12288
 v_mfma_f32_16x16x32_bf16 v[128:131], v[24:27], v[48:51], v[128:131]
 ds_read_b128 v[80:83], v3 offset:49152
 v_mfma_f32_16x16x32_bf16 v[132:135], v[28:31], v[48:51], v[132:135]
 ds_read_b64_tr_b16 v[68:69], v9 offset:8192
 buffer_load_dwordx4 v0, s[8:11], s62 offen offset:1024 sc1 lds
 v_mfma_f32_16x16x32_bf16 v[136:139], v[32:35], v[48:51], v[136:139]
 ds_read_b64_tr_b16 v[70:71], v9 offset:12288
 v_mfma_f32_16x16x32_bf16 v[140:143], v[36:39], v[48:51], v[140:143]
 ds_read_b128 v[84:87], v3 offset:50176
 v_mfma_f32_16x16x32_bf16 v[156:159], v[36:39], v[52:55], v[156:159]
 s_add_u32 m0, s51, 0
 s_bfe_u32 s63, s52, 0x40000
 s_lshl_b32 s63, s63, 17
 s_add_u32 s63, s63, s58
 v_mfma_f32_16x16x32_bf16 v[152:155], v[32:35], v[52:55], v[152:155]
 buffer_load_dwordx4 v11, s[20:23], s63 offen lds
 v_mfma_f32_16x16x32_bf16 v[148:151], v[28:31], v[52:55], v[148:151]
 v_mfma_f32_16x16x32_bf16 v[144:147], v[24:27], v[52:55], v[144:147]
 s_waitcnt vmcnt(12) lgkmcnt(0)
 s_barrier
 v_mfma_f32_16x16x32_bf16 v[96:99], v[56:59], v[72:75], v[96:99]
 ds_read_b128 v[40:43], v4 offset:0
 v_mfma_f32_16x16x32_bf16 v[100:103], v[60:63], v[72:75], v[100:103]
 ds_read_b64_tr_b16 v[24:25], v6 offset:16384
 v_mfma_f32_16x16x32_bf16 v[104:107], v[64:67], v[72:75], v[104:107]
 ds_read_b64_tr_b16 v[26:27], v6 offset:20480
 v_mfma_f32_16x16x32_bf16 v[108:111], v[68:71], v[72:75], v[108:111]
 ds_read_b64_tr_b16 v[28:29], v7 offset:16384
 s_add_u32 m0, s50, 49152
 s_bfe_u32 s62, s52, 0x40004
 s_lshl_b32 s62, s62, 15
 s_add_u32 s62, s62, s57
 v_mfma_f32_16x16x32_bf16 v[124:127], v[68:71], v[76:79], v[124:127]
 ds_read_b64_tr_b16 v[30:31], v7 offset:20480
 buffer_load_dwordx4 v0, s[8:11], s62 offen offset:0 sc1 lds
 v_mfma_f32_16x16x32_bf16 v[120:123], v[64:67], v[76:79], v[120:123]
 ds_read_b128 v[44:47], v4 offset:1024
 v_mfma_f32_16x16x32_bf16 v[116:119], v[60:63], v[76:79], v[116:119]
 ds_read_b64_tr_b16 v[32:33], v8 offset:16384
 v_mfma_f32_16x16x32_bf16 v[112:115], v[56:59], v[76:79], v[112:115]
 ds_read_b64_tr_b16 v[34:35], v8 offset:20480
 v_mfma_f32_16x16x32_bf16 v[128:131], v[56:59], v[80:83], v[128:131]
 ds_read_b128 v[48:51], v5 offset:0
 v_mfma_f32_16x16x32_bf16 v[132:135], v[60:63], v[80:83], v[132:135]
 ds_read_b64_tr_b16 v[36:37], v9 offset:16384
 buffer_load_dwordx4 v0, s[8:11], s62 offen offset:1024 sc1 lds
 v_mfma_f32_16x16x32_bf16 v[136:139], v[64:67], v[80:83], v[136:139]
 ds_read_b64_tr_b16 v[38:39], v9 offset:20480
 v_mfma_f32_16x16x32_bf16 v[140:143], v[68:71], v[80:83], v[140:143]
 ds_read_b128 v[52:55], v5 offset:1024
 v_mfma_f32_16x16x32_bf16 v[156:159], v[68:71], v[84:87], v[156:159]
 s_add_u32 m0, s51, 8192
 s_bfe_u32 s63, s52, 0x40004
 s_lshl_b32 s63, s63, 17
 s_add_u32 s63, s63, s58
 v_mfma_f32_16x16x32_bf16 v[152:155], v[64:67], v[84:87], v[152:155]
 buffer_load_dwordx4 v11, s[20:23], s63 offen lds
 v_mfma_f32_16x16x32_bf16 v[148:151], v[60:63], v[84:87], v[148:151]
 v_mfma_f32_16x16x32_bf16 v[144:147], v[56:59], v[84:87], v[144:147]
 s_waitcnt vmcnt(12) lgkmcnt(0)
 s_barrier
 v_mfma_f32_16x16x32_bf16 v[96:99], v[24:27], v[40:43], v[96:99]
 ds_read_b128 v[72:75], v4 offset:16384
 v_mfma_f32_16x16x32_bf16 v[100:103], v[28:31], v[40:43], v[100:103]
 ds_read_b64_tr_b16 v[56:57], v6 offset:24576
 v_mfma_f32_16x16x32_bf16 v[104:107], v[32:35], v[40:43], v[104:107]
 ds_read_b64_tr_b16 v[58:59], v6 offset:28672
 v_mfma_f32_16x16x32_bf16 v[108:111], v[36:39], v[40:43], v[108:111]
 ds_read_b64_tr_b16 v[60:61], v7 offset:24576
 s_add_u32 m0, s50, 65536
 s_bfe_u32 s62, s52, 0x40008
 s_lshl_b32 s62, s62, 15
 s_add_u32 s62, s62, s57
 v_mfma_f32_16x16x32_bf16 v[124:127], v[36:39], v[44:47], v[124:127]
 ds_read_b64_tr_b16 v[62:63], v7 offset:28672
 buffer_load_dwordx4 v0, s[8:11], s62 offen offset:0 sc1 lds
 v_mfma_f32_16x16x32_bf16 v[120:123], v[32:35], v[44:47], v[120:123]
 ds_read_b128 v[76:79], v4 offset:17408
 v_mfma_f32_16x16x32_bf16 v[116:119], v[28:31], v[44:47], v[116:119]
 ds_read_b64_tr_b16 v[64:65], v8 offset:24576
 v_mfma_f32_16x16x32_bf16 v[112:115], v[24:27], v[44:47], v[112:115]
 ds_read_b64_tr_b16 v[66:67], v8 offset:28672
 v_mfma_f32_16x16x32_bf16 v[128:131], v[24:27], v[48:51], v[128:131]
 ds_read_b128 v[80:83], v5 offset:16384
 v_mfma_f32_16x16x32_bf16 v[132:135], v[28:31], v[48:51], v[132:135]
 ds_read_b64_tr_b16 v[68:69], v9 offset:24576
 buffer_load_dwordx4 v0, s[8:11], s62 offen offset:1024 sc1 lds
 v_mfma_f32_16x16x32_bf16 v[136:139], v[32:35], v[48:51], v[136:139]
 ds_read_b64_tr_b16 v[70:71], v9 offset:28672
 v_mfma_f32_16x16x32_bf16 v[140:143], v[36:39], v[48:51], v[140:143]
 ds_read_b128 v[84:87], v5 offset:17408
 v_mfma_f32_16x16x32_bf16 v[156:159], v[36:39], v[52:55], v[156:159]
 s_add_u32 m0, s51, 16384
 s_bfe_u32 s63, s52, 0x40008
 s_lshl_b32 s63, s63, 17
 s_add_u32 s63, s63, s58
 v_mfma_f32_16x16x32_bf16 v[152:155], v[32:35], v[52:55], v[152:155]
 buffer_load_dwordx4 v11, s[20:23], s63 offen lds
 v_mfma_f32_16x16x32_bf16 v[148:151], v[28:31], v[52:55], v[148:151]
 v_mfma_f32_16x16x32_bf16 v[144:147], v[24:27], v[52:55], v[144:147]
 s_waitcnt vmcnt(12) lgkmcnt(0)
 s_barrier
 v_mfma_f32_16x16x32_bf16 v[96:99], v[56:59], v[72:75], v[96:99]
 ds_read_b128 v[40:43], v2 offset:0
 v_mfma_f32_16x16x32_bf16 v[100:103], v[60:63], v[72:75], v[100:103]
 ds_read_b64_tr_b16 v[24:25], v6 offset:32768
 v_mfma_f32_16x16x32_bf16 v[104:107], v[64:67], v[72:75], v[104:107]
 ds_read_b64_tr_b16 v[26:27], v6 offset:36864
 v_mfma_f32_16x16x32_bf16 v[108:111], v[68:71], v[72:75], v[108:111]
 ds_read_b64_tr_b16 v[28:29], v7 offset:32768
 s_add_u32 m0, s50, 81920
 s_bfe_u32 s62, s52, 0x4000c
 s_lshl_b32 s62, s62, 15
 s_add_u32 s62, s62, s57
 v_mfma_f32_16x16x32_bf16 v[124:127], v[68:71], v[76:79], v[124:127]
 ds_read_b64_tr_b16 v[30:31], v7 offset:36864
 buffer_load_dwordx4 v0, s[8:11], s62 offen offset:0 sc1 lds
 v_mfma_f32_16x16x32_bf16 v[120:123], v[64:67], v[76:79], v[120:123]
 ds_read_b128 v[44:47], v2 offset:1024
 v_mfma_f32_16x16x32_bf16 v[116:119], v[60:63], v[76:79], v[116:119]
 ds_read_b64_tr_b16 v[32:33], v8 offset:32768
 v_mfma_f32_16x16x32_bf16 v[112:115], v[56:59], v[76:79], v[112:115]
 ds_read_b64_tr_b16 v[34:35], v8 offset:36864
 v_mfma_f32_16x16x32_bf16 v[128:131], v[56:59], v[80:83], v[128:131]
 ds_read_b128 v[48:51], v3 offset:0
 v_mfma_f32_16x16x32_bf16 v[132:135], v[60:63], v[80:83], v[132:135]
 ds_read_b64_tr_b16 v[36:37], v9 offset:32768
 buffer_load_dwordx4 v0, s[8:11], s62 offen offset:1024 sc1 lds
 v_mfma_f32_16x16x32_bf16 v[136:139], v[64:67], v[80:83], v[136:139]
 ds_read_b64_tr_b16 v[38:39], v9 offset:36864
 v_mfma_f32_16x16x32_bf16 v[140:143], v[68:71], v[80:83], v[140:143]
 ds_read_b128 v[52:55], v3 offset:1024
 v_mfma_f32_16x16x32_bf16 v[156:159], v[68:71], v[84:87], v[156:159]
 s_add_u32 m0, s51, 24576
 s_bfe_u32 s63, s52, 0x4000c
 s_lshl_b32 s63, s63, 17
 s_add_u32 s63, s63, s58
 v_mfma_f32_16x16x32_bf16 v[152:155], v[64:67], v[84:87], v[152:155]
 buffer_load_dwordx4 v11, s[20:23], s63 offen lds
 v_mfma_f32_16x16x32_bf16 v[148:151], v[60:63], v[84:87], v[148:151]
 v_mfma_f32_16x16x32_bf16 v[144:147], v[56:59], v[84:87], v[144:147]
 s_waitcnt vmcnt(12) lgkmcnt(0)
 s_barrier
 v_mfma_f32_16x16x32_bf16 v[96:99], v[24:27], v[40:43], v[96:99]
 ds_read_b128 v[72:75], v2 offset:16384
 v_mfma_f32_16x16x32_bf16 v[100:103], v[28:31], v[40:43], v[100:103]
 ds_read_b64_tr_b16 v[56:57], v6 offset:40960
 v_mfma_f32_16x16x32_bf16 v[104:107], v[32:35], v[40:43], v[104:107]
 ds_read_b64_tr_b16 v[58:59], v6 offset:45056
 v_mfma_f32_16x16x32_bf16 v[108:111], v[36:39], v[40:43], v[108:111]
 ds_read_b64_tr_b16 v[60:61], v7 offset:40960
 s_add_u32 m0, s50, 0
 s_bfe_u32 s62, s52, 0x40010
 s_lshl_b32 s62, s62, 15
 s_add_u32 s62, s62, s57
 v_mfma_f32_16x16x32_bf16 v[124:127], v[36:39], v[44:47], v[124:127]
 ds_read_b64_tr_b16 v[62:63], v7 offset:45056
 buffer_load_dwordx4 v0, s[8:11], s62 offen offset:0 sc1 lds
 v_mfma_f32_16x16x32_bf16 v[120:123], v[32:35], v[44:47], v[120:123]
 ds_read_b128 v[76:79], v2 offset:17408
 v_mfma_f32_16x16x32_bf16 v[116:119], v[28:31], v[44:47], v[116:119]
 ds_read_b64_tr_b16 v[64:65], v8 offset:40960
 v_mfma_f32_16x16x32_bf16 v[112:115], v[24:27], v[44:47], v[112:115]
 ds_read_b64_tr_b16 v[66:67], v8 offset:45056
 v_mfma_f32_16x16x32_bf16 v[128:131], v[24:27], v[48:51], v[128:131]
 ds_read_b128 v[80:83], v3 offset:16384
 v_mfma_f32_16x16x32_bf16 v[132:135], v[28:31], v[48:51], v[132:135]
 ds_read_b64_tr_b16 v[68:69], v9 offset:40960
 buffer_load_dwordx4 v0, s[8:11], s62 offen offset:1024 sc1 lds
 v_mfma_f32_16x16x32_bf16 v[136:139], v[32:35], v[48:51], v[136:139]
 ds_read_b64_tr_b16 v[70:71], v9 offset:45056
 v_mfma_f32_16x16x32_bf16 v[140:143], v[36:39], v[48:51], v[140:143]
 ds_read_b128 v[84:87], v3 offset:17408
 v_mfma_f32_16x16x32_bf16 v[156:159], v[36:39], v[52:55], v[156:159]
 s_add_u32 m0, s51, 32768
 s_bfe_u32 s63, s52, 0x40010
 s_lshl_b32 s63, s63, 17
 s_add_u32 s63, s63, s58
 v_mfma_f32_16x16x32_bf16 v[152:155], v[32:35], v[52:55], v[152:155]
 buffer_load_dwordx4 v11, s[20:23], s63 offen lds
 v_mfma_f32_16x16x32_bf16 v[148:151], v[28:31], v[52:55], v[148:151]
 v_mfma_f32_16x16x32_bf16 v[144:147], v[24:27], v[52:55], v[144:147]
 s_waitcnt vmcnt(12) lgkmcnt(0)
 s_barrier
 v_mfma_f32_16x16x32_bf16 v[96:99], v[56:59], v[72:75], v[96:99]
 ds_read_b128 v[40:43], v15 offset:32768
 v_mfma_f32_16x16x32_bf16 v[100:103], v[60:63], v[72:75], v[100:103]
 ds_read_b64_tr_b16 v[24:25], v6 offset:0
 v_mfma_f32_16x16x32_bf16 v[104:107], v[64:67], v[72:75], v[104:107]
 ds_read_b64_tr_b16 v[26:27], v6 offset:4096
 v_mfma_f32_16x16x32_bf16 v[108:111], v[68:71], v[72:75], v[108:111]
 ds_read_b64_tr_b16 v[28:29], v7 offset:0
 s_add_u32 m0, s50, 16384
 s_bfe_u32 s62, s52, 0x40014
 s_lshl_b32 s62, s62, 15
 s_add_u32 s62, s62, s57
 v_mfma_f32_16x16x32_bf16 v[124:127], v[68:71], v[76:79], v[124:127]
 ds_read_b64_tr_b16 v[30:31], v7 offset:4096
 buffer_load_dwordx4 v0, s[8:11], s62 offen offset:0 sc1 lds
 v_mfma_f32_16x16x32_bf16 v[120:123], v[64:67], v[76:79], v[120:123]
 ds_read_b128 v[44:47], v15 offset:33792
 v_mfma_f32_16x16x32_bf16 v[116:119], v[60:63], v[76:79], v[116:119]
 ds_read_b64_tr_b16 v[32:33], v8 offset:0
 v_mfma_f32_16x16x32_bf16 v[112:115], v[56:59], v[76:79], v[112:115]
 ds_read_b64_tr_b16 v[34:35], v8 offset:4096
 v_mfma_f32_16x16x32_bf16 v[128:131], v[56:59], v[80:83], v[128:131]
 ds_read_b128 v[48:51], v15 offset:40960
 v_mfma_f32_16x16x32_bf16 v[132:135], v[60:63], v[80:83], v[132:135]
 ds_read_b64_tr_b16 v[36:37], v9 offset:0
 buffer_load_dwordx4 v0, s[8:11], s62 offen offset:1024 sc1 lds
 v_mfma_f32_16x16x32_bf16 v[136:139], v[64:67], v[80:83], v[136:139]
 ds_read_b64_tr_b16 v[38:39], v9 offset:4096
 v_mfma_f32_16x16x32_bf16 v[140:143], v[68:71], v[80:83], v[140:143]
 ds_read_b128 v[52:55], v15 offset:41984
 v_mfma_f32_16x16x32_bf16 v[156:159], v[68:71], v[84:87], v[156:159]
 s_add_u32 m0, s51, 40960
 s_bfe_u32 s63, s52, 0x40014
 s_lshl_b32 s63, s63, 17
 s_add_u32 s63, s63, s58
 v_mfma_f32_16x16x32_bf16 v[152:155], v[64:67], v[84:87], v[152:155]
 buffer_load_dwordx4 v11, s[20:23], s63 offen lds
 v_mfma_f32_16x16x32_bf16 v[148:151], v[60:63], v[84:87], v[148:151]
 v_mfma_f32_16x16x32_bf16 v[144:147], v[56:59], v[84:87], v[144:147]
 s_waitcnt vmcnt(12) lgkmcnt(0)
 s_barrier
 v_mfma_f32_16x16x32_bf16 v[96:99], v[24:27], v[40:43], v[96:99]
 ds_read_b128 v[72:75], v15 offset:49152
 ds_read_b64_tr_b16 v[56:57], v6 offset:8192
 v_cvt_pk_bf16_f32 v104, v104, v105
 v_cvt_pk_bf16_f32 v105, v106, v107
 v_cvt_pk_bf16_f32 v106, v108, v109
 v_cvt_pk_bf16_f32 v107, v110, v111
 s_xor_b32 s85, s4, 1
 s_mul_i32 s85, s85, 49152
 s_add_u32 s85, s85, s60
 v_mfma_f32_16x16x32_bf16 v[100:103], v[28:31], v[40:43], v[100:103]
 ds_read_b64_tr_b16 v[58:59], v6 offset:12288
 ds_read_b64_tr_b16 v[60:61], v7 offset:8192
 buffer_store_dwordx4 v[104:107], v13, s[8:11], s85 offen offset:0 sc1
 v_cvt_pk_bf16_f32 v120, v120, v121
 v_cvt_pk_bf16_f32 v121, v122, v123
 v_cvt_pk_bf16_f32 v122, v124, v125
 v_cvt_pk_bf16_f32 v123, v126, v127
 s_xor_b32 s85, s4, 1
 v_mfma_f32_16x16x32_bf16 v[116:119], v[28:31], v[44:47], v[116:119]
 ds_read_b64_tr_b16 v[62:63], v7 offset:12288
 ds_read_b128 v[76:79], v15 offset:50176
 s_mul_i32 s85, s85, 49152
 s_add_u32 s85, s85, s60
 buffer_store_dwordx4 v[120:123], v13, s[8:11], s85 offen offset:1024 sc1
 v_cvt_pk_bf16_f32 v128, v128, v129
 v_cvt_pk_bf16_f32 v129, v130, v131
 v_cvt_pk_bf16_f32 v130, v132, v133
 v_cvt_pk_bf16_f32 v131, v134, v135
 v_mfma_f32_16x16x32_bf16 v[112:115], v[24:27], v[44:47], v[112:115]
 ds_read_b64_tr_b16 v[64:65], v8 offset:8192
 ds_read_b64_tr_b16 v[66:67], v8 offset:12288
 s_xor_b32 s85, s4, 2
 s_mul_i32 s85, s85, 49152
 s_add_u32 s85, s85, s60
 s_add_u32 s85, s85, 16384
 buffer_store_dwordx4 v[128:131], v13, s[8:11], s85 offen offset:0 sc1
 v_cvt_pk_bf16_f32 v144, v144, v145
 v_mfma_f32_16x16x32_bf16 v[96:99], v[32:35], v[48:51], v[96:99]
 ds_read_b128 v[80:83], v15 offset:57344
 ds_read_b64_tr_b16 v[68:69], v9 offset:8192
 v_cvt_pk_bf16_f32 v145, v146, v147
 v_cvt_pk_bf16_f32 v146, v148, v149
 v_cvt_pk_bf16_f32 v147, v150, v151
 s_xor_b32 s85, s4, 2
 s_mul_i32 s85, s85, 49152
 s_add_u32 s85, s85, s60
 s_add_u32 s85, s85, 16384
 v_mfma_f32_16x16x32_bf16 v[100:103], v[36:39], v[48:51], v[100:103]
 ds_read_b64_tr_b16 v[70:71], v9 offset:12288
 ds_read_b128 v[84:87], v15 offset:58368
 buffer_store_dwordx4 v[144:147], v13, s[8:11], s85 offen offset:1024 sc1
 v_cvt_pk_bf16_f32 v136, v136, v137
 v_cvt_pk_bf16_f32 v137, v138, v139
 v_cvt_pk_bf16_f32 v138, v140, v141
 v_cvt_pk_bf16_f32 v139, v142, v143
 s_xor_b32 s85, s4, 3
 v_mfma_f32_16x16x32_bf16 v[116:119], v[36:39], v[52:55], v[116:119]
 s_mul_i32 s85, s85, 49152
 s_add_u32 s85, s85, s60
 s_add_u32 s85, s85, 32768
 buffer_store_dwordx4 v[136:139], v13, s[8:11], s85 offen offset:0 sc1
 v_cvt_pk_bf16_f32 v152, v152, v153
 v_cvt_pk_bf16_f32 v153, v154, v155
 v_cvt_pk_bf16_f32 v154, v156, v157
 v_mfma_f32_16x16x32_bf16 v[112:115], v[32:35], v[52:55], v[112:115]
 v_cvt_pk_bf16_f32 v155, v158, v159
 s_xor_b32 s85, s4, 3
 s_mul_i32 s85, s85, 49152
 s_add_u32 s85, s85, s60
 s_add_u32 s85, s85, 32768
 buffer_store_dwordx4 v[152:155], v13, s[8:11], s85 offen offset:1024 sc1
 s_waitcnt vmcnt(6) lgkmcnt(0)
 s_barrier
 v_mfma_f32_16x16x32_bf16 v[96:99], v[56:59], v[72:75], v[96:99]
 ds_read_b128 v[40:43], v17 offset:0
 ds_read_b64_tr_b16 v[24:25], v6 offset:16384
 v_mfma_f32_16x16x32_bf16 v[100:103], v[60:63], v[72:75], v[100:103]
 ds_read_b64_tr_b16 v[26:27], v6 offset:20480
 ds_read_b64_tr_b16 v[28:29], v7 offset:16384
 v_mfma_f32_16x16x32_bf16 v[116:119], v[60:63], v[76:79], v[116:119]
 ds_read_b64_tr_b16 v[30:31], v7 offset:20480
 ds_read_b128 v[44:47], v17 offset:1024
 v_mfma_f32_16x16x32_bf16 v[112:115], v[56:59], v[76:79], v[112:115]
 ds_read_b64_tr_b16 v[32:33], v8 offset:16384
 ds_read_b64_tr_b16 v[34:35], v8 offset:20480
 v_mfma_f32_16x16x32_bf16 v[96:99], v[64:67], v[80:83], v[96:99]
 ds_read_b128 v[48:51], v17 offset:8192
 ds_read_b64_tr_b16 v[36:37], v9 offset:16384
 v_mfma_f32_16x16x32_bf16 v[100:103], v[68:71], v[80:83], v[100:103]
 ds_read_b64_tr_b16 v[38:39], v9 offset:20480
 ds_read_b128 v[52:55], v17 offset:9216
 v_mfma_f32_16x16x32_bf16 v[116:119], v[68:71], v[84:87], v[116:119]
 v_mfma_f32_16x16x32_bf16 v[112:115], v[64:67], v[84:87], v[112:115]
 s_waitcnt lgkmcnt(0)
 v_mfma_f32_16x16x32_bf16 v[96:99], v[24:27], v[40:43], v[96:99]
 ds_read_b128 v[72:75], v17 offset:16384
 ds_read_b64_tr_b16 v[56:57], v6 offset:24576
 s_xor_b32 s92, s71, 1024
 v_mov_b32 v91, 1
 v_mfma_f32_16x16x32_bf16 v[100:103], v[28:31], v[40:43], v[100:103]
 ds_read_b64_tr_b16 v[58:59], v6 offset:28672
 ds_read_b64_tr_b16 v[60:61], v7 offset:24576
 s_waitcnt vmcnt(4)
 v_mfma_f32_16x16x32_bf16 v[116:119], v[28:31], v[44:47], v[116:119]
 ds_read_b64_tr_b16 v[62:63], v7 offset:28672
 ds_read_b128 v[76:79], v17 offset:17408
 buffer_store_byte v91, off, s[8:11], s92 sc1
 s_xor_b32 s92, s71, 2048
 v_mfma_f32_16x16x32_bf16 v[112:115], v[24:27], v[44:47], v[112:115]
 ds_read_b64_tr_b16 v[64:65], v8 offset:24576
 ds_read_b64_tr_b16 v[66:67], v8 offset:28672
 v_mov_b32 v91, 1
 v_mfma_f32_16x16x32_bf16 v[96:99], v[32:35], v[48:51], v[96:99]
 ds_read_b128 v[80:83], v17 offset:24576
 ds_read_b64_tr_b16 v[68:69], v9 offset:24576
 s_waitcnt vmcnt(3)
 buffer_store_byte v91, off, s[8:11], s92 offset:1 sc1
 v_mfma_f32_16x16x32_bf16 v[100:103], v[36:39], v[48:51], v[100:103]
 ds_read_b64_tr_b16 v[70:71], v9 offset:28672
 ds_read_b128 v[84:87], v17 offset:25600
 s_xor_b32 s92, s71, 3072
 v_mfma_f32_16x16x32_bf16 v[116:119], v[36:39], v[52:55], v[116:119]
 v_mov_b32 v91, 1
 s_waitcnt vmcnt(2)
 v_mfma_f32_16x16x32_bf16 v[112:115], v[32:35], v[52:55], v[112:115]
 buffer_store_byte v91, off, s[8:11], s92 offset:2 sc1
 s_waitcnt lgkmcnt(0)
 v_mfma_f32_16x16x32_bf16 v[96:99], v[56:59], v[72:75], v[96:99]
 ds_read_b128 v[40:43], v15 offset:0
 ds_read_b64_tr_b16 v[24:25], v6 offset:32768
 v_mfma_f32_16x16x32_bf16 v[100:103], v[60:63], v[72:75], v[100:103]
 ds_read_b64_tr_b16 v[26:27], v6 offset:36864
 ds_read_b64_tr_b16 v[28:29], v7 offset:32768
 v_mfma_f32_16x16x32_bf16 v[116:119], v[60:63], v[76:79], v[116:119]
 ds_read_b64_tr_b16 v[30:31], v7 offset:36864
 ds_read_b128 v[44:47], v15 offset:1024
 v_mfma_f32_16x16x32_bf16 v[112:115], v[56:59], v[76:79], v[112:115]
 ds_read_b64_tr_b16 v[32:33], v8 offset:32768
 ds_read_b64_tr_b16 v[34:35], v8 offset:36864
 v_mfma_f32_16x16x32_bf16 v[96:99], v[64:67], v[80:83], v[96:99]
 ds_read_b128 v[48:51], v15 offset:8192
 ds_read_b64_tr_b16 v[36:37], v9 offset:32768
 v_mfma_f32_16x16x32_bf16 v[100:103], v[68:71], v[80:83], v[100:103]
 ds_read_b64_tr_b16 v[38:39], v9 offset:36864
 ds_read_b128 v[52:55], v15 offset:9216
 v_mfma_f32_16x16x32_bf16 v[116:119], v[68:71], v[84:87], v[116:119]
 v_mfma_f32_16x16x32_bf16 v[112:115], v[64:67], v[84:87], v[112:115]
 s_waitcnt lgkmcnt(0)
 v_mfma_f32_16x16x32_bf16 v[96:99], v[24:27], v[40:43], v[96:99]
 ds_read_b128 v[72:75], v15 offset:16384
 ds_read_b64_tr_b16 v[56:57], v6 offset:40960
 v_mfma_f32_16x16x32_bf16 v[100:103], v[28:31], v[40:43], v[100:103]
 ds_read_b64_tr_b16 v[58:59], v6 offset:45056
 ds_read_b64_tr_b16 v[60:61], v7 offset:40960
 v_mfma_f32_16x16x32_bf16 v[116:119], v[28:31], v[44:47], v[116:119]
 ds_read_b64_tr_b16 v[62:63], v7 offset:45056
 ds_read_b128 v[76:79], v15 offset:17408
 v_mfma_f32_16x16x32_bf16 v[112:115], v[24:27], v[44:47], v[112:115]
 ds_read_b64_tr_b16 v[64:65], v8 offset:40960
 ds_read_b64_tr_b16 v[66:67], v8 offset:45056
 v_mfma_f32_16x16x32_bf16 v[96:99], v[32:35], v[48:51], v[96:99]
 ds_read_b128 v[80:83], v15 offset:24576
 ds_read_b64_tr_b16 v[68:69], v9 offset:40960
 v_mfma_f32_16x16x32_bf16 v[100:103], v[36:39], v[48:51], v[100:103]
 ds_read_b64_tr_b16 v[70:71], v9 offset:45056
 ds_read_b128 v[84:87], v15 offset:25600
 v_mfma_f32_16x16x32_bf16 v[116:119], v[36:39], v[52:55], v[116:119]
 v_mfma_f32_16x16x32_bf16 v[112:115], v[32:35], v[52:55], v[112:115]
 s_waitcnt lgkmcnt(0)
 v_mfma_f32_16x16x32_bf16 v[96:99], v[56:59], v[72:75], v[96:99]
 s_buffer_load_dword s72, s[8:11], s71 glc
 v_mfma_f32_16x16x32_bf16 v[100:103], v[60:63], v[72:75], v[100:103]
 v_mfma_f32_16x16x32_bf16 v[116:119], v[60:63], v[76:79], v[116:119]
 v_mfma_f32_16x16x32_bf16 v[112:115], v[56:59], v[76:79], v[112:115]
 v_mfma_f32_16x16x32_bf16 v[96:99], v[64:67], v[80:83], v[96:99]
 v_mfma_f32_16x16x32_bf16 v[100:103], v[68:71], v[80:83], v[100:103]
 v_mfma_f32_16x16x32_bf16 v[116:119], v[68:71], v[84:87], v[116:119]
 v_mfma_f32_16x16x32_bf16 v[112:115], v[64:67], v[84:87], v[112:115]
 s_waitcnt lgkmcnt(0)
 s_cmp_eq_u32 s72, 0x10101
 s_cbranch_scc0 Lsp_96
Lok_97:
 s_mul_i32 s85, s4, 49152
 s_add_u32 s85, s85, s60
 buffer_load_dwordx4 v[160:163], v13, s[8:11], s85 offen offset:0 sc1
 buffer_load_dwordx4 v[164:167], v13, s[8:11], s85 offen offset:1024 sc1
 s_mul_i32 s85, s4, 49152
 s_add_u32 s85, s85, s60
 s_add_u32 s85, s85, 16384
 buffer_load_dwordx4 v[168:171], v13, s[8:11], s85 offen offset:0 sc1
 buffer_load_dwordx4 v[172:175], v13, s[8:11], s85 offen offset:1024 sc1
 s_mul_i32 s85, s4, 49152
 s_add_u32 s85, s85, s60
 s_add_u32 s85, s85, 32768
 buffer_load_dwordx4 v[176:179], v13, s[8:11], s85 offen offset:0 sc1
 buffer_load_dwordx4 v[180:183], v13, s[8:11], s85 offen offset:1024 sc1
 s_waitcnt vmcnt(4)
 v_lshlrev_b32 v208, 16, v160
 v_and_b32 v209, s89, v160
 v_add_f32 v192, v192, v208
 v_add_f32 v193, v193, v209
 v_lshlrev_b32 v210, 16, v161
 v_and_b32 v211, s89, v161
 v_add_f32 v194, v194, v210
 v_add_f32 v195, v195, v211
 v_lshlrev_b32 v208, 16, v162
 v_and_b32 v209, s89, v162
 v_add_f32 v196, v196, v208
 v_add_f32 v197, v197, v209
 v_lshlrev_b32 v210, 16, v163
 v_and_b32 v211, s89, v163
 v_add_f32 v198, v198, v210
 v_add_f32 v199, v199, v211
 v_lshlrev_b32 v208, 16, v164
 v_and_b32 v209, s89, v164
 v_add_f32 v200, v200, v208
 v_add_f32 v201, v201, v209
 v_lshlrev_b32 v210, 16, v165
 v_and_b32 v211, s89, v165
 v_add_f32 v202, v202, v210
 v_add_f32 v203, v203, v211
 v_lshlrev_b32 v208, 16, v166
 v_and_b32 v209, s89, v166
 v_add_f32 v204, v204, v208
 v_add_f32 v205, v205, v209
 v_lshlrev_b32 v210, 16, v167
 v_and_b32 v211, s89, v167
 v_add_f32 v206, v206, v210
 v_add_f32 v207, v207, v211
 s_waitcnt vmcnt(2)
 v_lshlrev_b32 v208, 16, v168
 v_and_b32 v209, s89, v168
 v_add_f32 v192, v192, v208
 v_add_f32 v193, v193, v209
 v_lshlrev_b32 v210, 16, v169
 v_and_b32 v211, s89, v169
 v_add_f32 v194, v194, v210
 v_add_f32 v195, v195, v211
 v_lshlrev_b32 v208, 16, v170
 v_and_b32 v209, s89, v170
 v_add_f32 v196, v196, v208
 v_add_f32 v197, v197, v209
 v_lshlrev_b32 v210, 16, v171
 v_and_b32 v211, s89, v171
 v_add_f32 v198, v198, v210
 v_add_f32 v199, v199, v211
 v_lshlrev_b32 v208, 16, v172
 v_and_b32 v209, s89, v172
 v_add_f32 v200, v200, v208
 v_add_f32 v201, v201, v209
 v_lshlrev_b32 v210, 16, v173
 v_and_b32 v211, s89, v173
 v_add_f32 v202, v202, v210
 v_add_f32 v203, v203, v211
 v_lshlrev_b32 v208, 16, v174
 v_and_b32 v209, s89, v174
 v_add_f32 v204, v204, v208
 v_add_f32 v205, v205, v209
 v_lshlrev_b32 v210, 16, v175
 v_and_b32 v211, s89, v175
 v_add_f32 v206, v206, v210
 v_add_f32 v207, v207, v211
 s_waitcnt vmcnt(0)
 v_lshlrev_b32 v208, 16, v176
 v_and_b32 v209, s89, v176
 v_add_f32 v192, v192, v208
 v_add_f32 v193, v193, v209
 v_lshlrev_b32 v210, 16, v177
 v_and_b32 v211, s89, v177
 v_add_f32 v194, v194, v210
 v_add_f32 v195, v195, v211
 v_lshlrev_b32 v208, 16, v178
 v_and_b32 v209, s89, v178
 v_add_f32 v196, v196, v208
 v_add_f32 v197, v197, v209
 v_lshlrev_b32 v210, 16, v179
 v_and_b32 v211, s89, v179
 v_add_f32 v198, v198, v210
 v_add_f32 v199, v199, v211
 v_lshlrev_b32 v208, 16, v180
 v_and_b32 v209, s89, v180
 v_add_f32 v200, v200, v208
 v_add_f32 v201, v201, v209
 v_lshlrev_b32 v210, 16, v181
 v_and_b32 v211, s89, v181
 v_add_f32 v202, v202, v210
 v_add_f32 v203, v203, v211
 v_lshlrev_b32 v208, 16, v182
 v_and_b32 v209, s89, v182
 v_add_f32 v204, v204, v208
 v_add_f32 v205, v205, v209
 v_lshlrev_b32 v210, 16, v183
 v_and_b32 v211, s89, v183
 v_add_f32 v206, v206, v210
 v_add_f32 v207, v207, v211
 v_add_f32 v96, v96, v192
 v_add_f32 v97, v97, v193
 v_add_f32 v98, v98, v194
 v_add_f32 v99, v99, v195
 v_add_f32 v100, v100, v196
 v_add_f32 v101, v101, v197
 v_add_f32 v102, v102, v198
 v_add_f32 v103, v103, v199
 v_cvt_pk_bf16_f32 v96, v96, v97
 v_cvt_pk_bf16_f32 v97, v98, v99
 v_cvt_pk_bf16_f32 v98, v100, v101
 v_cvt_pk_bf16_f32 v99, v102, v103
 s_nop 0
 v_permlane16_swap_b32 v96, v98
 v_permlane16_swap_b32 v97, v99
 buffer_store_dwordx4 v[96:99], v94, s[28:31], s61 offen
 v_add_f32 v112, v112, v200
 v_add_f32 v113, v113, v201
 v_add_f32 v114, v114, v202
 v_add_f32 v115, v115, v203
 v_add_f32 v116, v116, v204
 v_add_f32 v117, v117, v205
 v_add_f32 v118, v118, v206
 v_add_f32 v119, v119, v207
 v_cvt_pk_bf16_f32 v112, v112, v113
 v_cvt_pk_bf16_f32 v113, v114, v115
 v_cvt_pk_bf16_f32 v114, v116, v117
 v_cvt_pk_bf16_f32 v115, v118, v119
 s_nop 0
 v_permlane16_swap_b32 v112, v114
 v_permlane16_swap_b32 v113, v115
 buffer_store_dwordx4 v[112:115], v94, s[28:31], s66 offen
 s_endpgm
Lsp_93:
 s_mov_b32 s95, 0
Llp_95:
 s_buffer_load_dwordx2 s[72:73], s[8:11], s64 glc
 s_waitcnt lgkmcnt(0)
 s_add_u32 s95, s95, 1
 s_and_b32 s72, s72, s73
 s_cmp_eq_u32 s72, 0x1010101
 s_cbranch_scc1 Lok_94
 s_cmp_lt_u32 s95, 0x40000
 s_cbranch_scc1 Llp_95
 s_branch Lok_94
Lsp_96:
 s_mov_b32 s95, 0
Llp_98:
 s_buffer_load_dword s72, s[8:11], s71 glc
 s_waitcnt lgkmcnt(0)
 s_add_u32 s95, s95, 1
 s_cmp_eq_u32 s72, 0x10101
 s_cbranch_scc1 Lok_97
 s_cmp_lt_u32 s95, 0x40000
 s_cbranch_scc1 Llp_98
 s_branch Lok_97
L5_v04:
 s_lshl_b32 s52, s52, 16
 s_lshr_b32 s84, 0x32103210, s84
 s_and_b32 s84, s84, 0xffff
 s_or_b32 s52, s52, s84
 s_xor_b32 s52, s52, s96
 s_waitcnt vmcnt(12) lgkmcnt(0)
 s_barrier
 v_mfma_f32_16x16x32_bf16 v[96:99], v[24:27], v[40:43], v[96:99]
 ds_read_b128 v[72:75], v2 offset:16384
 v_mfma_f32_16x16x32_bf16 v[100:103], v[28:31], v[40:43], v[100:103]
 ds_read_b64_tr_b16 v[56:57], v6 offset:40960
 v_mfma_f32_16x16x32_bf16 v[104:107], v[32:35], v[40:43], v[104:107]
 ds_read_b64_tr_b16 v[58:59], v6 offset:45056
 v_mfma_f32_16x16x32_bf16 v[108:111], v[36:39], v[40:43], v[108:111]
 ds_read_b64_tr_b16 v[60:61], v7 offset:40960
 v_mfma_f32_16x16x32_bf16 v[124:127], v[36:39], v[44:47], v[124:127]
 ds_read_b64_tr_b16 v[62:63], v7 offset:45056
 v_mfma_f32_16x16x32_bf16 v[120:123], v[32:35], v[44:47], v[120:123]
 ds_read_b128 v[76:79], v2 offset:17408
 v_mfma_f32_16x16x32_bf16 v[116:119], v[28:31], v[44:47], v[116:119]
 ds_read_b64_tr_b16 v[64:65], v8 offset:40960
 v_mfma_f32_16x16x32_bf16 v[112:115], v[24:27], v[44:47], v[112:115]
 ds_read_b64_tr_b16 v[66:67], v8 offset:45056
 v_mfma_f32_16x16x32_bf16 v[128:131], v[24:27], v[48:51], v[128:131]
 ds_read_b128 v[80:83], v3 offset:16384
 s_add_u32 m0, s51, 32768
 s_bfe_u32 s63, s52, 0x40000
 s_lshl_b32 s63, s63, 17
 s_add_u32 s63, s63, s58
 v_mfma_f32_16x16x32_bf16 v[132:135], v[28:31], v[48:51], v[132:135]
 ds_read_b64_tr_b16 v[68:69], v9 offset:40960
 buffer_load_dwordx4 v11, s[20:23], s63 offen lds
 v_mfma_f32_16x16x32_bf16 v[136:139], v[32:35], v[48:51], v[136:139]
 ds_read_b64_tr_b16 v[70:71], v9 offset:45056
 v_mfma_f32_16x16x32_bf16 v[140:143], v[36:39], v[48:51], v[140:143]
 ds_read_b128 v[84:87], v3 offset:17408
 v_mfma_f32_16x16x32_bf16 v[156:159], v[36:39], v[52:55], v[156:159]
 v_mfma_f32_16x16x32_bf16 v[152:155], v[32:35], v[52:55], v[152:155]
 v_mfma_f32_16x16x32_bf16 v[148:151], v[28:31], v[52:55], v[148:151]
 v_mfma_f32_16x16x32_bf16 v[144:147], v[24:27], v[52:55], v[144:147]
 s_waitcnt vmcnt(10) lgkmcnt(0)
 s_barrier
 v_mfma_f32_16x16x32_bf16 v[96:99], v[56:59], v[72:75], v[96:99]
 ds_read_b128 v[40:43], v2 offset:32768
 v_mfma_f32_16x16x32_bf16 v[100:103], v[60:63], v[72:75], v[100:103]
 ds_read_b64_tr_b16 v[24:25], v6 offset:0
 v_mfma_f32_16x16x32_bf16 v[104:107], v[64:67], v[72:75], v[104:107]
 ds_read_b64_tr_b16 v[26:27], v6 offset:4096
 v_mfma_f32_16x16x32_bf16 v[108:111], v[68:71], v[72:75], v[108:111]
 ds_read_b64_tr_b16 v[28:29], v7 offset:0
 v_mfma_f32_16x16x32_bf16 v[124:127], v[68:71], v[76:79], v[124:127]
 ds_read_b64_tr_b16 v[30:31], v7 offset:4096
 s_lshl2_add_u32 s64, s83, s4
 v_mfma_f32_16x16x32_bf16 v[120:123], v[64:67], v[76:79], v[120:123]
 ds_read_b128 v[44:47], v2 offset:33792
 s_lshl2_add_u32 s64, s64, s7
 s_lshl_b32 s64, s64, 7
 v_mfma_f32_16x16x32_bf16 v[116:119], v[60:63], v[76:79], v[116:119]
 ds_read_b64_tr_b16 v[32:33], v8 offset:0
 s_add_u32 s64, s64, 39927808
 v_mfma_f32_16x16x32_bf16 v[112:115], v[56:59], v[76:79], v[112:115]
 ds_read_b64_tr_b16 v[34:35], v8 offset:4096
 s_buffer_load_dwordx2 s[72:73], s[8:11], s64 glc
 v_mfma_f32_16x16x32_bf16 v[128:131], v[56:59], v[80:83], v[128:131]
 ds_read_b128 v[48:51], v3 offset:32768
 s_add_u32 m0, s51, 40960
 s_bfe_u32 s63, s52, 0x40004
 s_lshl_b32 s63, s63, 17
 s_add_u32 s63, s63, s58
 v_mfma_f32_16x16x32_bf16 v[132:135], v[60:63], v[80:83], v[132:135]
 ds_read_b64_tr_b16 v[36:37], v9 offset:0
 buffer_load_dwordx4 v11, s[20:23], s63 offen lds
 v_mfma_f32_16x16x32_bf16 v[136:139], v[64:67], v[80:83], v[136:139]
 ds_read_b64_tr_b16 v[38:39], v9 offset:4096
 v_mfma_f32_16x16x32_bf16 v[140:143], v[68:71], v[80:83], v[140:143]
 ds_read_b128 v[52:55], v3 offset:33792
 ds_read_b32 v90, v0
 ds_read_b32 v90, v0
 v_mfma_f32_16x16x32_bf16 v[156:159], v[68:71], v[84:87], v[156:159]
 v_mfma_f32_16x16x32_bf16 v[152:155], v[64:67], v[84:87], v[152:155]
 v_mfma_f32_16x16x32_bf16 v[148:151], v[60:63], v[84:87], v[148:151]
 v_mfma_f32_16x16x32_bf16 v[144:147], v[56:59], v[84:87], v[144:147]
 s_waitcnt vmcnt(8) lgkmcnt(2)
 s_barrier
 v_mfma_f32_16x16x32_bf16 v[96:99], v[24:27], v[40:43], v[96:99]
 ds_read_b128 v[72:75], v2 offset:49152
 v_mfma_f32_16x16x32_bf16 v[100:103], v[28:31], v[40:43], v[100:103]
 ds_read_b64_tr_b16 v[56:57], v6 offset:8192
 v_mfma_f32_16x16x32_bf16 v[104:107], v[32:35], v[40:43], v[104:107]
 ds_read_b64_tr_b16 v[58:59], v6 offset:12288
 v_mfma_f32_16x16x32_bf16 v[108:111], v[36:39], v[40:43], v[108:111]
 ds_read_b64_tr_b16 v[60:61], v7 offset:8192
 v_mfma_f32_16x16x32_bf16 v[124:127], v[36:39], v[44:47], v[124:127]
 ds_read_b64_tr_b16 v[62:63], v7 offset:12288
 v_mfma_f32_16x16x32_bf16 v[120:123], v[32:35], v[44:47], v[120:123]
 ds_read_b128 v[76:79], v2 offset:50176
 v_mfma_f32_16x16x32_bf16 v[116:119], v[28:31], v[44:47], v[116:119]
 ds_read_b64_tr_b16 v[64:65], v8 offset:8192
 v_mfma_f32_16x16x32_bf16 v[112:115], v[24:27], v[44:47], v[112:115]
 ds_read_b64_tr_b16 v[66:67], v8 offset:12288
 v_mfma_f32_16x16x32_bf16 v[128:131], v[24:27], v[48:51], v[128:131]
 ds_read_b128 v[80:83], v3 offset:49152
 s_add_u32 m0, s51, 0
 s_bfe_u32 s63, s52, 0x40008
 s_lshl_b32 s63, s63, 17
 s_add_u32 s63, s63, s58
 v_mfma_f32_16x16x32_bf16 v[132:135], v[28:31], v[48:51], v[132:135]
 ds_read_b64_tr_b16 v[68:69], v9 offset:8192
 buffer_load_dwordx4 v11, s[20:23], s63 offen lds
 v_mfma_f32_16x16x32_bf16 v[136:139], v[32:35], v[48:51], v[136:139]
 ds_read_b64_tr_b16 v[70:71], v9 offset:12288
 v_mfma_f32_16x16x32_bf16 v[140:143], v[36:39], v[48:51], v[140:143]
 ds_read_b128 v[84:87], v3 offset:50176
 v_mfma_f32_16x16x32_bf16 v[156:159], v[36:39], v[52:55], v[156:159]
 v_mfma_f32_16x16x32_bf16 v[152:155], v[32:35], v[52:55], v[152:155]
 v_mfma_f32_16x16x32_bf16 v[148:151], v[28:31], v[52:55], v[148:151]
 v_mfma_f32_16x16x32_bf16 v[144:147], v[24:27], v[52:55], v[144:147]
 s_waitcnt lgkmcnt(0)
 s_and_b32 s72, s72, s73
 s_cmp_eq_u32 s72, 0x1010101
 s_cbranch_scc0 Lsp_99
Lok_100:
 s_waitcnt vmcnt(6) lgkmcnt(0)
 s_barrier
 v_mfma_f32_16x16x32_bf16 v[96:99], v[56:59], v[72:75], v[96:99]
 ds_read_b128 v[40:43], v4 offset:0
 v_mfma_f32_16x16x32_bf16 v[100:103], v[60:63], v[72:75], v[100:103]
 ds_read_b64_tr_b16 v[24:25], v6 offset:16384
 v_mfma_f32_16x16x32_bf16 v[104:107], v[64:67], v[72:75], v[104:107]
 ds_read_b64_tr_b16 v[26:27], v6 offset:20480
 s_add_u32 m0, s50, 0
 s_bfe_u32 s62, s52, 0x40000
 s_lshl_b32 s62, s62, 15
 s_add_u32 s62, s62, s57
 v_mfma_f32_16x16x32_bf16 v[108:111], v[68:71], v[72:75], v[108:111]
 ds_read_b64_tr_b16 v[28:29], v7 offset:16384
 buffer_load_dwordx4 v0, s[8:11], s62 offen offset:0 sc1 lds
 v_mfma_f32_16x16x32_bf16 v[124:127], v[68:71], v[76:79], v[124:127]
 ds_read_b64_tr_b16 v[30:31], v7 offset:20480
 v_mfma_f32_16x16x32_bf16 v[120:123], v[64:67], v[76:79], v[120:123]
 ds_read_b128 v[44:47], v4 offset:1024
 buffer_load_dwordx4 v0, s[8:11], s62 offen offset:1024 sc1 lds
 v_mfma_f32_16x16x32_bf16 v[116:119], v[60:63], v[76:79], v[116:119]
 ds_read_b64_tr_b16 v[32:33], v8 offset:16384
 s_add_u32 m0, s50, 16384
 s_bfe_u32 s62, s52, 0x40004
 s_lshl_b32 s62, s62, 15
 s_add_u32 s62, s62, s57
 v_mfma_f32_16x16x32_bf16 v[112:115], v[56:59], v[76:79], v[112:115]
 ds_read_b64_tr_b16 v[34:35], v8 offset:20480
 buffer_load_dwordx4 v0, s[8:11], s62 offen offset:0 sc1 lds
 v_mfma_f32_16x16x32_bf16 v[128:131], v[56:59], v[80:83], v[128:131]
 ds_read_b128 v[48:51], v5 offset:0
 v_mfma_f32_16x16x32_bf16 v[132:135], v[60:63], v[80:83], v[132:135]
 ds_read_b64_tr_b16 v[36:37], v9 offset:16384
 v_mfma_f32_16x16x32_bf16 v[136:139], v[64:67], v[80:83], v[136:139]
 ds_read_b64_tr_b16 v[38:39], v9 offset:20480
 buffer_load_dwordx4 v0, s[8:11], s62 offen offset:1024 sc1 lds
 v_mfma_f32_16x16x32_bf16 v[140:143], v[68:71], v[80:83], v[140:143]
 ds_read_b128 v[52:55], v5 offset:1024
 s_add_u32 m0, s50, 32768
 s_bfe_u32 s62, s52, 0x40008
 s_lshl_b32 s62, s62, 15
 s_add_u32 s62, s62, s57
 v_mfma_f32_16x16x32_bf16 v[156:159], v[68:71], v[84:87], v[156:159]
 buffer_load_dwordx4 v0, s[8:11], s62 offen offset:0 sc1 lds
 v_mfma_f32_16x16x32_bf16 v[152:155], v[64:67], v[84:87], v[152:155]
 v_mfma_f32_16x16x32_bf16 v[148:151], v[60:63], v[84:87], v[148:151]
 buffer_load_dwordx4 v0, s[8:11], s62 offen offset:1024 sc1 lds
 v_mfma_f32_16x16x32_bf16 v[144:147], v[56:59], v[84:87], v[144:147]
 s_waitcnt vmcnt(9) lgkmcnt(0)
 s_barrier
 v_mfma_f32_16x16x32_bf16 v[96:99], v[24:27], v[40:43], v[96:99]
 ds_read_b128 v[72:75], v4 offset:16384
 s_mov_b32 s89, 0xffff0000
 s_waitcnt vmcnt(28)
 v_mfma_f32_16x16x32_bf16 v[100:103], v[28:31], v[40:43], v[100:103]
 ds_read_b64_tr_b16 v[56:57], v6 offset:24576
 v_permlane16_swap_b32 v184, v186
 v_mfma_f32_16x16x32_bf16 v[104:107], v[32:35], v[40:43], v[104:107]
 ds_read_b64_tr_b16 v[58:59], v6 offset:28672
 v_permlane16_swap_b32 v185, v187
 v_permlane16_swap_b32 v188, v190
 s_add_u32 m0, s50, 49152
 s_bfe_u32 s62, s52, 0x4000c
 s_lshl_b32 s62, s62, 15
 s_add_u32 s62, s62, s57
 v_mfma_f32_16x16x32_bf16 v[108:111], v[36:39], v[40:43], v[108:111]
 ds_read_b64_tr_b16 v[60:61], v7 offset:24576
 buffer_load_dwordx4 v0, s[8:11], s62 offen offset:0 sc1 lds
 v_permlane16_swap_b32 v189, v191
 v_mfma_f32_16x16x32_bf16 v[124:127], v[36:39], v[44:47], v[124:127]
 ds_read_b64_tr_b16 v[62:63], v7 offset:28672
 v_lshlrev_b32 v192, 16, v184
 v_mfma_f32_16x16x32_bf16 v[120:123], v[32:35], v[44:47], v[120:123]
 ds_read_b128 v[76:79], v4 offset:17408
 v_and_b32 v193, s89, v184
 v_lshlrev_b32 v194, 16, v185
 v_mfma_f32_16x16x32_bf16 v[116:119], v[28:31], v[44:47], v[116:119]
 ds_read_b64_tr_b16 v[64:65], v8 offset:24576
 v_and_b32 v195, s89, v185
 v_mfma_f32_16x16x32_bf16 v[112:115], v[24:27], v[44:47], v[112:115]
 ds_read_b64_tr_b16 v[66:67], v8 offset:28672
 buffer_load_dwordx4 v0, s[8:11], s62 offen offset:1024 sc1 lds
 v_lshlrev_b32 v196, 16, v186
 v_mfma_f32_16x16x32_bf16 v[128:131], v[24:27], v[48:51], v[128:131]
 ds_read_b128 v[80:83], v5 offset:16384
 v_and_b32 v197, s89, v186
 v_lshlrev_b32 v198, 16, v187
 v_mfma_f32_16x16x32_bf16 v[132:135], v[28:31], v[48:51], v[132:135]
 ds_read_b64_tr_b16 v[68:69], v9 offset:24576
 v_and_b32 v199, s89, v187
 s_add_u32 m0, s51, 8192
 s_bfe_u32 s63, s52, 0x4000c
 s_lshl_b32 s63, s63, 17
 s_add_u32 s63, s63, s58
 v_mfma_f32_16x16x32_bf16 v[136:139], v[32:35], v[48:51], v[136:139]
 ds_read_b64_tr_b16 v[70:71], v9 offset:28672
 buffer_load_dwordx4 v11, s[20:23], s63 offen lds
 v_lshlrev_b32 v200, 16, v188
 v_and_b32 v201, s89, v188
 v_mfma_f32_16x16x32_bf16 v[140:143], v[36:39], v[48:51], v[140:143]
 ds_read_b128 v[84:87], v5 offset:17408
 v_lshlrev_b32 v202, 16, v189
 v_mfma_f32_16x16x32_bf16 v[156:159], v[36:39], v[52:55], v[156:159]
 v_and_b32 v203, s89, v189
 v_mfma_f32_16x16x32_bf16 v[152:155], v[32:35], v[52:55], v[152:155]
 v_lshlrev_b32 v204, 16, v190
 v_and_b32 v205, s89, v190
 s_add_u32 m0, s51, 16384
 s_bfe_u32 s63, s52, 0x40010
 s_lshl_b32 s63, s63, 17
 s_add_u32 s63, s63, s58
 v_mfma_f32_16x16x32_bf16 v[148:151], v[28:31], v[52:55], v[148:151]
 buffer_load_dwordx4 v11, s[20:23], s63 offen lds
 v_lshlrev_b32 v206, 16, v191
 v_mfma_f32_16x16x32_bf16 v[144:147], v[24:27], v[52:55], v[144:147]
 v_and_b32 v207, s89, v191
 s_waitcnt vmcnt(8) lgkmcnt(0)
 s_barrier
 v_mfma_f32_16x16x32_bf16 v[96:99], v[56:59], v[72:75], v[96:99]
 ds_read_b128 v[40:43], v15 offset:0
 v_mfma_f32_16x16x32_bf16 v[100:103], v[60:63], v[72:75], v[100:103]
 ds_read_b64_tr_b16 v[24:25], v6 offset:32768
 v_mfma_f32_16x16x32_bf16 v[104:107], v[64:67], v[72:75], v[104:107]
 ds_read_b64_tr_b16 v[26:27], v6 offset:36864
 s_add_u32 m0, s50, 65536
 s_bfe_u32 s62, s52, 0x40010
 s_lshl_b32 s62, s62, 15
 s_add_u32 s62, s62, s57
 v_mfma_f32_16x16x32_bf16 v[108:111], v[68:71], v[72:75], v[108:111]
 ds_read_b64_tr_b16 v[28:29], v7 offset:32768
 buffer_load_dwordx4 v0, s[8:11], s62 offen offset:0 sc1 lds
 v_mfma_f32_16x16x32_bf16 v[124:127], v[68:71], v[76:79], v[124:127]
 ds_read_b64_tr_b16 v[30:31], v7 offset:36864
 v_mfma_f32_16x16x32_bf16 v[120:123], v[64:67], v[76:79], v[120:123]
 ds_read_b128 v[44:47], v15 offset:1024
 v_mfma_f32_16x16x32_bf16 v[116:119], v[60:63], v[76:79], v[116:119]
 ds_read_b64_tr_b16 v[32:33], v8 offset:32768
 buffer_load_dwordx4 v0, s[8:11], s62 offen offset:1024 sc1 lds
 v_mfma_f32_16x16x32_bf16 v[112:115], v[56:59], v[76:79], v[112:115]
 ds_read_b64_tr_b16 v[34:35], v8 offset:36864
 v_mfma_f32_16x16x32_bf16 v[128:131], v[56:59], v[80:83], v[128:131]
 ds_read_b128 v[48:51], v15 offset:8192
 s_add_u32 m0, s50, 81920
 s_bfe_u32 s62, s52, 0x40014
 s_lshl_b32 s62, s62, 15
 s_add_u32 s62, s62, s57
 v_mfma_f32_16x16x32_bf16 v[132:135], v[60:63], v[80:83], v[132:135]
 ds_read_b64_tr_b16 v[36:37], v9 offset:32768
 buffer_load_dwordx4 v0, s[8:11], s62 offen offset:0 sc1 lds
 v_mfma_f32_16x16x32_bf16 v[136:139], v[64:67], v[80:83], v[136:139]
 ds_read_b64_tr_b16 v[38:39], v9 offset:36864
 v_mfma_f32_16x16x32_bf16 v[140:143], v[68:71], v[80:83], v[140:143]
 ds_read_b128 v[52:55], v15 offset:9216
 buffer_load_dwordx4 v0, s[8:11], s62 offen offset:1024 sc1 lds
 v_mfma_f32_16x16x32_bf16 v[156:159], v[68:71], v[84:87], v[156:159]
 v_mfma_f32_16x16x32_bf16 v[152:155], v[64:67], v[84:87], v[152:155]
 s_add_u32 m0, s51, 24576
 s_bfe_u32 s63, s52, 0x40014
 s_lshl_b32 s63, s63, 17
 s_add_u32 s63, s63, s58
 v_mfma_f32_16x16x32_bf16 v[148:151], v[60:63], v[84:87], v[148:151]
 buffer_load_dwordx4 v11, s[20:23], s63 offen lds
 v_mfma_f32_16x16x32_bf16 v[144:147], v[56:59], v[84:87], v[144:147]
 s_waitcnt vmcnt(11) lgkmcnt(0)
 s_barrier
 v_mfma_f32_16x16x32_bf16 v[96:99], v[24:27], v[40:43], v[96:99]
 ds_read_b128 v[72:75], v15 offset:16384
 ds_read_b64_tr_b16 v[56:57], v6 offset:40960
 v_cvt_pk_bf16_f32 v104, v104, v105
 v_cvt_pk_bf16_f32 v105, v106, v107
 v_cvt_pk_bf16_f32 v106, v108, v109
 v_cvt_pk_bf16_f32 v107, v110, v111
 s_xor_b32 s85, s4, 1
 s_mul_i32 s85, s85, 49152
 s_add_u32 s85, s85, s60
 v_mfma_f32_16x16x32_bf16 v[100:103], v[28:31], v[40:43], v[100:103]
 ds_read_b64_tr_b16 v[58:59], v6 offset:45056
 ds_read_b64_tr_b16 v[60:61], v7 offset:40960
 buffer_store_dwordx4 v[104:107], v13, s[8:11], s85 offen offset:0 sc1
 v_cvt_pk_bf16_f32 v120, v120, v121
 v_cvt_pk_bf16_f32 v121, v122, v123
 v_cvt_pk_bf16_f32 v122, v124, v125
 v_cvt_pk_bf16_f32 v123, v126, v127
 s_xor_b32 s85, s4, 1
 v_mfma_f32_16x16x32_bf16 v[116:119], v[28:31], v[44:47], v[116:119]
 ds_read_b64_tr_b16 v[62:63], v7 offset:45056
 ds_read_b128 v[76:79], v15 offset:17408
 s_mul_i32 s85, s85, 49152
 s_add_u32 s85, s85, s60
 buffer_store_dwordx4 v[120:123], v13, s[8:11], s85 offen offset:1024 sc1
 v_cvt_pk_bf16_f32 v128, v128, v129
 v_cvt_pk_bf16_f32 v129, v130, v131
 v_cvt_pk_bf16_f32 v130, v132, v133
 v_cvt_pk_bf16_f32 v131, v134, v135
 v_mfma_f32_16x16x32_bf16 v[112:115], v[24:27], v[44:47], v[112:115]
 ds_read_b64_tr_b16 v[64:65], v8 offset:40960
 ds_read_b64_tr_b16 v[66:67], v8 offset:45056
 s_xor_b32 s85, s4, 2
 s_mul_i32 s85, s85, 49152
 s_add_u32 s85, s85, s60
 s_add_u32 s85, s85, 16384
 buffer_store_dwordx4 v[128:131], v13, s[8:11], s85 offen offset:0 sc1
 v_cvt_pk_bf16_f32 v144, v144, v145
 v_mfma_f32_16x16x32_bf16 v[96:99], v[32:35], v[48:51], v[96:99]
 ds_read_b128 v[80:83], v15 offset:24576
 ds_read_b64_tr_b16 v[68:69], v9 offset:40960
 v_cvt_pk_bf16_f32 v145, v146, v147
 v_cvt_pk_bf16_f32 v146, v148, v149
 v_cvt_pk_bf16_f32 v147, v150, v151
 s_xor_b32 s85, s4, 2
 s_mul_i32 s85, s85, 49152
 s_add_u32 s85, s85, s60
 s_add_u32 s85, s85, 16384
 v_mfma_f32_16x16x32_bf16 v[100:103], v[36:39], v[48:51], v[100:103]
 ds_read_b64_tr_b16 v[70:71], v9 offset:45056
 ds_read_b128 v[84:87], v15 offset:25600
 buffer_store_dwordx4 v[144:147], v13, s[8:11], s85 offen offset:1024 sc1
 v_cvt_pk_bf16_f32 v136, v136, v137
 v_cvt_pk_bf16_f32 v137, v138, v139
 v_cvt_pk_bf16_f32 v138, v140, v141
 v_cvt_pk_bf16_f32 v139, v142, v143
 s_xor_b32 s85, s4, 3
 v_mfma_f32_16x16x32_bf16 v[116:119], v[36:39], v[52:55], v[116:119]
 s_mul_i32 s85, s85, 49152
 s_add_u32 s85, s85, s60
 s_add_u32 s85, s85, 32768
 buffer_store_dwordx4 v[136:139], v13, s[8:11], s85 offen offset:0 sc1
 v_cvt_pk_bf16_f32 v152, v152, v153
 v_cvt_pk_bf16_f32 v153, v154, v155
 v_cvt_pk_bf16_f32 v154, v156, v157
 v_mfma_f32_16x16x32_bf16 v[112:115], v[32:35], v[52:55], v[112:115]
 v_cvt_pk_bf16_f32 v155, v158, v159
 s_xor_b32 s85, s4, 3
 s_mul_i32 s85, s85, 49152
 s_add_u32 s85, s85, s60
 s_add_u32 s85, s85, 32768
 buffer_store_dwordx4 v[152:155], v13, s[8:11], s85 offen offset:1024 sc1
 s_waitcnt vmcnt(6) lgkmcnt(0)
 s_barrier
 v_mfma_f32_16x16x32_bf16 v[96:99], v[56:59], v[72:75], v[96:99]
 ds_read_b128 v[40:43], v15 offset:32768
 ds_read_b64_tr_b16 v[24:25], v6 offset:0
 v_mfma_f32_16x16x32_bf16 v[100:103], v[60:63], v[72:75], v[100:103]
 ds_read_b64_tr_b16 v[26:27], v6 offset:4096
 ds_read_b64_tr_b16 v[28:29], v7 offset:0
 v_mfma_f32_16x16x32_bf16 v[116:119], v[60:63], v[76:79], v[116:119]
 ds_read_b64_tr_b16 v[30:31], v7 offset:4096
 ds_read_b128 v[44:47], v15 offset:33792
 v_mfma_f32_16x16x32_bf16 v[112:115], v[56:59], v[76:79], v[112:115]
 ds_read_b64_tr_b16 v[32:33], v8 offset:0
 ds_read_b64_tr_b16 v[34:35], v8 offset:4096
 v_mfma_f32_16x16x32_bf16 v[96:99], v[64:67], v[80:83], v[96:99]
 ds_read_b128 v[48:51], v15 offset:40960
 ds_read_b64_tr_b16 v[36:37], v9 offset:0
 v_mfma_f32_16x16x32_bf16 v[100:103], v[68:71], v[80:83], v[100:103]
 ds_read_b64_tr_b16 v[38:39], v9 offset:4096
 ds_read_b128 v[52:55], v15 offset:41984
 v_mfma_f32_16x16x32_bf16 v[116:119], v[68:71], v[84:87], v[116:119]
 v_mfma_f32_16x16x32_bf16 v[112:115], v[64:67], v[84:87], v[112:115]
 s_waitcnt lgkmcnt(0)
 v_mfma_f32_16x16x32_bf16 v[96:99], v[24:27], v[40:43], v[96:99]
 ds_read_b128 v[72:75], v15 offset:49152
 ds_read_b64_tr_b16 v[56:57], v6 offset:8192
 s_xor_b32 s92, s71, 1024
 v_mov_b32 v91, 1
 v_mfma_f32_16x16x32_bf16 v[100:103], v[28:31], v[40:43], v[100:103]
 ds_read_b64_tr_b16 v[58:59], v6 offset:12288
 ds_read_b64_tr_b16 v[60:61], v7 offset:8192
 s_waitcnt vmcnt(4)
 v_mfma_f32_16x16x32_bf16 v[116:119], v[28:31], v[44:47], v[116:119]
 ds_read_b64_tr_b16 v[62:63], v7 offset:12288
 ds_read_b128 v[76:79], v15 offset:50176
 buffer_store_byte v91, off, s[8:11], s92 sc1
 s_xor_b32 s92, s71, 2048
 v_mfma_f32_16x16x32_bf16 v[112:115], v[24:27], v[44:47], v[112:115]
 ds_read_b64_tr_b16 v[64:65], v8 offset:8192
 ds_read_b64_tr_b16 v[66:67], v8 offset:12288
 v_mov_b32 v91, 1
 v_mfma_f32_16x16x32_bf16 v[96:99], v[32:35], v[48:51], v[96:99]
 ds_read_b128 v[80:83], v15 offset:57344
 ds_read_b64_tr_b16 v[68:69], v9 offset:8192
 s_waitcnt vmcnt(3)
 buffer_store_byte v91, off, s[8:11], s92 offset:1 sc1
 v_mfma_f32_16x16x32_bf16 v[100:103], v[36:39], v[48:51], v[100:103]
 ds_read_b64_tr_b16 v[70:71], v9 offset:12288
 ds_read_b128 v[84:87], v15 offset:58368
 s_xor_b32 s92, s71, 3072
 v_mfma_f32_16x16x32_bf16 v[116:119], v[36:39], v[52:55], v[116:119]
 v_mov_b32 v91, 1
 s_waitcnt vmcnt(2)
 v_mfma_f32_16x16x32_bf16 v[112:115], v[32:35], v[52:55], v[112:115]
 buffer_store_byte v91, off, s[8:11], s92 offset:2 sc1
 s_waitcnt lgkmcnt(0)
 v_mfma_f32_16x16x32_bf16 v[96:99], v[56:59], v[72:75], v[96:99]
 ds_read_b128 v[40:43], v17 offset:0
 ds_read_b64_tr_b16 v[24:25], v6 offset:16384
 v_mfma_f32_16x16x32_bf16 v[100:103], v[60:63], v[72:75], v[100:103]
 ds_read_b64_tr_b16 v[26:27], v6 offset:20480
 ds_read_b64_tr_b16 v[28:29], v7 offset:16384
 v_mfma_f32_16x16x32_bf16 v[116:119], v[60:63], v[76:79], v[116:119]
 ds_read_b64_tr_b16 v[30:31], v7 offset:20480
 ds_read_b128 v[44:47], v17 offset:1024
 v_mfma_f32_16x16x32_bf16 v[112:115], v[56:59], v[76:79], v[112:115]
 ds_read_b64_tr_b16 v[32:33], v8 offset:16384
 ds_read_b64_tr_b16 v[34:35], v8 offset:20480
 v_mfma_f32_16x16x32_bf16 v[96:99], v[64:67], v[80:83], v[96:99]
 ds_read_b128 v[48:51], v17 offset:8192
 ds_read_b64_tr_b16 v[36:37], v9 offset:16384
 v_mfma_f32_16x16x32_bf16 v[100:103], v[68:71], v[80:83], v[100:103]
 ds_read_b64_tr_b16 v[38:39], v9 offset:20480
 ds_read_b128 v[52:55], v17 offset:9216
 v_mfma_f32_16x16x32_bf16 v[116:119], v[68:71], v[84:87], v[116:119]
 v_mfma_f32_16x16x32_bf16 v[112:115], v[64:67], v[84:87], v[112:115]
 s_waitcnt lgkmcnt(0)
 v_mfma_f32_16x16x32_bf16 v[96:99], v[24:27], v[40:43], v[96:99]
 ds_read_b128 v[72:75], v17 offset:16384
 ds_read_b64_tr_b16 v[56:57], v6 offset:24576
 v_mfma_f32_16x16x32_bf16 v[100:103], v[28:31], v[40:43], v[100:103]
 ds_read_b64_tr_b16 v[58:59], v6 offset:28672
 ds_read_b64_tr_b16 v[60:61], v7 offset:24576
 v_mfma_f32_16x16x32_bf16 v[116:119], v[28:31], v[44:47], v[116:119]
 ds_read_b64_tr_b16 v[62:63], v7 offset:28672
 ds_read_b128 v[76:79], v17 offset:17408
 v_mfma_f32_16x16x32_bf16 v[112:115], v[24:27], v[44:47], v[112:115]
 ds_read_b64_tr_b16 v[64:65], v8 offset:24576
 ds_read_b64_tr_b16 v[66:67], v8 offset:28672
 v_mfma_f32_16x16x32_bf16 v[96:99], v[32:35], v[48:51], v[96:99]
 ds_read_b128 v[80:83], v17 offset:24576
 ds_read_b64_tr_b16 v[68:69], v9 offset:24576
 v_mfma_f32_16x16x32_bf16 v[100:103], v[36:39], v[48:51], v[100:103]
 ds_read_b64_tr_b16 v[70:71], v9 offset:28672
 ds_read_b128 v[84:87], v17 offset:25600
 v_mfma_f32_16x16x32_bf16 v[116:119], v[36:39], v[52:55], v[116:119]
 v_mfma_f32_16x16x32_bf16 v[112:115], v[32:35], v[52:55], v[112:115]
 s_waitcnt lgkmcnt(0)
 v_mfma_f32_16x16x32_bf16 v[96:99], v[56:59], v[72:75], v[96:99]
 s_buffer_load_dword s72, s[8:11], s71 glc
 v_mfma_f32_16x16x32_bf16 v[100:103], v[60:63], v[72:75], v[100:103]
 v_mfma_f32_16x16x32_bf16 v[116:119], v[60:63], v[76:79], v[116:119]
 v_mfma_f32_16x16x32_bf16 v[112:115], v[56:59], v[76:79], v[112:115]
 v_mfma_f32_16x16x32_bf16 v[96:99], v[64:67], v[80:83], v[96:99]
 v_mfma_f32_16x16x32_bf16 v[100:103], v[68:71], v[80:83], v[100:103]
 v_mfma_f32_16x16x32_bf16 v[116:119], v[68:71], v[84:87], v[116:119]
 v_mfma_f32_16x16x32_bf16 v[112:115], v[64:67], v[84:87], v[112:115]
 s_waitcnt lgkmcnt(0)
 s_cmp_eq_u32 s72, 0x10101
 s_cbranch_scc0 Lsp_102
Lok_103:
 s_mul_i32 s85, s4, 49152
 s_add_u32 s85, s85, s60
 buffer_load_dwordx4 v[160:163], v13, s[8:11], s85 offen offset:0 sc1
 buffer_load_dwordx4 v[164:167], v13, s[8:11], s85 offen offset:1024 sc1
 s_mul_i32 s85, s4, 49152
 s_add_u32 s85, s85, s60
 s_add_u32 s85, s85, 16384
 buffer_load_dwordx4 v[168:171], v13, s[8:11], s85 offen offset:0 sc1
 buffer_load_dwordx4 v[172:175], v13, s[8:11], s85 offen offset:1024 sc1
 s_mul_i32 s85, s4, 49152
 s_add_u32 s85, s85, s60
 s_add_u32 s85, s85, 32768
 buffer_load_dwordx4 v[176:179], v13, s[8:11], s85 offen offset:0 sc1
 buffer_load_dwordx4 v[180:183], v13, s[8:11], s85 offen offset:1024 sc1
 s_waitcnt vmcnt(4)
 v_lshlrev_b32 v208, 16, v160
 v_and_b32 v209, s89, v160
 v_add_f32 v192, v192, v208
 v_add_f32 v193, v193, v209
 v_lshlrev_b32 v210, 16, v161
 v_and_b32 v211, s89, v161
 v_add_f32 v194, v194, v210
 v_add_f32 v195, v195, v211
 v_lshlrev_b32 v208, 16, v162
 v_and_b32 v209, s89, v162
 v_add_f32 v196, v196, v208
 v_add_f32 v197, v197, v209
 v_lshlrev_b32 v210, 16, v163
 v_and_b32 v211, s89, v163
 v_add_f32 v198, v198, v210
 v_add_f32 v199, v199, v211
 v_lshlrev_b32 v208, 16, v164
 v_and_b32 v209, s89, v164
 v_add_f32 v200, v200, v208
 v_add_f32 v201, v201, v209
 v_lshlrev_b32 v210, 16, v165
 v_and_b32 v211, s89, v165
 v_add_f32 v202, v202, v210
 v_add_f32 v203, v203, v211
 v_lshlrev_b32 v208, 16, v166
 v_and_b32 v209, s89, v166
 v_add_f32 v204, v204, v208
 v_add_f32 v205, v205, v209
 v_lshlrev_b32 v210, 16, v167
 v_and_b32 v211, s89, v167
 v_add_f32 v206, v206, v210
 v_add_f32 v207, v207, v211
 s_waitcnt vmcnt(2)
 v_lshlrev_b32 v208, 16, v168
 v_and_b32 v209, s89, v168
 v_add_f32 v192, v192, v208
 v_add_f32 v193, v193, v209
 v_lshlrev_b32 v210, 16, v169
 v_and_b32 v211, s89, v169
 v_add_f32 v194, v194, v210
 v_add_f32 v195, v195, v211
 v_lshlrev_b32 v208, 16, v170
 v_and_b32 v209, s89, v170
 v_add_f32 v196, v196, v208
 v_add_f32 v197, v197, v209
 v_lshlrev_b32 v210, 16, v171
 v_and_b32 v211, s89, v171
 v_add_f32 v198, v198, v210
 v_add_f32 v199, v199, v211
 v_lshlrev_b32 v208, 16, v172
 v_and_b32 v209, s89, v172
 v_add_f32 v200, v200, v208
 v_add_f32 v201, v201, v209
 v_lshlrev_b32 v210, 16, v173
 v_and_b32 v211, s89, v173
 v_add_f32 v202, v202, v210
 v_add_f32 v203, v203, v211
 v_lshlrev_b32 v208, 16, v174
 v_and_b32 v209, s89, v174
 v_add_f32 v204, v204, v208
 v_add_f32 v205, v205, v209
 v_lshlrev_b32 v210, 16, v175
 v_and_b32 v211, s89, v175
 v_add_f32 v206, v206, v210
 v_add_f32 v207, v207, v211
 s_waitcnt vmcnt(0)
 v_lshlrev_b32 v208, 16, v176
 v_and_b32 v209, s89, v176
 v_add_f32 v192, v192, v208
 v_add_f32 v193, v193, v209
 v_lshlrev_b32 v210, 16, v177
 v_and_b32 v211, s89, v177
 v_add_f32 v194, v194, v210
 v_add_f32 v195, v195, v211
 v_lshlrev_b32 v208, 16, v178
 v_and_b32 v209, s89, v178
 v_add_f32 v196, v196, v208
 v_add_f32 v197, v197, v209
 v_lshlrev_b32 v210, 16, v179
 v_and_b32 v211, s89, v179
 v_add_f32 v198, v198, v210
 v_add_f32 v199, v199, v211
 v_lshlrev_b32 v208, 16, v180
 v_and_b32 v209, s89, v180
 v_add_f32 v200, v200, v208
 v_add_f32 v201, v201, v209
 v_lshlrev_b32 v210, 16, v181
 v_and_b32 v211, s89, v181
 v_add_f32 v202, v202, v210
 v_add_f32 v203, v203, v211
 v_lshlrev_b32 v208, 16, v182
 v_and_b32 v209, s89, v182
 v_add_f32 v204, v204, v208
 v_add_f32 v205, v205, v209
 v_lshlrev_b32 v210, 16, v183
 v_and_b32 v211, s89, v183
 v_add_f32 v206, v206, v210
 v_add_f32 v207, v207, v211
 v_add_f32 v96, v96, v192
 v_add_f32 v97, v97, v193
 v_add_f32 v98, v98, v194
 v_add_f32 v99, v99, v195
 v_add_f32 v100, v100, v196
 v_add_f32 v101, v101, v197
 v_add_f32 v102, v102, v198
 v_add_f32 v103, v103, v199
 v_cvt_pk_bf16_f32 v96, v96, v97
 v_cvt_pk_bf16_f32 v97, v98, v99
 v_cvt_pk_bf16_f32 v98, v100, v101
 v_cvt_pk_bf16_f32 v99, v102, v103
 s_nop 0
 v_permlane16_swap_b32 v96, v98
 v_permlane16_swap_b32 v97, v99
 buffer_store_dwordx4 v[96:99], v94, s[28:31], s61 offen
 v_add_f32 v112, v112, v200
 v_add_f32 v113, v113, v201
 v_add_f32 v114, v114, v202
 v_add_f32 v115, v115, v203
 v_add_f32 v116, v116, v204
 v_add_f32 v117, v117, v205
 v_add_f32 v118, v118, v206
 v_add_f32 v119, v119, v207
 v_cvt_pk_bf16_f32 v112, v112, v113
 v_cvt_pk_bf16_f32 v113, v114, v115
 v_cvt_pk_bf16_f32 v114, v116, v117
 v_cvt_pk_bf16_f32 v115, v118, v119
 s_nop 0
 v_permlane16_swap_b32 v112, v114
 v_permlane16_swap_b32 v113, v115
 buffer_store_dwordx4 v[112:115], v94, s[28:31], s66 offen
 s_endpgm
Lsp_99:
 s_mov_b32 s95, 0
Llp_101:
 s_buffer_load_dwordx2 s[72:73], s[8:11], s64 glc
 s_waitcnt lgkmcnt(0)
 s_add_u32 s95, s95, 1
 s_and_b32 s72, s72, s73
 s_cmp_eq_u32 s72, 0x1010101
 s_cbranch_scc1 Lok_100
 s_cmp_lt_u32 s95, 0x40000
 s_cbranch_scc1 Llp_101
 s_branch Lok_100
Lsp_102:
 s_mov_b32 s95, 0
Llp_104:
 s_buffer_load_dword s72, s[8:11], s71 glc
 s_waitcnt lgkmcnt(0)
 s_add_u32 s95, s95, 1
 s_cmp_eq_u32 s72, 0x10101
 s_cbranch_scc1 Lok_103
 s_cmp_lt_u32 s95, 0x40000
 s_cbranch_scc1 Llp_104
 s_branch Lok_103
L5_v1:
L5_v11:
 s_lshl_b32 s52, s52, 4
 s_lshr_b32 s84, 0x33333333, s84
 s_and_b32 s84, s84, 0xf
 s_or_b32 s52, s52, s84
 s_xor_b32 s52, s52, s96
 s_waitcnt vmcnt(17) lgkmcnt(0)
 s_barrier
 v_mfma_f32_16x16x32_bf16 v[96:99], v[24:27], v[40:43], v[96:99]
 ds_read_b128 v[72:75], v2 offset:16384
 v_mfma_f32_16x16x32_bf16 v[100:103], v[28:31], v[40:43], v[100:103]
 ds_read_b64_tr_b16 v[56:57], v6 offset:40960
 v_mfma_f32_16x16x32_bf16 v[104:107], v[32:35], v[40:43], v[104:107]
 ds_read_b64_tr_b16 v[58:59], v6 offset:45056
 v_mfma_f32_16x16x32_bf16 v[108:111], v[36:39], v[40:43], v[108:111]
 ds_read_b64_tr_b16 v[60:61], v7 offset:40960
 v_mfma_f32_16x16x32_bf16 v[124:127], v[36:39], v[44:47], v[124:127]
 ds_read_b64_tr_b16 v[62:63], v7 offset:45056
 v_mfma_f32_16x16x32_bf16 v[120:123], v[32:35], v[44:47], v[120:123]
 ds_read_b128 v[76:79], v2 offset:17408
 v_mfma_f32_16x16x32_bf16 v[116:119], v[28:31], v[44:47], v[116:119]
 ds_read_b64_tr_b16 v[64:65], v8 offset:40960
 v_mfma_f32_16x16x32_bf16 v[112:115], v[24:27], v[44:47], v[112:115]
 ds_read_b64_tr_b16 v[66:67], v8 offset:45056
 v_mfma_f32_16x16x32_bf16 v[128:131], v[24:27], v[48:51], v[128:131]
 ds_read_b128 v[80:83], v3 offset:16384
 s_add_u32 m0, s51, 32768
 s_lshl_b32 s63, s6, 2
 s_lshr_b32 s63, 0x3210, s63
 s_and_b32 s63, s63, 7
 s_mul_i32 s63, s63, 65536
 s_add_u32 s63, s63, s65
 v_mfma_f32_16x16x32_bf16 v[132:135], v[28:31], v[48:51], v[132:135]
 ds_read_b64_tr_b16 v[68:69], v9 offset:40960
 buffer_load_dwordx4 v10, s[20:23], s63 offen lds
 v_mfma_f32_16x16x32_bf16 v[136:139], v[32:35], v[48:51], v[136:139]
 ds_read_b64_tr_b16 v[70:71], v9 offset:45056
 v_mfma_f32_16x16x32_bf16 v[140:143], v[36:39], v[48:51], v[140:143]
 ds_read_b128 v[84:87], v3 offset:17408
 v_mfma_f32_16x16x32_bf16 v[156:159], v[36:39], v[52:55], v[156:159]
 v_mfma_f32_16x16x32_bf16 v[152:155], v[32:35], v[52:55], v[152:155]
 v_mfma_f32_16x16x32_bf16 v[148:151], v[28:31], v[52:55], v[148:151]
 v_mfma_f32_16x16x32_bf16 v[144:147], v[24:27], v[52:55], v[144:147]
 s_waitcnt vmcnt(14) lgkmcnt(0)
 s_barrier
 v_mfma_f32_16x16x32_bf16 v[96:99], v[56:59], v[72:75], v[96:99]
 ds_read_b128 v[40:43], v2 offset:32768
 v_and_b32 v94, 15, v1
 v_mfma_f32_16x16x32_bf16 v[100:103], v[60:63], v[72:75], v[100:103]
 ds_read_b64_tr_b16 v[24:25], v6 offset:0
 v_mfma_f32_16x16x32_bf16 v[104:107], v[64:67], v[72:75], v[104:107]
 ds_read_b64_tr_b16 v[26:27], v6 offset:4096
 v_lshlrev_b32 v94, 11, v94
 v_mfma_f32_16x16x32_bf16 v[108:111], v[68:71], v[72:75], v[108:111]
 ds_read_b64_tr_b16 v[28:29], v7 offset:0
 v_mfma_f32_16x16x32_bf16 v[124:127], v[68:71], v[76:79], v[124:127]
 ds_read_b64_tr_b16 v[30:31], v7 offset:4096
 v_bfe_u32 v92, v1, 4, 1
 v_mfma_f32_16x16x32_bf16 v[120:123], v[64:67], v[76:79], v[120:123]
 ds_read_b128 v[44:47], v2 offset:33792
 v_mfma_f32_16x16x32_bf16 v[116:119], v[60:63], v[76:79], v[116:119]
 ds_read_b64_tr_b16 v[32:33], v8 offset:0
 v_lshl_add_u32 v94, v92, 5, v94
 v_mfma_f32_16x16x32_bf16 v[112:115], v[56:59], v[76:79], v[112:115]
 ds_read_b64_tr_b16 v[34:35], v8 offset:4096
 v_mfma_f32_16x16x32_bf16 v[128:131], v[56:59], v[80:83], v[128:131]
 ds_read_b128 v[48:51], v3 offset:32768
 v_lshrrev_b32 v92, 5, v1
 s_add_u32 m0, s51, 40960
 s_lshl_b32 s63, s6, 2
 s_lshr_b32 s63, 0x4321, s63
 s_and_b32 s63, s63, 7
 s_mul_i32 s63, s63, 65536
 s_add_u32 s63, s63, s65
 v_mfma_f32_16x16x32_bf16 v[132:135], v[60:63], v[80:83], v[132:135]
 ds_read_b64_tr_b16 v[36:37], v9 offset:0
 buffer_load_dwordx4 v10, s[20:23], s63 offen lds
 v_mfma_f32_16x16x32_bf16 v[136:139], v[64:67], v[80:83], v[136:139]
 ds_read_b64_tr_b16 v[38:39], v9 offset:4096
 v_lshl_add_u32 v94, v92, 4, v94
 v_mfma_f32_16x16x32_bf16 v[140:143], v[68:71], v[80:83], v[140:143]
 ds_read_b128 v[52:55], v3 offset:33792
 v_mfma_f32_16x16x32_bf16 v[156:159], v[68:71], v[84:87], v[156:159]
 buffer_load_dwordx4 v[184:187], v94, s[16:19], s61 offen
 v_mfma_f32_16x16x32_bf16 v[152:155], v[64:67], v[84:87], v[152:155]
 v_mfma_f32_16x16x32_bf16 v[148:151], v[60:63], v[84:87], v[148:151]
 buffer_load_dwordx4 v[188:191], v94, s[16:19], s66 offen
 v_mfma_f32_16x16x32_bf16 v[144:147], v[56:59], v[84:87], v[144:147]
 s_waitcnt vmcnt(11) lgkmcnt(0)
 s_barrier
 v_mfma_f32_16x16x32_bf16 v[96:99], v[24:27], v[40:43], v[96:99]
 ds_read_b128 v[72:75], v2 offset:49152
 v_mfma_f32_16x16x32_bf16 v[100:103], v[28:31], v[40:43], v[100:103]
 ds_read_b64_tr_b16 v[56:57], v6 offset:8192
 v_mfma_f32_16x16x32_bf16 v[104:107], v[32:35], v[40:43], v[104:107]
 ds_read_b64_tr_b16 v[58:59], v6 offset:12288
 v_mfma_f32_16x16x32_bf16 v[108:111], v[36:39], v[40:43], v[108:111]
 ds_read_b64_tr_b16 v[60:61], v7 offset:8192
 v_mfma_f32_16x16x32_bf16 v[124:127], v[36:39], v[44:47], v[124:127]
 ds_read_b64_tr_b16 v[62:63], v7 offset:12288
 v_mfma_f32_16x16x32_bf16 v[120:123], v[32:35], v[44:47], v[120:123]
 ds_read_b128 v[76:79], v2 offset:50176
 v_mfma_f32_16x16x32_bf16 v[116:119], v[28:31], v[44:47], v[116:119]
 ds_read_b64_tr_b16 v[64:65], v8 offset:8192
 v_mfma_f32_16x16x32_bf16 v[112:115], v[24:27], v[44:47], v[112:115]
 ds_read_b64_tr_b16 v[66:67], v8 offset:12288
 v_mfma_f32_16x16x32_bf16 v[128:131], v[24:27], v[48:51], v[128:131]
 ds_read_b128 v[80:83], v3 offset:49152
 s_add_u32 m0, s51, 0
 s_lshl_b32 s63, s6, 2
 s_lshr_b32 s63, 0x5432, s63
 s_and_b32 s63, s63, 7
 s_mul_i32 s63, s63, 65536
 s_add_u32 s63, s63, s65
 v_mfma_f32_16x16x32_bf16 v[132:135], v[28:31], v[48:51], v[132:135]
 ds_read_b64_tr_b16 v[68:69], v9 offset:8192
 buffer_load_dwordx4 v10, s[20:23], s63 offen lds
 v_mfma_f32_16x16x32_bf16 v[136:139], v[32:35], v[48:51], v[136:139]
 ds_read_b64_tr_b16 v[70:71], v9 offset:12288
 v_mfma_f32_16x16x32_bf16 v[140:143], v[36:39], v[48:51], v[140:143]
 ds_read_b128 v[84:87], v3 offset:50176
 v_mfma_f32_16x16x32_bf16 v[156:159], v[36:39], v[52:55], v[156:159]
 v_mfma_f32_16x16x32_bf16 v[152:155], v[32:35], v[52:55], v[152:155]
 v_mfma_f32_16x16x32_bf16 v[148:151], v[28:31], v[52:55], v[148:151]
 v_mfma_f32_16x16x32_bf16 v[144:147], v[24:27], v[52:55], v[144:147]
 s_waitcnt vmcnt(9) lgkmcnt(0)
 s_barrier
 v_mfma_f32_16x16x32_bf16 v[96:99], v[56:59], v[72:75], v[96:99]
 ds_read_b128 v[40:43], v4 offset:0
 v_mfma_f32_16x16x32_bf16 v[100:103], v[60:63], v[72:75], v[100:103]
 ds_read_b64_tr_b16 v[24:25], v6 offset:16384
 v_mfma_f32_16x16x32_bf16 v[104:107], v[64:67], v[72:75], v[104:107]
 ds_read_b64_tr_b16 v[26:27], v6 offset:20480
 s_add_u32 m0, s50, 0
 s_lshl_b32 s62, s6, 2
 s_lshr_b32 s62, 0x3210, s62
 s_and_b32 s62, s62, 7
 s_mul_i32 s62, s62, 16384
 s_add_u32 s62, s62, s54
 v_mfma_f32_16x16x32_bf16 v[108:111], v[68:71], v[72:75], v[108:111]
 ds_read_b64_tr_b16 v[28:29], v7 offset:16384
 buffer_load_dwordx4 v13, s[8:11], s62 offen offset:0 sc1 lds
 v_mfma_f32_16x16x32_bf16 v[124:127], v[68:71], v[76:79], v[124:127]
 ds_read_b64_tr_b16 v[30:31], v7 offset:20480
 v_mfma_f32_16x16x32_bf16 v[120:123], v[64:67], v[76:79], v[120:123]
 ds_read_b128 v[44:47], v4 offset:1024
 buffer_load_dwordx4 v13, s[8:11], s62 offen offset:1024 sc1 lds
 v_mfma_f32_16x16x32_bf16 v[116:119], v[60:63], v[76:79], v[116:119]
 ds_read_b64_tr_b16 v[32:33], v8 offset:16384
 s_add_u32 m0, s50, 16384
 s_lshl_b32 s62, s6, 2
 s_lshr_b32 s62, 0x4321, s62
 s_and_b32 s62, s62, 7
 s_mul_i32 s62, s62, 16384
 s_add_u32 s62, s62, s54
 v_mfma_f32_16x16x32_bf16 v[112:115], v[56:59], v[76:79], v[112:115]
 ds_read_b64_tr_b16 v[34:35], v8 offset:20480
 buffer_load_dwordx4 v13, s[8:11], s62 offen offset:0 sc1 lds
 v_mfma_f32_16x16x32_bf16 v[128:131], v[56:59], v[80:83], v[128:131]
 ds_read_b128 v[48:51], v5 offset:0
 v_mfma_f32_16x16x32_bf16 v[132:135], v[60:63], v[80:83], v[132:135]
 ds_read_b64_tr_b16 v[36:37], v9 offset:16384
 v_mfma_f32_16x16x32_bf16 v[136:139], v[64:67], v[80:83], v[136:139]
 ds_read_b64_tr_b16 v[38:39], v9 offset:20480
 buffer_load_dwordx4 v13, s[8:11], s62 offen offset:1024 sc1 lds
 v_mfma_f32_16x16x32_bf16 v[140:143], v[68:71], v[80:83], v[140:143]
 ds_read_b128 v[52:55], v5 offset:1024
 s_add_u32 m0, s50, 32768
 s_lshl_b32 s62, s6, 2
 s_lshr_b32 s62, 0x5432, s62
 s_and_b32 s62, s62, 7
 s_mul_i32 s62, s62, 16384
 s_add_u32 s62, s62, s54
 v_mfma_f32_16x16x32_bf16 v[156:159], v[68:71], v[84:87], v[156:159]
 buffer_load_dwordx4 v13, s[8:11], s62 offen offset:0 sc1 lds
 v_mfma_f32_16x16x32_bf16 v[152:155], v[64:67], v[84:87], v[152:155]
 v_mfma_f32_16x16x32_bf16 v[148:151], v[60:63], v[84:87], v[148:151]
 buffer_load_dwordx4 v13, s[8:11], s62 offen offset:1024 sc1 lds
 v_mfma_f32_16x16x32_bf16 v[144:147], v[56:59], v[84:87], v[144:147]
 s_waitcnt vmcnt(11) lgkmcnt(0)
 s_barrier
 v_mfma_f32_16x16x32_bf16 v[96:99], v[24:27], v[40:43], v[96:99]
 ds_read_b128 v[72:75], v4 offset:16384
 s_mov_b32 s89, 0xffff0000
 s_waitcnt vmcnt(7)
 v_mfma_f32_16x16x32_bf16 v[100:103], v[28:31], v[40:43], v[100:103]
 ds_read_b64_tr_b16 v[56:57], v6 offset:24576
 v_permlane16_swap_b32 v184, v186
 v_mfma_f32_16x16x32_bf16 v[104:107], v[32:35], v[40:43], v[104:107]
 ds_read_b64_tr_b16 v[58:59], v6 offset:28672
 v_permlane16_swap_b32 v185, v187
 v_permlane16_swap_b32 v188, v190
 s_add_u32 m0, s50, 49152
 s_lshl_b32 s62, s6, 2
 s_lshr_b32 s62, 0x543, s62
 s_and_b32 s62, s62, 7
 s_mul_i32 s62, s62, 16384
 s_add_u32 s62, s62, s54
 v_mfma_f32_16x16x32_bf16 v[108:111], v[36:39], v[40:43], v[108:111]
 ds_read_b64_tr_b16 v[60:61], v7 offset:24576
 buffer_load_dwordx4 v13, s[8:11], s62 offen offset:0 sc1 lds
 v_permlane16_swap_b32 v189, v191
 v_mfma_f32_16x16x32_bf16 v[124:127], v[36:39], v[44:47], v[124:127]
 ds_read_b64_tr_b16 v[62:63], v7 offset:28672
 v_lshlrev_b32 v192, 16, v184
 v_mfma_f32_16x16x32_bf16 v[120:123], v[32:35], v[44:47], v[120:123]
 ds_read_b128 v[76:79], v4 offset:17408
 buffer_load_dwordx4 v13, s[8:11], s62 offen offset:1024 sc1 lds
 v_and_b32 v193, s89, v184
 v_lshlrev_b32 v194, 16, v185
 v_mfma_f32_16x16x32_bf16 v[116:119], v[28:31], v[44:47], v[116:119]
 ds_read_b64_tr_b16 v[64:65], v8 offset:24576
 v_and_b32 v195, s89, v185
 s_add_u32 m0, s51, 8192
 s_lshl_b32 s63, s6, 2
 s_lshr_b32 s63, 0x543, s63
 s_and_b32 s63, s63, 7
 s_mul_i32 s63, s63, 65536
 s_add_u32 s63, s63, s65
 v_mfma_f32_16x16x32_bf16 v[112:115], v[24:27], v[44:47], v[112:115]
 ds_read_b64_tr_b16 v[66:67], v8 offset:28672
 buffer_load_dwordx4 v10, s[20:23], s63 offen lds
 v_lshlrev_b32 v196, 16, v186
 v_mfma_f32_16x16x32_bf16 v[128:131], v[24:27], v[48:51], v[128:131]
 ds_read_b128 v[80:83], v5 offset:16384
 v_and_b32 v197, s89, v186
 v_lshlrev_b32 v198, 16, v187
 v_mfma_f32_16x16x32_bf16 v[132:135], v[28:31], v[48:51], v[132:135]
 ds_read_b64_tr_b16 v[68:69], v9 offset:24576
 v_and_b32 v199, s89, v187
 s_add_u32 m0, s50, 65536
 s_lshl_b32 s62, s6, 2
 s_lshr_b32 s62, 0x1054, s62
 s_and_b32 s62, s62, 7
 s_mul_i32 s62, s62, 16384
 s_add_u32 s62, s62, s54
 v_mfma_f32_16x16x32_bf16 v[136:139], v[32:35], v[48:51], v[136:139]
 ds_read_b64_tr_b16 v[70:71], v9 offset:28672
 buffer_load_dwordx4 v13, s[8:11], s62 offen offset:0 sc1 lds
 v_lshlrev_b32 v200, 16, v188
 v_and_b32 v201, s89, v188
 v_mfma_f32_16x16x32_bf16 v[140:143], v[36:39], v[48:51], v[140:143]
 ds_read_b128 v[84:87], v5 offset:17408
 v_lshlrev_b32 v202, 16, v189
 v_mfma_f32_16x16x32_bf16 v[156:159], v[36:39], v[52:55], v[156:159]
 buffer_load_dwordx4 v13, s[8:11], s62 offen offset:1024 sc1 lds
 v_and_b32 v203, s89, v189
 v_mfma_f32_16x16x32_bf16 v[152:155], v[32:35], v[52:55], v[152:155]
 v_lshlrev_b32 v204, 16, v190
 v_and_b32 v205, s89, v190
 s_add_u32 m0, s51, 16384
 s_lshl_b32 s63, s6, 2
 s_lshr_b32 s63, 0x1054, s63
 s_and_b32 s63, s63, 7
 s_mul_i32 s63, s63, 65536
 s_add_u32 s63, s63, s65
 v_mfma_f32_16x16x32_bf16 v[148:151], v[28:31], v[52:55], v[148:151]
 buffer_load_dwordx4 v10, s[20:23], s63 offen lds
 v_lshlrev_b32 v206, 16, v191
 v_mfma_f32_16x16x32_bf16 v[144:147], v[24:27], v[52:55], v[144:147]
 v_and_b32 v207, s89, v191
 s_waitcnt vmcnt(10) lgkmcnt(0)
 s_barrier
 v_mfma_f32_16x16x32_bf16 v[96:99], v[56:59], v[72:75], v[96:99]
 ds_read_b128 v[40:43], v2 offset:0
 v_mfma_f32_16x16x32_bf16 v[100:103], v[60:63], v[72:75], v[100:103]
 ds_read_b64_tr_b16 v[24:25], v6 offset:32768
 v_mfma_f32_16x16x32_bf16 v[104:107], v[64:67], v[72:75], v[104:107]
 ds_read_b64_tr_b16 v[26:27], v6 offset:36864
 v_mfma_f32_16x16x32_bf16 v[108:111], v[68:71], v[72:75], v[108:111]
 ds_read_b64_tr_b16 v[28:29], v7 offset:32768
 s_add_u32 m0, s50, 81920
 s_lshl_b32 s62, s6, 2
 s_lshr_b32 s62, 0x2105, s62
 s_and_b32 s62, s62, 7
 s_mul_i32 s62, s62, 16384
 s_add_u32 s62, s62, s54
 v_mfma_f32_16x16x32_bf16 v[124:127], v[68:71], v[76:79], v[124:127]
 ds_read_b64_tr_b16 v[30:31], v7 offset:36864
 buffer_load_dwordx4 v13, s[8:11], s62 offen offset:0 sc1 lds
 v_mfma_f32_16x16x32_bf16 v[120:123], v[64:67], v[76:79], v[120:123]
 ds_read_b128 v[44:47], v2 offset:1024
 v_mfma_f32_16x16x32_bf16 v[116:119], v[60:63], v[76:79], v[116:119]
 ds_read_b64_tr_b16 v[32:33], v8 offset:32768
 s_lshl4_add_u32 s64, s83, s7
 v_mfma_f32_16x16x32_bf16 v[112:115], v[56:59], v[76:79], v[112:115]
 ds_read_b64_tr_b16 v[34:35], v8 offset:36864
 s_lshl_b32 s64, s64, 7
 v_mfma_f32_16x16x32_bf16 v[128:131], v[56:59], v[80:83], v[128:131]
 ds_read_b128 v[48:51], v3 offset:0
 s_add_u32 s64, s64, 39927808
 v_mfma_f32_16x16x32_bf16 v[132:135], v[60:63], v[80:83], v[132:135]
 ds_read_b64_tr_b16 v[36:37], v9 offset:32768
 buffer_load_dwordx4 v13, s[8:11], s62 offen offset:1024 sc1 lds
 s_buffer_load_dwordx2 s[72:73], s[8:11], s64 offset:0 glc
 s_buffer_load_dwordx2 s[74:75], s[8:11], s64 offset:512 glc
 s_buffer_load_dwordx2 s[76:77], s[8:11], s64 offset:1024 glc
 s_buffer_load_dwordx2 s[78:79], s[8:11], s64 offset:1536 glc
 v_mfma_f32_16x16x32_bf16 v[136:139], v[64:67], v[80:83], v[136:139]
 ds_read_b64_tr_b16 v[38:39], v9 offset:36864
 v_mfma_f32_16x16x32_bf16 v[140:143], v[68:71], v[80:83], v[140:143]
 ds_read_b128 v[52:55], v3 offset:1024
 ds_read_b32 v90, v0
 ds_read_b32 v90, v0
 ds_read_b32 v90, v0
 ds_read_b32 v90, v0
 ds_read_b32 v90, v0
 ds_read_b32 v90, v0
 ds_read_b32 v90, v0
 ds_read_b32 v90, v0
 v_mfma_f32_16x16x32_bf16 v[156:159], v[68:71], v[84:87], v[156:159]
 s_add_u32 m0, s51, 24576
 s_lshl_b32 s63, s6, 2
 s_lshr_b32 s63, 0x2105, s63
 s_and_b32 s63, s63, 7
 s_mul_i32 s63, s63, 65536
 s_add_u32 s63, s63, s65
 v_mfma_f32_16x16x32_bf16 v[152:155], v[64:67], v[84:87], v[152:155]
 buffer_load_dwordx4 v10, s[20:23], s63 offen lds
 v_mfma_f32_16x16x32_bf16 v[148:151], v[60:63], v[84:87], v[148:151]
 v_mfma_f32_16x16x32_bf16 v[144:147], v[56:59], v[84:87], v[144:147]
 s_waitcnt vmcnt(11) lgkmcnt(8)
 s_barrier
 v_mfma_f32_16x16x32_bf16 v[96:99], v[24:27], v[40:43], v[96:99]
 ds_read_b128 v[72:75], v2 offset:16384
 v_mfma_f32_16x16x32_bf16 v[100:103], v[28:31], v[40:43], v[100:103]
 ds_read_b64_tr_b16 v[56:57], v6 offset:40960
 v_mfma_f32_16x16x32_bf16 v[104:107], v[32:35], v[40:43], v[104:107]
 ds_read_b64_tr_b16 v[58:59], v6 offset:45056
 v_mfma_f32_16x16x32_bf16 v[108:111], v[36:39], v[40:43], v[108:111]
 ds_read_b64_tr_b16 v[60:61], v7 offset:40960
 s_add_u32 m0, s50, 0
 s_bfe_u32 s62, s52, 0x40000
 s_lshl_b32 s62, s62, 15
 s_add_u32 s62, s62, s57
 v_mfma_f32_16x16x32_bf16 v[124:127], v[36:39], v[44:47], v[124:127]
 ds_read_b64_tr_b16 v[62:63], v7 offset:45056
 buffer_load_dwordx4 v0, s[8:11], s62 offen offset:0 sc1 lds
 v_mfma_f32_16x16x32_bf16 v[120:123], v[32:35], v[44:47], v[120:123]
 ds_read_b128 v[76:79], v2 offset:17408
 v_mfma_f32_16x16x32_bf16 v[116:119], v[28:31], v[44:47], v[116:119]
 ds_read_b64_tr_b16 v[64:65], v8 offset:40960
 v_mfma_f32_16x16x32_bf16 v[112:115], v[24:27], v[44:47], v[112:115]
 ds_read_b64_tr_b16 v[66:67], v8 offset:45056
 v_mfma_f32_16x16x32_bf16 v[128:131], v[24:27], v[48:51], v[128:131]
 ds_read_b128 v[80:83], v3 offset:16384
 v_mfma_f32_16x16x32_bf16 v[132:135], v[28:31], v[48:51], v[132:135]
 ds_read_b64_tr_b16 v[68:69], v9 offset:40960
 buffer_load_dwordx4 v0, s[8:11], s62 offen offset:1024 sc1 lds
 v_mfma_f32_16x16x32_bf16 v[136:139], v[32:35], v[48:51], v[136:139]
 ds_read_b64_tr_b16 v[70:71], v9 offset:45056
 v_mfma_f32_16x16x32_bf16 v[140:143], v[36:39], v[48:51], v[140:143]
 ds_read_b128 v[84:87], v3 offset:17408
 v_mfma_f32_16x16x32_bf16 v[156:159], v[36:39], v[52:55], v[156:159]
 s_add_u32 m0, s51, 32768
 s_bfe_u32 s63, s52, 0x40000
 s_lshl_b32 s63, s63, 17
 s_add_u32 s63, s63, s58
 v_mfma_f32_16x16x32_bf16 v[152:155], v[32:35], v[52:55], v[152:155]
 buffer_load_dwordx4 v11, s[20:23], s63 offen lds
 v_mfma_f32_16x16x32_bf16 v[148:151], v[28:31], v[52:55], v[148:151]
 v_mfma_f32_16x16x32_bf16 v[144:147], v[24:27], v[52:55], v[144:147]
 s_waitcnt lgkmcnt(0)
 s_and_b64 s[72:73], s[72:73], s[74:75]
 s_and_b64 s[76:77], s[76:77], s[78:79]
 s_and_b64 s[72:73], s[72:73], s[76:77]
 s_and_b32 s72, s72, s73
 s_cmp_eq_u32 s72, 0x1010101
 s_cbranch_scc0 Lsp_177
Lok_178:
 s_waitcnt vmcnt(12) lgkmcnt(0)
 s_barrier
 v_mfma_f32_16x16x32_bf16 v[96:99], v[56:59], v[72:75], v[96:99]
 ds_read_b128 v[40:43], v2 offset:32768
 v_mfma_f32_16x16x32_bf16 v[100:103], v[60:63], v[72:75], v[100:103]
 ds_read_b64_tr_b16 v[24:25], v6 offset:0
 v_mfma_f32_16x16x32_bf16 v[104:107], v[64:67], v[72:75], v[104:107]
 ds_read_b64_tr_b16 v[26:27], v6 offset:4096
 v_mfma_f32_16x16x32_bf16 v[108:111], v[68:71], v[72:75], v[108:111]
 ds_read_b64_tr_b16 v[28:29], v7 offset:0
 s_add_u32 m0, s50, 16384
 s_bfe_u32 s62, s52, 0x40004
 s_lshl_b32 s62, s62, 15
 s_add_u32 s62, s62, s57
 v_mfma_f32_16x16x32_bf16 v[124:127], v[68:71], v[76:79], v[124:127]
 ds_read_b64_tr_b16 v[30:31], v7 offset:4096
 buffer_load_dwordx4 v0, s[8:11], s62 offen offset:0 sc1 lds
 v_mfma_f32_16x16x32_bf16 v[120:123], v[64:67], v[76:79], v[120:123]
 ds_read_b128 v[44:47], v2 offset:33792
 v_mfma_f32_16x16x32_bf16 v[116:119], v[60:63], v[76:79], v[116:119]
 ds_read_b64_tr_b16 v[32:33], v8 offset:0
 v_mfma_f32_16x16x32_bf16 v[112:115], v[56:59], v[76:79], v[112:115]
 ds_read_b64_tr_b16 v[34:35], v8 offset:4096
 v_mfma_f32_16x16x32_bf16 v[128:131], v[56:59], v[80:83], v[128:131]
 ds_read_b128 v[48:51], v3 offset:32768
 v_mfma_f32_16x16x32_bf16 v[132:135], v[60:63], v[80:83], v[132:135]
 ds_read_b64_tr_b16 v[36:37], v9 offset:0
 buffer_load_dwordx4 v0, s[8:11], s62 offen offset:1024 sc1 lds
 v_mfma_f32_16x16x32_bf16 v[136:139], v[64:67], v[80:83], v[136:139]
 ds_read_b64_tr_b16 v[38:39], v9 offset:4096
 v_mfma_f32_16x16x32_bf16 v[140:143], v[68:71], v[80:83], v[140:143]
 ds_read_b128 v[52:55], v3 offset:33792
 v_mfma_f32_16x16x32_bf16 v[156:159], v[68:71], v[84:87], v[156:159]
 s_add_u32 m0, s51, 40960
 s_bfe_u32 s63, s52, 0x40004
 s_lshl_b32 s63, s63, 17
 s_add_u32 s63, s63, s58
 v_mfma_f32_16x16x32_bf16 v[152:155], v[64:67], v[84:87], v[152:155]
 buffer_load_dwordx4 v11, s[20:23], s63 offen lds
 v_mfma_f32_16x16x32_bf16 v[148:151], v[60:63], v[84:87], v[148:151]
 v_mfma_f32_16x16x32_bf16 v[144:147], v[56:59], v[84:87], v[144:147]
 s_waitcnt vmcnt(12) lgkmcnt(0)
 s_barrier
 v_mfma_f32_16x16x32_bf16 v[96:99], v[24:27], v[40:43], v[96:99]
 ds_read_b128 v[72:75], v2 offset:49152
 v_mfma_f32_16x16x32_bf16 v[100:103], v[28:31], v[40:43], v[100:103]
 ds_read_b64_tr_b16 v[56:57], v6 offset:8192
 v_mfma_f32_16x16x32_bf16 v[104:107], v[32:35], v[40:43], v[104:107]
 ds_read_b64_tr_b16 v[58:59], v6 offset:12288
 v_mfma_f32_16x16x32_bf16 v[108:111], v[36:39], v[40:43], v[108:111]
 ds_read_b64_tr_b16 v[60:61], v7 offset:8192
 s_add_u32 m0, s50, 32768
 s_bfe_u32 s62, s52, 0x40008
 s_lshl_b32 s62, s62, 15
 s_add_u32 s62, s62, s57
 v_mfma_f32_16x16x32_bf16 v[124:127], v[36:39], v[44:47], v[124:127]
 ds_read_b64_tr_b16 v[62:63], v7 offset:12288
 buffer_load_dwordx4 v0, s[8:11], s62 offen offset:0 sc1 lds
 v_mfma_f32_16x16x32_bf16 v[120:123], v[32:35], v[44:47], v[120:123]
 ds_read_b128 v[76:79], v2 offset:50176
 v_mfma_f32_16x16x32_bf16 v[116:119], v[28:31], v[44:47], v[116:119]
 ds_read_b64_tr_b16 v[64:65], v8 offset:8192
 v_mfma_f32_16x16x32_bf16 v[112:115], v[24:27], v[44:47], v[112:115]
 ds_read_b64_tr_b16 v[66:67], v8 offset:12288
 v_mfma_f32_16x16x32_bf16 v[128:131], v[24:27], v[48:51], v[128:131]
 ds_read_b128 v[80:83], v3 offset:49152
 v_mfma_f32_16x16x32_bf16 v[132:135], v[28:31], v[48:51], v[132:135]
 ds_read_b64_tr_b16 v[68:69], v9 offset:8192
 buffer_load_dwordx4 v0, s[8:11], s62 offen offset:1024 sc1 lds
 v_mfma_f32_16x16x32_bf16 v[136:139], v[32:35], v[48:51], v[136:139]
 ds_read_b64_tr_b16 v[70:71], v9 offset:12288
 v_mfma_f32_16x16x32_bf16 v[140:143], v[36:39], v[48:51], v[140:143]
 ds_read_b128 v[84:87], v3 offset:50176
 v_mfma_f32_16x16x32_bf16 v[156:159], v[36:39], v[52:55], v[156:159]
 s_add_u32 m0, s51, 0
 s_bfe_u32 s63, s52, 0x40008
 s_lshl_b32 s63, s63, 17
 s_add_u32 s63, s63, s58
 v_mfma_f32_16x16x32_bf16 v[152:155], v[32:35], v[52:55], v[152:155]
 buffer_load_dwordx4 v11, s[20:23], s63 offen lds
 v_mfma_f32_16x16x32_bf16 v[148:151], v[28:31], v[52:55], v[148:151]
 v_mfma_f32_16x16x32_bf16 v[144:147], v[24:27], v[52:55], v[144:147]
 s_waitcnt vmcnt(12) lgkmcnt(0)
 s_barrier
 v_mfma_f32_16x16x32_bf16 v[96:99], v[56:59], v[72:75], v[96:99]
 ds_read_b128 v[40:43], v4 offset:0
 v_mfma_f32_16x16x32_bf16 v[100:103], v[60:63], v[72:75], v[100:103]
 ds_read_b64_tr_b16 v[24:25], v6 offset:16384
 v_mfma_f32_16x16x32_bf16 v[104:107], v[64:67], v[72:75], v[104:107]
 ds_read_b64_tr_b16 v[26:27], v6 offset:20480
 v_mfma_f32_16x16x32_bf16 v[108:111], v[68:71], v[72:75], v[108:111]
 ds_read_b64_tr_b16 v[28:29], v7 offset:16384
 s_add_u32 m0, s50, 49152
 s_bfe_u32 s62, s52, 0x4000c
 s_lshl_b32 s62, s62, 15
 s_add_u32 s62, s62, s57
 v_mfma_f32_16x16x32_bf16 v[124:127], v[68:71], v[76:79], v[124:127]
 ds_read_b64_tr_b16 v[30:31], v7 offset:20480
 buffer_load_dwordx4 v0, s[8:11], s62 offen offset:0 sc1 lds
 v_mfma_f32_16x16x32_bf16 v[120:123], v[64:67], v[76:79], v[120:123]
 ds_read_b128 v[44:47], v4 offset:1024
 v_mfma_f32_16x16x32_bf16 v[116:119], v[60:63], v[76:79], v[116:119]
 ds_read_b64_tr_b16 v[32:33], v8 offset:16384
 v_mfma_f32_16x16x32_bf16 v[112:115], v[56:59], v[76:79], v[112:115]
 ds_read_b64_tr_b16 v[34:35], v8 offset:20480
 v_mfma_f32_16x16x32_bf16 v[128:131], v[56:59], v[80:83], v[128:131]
 ds_read_b128 v[48:51], v5 offset:0
 v_mfma_f32_16x16x32_bf16 v[132:135], v[60:63], v[80:83], v[132:135]
 ds_read_b64_tr_b16 v[36:37], v9 offset:16384
 buffer_load_dwordx4 v0, s[8:11], s62 offen offset:1024 sc1 lds
 v_mfma_f32_16x16x32_bf16 v[136:139], v[64:67], v[80:83], v[136:139]
 ds_read_b64_tr_b16 v[38:39], v9 offset:20480
 v_mfma_f32_16x16x32_bf16 v[140:143], v[68:71], v[80:83], v[140:143]
 ds_read_b128 v[52:55], v5 offset:1024
 v_mfma_f32_16x16x32_bf16 v[156:159], v[68:71], v[84:87], v[156:159]
 s_add_u32 m0, s51, 8192
 s_bfe_u32 s63, s52, 0x4000c
 s_lshl_b32 s63, s63, 17
 s_add_u32 s63, s63, s58
 v_mfma_f32_16x16x32_bf16 v[152:155], v[64:67], v[84:87], v[152:155]
 buffer_load_dwordx4 v11, s[20:23], s63 offen lds
 v_mfma_f32_16x16x32_bf16 v[148:151], v[60:63], v[84:87], v[148:151]
 v_mfma_f32_16x16x32_bf16 v[144:147], v[56:59], v[84:87], v[144:147]
 s_waitcnt vmcnt(12) lgkmcnt(0)
 s_barrier
 v_mfma_f32_16x16x32_bf16 v[96:99], v[24:27], v[40:43], v[96:99]
 ds_read_b128 v[72:75], v4 offset:16384
 v_mfma_f32_16x16x32_bf16 v[100:103], v[28:31], v[40:43], v[100:103]
 ds_read_b64_tr_b16 v[56:57], v6 offset:24576
 v_mfma_f32_16x16x32_bf16 v[104:107], v[32:35], v[40:43], v[104:107]
 ds_read_b64_tr_b16 v[58:59], v6 offset:28672
 v_mfma_f32_16x16x32_bf16 v[108:111], v[36:39], v[40:43], v[108:111]
 ds_read_b64_tr_b16 v[60:61], v7 offset:24576
 s_add_u32 m0, s50, 65536
 s_bfe_u32 s62, s52, 0x40010
 s_lshl_b32 s62, s62, 15
 s_add_u32 s62, s62, s57
 v_mfma_f32_16x16x32_bf16 v[124:127], v[36:39], v[44:47], v[124:127]
 ds_read_b64_tr_b16 v[62:63], v7 offset:28672
 buffer_load_dwordx4 v0, s[8:11], s62 offen offset:0 sc1 lds
 v_mfma_f32_16x16x32_bf16 v[120:123], v[32:35], v[44:47], v[120:123]
 ds_read_b128 v[76:79], v4 offset:17408
 v_mfma_f32_16x16x32_bf16 v[116:119], v[28:31], v[44:47], v[116:119]
 ds_read_b64_tr_b16 v[64:65], v8 offset:24576
 v_mfma_f32_16x16x32_bf16 v[112:115], v[24:27], v[44:47], v[112:115]
 ds_read_b64_tr_b16 v[66:67], v8 offset:28672
 v_mfma_f32_16x16x32_bf16 v[128:131], v[24:27], v[48:51], v[128:131]
 ds_read_b128 v[80:83], v5 offset:16384
 v_mfma_f32_16x16x32_bf16 v[132:135], v[28:31], v[48:51], v[132:135]
 ds_read_b64_tr_b16 v[68:69], v9 offset:24576
 buffer_load_dwordx4 v0, s[8:11], s62 offen offset:1024 sc1 lds
 v_mfma_f32_16x16x32_bf16 v[136:139], v[32:35], v[48:51], v[136:139]
 ds_read_b64_tr_b16 v[70:71], v9 offset:28672
 v_mfma_f32_16x16x32_bf16 v[140:143], v[36:39], v[48:51], v[140:143]
 ds_read_b128 v[84:87], v5 offset:17408
 v_mfma_f32_16x16x32_bf16 v[156:159], v[36:39], v[52:55], v[156:159]
 s_add_u32 m0, s51, 16384
 s_bfe_u32 s63, s52, 0x40010
 s_lshl_b32 s63, s63, 17
 s_add_u32 s63, s63, s58
 v_mfma_f32_16x16x32_bf16 v[152:155], v[32:35], v[52:55], v[152:155]
 buffer_load_dwordx4 v11, s[20:23], s63 offen lds
 v_mfma_f32_16x16x32_bf16 v[148:151], v[28:31], v[52:55], v[148:151]
 v_mfma_f32_16x16x32_bf16 v[144:147], v[24:27], v[52:55], v[144:147]
 s_waitcnt vmcnt(12) lgkmcnt(0)
 s_barrier
 v_mfma_f32_16x16x32_bf16 v[96:99], v[56:59], v[72:75], v[96:99]
 ds_read_b128 v[40:43], v15 offset:0
 v_mfma_f32_16x16x32_bf16 v[100:103], v[60:63], v[72:75], v[100:103]
 ds_read_b64_tr_b16 v[24:25], v6 offset:32768
 v_mfma_f32_16x16x32_bf16 v[104:107], v[64:67], v[72:75], v[104:107]
 ds_read_b64_tr_b16 v[26:27], v6 offset:36864
 v_mfma_f32_16x16x32_bf16 v[108:111], v[68:71], v[72:75], v[108:111]
 ds_read_b64_tr_b16 v[28:29], v7 offset:32768
 s_add_u32 m0, s50, 81920
 s_bfe_u32 s62, s52, 0x40014
 s_lshl_b32 s62, s62, 15
 s_add_u32 s62, s62, s57
 v_mfma_f32_16x16x32_bf16 v[124:127], v[68:71], v[76:79], v[124:127]
 ds_read_b64_tr_b16 v[30:31], v7 offset:36864
 buffer_load_dwordx4 v0, s[8:11], s62 offen offset:0 sc1 lds
 v_mfma_f32_16x16x32_bf16 v[120:123], v[64:67], v[76:79], v[120:123]
 ds_read_b128 v[44:47], v15 offset:1024
 v_mfma_f32_16x16x32_bf16 v[116:119], v[60:63], v[76:79], v[116:119]
 ds_read_b64_tr_b16 v[32:33], v8 offset:32768
 v_mfma_f32_16x16x32_bf16 v[112:115], v[56:59], v[76:79], v[112:115]
 ds_read_b64_tr_b16 v[34:35], v8 offset:36864
 v_mfma_f32_16x16x32_bf16 v[128:131], v[56:59], v[80:83], v[128:131]
 ds_read_b128 v[48:51], v15 offset:8192
 v_mfma_f32_16x16x32_bf16 v[132:135], v[60:63], v[80:83], v[132:135]
 ds_read_b64_tr_b16 v[36:37], v9 offset:32768
 buffer_load_dwordx4 v0, s[8:11], s62 offen offset:1024 sc1 lds
 v_mfma_f32_16x16x32_bf16 v[136:139], v[64:67], v[80:83], v[136:139]
 ds_read_b64_tr_b16 v[38:39], v9 offset:36864
 v_mfma_f32_16x16x32_bf16 v[140:143], v[68:71], v[80:83], v[140:143]
 ds_read_b128 v[52:55], v15 offset:9216
 v_mfma_f32_16x16x32_bf16 v[156:159], v[68:71], v[84:87], v[156:159]
 s_add_u32 m0, s51, 24576
 s_bfe_u32 s63, s52, 0x40014
 s_lshl_b32 s63, s63, 17
 s_add_u32 s63, s63, s58
 v_mfma_f32_16x16x32_bf16 v[152:155], v[64:67], v[84:87], v[152:155]
 buffer_load_dwordx4 v11, s[20:23], s63 offen lds
 v_mfma_f32_16x16x32_bf16 v[148:151], v[60:63], v[84:87], v[148:151]
 v_mfma_f32_16x16x32_bf16 v[144:147], v[56:59], v[84:87], v[144:147]
 s_waitcnt vmcnt(12) lgkmcnt(0)
 s_barrier
 v_mfma_f32_16x16x32_bf16 v[96:99], v[24:27], v[40:43], v[96:99]
 ds_read_b128 v[72:75], v15 offset:16384
 ds_read_b64_tr_b16 v[56:57], v6 offset:40960
 v_cvt_pk_bf16_f32 v104, v104, v105
 v_cvt_pk_bf16_f32 v105, v106, v107
 v_cvt_pk_bf16_f32 v106, v108, v109
 v_cvt_pk_bf16_f32 v107, v110, v111
 s_xor_b32 s85, s4, 1
 s_mul_i32 s85, s85, 49152
 s_add_u32 s85, s85, s60
 v_mfma_f32_16x16x32_bf16 v[100:103], v[28:31], v[40:43], v[100:103]
 ds_read_b64_tr_b16 v[58:59], v6 offset:45056
 ds_read_b64_tr_b16 v[60:61], v7 offset:40960
 buffer_store_dwordx4 v[104:107], v13, s[8:11], s85 offen offset:0 sc1
 v_cvt_pk_bf16_f32 v120, v120, v121
 v_cvt_pk_bf16_f32 v121, v122, v123
 v_cvt_pk_bf16_f32 v122, v124, v125
 v_cvt_pk_bf16_f32 v123, v126, v127
 s_xor_b32 s85, s4, 1
 v_mfma_f32_16x16x32_bf16 v[116:119], v[28:31], v[44:47], v[116:119]
 ds_read_b64_tr_b16 v[62:63], v7 offset:45056
 ds_read_b128 v[76:79], v15 offset:17408
 s_mul_i32 s85, s85, 49152
 s_add_u32 s85, s85, s60
 buffer_store_dwordx4 v[120:123], v13, s[8:11], s85 offen offset:1024 sc1
 v_cvt_pk_bf16_f32 v128, v128, v129
 v_cvt_pk_bf16_f32 v129, v130, v131
 v_cvt_pk_bf16_f32 v130, v132, v133
 v_cvt_pk_bf16_f32 v131, v134, v135
 v_mfma_f32_16x16x32_bf16 v[112:115], v[24:27], v[44:47], v[112:115]
 ds_read_b64_tr_b16 v[64:65], v8 offset:40960
 ds_read_b64_tr_b16 v[66:67], v8 offset:45056
 s_xor_b32 s85, s4, 2
 s_mul_i32 s85, s85, 49152
 s_add_u32 s85, s85, s60
 s_add_u32 s85, s85, 16384
 buffer_store_dwordx4 v[128:131], v13, s[8:11], s85 offen offset:0 sc1
 v_cvt_pk_bf16_f32 v144, v144, v145
 v_mfma_f32_16x16x32_bf16 v[96:99], v[32:35], v[48:51], v[96:99]
 ds_read_b128 v[80:83], v15 offset:24576
 ds_read_b64_tr_b16 v[68:69], v9 offset:40960
 v_cvt_pk_bf16_f32 v145, v146, v147
 v_cvt_pk_bf16_f32 v146, v148, v149
 v_cvt_pk_bf16_f32 v147, v150, v151
 s_xor_b32 s85, s4, 2
 s_mul_i32 s85, s85, 49152
 s_add_u32 s85, s85, s60
 s_add_u32 s85, s85, 16384
 v_mfma_f32_16x16x32_bf16 v[100:103], v[36:39], v[48:51], v[100:103]
 ds_read_b64_tr_b16 v[70:71], v9 offset:45056
 ds_read_b128 v[84:87], v15 offset:25600
 buffer_store_dwordx4 v[144:147], v13, s[8:11], s85 offen offset:1024 sc1
 v_cvt_pk_bf16_f32 v136, v136, v137
 v_cvt_pk_bf16_f32 v137, v138, v139
 v_cvt_pk_bf16_f32 v138, v140, v141
 v_cvt_pk_bf16_f32 v139, v142, v143
 s_xor_b32 s85, s4, 3
 v_mfma_f32_16x16x32_bf16 v[116:119], v[36:39], v[52:55], v[116:119]
 s_mul_i32 s85, s85, 49152
 s_add_u32 s85, s85, s60
 s_add_u32 s85, s85, 32768
 buffer_store_dwordx4 v[136:139], v13, s[8:11], s85 offen offset:0 sc1
 v_cvt_pk_bf16_f32 v152, v152, v153
 v_cvt_pk_bf16_f32 v153, v154, v155
 v_cvt_pk_bf16_f32 v154, v156, v157
 v_mfma_f32_16x16x32_bf16 v[112:115], v[32:35], v[52:55], v[112:115]
 v_cvt_pk_bf16_f32 v155, v158, v159
 s_xor_b32 s85, s4, 3
 s_mul_i32 s85, s85, 49152
 s_add_u32 s85, s85, s60
 s_add_u32 s85, s85, 32768
 buffer_store_dwordx4 v[152:155], v13, s[8:11], s85 offen offset:1024 sc1
 s_waitcnt vmcnt(6) lgkmcnt(0)
 s_barrier
 v_mfma_f32_16x16x32_bf16 v[96:99], v[56:59], v[72:75], v[96:99]
 ds_read_b128 v[40:43], v15 offset:32768
 ds_read_b64_tr_b16 v[24:25], v6 offset:0
 v_mfma_f32_16x16x32_bf16 v[100:103], v[60:63], v[72:75], v[100:103]
 ds_read_b64_tr_b16 v[26:27], v6 offset:4096
 ds_read_b64_tr_b16 v[28:29], v7 offset:0
 v_mfma_f32_16x16x32_bf16 v[116:119], v[60:63], v[76:79], v[116:119]
 ds_read_b64_tr_b16 v[30:31], v7 offset:4096
 ds_read_b128 v[44:47], v15 offset:33792
 v_mfma_f32_16x16x32_bf16 v[112:115], v[56:59], v[76:79], v[112:115]
 ds_read_b64_tr_b16 v[32:33], v8 offset:0
 ds_read_b64_tr_b16 v[34:35], v8 offset:4096
 v_mfma_f32_16x16x32_bf16 v[96:99], v[64:67], v[80:83], v[96:99]
 ds_read_b128 v[48:51], v15 offset:40960
 ds_read_b64_tr_b16 v[36:37], v9 offset:0
 v_mfma_f32_16x16x32_bf16 v[100:103], v[68:71], v[80:83], v[100:103]
 ds_read_b64_tr_b16 v[38:39], v9 offset:4096
 ds_read_b128 v[52:55], v15 offset:41984
 v_mfma_f32_16x16x32_bf16 v[116:119], v[68:71], v[84:87], v[116:119]
 v_mfma_f32_16x16x32_bf16 v[112:115], v[64:67], v[84:87], v[112:115]
 s_waitcnt lgkmcnt(0)
 v_mfma_f32_16x16x32_bf16 v[96:99], v[24:27], v[40:43], v[96:99]
 ds_read_b128 v[72:75], v15 offset:49152
 ds_read_b64_tr_b16 v[56:57], v6 offset:8192
 s_xor_b32 s92, s71, 1024
 v_mov_b32 v91, 1
 v_mfma_f32_16x16x32_bf16 v[100:103], v[28:31], v[40:43], v[100:103]
 ds_read_b64_tr_b16 v[58:59], v6 offset:12288
 ds_read_b64_tr_b16 v[60:61], v7 offset:8192
 s_waitcnt vmcnt(4)
 v_mfma_f32_16x16x32_bf16 v[116:119], v[28:31], v[44:47], v[116:119]
 ds_read_b64_tr_b16 v[62:63], v7 offset:12288
 ds_read_b128 v[76:79], v15 offset:50176
 buffer_store_byte v91, off, s[8:11], s92 sc1
 s_xor_b32 s92, s71, 2048
 v_mfma_f32_16x16x32_bf16 v[112:115], v[24:27], v[44:47], v[112:115]
 ds_read_b64_tr_b16 v[64:65], v8 offset:8192
 ds_read_b64_tr_b16 v[66:67], v8 offset:12288
 v_mov_b32 v91, 1
 v_mfma_f32_16x16x32_bf16 v[96:99], v[32:35], v[48:51], v[96:99]
 ds_read_b128 v[80:83], v15 offset:57344
 ds_read_b64_tr_b16 v[68:69], v9 offset:8192
 s_waitcnt vmcnt(3)
 buffer_store_byte v91, off, s[8:11], s92 offset:1 sc1
 v_mfma_f32_16x16x32_bf16 v[100:103], v[36:39], v[48:51], v[100:103]
 ds_read_b64_tr_b16 v[70:71], v9 offset:12288
 ds_read_b128 v[84:87], v15 offset:58368
 s_xor_b32 s92, s71, 3072
 v_mfma_f32_16x16x32_bf16 v[116:119], v[36:39], v[52:55], v[116:119]
 v_mov_b32 v91, 1
 s_waitcnt vmcnt(2)
 v_mfma_f32_16x16x32_bf16 v[112:115], v[32:35], v[52:55], v[112:115]
 buffer_store_byte v91, off, s[8:11], s92 offset:2 sc1
 s_waitcnt lgkmcnt(0)
 v_mfma_f32_16x16x32_bf16 v[96:99], v[56:59], v[72:75], v[96:99]
 ds_read_b128 v[40:43], v17 offset:0
 ds_read_b64_tr_b16 v[24:25], v6 offset:16384
 v_mfma_f32_16x16x32_bf16 v[100:103], v[60:63], v[72:75], v[100:103]
 ds_read_b64_tr_b16 v[26:27], v6 offset:20480
 ds_read_b64_tr_b16 v[28:29], v7 offset:16384
 v_mfma_f32_16x16x32_bf16 v[116:119], v[60:63], v[76:79], v[116:119]
 ds_read_b64_tr_b16 v[30:31], v7 offset:20480
 ds_read_b128 v[44:47], v17 offset:1024
 v_mfma_f32_16x16x32_bf16 v[112:115], v[56:59], v[76:79], v[112:115]
 ds_read_b64_tr_b16 v[32:33], v8 offset:16384
 ds_read_b64_tr_b16 v[34:35], v8 offset:20480
 v_mfma_f32_16x16x32_bf16 v[96:99], v[64:67], v[80:83], v[96:99]
 ds_read_b128 v[48:51], v17 offset:8192
 ds_read_b64_tr_b16 v[36:37], v9 offset:16384
 v_mfma_f32_16x16x32_bf16 v[100:103], v[68:71], v[80:83], v[100:103]
 ds_read_b64_tr_b16 v[38:39], v9 offset:20480
 ds_read_b128 v[52:55], v17 offset:9216
 v_mfma_f32_16x16x32_bf16 v[116:119], v[68:71], v[84:87], v[116:119]
 v_mfma_f32_16x16x32_bf16 v[112:115], v[64:67], v[84:87], v[112:115]
 s_waitcnt lgkmcnt(0)
 v_mfma_f32_16x16x32_bf16 v[96:99], v[24:27], v[40:43], v[96:99]
 ds_read_b128 v[72:75], v17 offset:16384
 ds_read_b64_tr_b16 v[56:57], v6 offset:24576
 v_mfma_f32_16x16x32_bf16 v[100:103], v[28:31], v[40:43], v[100:103]
 ds_read_b64_tr_b16 v[58:59], v6 offset:28672
 ds_read_b64_tr_b16 v[60:61], v7 offset:24576
 v_mfma_f32_16x16x32_bf16 v[116:119], v[28:31], v[44:47], v[116:119]
 ds_read_b64_tr_b16 v[62:63], v7 offset:28672
 ds_read_b128 v[76:79], v17 offset:17408
 v_mfma_f32_16x16x32_bf16 v[112:115], v[24:27], v[44:47], v[112:115]
 ds_read_b64_tr_b16 v[64:65], v8 offset:24576
 ds_read_b64_tr_b16 v[66:67], v8 offset:28672
 v_mfma_f32_16x16x32_bf16 v[96:99], v[32:35], v[48:51], v[96:99]
 ds_read_b128 v[80:83], v17 offset:24576
 ds_read_b64_tr_b16 v[68:69], v9 offset:24576
 v_mfma_f32_16x16x32_bf16 v[100:103], v[36:39], v[48:51], v[100:103]
 ds_read_b64_tr_b16 v[70:71], v9 offset:28672
 ds_read_b128 v[84:87], v17 offset:25600
 v_mfma_f32_16x16x32_bf16 v[116:119], v[36:39], v[52:55], v[116:119]
 v_mfma_f32_16x16x32_bf16 v[112:115], v[32:35], v[52:55], v[112:115]
 s_waitcnt lgkmcnt(0)
 v_mfma_f32_16x16x32_bf16 v[96:99], v[56:59], v[72:75], v[96:99]
 s_buffer_load_dword s72, s[8:11], s71 glc
 v_mfma_f32_16x16x32_bf16 v[100:103], v[60:63], v[72:75], v[100:103]
 v_mfma_f32_16x16x32_bf16 v[116:119], v[60:63], v[76:79], v[116:119]
 v_mfma_f32_16x16x32_bf16 v[112:115], v[56:59], v[76:79], v[112:115]
 v_mfma_f32_16x16x32_bf16 v[96:99], v[64:67], v[80:83], v[96:99]
 v_mfma_f32_16x16x32_bf16 v[100:103], v[68:71], v[80:83], v[100:103]
 v_mfma_f32_16x16x32_bf16 v[116:119], v[68:71], v[84:87], v[116:119]
 v_mfma_f32_16x16x32_bf16 v[112:115], v[64:67], v[84:87], v[112:115]
 s_waitcnt lgkmcnt(0)
 s_cmp_eq_u32 s72, 0x10101
 s_cbranch_scc0 Lsp_180
Lok_181:
 s_mul_i32 s85, s4, 49152
 s_add_u32 s85, s85, s60
 buffer_load_dwordx4 v[160:163], v13, s[8:11], s85 offen offset:0 sc1
 buffer_load_dwordx4 v[164:167], v13, s[8:11], s85 offen offset:1024 sc1
 s_mul_i32 s85, s4, 49152
 s_add_u32 s85, s85, s60
 s_add_u32 s85, s85, 16384
 buffer_load_dwordx4 v[168:171], v13, s[8:11], s85 offen offset:0 sc1
 buffer_load_dwordx4 v[172:175], v13, s[8:11], s85 offen offset:1024 sc1
 s_mul_i32 s85, s4, 49152
 s_add_u32 s85, s85, s60
 s_add_u32 s85, s85, 32768
 buffer_load_dwordx4 v[176:179], v13, s[8:11], s85 offen offset:0 sc1
 buffer_load_dwordx4 v[180:183], v13, s[8:11], s85 offen offset:1024 sc1
 s_waitcnt vmcnt(4)
 v_lshlrev_b32 v208, 16, v160
 v_and_b32 v209, s89, v160
 v_add_f32 v192, v192, v208
 v_add_f32 v193, v193, v209
 v_lshlrev_b32 v210, 16, v161
 v_and_b32 v211, s89, v161
 v_add_f32 v194, v194, v210
 v_add_f32 v195, v195, v211
 v_lshlrev_b32 v208, 16, v162
 v_and_b32 v209, s89, v162
 v_add_f32 v196, v196, v208
 v_add_f32 v197, v197, v209
 v_lshlrev_b32 v210, 16, v163
 v_and_b32 v211, s89, v163
 v_add_f32 v198, v198, v210
 v_add_f32 v199, v199, v211
 v_lshlrev_b32 v208, 16, v164
 v_and_b32 v209, s89, v164
 v_add_f32 v200, v200, v208
 v_add_f32 v201, v201, v209
 v_lshlrev_b32 v210, 16, v165
 v_and_b32 v211, s89, v165
 v_add_f32 v202, v202, v210
 v_add_f32 v203, v203, v211
 v_lshlrev_b32 v208, 16, v166
 v_and_b32 v209, s89, v166
 v_add_f32 v204, v204, v208
 v_add_f32 v205, v205, v209
 v_lshlrev_b32 v210, 16, v167
 v_and_b32 v211, s89, v167
 v_add_f32 v206, v206, v210
 v_add_f32 v207, v207, v211
 s_waitcnt vmcnt(2)
 v_lshlrev_b32 v208, 16, v168
 v_and_b32 v209, s89, v168
 v_add_f32 v192, v192, v208
 v_add_f32 v193, v193, v209
 v_lshlrev_b32 v210, 16, v169
 v_and_b32 v211, s89, v169
 v_add_f32 v194, v194, v210
 v_add_f32 v195, v195, v211
 v_lshlrev_b32 v208, 16, v170
 v_and_b32 v209, s89, v170
 v_add_f32 v196, v196, v208
 v_add_f32 v197, v197, v209
 v_lshlrev_b32 v210, 16, v171
 v_and_b32 v211, s89, v171
 v_add_f32 v198, v198, v210
 v_add_f32 v199, v199, v211
 v_lshlrev_b32 v208, 16, v172
 v_and_b32 v209, s89, v172
 v_add_f32 v200, v200, v208
 v_add_f32 v201, v201, v209
 v_lshlrev_b32 v210, 16, v173
 v_and_b32 v211, s89, v173
 v_add_f32 v202, v202, v210
 v_add_f32 v203, v203, v211
 v_lshlrev_b32 v208, 16, v174
 v_and_b32 v209, s89, v174
 v_add_f32 v204, v204, v208
 v_add_f32 v205, v205, v209
 v_lshlrev_b32 v210, 16, v175
 v_and_b32 v211, s89, v175
 v_add_f32 v206, v206, v210
 v_add_f32 v207, v207, v211
 s_waitcnt vmcnt(0)
 v_lshlrev_b32 v208, 16, v176
 v_and_b32 v209, s89, v176
 v_add_f32 v192, v192, v208
 v_add_f32 v193, v193, v209
 v_lshlrev_b32 v210, 16, v177
 v_and_b32 v211, s89, v177
 v_add_f32 v194, v194, v210
 v_add_f32 v195, v195, v211
 v_lshlrev_b32 v208, 16, v178
 v_and_b32 v209, s89, v178
 v_add_f32 v196, v196, v208
 v_add_f32 v197, v197, v209
 v_lshlrev_b32 v210, 16, v179
 v_and_b32 v211, s89, v179
 v_add_f32 v198, v198, v210
 v_add_f32 v199, v199, v211
 v_lshlrev_b32 v208, 16, v180
 v_and_b32 v209, s89, v180
 v_add_f32 v200, v200, v208
 v_add_f32 v201, v201, v209
 v_lshlrev_b32 v210, 16, v181
 v_and_b32 v211, s89, v181
 v_add_f32 v202, v202, v210
 v_add_f32 v203, v203, v211
 v_lshlrev_b32 v208, 16, v182
 v_and_b32 v209, s89, v182
 v_add_f32 v204, v204, v208
 v_add_f32 v205, v205, v209
 v_lshlrev_b32 v210, 16, v183
 v_and_b32 v211, s89, v183
 v_add_f32 v206, v206, v210
 v_add_f32 v207, v207, v211
 v_add_f32 v96, v96, v192
 v_add_f32 v97, v97, v193
 v_add_f32 v98, v98, v194
 v_add_f32 v99, v99, v195
 v_add_f32 v100, v100, v196
 v_add_f32 v101, v101, v197
 v_add_f32 v102, v102, v198
 v_add_f32 v103, v103, v199
 v_cvt_pk_bf16_f32 v96, v96, v97
 v_cvt_pk_bf16_f32 v97, v98, v99
 v_cvt_pk_bf16_f32 v98, v100, v101
 v_cvt_pk_bf16_f32 v99, v102, v103
 s_nop 0
 v_permlane16_swap_b32 v96, v98
 v_permlane16_swap_b32 v97, v99
 buffer_store_dwordx4 v[96:99], v94, s[28:31], s61 offen
 v_add_f32 v112, v112, v200
 v_add_f32 v113, v113, v201
 v_add_f32 v114, v114, v202
 v_add_f32 v115, v115, v203
 v_add_f32 v116, v116, v204
 v_add_f32 v117, v117, v205
 v_add_f32 v118, v118, v206
 v_add_f32 v119, v119, v207
 v_cvt_pk_bf16_f32 v112, v112, v113
 v_cvt_pk_bf16_f32 v113, v114, v115
 v_cvt_pk_bf16_f32 v114, v116, v117
 v_cvt_pk_bf16_f32 v115, v118, v119
 s_nop 0
 v_permlane16_swap_b32 v112, v114
 v_permlane16_swap_b32 v113, v115
 buffer_store_dwordx4 v[112:115], v94, s[28:31], s66 offen
 s_endpgm
Lsp_177:
 s_mov_b32 s95, 0
Llp_179:
 s_buffer_load_dwordx2 s[72:73], s[8:11], s64 offset:0 glc
 s_buffer_load_dwordx2 s[74:75], s[8:11], s64 offset:512 glc
 s_buffer_load_dwordx2 s[76:77], s[8:11], s64 offset:1024 glc
 s_buffer_load_dwordx2 s[78:79], s[8:11], s64 offset:1536 glc
 s_waitcnt lgkmcnt(0)
 s_add_u32 s95, s95, 1
 s_and_b64 s[72:73], s[72:73], s[74:75]
 s_and_b64 s[76:77], s[76:77], s[78:79]
 s_and_b64 s[72:73], s[72:73], s[76:77]
 s_and_b32 s72, s72, s73
 s_cmp_eq_u32 s72, 0x1010101
 s_cbranch_scc1 Lok_178
 s_cmp_lt_u32 s95, 0x40000
 s_cbranch_scc1 Llp_179
 s_branch Lok_178
Lsp_180:
 s_mov_b32 s95, 0
Llp_182:
 s_buffer_load_dword s72, s[8:11], s71 glc
 s_waitcnt lgkmcnt(0)
 s_add_u32 s95, s95, 1
 s_cmp_eq_u32 s72, 0x10101
 s_cbranch_scc1 Lok_181
 s_cmp_lt_u32 s95, 0x40000
 s_cbranch_scc1 Llp_182
 s_branch Lok_181
L5_v13:
 s_lshl_b32 s52, s52, 12
 s_lshr_b32 s84, 0x21321321, s84
 s_and_b32 s84, s84, 0xfff
 s_or_b32 s52, s52, s84
 s_xor_b32 s52, s52, s96
 s_waitcnt vmcnt(17) lgkmcnt(0)
 s_barrier
 v_mfma_f32_16x16x32_bf16 v[96:99], v[24:27], v[40:43], v[96:99]
 ds_read_b128 v[72:75], v2 offset:16384
 v_mfma_f32_16x16x32_bf16 v[100:103], v[28:31], v[40:43], v[100:103]
 ds_read_b64_tr_b16 v[56:57], v6 offset:40960
 v_mfma_f32_16x16x32_bf16 v[104:107], v[32:35], v[40:43], v[104:107]
 ds_read_b64_tr_b16 v[58:59], v6 offset:45056
 v_mfma_f32_16x16x32_bf16 v[108:111], v[36:39], v[40:43], v[108:111]
 ds_read_b64_tr_b16 v[60:61], v7 offset:40960
 v_mfma_f32_16x16x32_bf16 v[124:127], v[36:39], v[44:47], v[124:127]
 ds_read_b64_tr_b16 v[62:63], v7 offset:45056
 v_mfma_f32_16x16x32_bf16 v[120:123], v[32:35], v[44:47], v[120:123]
 ds_read_b128 v[76:79], v2 offset:17408
 v_mfma_f32_16x16x32_bf16 v[116:119], v[28:31], v[44:47], v[116:119]
 ds_read_b64_tr_b16 v[64:65], v8 offset:40960
 v_mfma_f32_16x16x32_bf16 v[112:115], v[24:27], v[44:47], v[112:115]
 ds_read_b64_tr_b16 v[66:67], v8 offset:45056
 v_mfma_f32_16x16x32_bf16 v[128:131], v[24:27], v[48:51], v[128:131]
 ds_read_b128 v[80:83], v3 offset:16384
 s_add_u32 m0, s51, 32768
 s_add_u32 s63, s6, 0
 s_and_b32 s63, s63, 1
 s_mul_i32 s63, s63, 65536
 s_add_u32 s63, s63, s65
 v_mfma_f32_16x16x32_bf16 v[132:135], v[28:31], v[48:51], v[132:135]
 ds_read_b64_tr_b16 v[68:69], v9 offset:40960
 buffer_load_dwordx4 v10, s[20:23], s63 offen lds
 v_mfma_f32_16x16x32_bf16 v[136:139], v[32:35], v[48:51], v[136:139]
 ds_read_b64_tr_b16 v[70:71], v9 offset:45056
 v_mfma_f32_16x16x32_bf16 v[140:143], v[36:39], v[48:51], v[140:143]
 ds_read_b128 v[84:87], v3 offset:17408
 v_mfma_f32_16x16x32_bf16 v[156:159], v[36:39], v[52:55], v[156:159]
 v_mfma_f32_16x16x32_bf16 v[152:155], v[32:35], v[52:55], v[152:155]
 v_mfma_f32_16x16x32_bf16 v[148:151], v[28:31], v[52:55], v[148:151]
 v_mfma_f32_16x16x32_bf16 v[144:147], v[24:27], v[52:55], v[144:147]
 s_waitcnt vmcnt(14) lgkmcnt(0)
 s_barrier
 v_mfma_f32_16x16x32_bf16 v[96:99], v[56:59], v[72:75], v[96:99]
 ds_read_b128 v[40:43], v2 offset:32768
 v_and_b32 v94, 15, v1
 v_mfma_f32_16x16x32_bf16 v[100:103], v[60:63], v[72:75], v[100:103]
 ds_read_b64_tr_b16 v[24:25], v6 offset:0
 v_mfma_f32_16x16x32_bf16 v[104:107], v[64:67], v[72:75], v[104:107]
 ds_read_b64_tr_b16 v[26:27], v6 offset:4096
 v_lshlrev_b32 v94, 11, v94
 v_mfma_f32_16x16x32_bf16 v[108:111], v[68:71], v[72:75], v[108:111]
 ds_read_b64_tr_b16 v[28:29], v7 offset:0
 v_mfma_f32_16x16x32_bf16 v[124:127], v[68:71], v[76:79], v[124:127]
 ds_read_b64_tr_b16 v[30:31], v7 offset:4096
 v_bfe_u32 v92, v1, 4, 1
 v_mfma_f32_16x16x32_bf16 v[120:123], v[64:67], v[76:79], v[120:123]
 ds_read_b128 v[44:47], v2 offset:33792
 v_mfma_f32_16x16x32_bf16 v[116:119], v[60:63], v[76:79], v[116:119]
 ds_read_b64_tr_b16 v[32:33], v8 offset:0
 v_lshl_add_u32 v94, v92, 5, v94
 v_mfma_f32_16x16x32_bf16 v[112:115], v[56:59], v[76:79], v[112:115]
 ds_read_b64_tr_b16 v[34:35], v8 offset:4096
 v_mfma_f32_16x16x32_bf16 v[128:131], v[56:59], v[80:83], v[128:131]
 ds_read_b128 v[48:51], v3 offset:32768
 v_lshrrev_b32 v92, 5, v1
 s_add_u32 m0, s51, 40960
 s_add_u32 s63, s6, 1
 s_and_b32 s63, s63, 1
 s_mul_i32 s63, s63, 65536
 s_add_u32 s63, s63, s65
 v_mfma_f32_16x16x32_bf16 v[132:135], v[60:63], v[80:83], v[132:135]
 ds_read_b64_tr_b16 v[36:37], v9 offset:0
 buffer_load_dwordx4 v10, s[20:23], s63 offen lds
 v_mfma_f32_16x16x32_bf16 v[136:139], v[64:67], v[80:83], v[136:139]
 ds_read_b64_tr_b16 v[38:39], v9 offset:4096
 v_lshl_add_u32 v94, v92, 4, v94
 v_mfma_f32_16x16x32_bf16 v[140:143], v[68:71], v[80:83], v[140:143]
 ds_read_b128 v[52:55], v3 offset:33792
 v_mfma_f32_16x16x32_bf16 v[156:159], v[68:71], v[84:87], v[156:159]
 buffer_load_dwordx4 v[184:187], v94, s[16:19], s61 offen
 v_mfma_f32_16x16x32_bf16 v[152:155], v[64:67], v[84:87], v[152:155]
 v_mfma_f32_16x16x32_bf16 v[148:151], v[60:63], v[84:87], v[148:151]
 buffer_load_dwordx4 v[188:191], v94, s[16:19], s66 offen
 v_mfma_f32_16x16x32_bf16 v[144:147], v[56:59], v[84:87], v[144:147]
 s_waitcnt vmcnt(11) lgkmcnt(0)
 s_barrier
 v_mfma_f32_16x16x32_bf16 v[96:99], v[24:27], v[40:43], v[96:99]
 ds_read_b128 v[72:75], v2 offset:49152
 v_mfma_f32_16x16x32_bf16 v[100:103], v[28:31], v[40:43], v[100:103]
 ds_read_b64_tr_b16 v[56:57], v6 offset:8192
 v_mfma_f32_16x16x32_bf16 v[104:107], v[32:35], v[40:43], v[104:107]
 ds_read_b64_tr_b16 v[58:59], v6 offset:12288
 v_mfma_f32_16x16x32_bf16 v[108:111], v[36:39], v[40:43], v[108:111]
 ds_read_b64_tr_b16 v[60:61], v7 offset:8192
 v_mfma_f32_16x16x32_bf16 v[124:127], v[36:39], v[44:47], v[124:127]
 ds_read_b64_tr_b16 v[62:63], v7 offset:12288
 v_mfma_f32_16x16x32_bf16 v[120:123], v[32:35], v[44:47], v[120:123]
 ds_read_b128 v[76:79], v2 offset:50176
 v_mfma_f32_16x16x32_bf16 v[116:119], v[28:31], v[44:47], v[116:119]
 ds_read_b64_tr_b16 v[64:65], v8 offset:8192
 v_mfma_f32_16x16x32_bf16 v[112:115], v[24:27], v[44:47], v[112:115]
 ds_read_b64_tr_b16 v[66:67], v8 offset:12288
 v_mfma_f32_16x16x32_bf16 v[128:131], v[24:27], v[48:51], v[128:131]
 ds_read_b128 v[80:83], v3 offset:49152
 s_add_u32 m0, s51, 0
 s_bfe_u32 s63, s52, 0x40000
 s_lshl_b32 s63, s63, 17
 s_add_u32 s63, s63, s58
 v_mfma_f32_16x16x32_bf16 v[132:135], v[28:31], v[48:51], v[132:135]
 ds_read_b64_tr_b16 v[68:69], v9 offset:8192
 buffer_load_dwordx4 v11, s[20:23], s63 offen lds
 v_mfma_f32_16x16x32_bf16 v[136:139], v[32:35], v[48:51], v[136:139]
 ds_read_b64_tr_b16 v[70:71], v9 offset:12288
 v_mfma_f32_16x16x32_bf16 v[140:143], v[36:39], v[48:51], v[140:143]
 ds_read_b128 v[84:87], v3 offset:50176
 v_mfma_f32_16x16x32_bf16 v[156:159], v[36:39], v[52:55], v[156:159]
 v_mfma_f32_16x16x32_bf16 v[152:155], v[32:35], v[52:55], v[152:155]
 v_mfma_f32_16x16x32_bf16 v[148:151], v[28:31], v[52:55], v[148:151]
 v_mfma_f32_16x16x32_bf16 v[144:147], v[24:27], v[52:55], v[144:147]
 s_waitcnt vmcnt(9) lgkmcnt(0)
 s_barrier
 v_mfma_f32_16x16x32_bf16 v[96:99], v[56:59], v[72:75], v[96:99]
 ds_read_b128 v[40:43], v4 offset:0
 v_mfma_f32_16x16x32_bf16 v[100:103], v[60:63], v[72:75], v[100:103]
 ds_read_b64_tr_b16 v[24:25], v6 offset:16384
 v_mfma_f32_16x16x32_bf16 v[104:107], v[64:67], v[72:75], v[104:107]
 ds_read_b64_tr_b16 v[26:27], v6 offset:20480
 s_add_u32 m0, s50, 0
 s_add_u32 s62, s6, 0
 s_and_b32 s62, s62, 1
 s_mul_i32 s62, s62, 16384
 s_add_u32 s62, s62, s54
 v_mfma_f32_16x16x32_bf16 v[108:111], v[68:71], v[72:75], v[108:111]
 ds_read_b64_tr_b16 v[28:29], v7 offset:16384
 buffer_load_dwordx4 v13, s[8:11], s62 offen offset:0 sc1 lds
 v_mfma_f32_16x16x32_bf16 v[124:127], v[68:71], v[76:79], v[124:127]
 ds_read_b64_tr_b16 v[30:31], v7 offset:20480
 v_mfma_f32_16x16x32_bf16 v[120:123], v[64:67], v[76:79], v[120:123]
 ds_read_b128 v[44:47], v4 offset:1024
 buffer_load_dwordx4 v13, s[8:11], s62 offen offset:1024 sc1 lds
 v_mfma_f32_16x16x32_bf16 v[116:119], v[60:63], v[76:79], v[116:119]
 ds_read_b64_tr_b16 v[32:33], v8 offset:16384
 s_lshl4_add_u32 s64, s83, s7
 s_add_u32 m0, s50, 16384
 s_add_u32 s62, s6, 1
 s_and_b32 s62, s62, 1
 s_mul_i32 s62, s62, 16384
 s_add_u32 s62, s62, s54
 v_mfma_f32_16x16x32_bf16 v[112:115], v[56:59], v[76:79], v[112:115]
 ds_read_b64_tr_b16 v[34:35], v8 offset:20480
 buffer_load_dwordx4 v13, s[8:11], s62 offen offset:0 sc1 lds
 s_lshl_b32 s64, s64, 7
 v_mfma_f32_16x16x32_bf16 v[128:131], v[56:59], v[80:83], v[128:131]
 ds_read_b128 v[48:51], v5 offset:0
 s_add_u32 s64, s64, 39927808
 v_mfma_f32_16x16x32_bf16 v[132:135], v[60:63], v[80:83], v[132:135]
 ds_read_b64_tr_b16 v[36:37], v9 offset:16384
 s_buffer_load_dwordx2 s[72:73], s[8:11], s64 offset:0 glc
 s_buffer_load_dwordx2 s[74:75], s[8:11], s64 offset:512 glc
 s_buffer_load_dwordx2 s[76:77], s[8:11], s64 offset:1024 glc
 s_buffer_load_dwordx2 s[78:79], s[8:11], s64 offset:1536 glc
 v_mfma_f32_16x16x32_bf16 v[136:139], v[64:67], v[80:83], v[136:139]
 ds_read_b64_tr_b16 v[38:39], v9 offset:20480
 buffer_load_dwordx4 v13, s[8:11], s62 offen offset:1024 sc1 lds
 v_mfma_f32_16x16x32_bf16 v[140:143], v[68:71], v[80:83], v[140:143]
 ds_read_b128 v[52:55], v5 offset:1024
 ds_read_b32 v90, v0
 ds_read_b32 v90, v0
 ds_read_b32 v90, v0
 ds_read_b32 v90, v0
 ds_read_b32 v90, v0
 ds_read_b32 v90, v0
 ds_read_b32 v90, v0
 ds_read_b32 v90, v0
 s_add_u32 m0, s50, 32768
 s_bfe_u32 s62, s52, 0x40000
 s_lshl_b32 s62, s62, 15
 s_add_u32 s62, s62, s57
 v_mfma_f32_16x16x32_bf16 v[156:159], v[68:71], v[84:87], v[156:159]
 buffer_load_dwordx4 v0, s[8:11], s62 offen offset:0 sc1 lds
 v_mfma_f32_16x16x32_bf16 v[152:155], v[64:67], v[84:87], v[152:155]
 v_mfma_f32_16x16x32_bf16 v[148:151], v[60:63], v[84:87], v[148:151]
 buffer_load_dwordx4 v0, s[8:11], s62 offen offset:1024 sc1 lds
 v_mfma_f32_16x16x32_bf16 v[144:147], v[56:59], v[84:87], v[144:147]
 s_waitcnt vmcnt(11) lgkmcnt(8)
 s_barrier
 v_mfma_f32_16x16x32_bf16 v[96:99], v[24:27], v[40:43], v[96:99]
 ds_read_b128 v[72:75], v4 offset:16384
 s_mov_b32 s89, 0xffff0000
 s_waitcnt vmcnt(7)
 v_mfma_f32_16x16x32_bf16 v[100:103], v[28:31], v[40:43], v[100:103]
 ds_read_b64_tr_b16 v[56:57], v6 offset:24576
 v_permlane16_swap_b32 v184, v186
 v_mfma_f32_16x16x32_bf16 v[104:107], v[32:35], v[40:43], v[104:107]
 ds_read_b64_tr_b16 v[58:59], v6 offset:28672
 v_permlane16_swap_b32 v185, v187
 v_permlane16_swap_b32 v188, v190
 s_add_u32 m0, s50, 49152
 s_bfe_u32 s62, s52, 0x40004
 s_lshl_b32 s62, s62, 15
 s_add_u32 s62, s62, s57
 v_mfma_f32_16x16x32_bf16 v[108:111], v[36:39], v[40:43], v[108:111]
 ds_read_b64_tr_b16 v[60:61], v7 offset:24576
 buffer_load_dwordx4 v0, s[8:11], s62 offen offset:0 sc1 lds
 v_permlane16_swap_b32 v189, v191
 v_mfma_f32_16x16x32_bf16 v[124:127], v[36:39], v[44:47], v[124:127]
 ds_read_b64_tr_b16 v[62:63], v7 offset:28672
 v_lshlrev_b32 v192, 16, v184
 v_and_b32 v193, s89, v184
 v_mfma_f32_16x16x32_bf16 v[120:123], v[32:35], v[44:47], v[120:123]
 ds_read_b128 v[76:79], v4 offset:17408
 buffer_load_dwordx4 v0, s[8:11], s62 offen offset:1024 sc1 lds
 v_lshlrev_b32 v194, 16, v185
 v_mfma_f32_16x16x32_bf16 v[116:119], v[28:31], v[44:47], v[116:119]
 ds_read_b64_tr_b16 v[64:65], v8 offset:24576
 v_and_b32 v195, s89, v185
 v_lshlrev_b32 v196, 16, v186
 s_add_u32 m0, s51, 8192
 s_bfe_u32 s63, s52, 0x40004
 s_lshl_b32 s63, s63, 17
 s_add_u32 s63, s63, s58
 v_mfma_f32_16x16x32_bf16 v[112:115], v[24:27], v[44:47], v[112:115]
 ds_read_b64_tr_b16 v[66:67], v8 offset:28672
 buffer_load_dwordx4 v11, s[20:23], s63 offen lds
 v_and_b32 v197, s89, v186
 v_mfma_f32_16x16x32_bf16 v[128:131], v[24:27], v[48:51], v[128:131]
 ds_read_b128 v[80:83], v5 offset:16384
 v_lshlrev_b32 v198, 16, v187
 v_mfma_f32_16x16x32_bf16 v[132:135], v[28:31], v[48:51], v[132:135]
 ds_read_b64_tr_b16 v[68:69], v9 offset:24576
 v_and_b32 v199, s89, v187
 v_lshlrev_b32 v200, 16, v188
 s_add_u32 m0, s50, 65536
 s_bfe_u32 s62, s52, 0x40008
 s_lshl_b32 s62, s62, 15
 s_add_u32 s62, s62, s57
 v_mfma_f32_16x16x32_bf16 v[136:139], v[32:35], v[48:51], v[136:139]
 ds_read_b64_tr_b16 v[70:71], v9 offset:28672
 buffer_load_dwordx4 v0, s[8:11], s62 offen offset:0 sc1 lds
 v_and_b32 v201, s89, v188
 v_mfma_f32_16x16x32_bf16 v[140:143], v[36:39], v[48:51], v[140:143]
 ds_read_b128 v[84:87], v5 offset:17408
 v_lshlrev_b32 v202, 16, v189
 v_and_b32 v203, s89, v189
 v_mfma_f32_16x16x32_bf16 v[156:159], v[36:39], v[52:55], v[156:159]
 buffer_load_dwordx4 v0, s[8:11], s62 offen offset:1024 sc1 lds
 v_lshlrev_b32 v204, 16, v190
 v_mfma_f32_16x16x32_bf16 v[152:155], v[32:35], v[52:55], v[152:155]
 v_and_b32 v205, s89, v190
 v_lshlrev_b32 v206, 16, v191
 s_add_u32 m0, s51, 16384
 s_bfe_u32 s63, s52, 0x40008
 s_lshl_b32 s63, s63, 17
 s_add_u32 s63, s63, s58
 v_mfma_f32_16x16x32_bf16 v[148:151], v[28:31], v[52:55], v[148:151]
 buffer_load_dwordx4 v11, s[20:23], s63 offen lds
 v_and_b32 v207, s89, v191
 v_mfma_f32_16x16x32_bf16 v[144:147], v[24:27], v[52:55], v[144:147]
 s_waitcnt lgkmcnt(0)
 s_and_b64 s[72:73], s[72:73], s[74:75]
 s_and_b64 s[76:77], s[76:77], s[78:79]
 s_and_b64 s[72:73], s[72:73], s[76:77]
 s_and_b32 s72, s72, s73
 s_cmp_eq_u32 s72, 0x1010101
 s_cbranch_scc0 Lsp_183
Lok_184:
 s_waitcnt vmcnt(10) lgkmcnt(0)
 s_barrier
 v_mfma_f32_16x16x32_bf16 v[96:99], v[56:59], v[72:75], v[96:99]
 ds_read_b128 v[40:43], v2 offset:0
 v_mfma_f32_16x16x32_bf16 v[100:103], v[60:63], v[72:75], v[100:103]
 ds_read_b64_tr_b16 v[24:25], v6 offset:32768
 v_mfma_f32_16x16x32_bf16 v[104:107], v[64:67], v[72:75], v[104:107]
 ds_read_b64_tr_b16 v[26:27], v6 offset:36864
 v_mfma_f32_16x16x32_bf16 v[108:111], v[68:71], v[72:75], v[108:111]
 ds_read_b64_tr_b16 v[28:29], v7 offset:32768
 s_add_u32 m0, s50, 81920
 s_bfe_u32 s62, s52, 0x4000c
 s_lshl_b32 s62, s62, 15
 s_add_u32 s62, s62, s57
 v_mfma_f32_16x16x32_bf16 v[124:127], v[68:71], v[76:79], v[124:127]
 ds_read_b64_tr_b16 v[30:31], v7 offset:36864
 buffer_load_dwordx4 v0, s[8:11], s62 offen offset:0 sc1 lds
 v_mfma_f32_16x16x32_bf16 v[120:123], v[64:67], v[76:79], v[120:123]
 ds_read_b128 v[44:47], v2 offset:1024
 v_mfma_f32_16x16x32_bf16 v[116:119], v[60:63], v[76:79], v[116:119]
 ds_read_b64_tr_b16 v[32:33], v8 offset:32768
 v_mfma_f32_16x16x32_bf16 v[112:115], v[56:59], v[76:79], v[112:115]
 ds_read_b64_tr_b16 v[34:35], v8 offset:36864
 v_mfma_f32_16x16x32_bf16 v[128:131], v[56:59], v[80:83], v[128:131]
 ds_read_b128 v[48:51], v3 offset:0
 v_mfma_f32_16x16x32_bf16 v[132:135], v[60:63], v[80:83], v[132:135]
 ds_read_b64_tr_b16 v[36:37], v9 offset:32768
 buffer_load_dwordx4 v0, s[8:11], s62 offen offset:1024 sc1 lds
 v_mfma_f32_16x16x32_bf16 v[136:139], v[64:67], v[80:83], v[136:139]
 ds_read_b64_tr_b16 v[38:39], v9 offset:36864
 v_mfma_f32_16x16x32_bf16 v[140:143], v[68:71], v[80:83], v[140:143]
 ds_read_b128 v[52:55], v3 offset:1024
 v_mfma_f32_16x16x32_bf16 v[156:159], v[68:71], v[84:87], v[156:159]
 s_add_u32 m0, s51, 24576
 s_bfe_u32 s63, s52, 0x4000c
 s_lshl_b32 s63, s63, 17
 s_add_u32 s63, s63, s58
 v_mfma_f32_16x16x32_bf16 v[152:155], v[64:67], v[84:87], v[152:155]
 buffer_load_dwordx4 v11, s[20:23], s63 offen lds
 v_mfma_f32_16x16x32_bf16 v[148:151], v[60:63], v[84:87], v[148:151]
 v_mfma_f32_16x16x32_bf16 v[144:147], v[56:59], v[84:87], v[144:147]
 s_waitcnt vmcnt(11) lgkmcnt(0)
 s_barrier
 v_mfma_f32_16x16x32_bf16 v[96:99], v[24:27], v[40:43], v[96:99]
 ds_read_b128 v[72:75], v2 offset:16384
 v_mfma_f32_16x16x32_bf16 v[100:103], v[28:31], v[40:43], v[100:103]
 ds_read_b64_tr_b16 v[56:57], v6 offset:40960
 v_mfma_f32_16x16x32_bf16 v[104:107], v[32:35], v[40:43], v[104:107]
 ds_read_b64_tr_b16 v[58:59], v6 offset:45056
 v_mfma_f32_16x16x32_bf16 v[108:111], v[36:39], v[40:43], v[108:111]
 ds_read_b64_tr_b16 v[60:61], v7 offset:40960
 s_add_u32 m0, s50, 0
 s_bfe_u32 s62, s52, 0x40010
 s_lshl_b32 s62, s62, 15
 s_add_u32 s62, s62, s57
 v_mfma_f32_16x16x32_bf16 v[124:127], v[36:39], v[44:47], v[124:127]
 ds_read_b64_tr_b16 v[62:63], v7 offset:45056
 buffer_load_dwordx4 v0, s[8:11], s62 offen offset:0 sc1 lds
 v_mfma_f32_16x16x32_bf16 v[120:123], v[32:35], v[44:47], v[120:123]
 ds_read_b128 v[76:79], v2 offset:17408
 v_mfma_f32_16x16x32_bf16 v[116:119], v[28:31], v[44:47], v[116:119]
 ds_read_b64_tr_b16 v[64:65], v8 offset:40960
 v_mfma_f32_16x16x32_bf16 v[112:115], v[24:27], v[44:47], v[112:115]
 ds_read_b64_tr_b16 v[66:67], v8 offset:45056
 v_mfma_f32_16x16x32_bf16 v[128:131], v[24:27], v[48:51], v[128:131]
 ds_read_b128 v[80:83], v3 offset:16384
 v_mfma_f32_16x16x32_bf16 v[132:135], v[28:31], v[48:51], v[132:135]
 ds_read_b64_tr_b16 v[68:69], v9 offset:40960
 buffer_load_dwordx4 v0, s[8:11], s62 offen offset:1024 sc1 lds
 v_mfma_f32_16x16x32_bf16 v[136:139], v[32:35], v[48:51], v[136:139]
 ds_read_b64_tr_b16 v[70:71], v9 offset:45056
 v_mfma_f32_16x16x32_bf16 v[140:143], v[36:39], v[48:51], v[140:143]
 ds_read_b128 v[84:87], v3 offset:17408
 v_mfma_f32_16x16x32_bf16 v[156:159], v[36:39], v[52:55], v[156:159]
 s_add_u32 m0, s51, 32768
 s_bfe_u32 s63, s52, 0x40010
 s_lshl_b32 s63, s63, 17
 s_add_u32 s63, s63, s58
 v_mfma_f32_16x16x32_bf16 v[152:155], v[32:35], v[52:55], v[152:155]
 buffer_load_dwordx4 v11, s[20:23], s63 offen lds
 v_mfma_f32_16x16x32_bf16 v[148:151], v[28:31], v[52:55], v[148:151]
 v_mfma_f32_16x16x32_bf16 v[144:147], v[24:27], v[52:55], v[144:147]
 s_waitcnt vmcnt(12) lgkmcnt(0)
 s_barrier
 v_mfma_f32_16x16x32_bf16 v[96:99], v[56:59], v[72:75], v[96:99]
 ds_read_b128 v[40:43], v15 offset:32768
 v_mfma_f32_16x16x32_bf16 v[100:103], v[60:63], v[72:75], v[100:103]
 ds_read_b64_tr_b16 v[24:25], v6 offset:0
 v_mfma_f32_16x16x32_bf16 v[104:107], v[64:67], v[72:75], v[104:107]
 ds_read_b64_tr_b16 v[26:27], v6 offset:4096
 v_mfma_f32_16x16x32_bf16 v[108:111], v[68:71], v[72:75], v[108:111]
 ds_read_b64_tr_b16 v[28:29], v7 offset:0
 s_add_u32 m0, s50, 16384
 s_bfe_u32 s62, s52, 0x40014
 s_lshl_b32 s62, s62, 15
 s_add_u32 s62, s62, s57
 v_mfma_f32_16x16x32_bf16 v[124:127], v[68:71], v[76:79], v[124:127]
 ds_read_b64_tr_b16 v[30:31], v7 offset:4096
 buffer_load_dwordx4 v0, s[8:11], s62 offen offset:0 sc1 lds
 v_mfma_f32_16x16x32_bf16 v[120:123], v[64:67], v[76:79], v[120:123]
 ds_read_b128 v[44:47], v15 offset:33792
 v_mfma_f32_16x16x32_bf16 v[116:119], v[60:63], v[76:79], v[116:119]
 ds_read_b64_tr_b16 v[32:33], v8 offset:0
 v_mfma_f32_16x16x32_bf16 v[112:115], v[56:59], v[76:79], v[112:115]
 ds_read_b64_tr_b16 v[34:35], v8 offset:4096
 v_mfma_f32_16x16x32_bf16 v[128:131], v[56:59], v[80:83], v[128:131]
 ds_read_b128 v[48:51], v15 offset:40960
 v_mfma_f32_16x16x32_bf16 v[132:135], v[60:63], v[80:83], v[132:135]
 ds_read_b64_tr_b16 v[36:37], v9 offset:0
 buffer_load_dwordx4 v0, s[8:11], s62 offen offset:1024 sc1 lds
 v_mfma_f32_16x16x32_bf16 v[136:139], v[64:67], v[80:83], v[136:139]
 ds_read_b64_tr_b16 v[38:39], v9 offset:4096
 v_mfma_f32_16x16x32_bf16 v[140:143], v[68:71], v[80:83], v[140:143]
 ds_read_b128 v[52:55], v15 offset:41984
 v_mfma_f32_16x16x32_bf16 v[156:159], v[68:71], v[84:87], v[156:159]
 s_add_u32 m0, s51, 40960
 s_bfe_u32 s63, s52, 0x40014
 s_lshl_b32 s63, s63, 17
 s_add_u32 s63, s63, s58
 v_mfma_f32_16x16x32_bf16 v[152:155], v[64:67], v[84:87], v[152:155]
 buffer_load_dwordx4 v11, s[20:23], s63 offen lds
 v_mfma_f32_16x16x32_bf16 v[148:151], v[60:63], v[84:87], v[148:151]
 v_mfma_f32_16x16x32_bf16 v[144:147], v[56:59], v[84:87], v[144:147]
 s_waitcnt vmcnt(12) lgkmcnt(0)
 s_barrier
 v_mfma_f32_16x16x32_bf16 v[96:99], v[24:27], v[40:43], v[96:99]
 ds_read_b128 v[72:75], v15 offset:49152
 ds_read_b64_tr_b16 v[56:57], v6 offset:8192
 v_cvt_pk_bf16_f32 v104, v104, v105
 v_cvt_pk_bf16_f32 v105, v106, v107
 v_cvt_pk_bf16_f32 v106, v108, v109
 v_cvt_pk_bf16_f32 v107, v110, v111
 s_xor_b32 s85, s4, 1
 s_mul_i32 s85, s85, 49152
 s_add_u32 s85, s85, s60
 v_mfma_f32_16x16x32_bf16 v[100:103], v[28:31], v[40:43], v[100:103]
 ds_read_b64_tr_b16 v[58:59], v6 offset:12288
 ds_read_b64_tr_b16 v[60:61], v7 offset:8192
 buffer_store_dwordx4 v[104:107], v13, s[8:11], s85 offen offset:0 sc1
 v_cvt_pk_bf16_f32 v120, v120, v121
 v_cvt_pk_bf16_f32 v121, v122, v123
 v_cvt_pk_bf16_f32 v122, v124, v125
 v_cvt_pk_bf16_f32 v123, v126, v127
 s_xor_b32 s85, s4, 1
 v_mfma_f32_16x16x32_bf16 v[116:119], v[28:31], v[44:47], v[116:119]
 ds_read_b64_tr_b16 v[62:63], v7 offset:12288
 ds_read_b128 v[76:79], v15 offset:50176
 s_mul_i32 s85, s85, 49152
 s_add_u32 s85, s85, s60
 buffer_store_dwordx4 v[120:123], v13, s[8:11], s85 offen offset:1024 sc1
 v_cvt_pk_bf16_f32 v128, v128, v129
 v_cvt_pk_bf16_f32 v129, v130, v131
 v_cvt_pk_bf16_f32 v130, v132, v133
 v_cvt_pk_bf16_f32 v131, v134, v135
 v_mfma_f32_16x16x32_bf16 v[112:115], v[24:27], v[44:47], v[112:115]
 ds_read_b64_tr_b16 v[64:65], v8 offset:8192
 ds_read_b64_tr_b16 v[66:67], v8 offset:12288
 s_xor_b32 s85, s4, 2
 s_mul_i32 s85, s85, 49152
 s_add_u32 s85, s85, s60
 s_add_u32 s85, s85, 16384
 buffer_store_dwordx4 v[128:131], v13, s[8:11], s85 offen offset:0 sc1
 v_cvt_pk_bf16_f32 v144, v144, v145
 v_mfma_f32_16x16x32_bf16 v[96:99], v[32:35], v[48:51], v[96:99]
 ds_read_b128 v[80:83], v15 offset:57344
 ds_read_b64_tr_b16 v[68:69], v9 offset:8192
 v_cvt_pk_bf16_f32 v145, v146, v147
 v_cvt_pk_bf16_f32 v146, v148, v149
 v_cvt_pk_bf16_f32 v147, v150, v151
 s_xor_b32 s85, s4, 2
 s_mul_i32 s85, s85, 49152
 s_add_u32 s85, s85, s60
 s_add_u32 s85, s85, 16384
 v_mfma_f32_16x16x32_bf16 v[100:103], v[36:39], v[48:51], v[100:103]
 ds_read_b64_tr_b16 v[70:71], v9 offset:12288
 ds_read_b128 v[84:87], v15 offset:58368
 buffer_store_dwordx4 v[144:147], v13, s[8:11], s85 offen offset:1024 sc1
 v_cvt_pk_bf16_f32 v136, v136, v137
 v_cvt_pk_bf16_f32 v137, v138, v139
 v_cvt_pk_bf16_f32 v138, v140, v141
 v_cvt_pk_bf16_f32 v139, v142, v143
 s_xor_b32 s85, s4, 3
 v_mfma_f32_16x16x32_bf16 v[116:119], v[36:39], v[52:55], v[116:119]
 s_mul_i32 s85, s85, 49152
 s_add_u32 s85, s85, s60
 s_add_u32 s85, s85, 32768
 buffer_store_dwordx4 v[136:139], v13, s[8:11], s85 offen offset:0 sc1
 v_cvt_pk_bf16_f32 v152, v152, v153
 v_cvt_pk_bf16_f32 v153, v154, v155
 v_cvt_pk_bf16_f32 v154, v156, v157
 v_mfma_f32_16x16x32_bf16 v[112:115], v[32:35], v[52:55], v[112:115]
 v_cvt_pk_bf16_f32 v155, v158, v159
 s_xor_b32 s85, s4, 3
 s_mul_i32 s85, s85, 49152
 s_add_u32 s85, s85, s60
 s_add_u32 s85, s85, 32768
 buffer_store_dwordx4 v[152:155], v13, s[8:11], s85 offen offset:1024 sc1
 s_waitcnt vmcnt(6) lgkmcnt(0)
 s_barrier
 v_mfma_f32_16x16x32_bf16 v[96:99], v[56:59], v[72:75], v[96:99]
 ds_read_b128 v[40:43], v17 offset:0
 ds_read_b64_tr_b16 v[24:25], v6 offset:16384
 v_mfma_f32_16x16x32_bf16 v[100:103], v[60:63], v[72:75], v[100:103]
 ds_read_b64_tr_b16 v[26:27], v6 offset:20480
 ds_read_b64_tr_b16 v[28:29], v7 offset:16384
 v_mfma_f32_16x16x32_bf16 v[116:119], v[60:63], v[76:79], v[116:119]
 ds_read_b64_tr_b16 v[30:31], v7 offset:20480
 ds_read_b128 v[44:47], v17 offset:1024
 v_mfma_f32_16x16x32_bf16 v[112:115], v[56:59], v[76:79], v[112:115]
 ds_read_b64_tr_b16 v[32:33], v8 offset:16384
 ds_read_b64_tr_b16 v[34:35], v8 offset:20480
 v_mfma_f32_16x16x32_bf16 v[96:99], v[64:67], v[80:83], v[96:99]
 ds_read_b128 v[48:51], v17 offset:8192
 ds_read_b64_tr_b16 v[36:37], v9 offset:16384
 v_mfma_f32_16x16x32_bf16 v[100:103], v[68:71], v[80:83], v[100:103]
 ds_read_b64_tr_b16 v[38:39], v9 offset:20480
 ds_read_b128 v[52:55], v17 offset:9216
 v_mfma_f32_16x16x32_bf16 v[116:119], v[68:71], v[84:87], v[116:119]
 v_mfma_f32_16x16x32_bf16 v[112:115], v[64:67], v[84:87], v[112:115]
 s_waitcnt lgkmcnt(0)
 v_mfma_f32_16x16x32_bf16 v[96:99], v[24:27], v[40:43], v[96:99]
 ds_read_b128 v[72:75], v17 offset:16384
 ds_read_b64_tr_b16 v[56:57], v6 offset:24576
 s_xor_b32 s92, s71, 1024
 v_mov_b32 v91, 1
 v_mfma_f32_16x16x32_bf16 v[100:103], v[28:31], v[40:43], v[100:103]
 ds_read_b64_tr_b16 v[58:59], v6 offset:28672
 ds_read_b64_tr_b16 v[60:61], v7 offset:24576
 s_waitcnt vmcnt(4)
 v_mfma_f32_16x16x32_bf16 v[116:119], v[28:31], v[44:47], v[116:119]
 ds_read_b64_tr_b16 v[62:63], v7 offset:28672
 ds_read_b128 v[76:79], v17 offset:17408
 buffer_store_byte v91, off, s[8:11], s92 sc1
 s_xor_b32 s92, s71, 2048
 v_mfma_f32_16x16x32_bf16 v[112:115], v[24:27], v[44:47], v[112:115]
 ds_read_b64_tr_b16 v[64:65], v8 offset:24576
 ds_read_b64_tr_b16 v[66:67], v8 offset:28672
 v_mov_b32 v91, 1
 v_mfma_f32_16x16x32_bf16 v[96:99], v[32:35], v[48:51], v[96:99]
 ds_read_b128 v[80:83], v17 offset:24576
 ds_read_b64_tr_b16 v[68:69], v9 offset:24576
 s_waitcnt vmcnt(3)
 buffer_store_byte v91, off, s[8:11], s92 offset:1 sc1
 v_mfma_f32_16x16x32_bf16 v[100:103], v[36:39], v[48:51], v[100:103]
 ds_read_b64_tr_b16 v[70:71], v9 offset:28672
 ds_read_b128 v[84:87], v17 offset:25600
 s_xor_b32 s92, s71, 3072
 v_mfma_f32_16x16x32_bf16 v[116:119], v[36:39], v[52:55], v[116:119]
 v_mov_b32 v91, 1
 s_waitcnt vmcnt(2)
 v_mfma_f32_16x16x32_bf16 v[112:115], v[32:35], v[52:55], v[112:115]
 buffer_store_byte v91, off, s[8:11], s92 offset:2 sc1
 s_waitcnt lgkmcnt(0)
 v_mfma_f32_16x16x32_bf16 v[96:99], v[56:59], v[72:75], v[96:99]
 ds_read_b128 v[40:43], v15 offset:0
 ds_read_b64_tr_b16 v[24:25], v6 offset:32768
 v_mfma_f32_16x16x32_bf16 v[100:103], v[60:63], v[72:75], v[100:103]
 ds_read_b64_tr_b16 v[26:27], v6 offset:36864
 ds_read_b64_tr_b16 v[28:29], v7 offset:32768
 v_mfma_f32_16x16x32_bf16 v[116:119], v[60:63], v[76:79], v[116:119]
 ds_read_b64_tr_b16 v[30:31], v7 offset:36864
 ds_read_b128 v[44:47], v15 offset:1024
 v_mfma_f32_16x16x32_bf16 v[112:115], v[56:59], v[76:79], v[112:115]
 ds_read_b64_tr_b16 v[32:33], v8 offset:32768
 ds_read_b64_tr_b16 v[34:35], v8 offset:36864
 v_mfma_f32_16x16x32_bf16 v[96:99], v[64:67], v[80:83], v[96:99]
 ds_read_b128 v[48:51], v15 offset:8192
 ds_read_b64_tr_b16 v[36:37], v9 offset:32768
 v_mfma_f32_16x16x32_bf16 v[100:103], v[68:71], v[80:83], v[100:103]
 ds_read_b64_tr_b16 v[38:39], v9 offset:36864
 ds_read_b128 v[52:55], v15 offset:9216
 v_mfma_f32_16x16x32_bf16 v[116:119], v[68:71], v[84:87], v[116:119]
 v_mfma_f32_16x16x32_bf16 v[112:115], v[64:67], v[84:87], v[112:115]
 s_waitcnt lgkmcnt(0)
 v_mfma_f32_16x16x32_bf16 v[96:99], v[24:27], v[40:43], v[96:99]
 ds_read_b128 v[72:75], v15 offset:16384
 ds_read_b64_tr_b16 v[56:57], v6 offset:40960
 v_mfma_f32_16x16x32_bf16 v[100:103], v[28:31], v[40:43], v[100:103]
 ds_read_b64_tr_b16 v[58:59], v6 offset:45056
 ds_read_b64_tr_b16 v[60:61], v7 offset:40960
 v_mfma_f32_16x16x32_bf16 v[116:119], v[28:31], v[44:47], v[116:119]
 ds_read_b64_tr_b16 v[62:63], v7 offset:45056
 ds_read_b128 v[76:79], v15 offset:17408
 v_mfma_f32_16x16x32_bf16 v[112:115], v[24:27], v[44:47], v[112:115]
 ds_read_b64_tr_b16 v[64:65], v8 offset:40960
 ds_read_b64_tr_b16 v[66:67], v8 offset:45056
 v_mfma_f32_16x16x32_bf16 v[96:99], v[32:35], v[48:51], v[96:99]
 ds_read_b128 v[80:83], v15 offset:24576
 ds_read_b64_tr_b16 v[68:69], v9 offset:40960
 v_mfma_f32_16x16x32_bf16 v[100:103], v[36:39], v[48:51], v[100:103]
 ds_read_b64_tr_b16 v[70:71], v9 offset:45056
 ds_read_b128 v[84:87], v15 offset:25600
 v_mfma_f32_16x16x32_bf16 v[116:119], v[36:39], v[52:55], v[116:119]
 v_mfma_f32_16x16x32_bf16 v[112:115], v[32:35], v[52:55], v[112:115]
 s_waitcnt lgkmcnt(0)
 v_mfma_f32_16x16x32_bf16 v[96:99], v[56:59], v[72:75], v[96:99]
 s_buffer_load_dword s72, s[8:11], s71 glc
 v_mfma_f32_16x16x32_bf16 v[100:103], v[60:63], v[72:75], v[100:103]
 v_mfma_f32_16x16x32_bf16 v[116:119], v[60:63], v[76:79], v[116:119]
 v_mfma_f32_16x16x32_bf16 v[112:115], v[56:59], v[76:79], v[112:115]
 v_mfma_f32_16x16x32_bf16 v[96:99], v[64:67], v[80:83], v[96:99]
 v_mfma_f32_16x16x32_bf16 v[100:103], v[68:71], v[80:83], v[100:103]
 v_mfma_f32_16x16x32_bf16 v[116:119], v[68:71], v[84:87], v[116:119]
 v_mfma_f32_16x16x32_bf16 v[112:115], v[64:67], v[84:87], v[112:115]
 s_waitcnt lgkmcnt(0)
 s_cmp_eq_u32 s72, 0x10101
 s_cbranch_scc0 Lsp_186
Lok_187:
 s_mul_i32 s85, s4, 49152
 s_add_u32 s85, s85, s60
 buffer_load_dwordx4 v[160:163], v13, s[8:11], s85 offen offset:0 sc1
 buffer_load_dwordx4 v[164:167], v13, s[8:11], s85 offen offset:1024 sc1
 s_mul_i32 s85, s4, 49152
 s_add_u32 s85, s85, s60
 s_add_u32 s85, s85, 16384
 buffer_load_dwordx4 v[168:171], v13, s[8:11], s85 offen offset:0 sc1
 buffer_load_dwordx4 v[172:175], v13, s[8:11], s85 offen offset:1024 sc1
 s_mul_i32 s85, s4, 49152
 s_add_u32 s85, s85, s60
 s_add_u32 s85, s85, 32768
 buffer_load_dwordx4 v[176:179], v13, s[8:11], s85 offen offset:0 sc1
 buffer_load_dwordx4 v[180:183], v13, s[8:11], s85 offen offset:1024 sc1
 s_waitcnt vmcnt(4)
 v_lshlrev_b32 v208, 16, v160
 v_and_b32 v209, s89, v160
 v_add_f32 v192, v192, v208
 v_add_f32 v193, v193, v209
 v_lshlrev_b32 v210, 16, v161
 v_and_b32 v211, s89, v161
 v_add_f32 v194, v194, v210
 v_add_f32 v195, v195, v211
 v_lshlrev_b32 v208, 16, v162
 v_and_b32 v209, s89, v162
 v_add_f32 v196, v196, v208
 v_add_f32 v197, v197, v209
 v_lshlrev_b32 v210, 16, v163
 v_and_b32 v211, s89, v163
 v_add_f32 v198, v198, v210
 v_add_f32 v199, v199, v211
 v_lshlrev_b32 v208, 16, v164
 v_and_b32 v209, s89, v164
 v_add_f32 v200, v200, v208
 v_add_f32 v201, v201, v209
 v_lshlrev_b32 v210, 16, v165
 v_and_b32 v211, s89, v165
 v_add_f32 v202, v202, v210
 v_add_f32 v203, v203, v211
 v_lshlrev_b32 v208, 16, v166
 v_and_b32 v209, s89, v166
 v_add_f32 v204, v204, v208
 v_add_f32 v205, v205, v209
 v_lshlrev_b32 v210, 16, v167
 v_and_b32 v211, s89, v167
 v_add_f32 v206, v206, v210
 v_add_f32 v207, v207, v211
 s_waitcnt vmcnt(2)
 v_lshlrev_b32 v208, 16, v168
 v_and_b32 v209, s89, v168
 v_add_f32 v192, v192, v208
 v_add_f32 v193, v193, v209
 v_lshlrev_b32 v210, 16, v169
 v_and_b32 v211, s89, v169
 v_add_f32 v194, v194, v210
 v_add_f32 v195, v195, v211
 v_lshlrev_b32 v208, 16, v170
 v_and_b32 v209, s89, v170
 v_add_f32 v196, v196, v208
 v_add_f32 v197, v197, v209
 v_lshlrev_b32 v210, 16, v171
 v_and_b32 v211, s89, v171
 v_add_f32 v198, v198, v210
 v_add_f32 v199, v199, v211
 v_lshlrev_b32 v208, 16, v172
 v_and_b32 v209, s89, v172
 v_add_f32 v200, v200, v208
 v_add_f32 v201, v201, v209
 v_lshlrev_b32 v210, 16, v173
 v_and_b32 v211, s89, v173
 v_add_f32 v202, v202, v210
 v_add_f32 v203, v203, v211
 v_lshlrev_b32 v208, 16, v174
 v_and_b32 v209, s89, v174
 v_add_f32 v204, v204, v208
 v_add_f32 v205, v205, v209
 v_lshlrev_b32 v210, 16, v175
 v_and_b32 v211, s89, v175
 v_add_f32 v206, v206, v210
 v_add_f32 v207, v207, v211
 s_waitcnt vmcnt(0)
 v_lshlrev_b32 v208, 16, v176
 v_and_b32 v209, s89, v176
 v_add_f32 v192, v192, v208
 v_add_f32 v193, v193, v209
 v_lshlrev_b32 v210, 16, v177
 v_and_b32 v211, s89, v177
 v_add_f32 v194, v194, v210
 v_add_f32 v195, v195, v211
 v_lshlrev_b32 v208, 16, v178
 v_and_b32 v209, s89, v178
 v_add_f32 v196, v196, v208
 v_add_f32 v197, v197, v209
 v_lshlrev_b32 v210, 16, v179
 v_and_b32 v211, s89, v179
 v_add_f32 v198, v198, v210
 v_add_f32 v199, v199, v211
 v_lshlrev_b32 v208, 16, v180
 v_and_b32 v209, s89, v180
 v_add_f32 v200, v200, v208
 v_add_f32 v201, v201, v209
 v_lshlrev_b32 v210, 16, v181
 v_and_b32 v211, s89, v181
 v_add_f32 v202, v202, v210
 v_add_f32 v203, v203, v211
 v_lshlrev_b32 v208, 16, v182
 v_and_b32 v209, s89, v182
 v_add_f32 v204, v204, v208
 v_add_f32 v205, v205, v209
 v_lshlrev_b32 v210, 16, v183
 v_and_b32 v211, s89, v183
 v_add_f32 v206, v206, v210
 v_add_f32 v207, v207, v211
 v_add_f32 v96, v96, v192
 v_add_f32 v97, v97, v193
 v_add_f32 v98, v98, v194
 v_add_f32 v99, v99, v195
 v_add_f32 v100, v100, v196
 v_add_f32 v101, v101, v197
 v_add_f32 v102, v102, v198
 v_add_f32 v103, v103, v199
 v_cvt_pk_bf16_f32 v96, v96, v97
 v_cvt_pk_bf16_f32 v97, v98, v99
 v_cvt_pk_bf16_f32 v98, v100, v101
 v_cvt_pk_bf16_f32 v99, v102, v103
 s_nop 0
 v_permlane16_swap_b32 v96, v98
 v_permlane16_swap_b32 v97, v99
 buffer_store_dwordx4 v[96:99], v94, s[28:31], s61 offen
 v_add_f32 v112, v112, v200
 v_add_f32 v113, v113, v201
 v_add_f32 v114, v114, v202
 v_add_f32 v115, v115, v203
 v_add_f32 v116, v116, v204
 v_add_f32 v117, v117, v205
 v_add_f32 v118, v118, v206
 v_add_f32 v119, v119, v207
 v_cvt_pk_bf16_f32 v112, v112, v113
 v_cvt_pk_bf16_f32 v113, v114, v115
 v_cvt_pk_bf16_f32 v114, v116, v117
 v_cvt_pk_bf16_f32 v115, v118, v119
 s_nop 0
 v_permlane16_swap_b32 v112, v114
 v_permlane16_swap_b32 v113, v115
 buffer_store_dwordx4 v[112:115], v94, s[28:31], s66 offen
 s_endpgm
Lsp_183:
 s_mov_b32 s95, 0
Llp_185:
 s_buffer_load_dwordx2 s[72:73], s[8:11], s64 offset:0 glc
 s_buffer_load_dwordx2 s[74:75], s[8:11], s64 offset:512 glc
 s_buffer_load_dwordx2 s[76:77], s[8:11], s64 offset:1024 glc
 s_buffer_load_dwordx2 s[78:79], s[8:11], s64 offset:1536 glc
 s_waitcnt lgkmcnt(0)
 s_add_u32 s95, s95, 1
 s_and_b64 s[72:73], s[72:73], s[74:75]
 s_and_b64 s[76:77], s[76:77], s[78:79]
 s_and_b64 s[72:73], s[72:73], s[76:77]
 s_and_b32 s72, s72, s73
 s_cmp_eq_u32 s72, 0x1010101
 s_cbranch_scc1 Lok_184
 s_cmp_lt_u32 s95, 0x40000
 s_cbranch_scc1 Llp_185
 s_branch Lok_184
Lsp_186:
 s_mov_b32 s95, 0
Llp_188:
 s_buffer_load_dword s72, s[8:11], s71 glc
 s_waitcnt lgkmcnt(0)
 s_add_u32 s95, s95, 1
 s_cmp_eq_u32 s72, 0x10101
 s_cbranch_scc1 Lok_187
 s_cmp_lt_u32 s95, 0x40000
 s_cbranch_scc1 Llp_188
 s_branch Lok_187
L5_v10:
 s_xor_b32 s52, s52, s96
 s_waitcnt vmcnt(17) lgkmcnt(0)
 s_barrier
 v_mfma_f32_16x16x32_bf16 v[96:99], v[24:27], v[40:43], v[96:99]
 ds_read_b128 v[72:75], v2 offset:16384
 v_mfma_f32_16x16x32_bf16 v[100:103], v[28:31], v[40:43], v[100:103]
 ds_read_b64_tr_b16 v[56:57], v6 offset:40960
 v_mfma_f32_16x16x32_bf16 v[104:107], v[32:35], v[40:43], v[104:107]
 ds_read_b64_tr_b16 v[58:59], v6 offset:45056
 v_mfma_f32_16x16x32_bf16 v[108:111], v[36:39], v[40:43], v[108:111]
 ds_read_b64_tr_b16 v[60:61], v7 offset:40960
 v_mfma_f32_16x16x32_bf16 v[124:127], v[36:39], v[44:47], v[124:127]
 ds_read_b64_tr_b16 v[62:63], v7 offset:45056
 v_mfma_f32_16x16x32_bf16 v[120:123], v[32:35], v[44:47], v[120:123]
 ds_read_b128 v[76:79], v2 offset:17408
 v_mfma_f32_16x16x32_bf16 v[116:119], v[28:31], v[44:47], v[116:119]
 ds_read_b64_tr_b16 v[64:65], v8 offset:40960
 v_mfma_f32_16x16x32_bf16 v[112:115], v[24:27], v[44:47], v[112:115]
 ds_read_b64_tr_b16 v[66:67], v8 offset:45056
 v_mfma_f32_16x16x32_bf16 v[128:131], v[24:27], v[48:51], v[128:131]
 ds_read_b128 v[80:83], v3 offset:16384
 s_add_u32 m0, s51, 32768
 s_add_u32 s63, s6, 0
 s_and_b32 s63, s63, 7
 s_mul_i32 s63, s63, 65536
 s_add_u32 s63, s63, s65
 v_mfma_f32_16x16x32_bf16 v[132:135], v[28:31], v[48:51], v[132:135]
 ds_read_b64_tr_b16 v[68:69], v9 offset:40960
 buffer_load_dwordx4 v10, s[20:23], s63 offen lds
 v_mfma_f32_16x16x32_bf16 v[136:139], v[32:35], v[48:51], v[136:139]
 ds_read_b64_tr_b16 v[70:71], v9 offset:45056
 v_mfma_f32_16x16x32_bf16 v[140:143], v[36:39], v[48:51], v[140:143]
 ds_read_b128 v[84:87], v3 offset:17408
 v_mfma_f32_16x16x32_bf16 v[156:159], v[36:39], v[52:55], v[156:159]
 v_mfma_f32_16x16x32_bf16 v[152:155], v[32:35], v[52:55], v[152:155]
 v_mfma_f32_16x16x32_bf16 v[148:151], v[28:31], v[52:55], v[148:151]
 v_mfma_f32_16x16x32_bf16 v[144:147], v[24:27], v[52:55], v[144:147]
 s_waitcnt vmcnt(14) lgkmcnt(0)
 s_barrier
 v_mfma_f32_16x16x32_bf16 v[96:99], v[56:59], v[72:75], v[96:99]
 ds_read_b128 v[40:43], v2 offset:32768
 v_and_b32 v94, 15, v1
 v_mfma_f32_16x16x32_bf16 v[100:103], v[60:63], v[72:75], v[100:103]
 ds_read_b64_tr_b16 v[24:25], v6 offset:0
 v_mfma_f32_16x16x32_bf16 v[104:107], v[64:67], v[72:75], v[104:107]
 ds_read_b64_tr_b16 v[26:27], v6 offset:4096
 v_lshlrev_b32 v94, 11, v94
 v_mfma_f32_16x16x32_bf16 v[108:111], v[68:71], v[72:75], v[108:111]
 ds_read_b64_tr_b16 v[28:29], v7 offset:0
 v_mfma_f32_16x16x32_bf16 v[124:127], v[68:71], v[76:79], v[124:127]
 ds_read_b64_tr_b16 v[30:31], v7 offset:4096
 v_bfe_u32 v92, v1, 4, 1
 v_mfma_f32_16x16x32_bf16 v[120:123], v[64:67], v[76:79], v[120:123]
 ds_read_b128 v[44:47], v2 offset:33792
 v_mfma_f32_16x16x32_bf16 v[116:119], v[60:63], v[76:79], v[116:119]
 ds_read_b64_tr_b16 v[32:33], v8 offset:0
 v_lshl_add_u32 v94, v92, 5, v94
 v_mfma_f32_16x16x32_bf16 v[112:115], v[56:59], v[76:79], v[112:115]
 ds_read_b64_tr_b16 v[34:35], v8 offset:4096
 v_mfma_f32_16x16x32_bf16 v[128:131], v[56:59], v[80:83], v[128:131]
 ds_read_b128 v[48:51], v3 offset:32768
 v_lshrrev_b32 v92, 5, v1
 s_add_u32 m0, s51, 40960
 s_add_u32 s63, s6, 1
 s_and_b32 s63, s63, 7
 s_mul_i32 s63, s63, 65536
 s_add_u32 s63, s63, s65
 v_mfma_f32_16x16x32_bf16 v[132:135], v[60:63], v[80:83], v[132:135]
 ds_read_b64_tr_b16 v[36:37], v9 offset:0
 buffer_load_dwordx4 v10, s[20:23], s63 offen lds
 v_mfma_f32_16x16x32_bf16 v[136:139], v[64:67], v[80:83], v[136:139]
 ds_read_b64_tr_b16 v[38:39], v9 offset:4096
 v_lshl_add_u32 v94, v92, 4, v94
 v_mfma_f32_16x16x32_bf16 v[140:143], v[68:71], v[80:83], v[140:143]
 ds_read_b128 v[52:55], v3 offset:33792
 v_mfma_f32_16x16x32_bf16 v[156:159], v[68:71], v[84:87], v[156:159]
 buffer_load_dwordx4 v[184:187], v94, s[16:19], s61 offen
 v_mfma_f32_16x16x32_bf16 v[152:155], v[64:67], v[84:87], v[152:155]
 v_mfma_f32_16x16x32_bf16 v[148:151], v[60:63], v[84:87], v[148:151]
 buffer_load_dwordx4 v[188:191], v94, s[16:19], s66 offen
 v_mfma_f32_16x16x32_bf16 v[144:147], v[56:59], v[84:87], v[144:147]
 s_waitcnt vmcnt(11) lgkmcnt(0)
 s_barrier
 v_mfma_f32_16x16x32_bf16 v[96:99], v[24:27], v[40:43], v[96:99]
 ds_read_b128 v[72:75], v2 offset:49152
 v_mfma_f32_16x16x32_bf16 v[100:103], v[28:31], v[40:43], v[100:103]
 ds_read_b64_tr_b16 v[56:57], v6 offset:8192
 v_mfma_f32_16x16x32_bf16 v[104:107], v[32:35], v[40:43], v[104:107]
 ds_read_b64_tr_b16 v[58:59], v6 offset:12288
 v_mfma_f32_16x16x32_bf16 v[108:111], v[36:39], v[40:43], v[108:111]
 ds_read_b64_tr_b16 v[60:61], v7 offset:8192
 v_mfma_f32_16x16x32_bf16 v[124:127], v[36:39], v[44:47], v[124:127]
 ds_read_b64_tr_b16 v[62:63], v7 offset:12288
 v_mfma_f32_16x16x32_bf16 v[120:123], v[32:35], v[44:47], v[120:123]
 ds_read_b128 v[76:79], v2 offset:50176
 v_mfma_f32_16x16x32_bf16 v[116:119], v[28:31], v[44:47], v[116:119]
 ds_read_b64_tr_b16 v[64:65], v8 offset:8192
 v_mfma_f32_16x16x32_bf16 v[112:115], v[24:27], v[44:47], v[112:115]
 ds_read_b64_tr_b16 v[66:67], v8 offset:12288
 v_mfma_f32_16x16x32_bf16 v[128:131], v[24:27], v[48:51], v[128:131]
 ds_read_b128 v[80:83], v3 offset:49152
 s_add_u32 m0, s51, 0
 s_add_u32 s63, s6, 2
 s_and_b32 s63, s63, 7
 s_mul_i32 s63, s63, 65536
 s_add_u32 s63, s63, s65
 v_mfma_f32_16x16x32_bf16 v[132:135], v[28:31], v[48:51], v[132:135]
 ds_read_b64_tr_b16 v[68:69], v9 offset:8192
 buffer_load_dwordx4 v10, s[20:23], s63 offen lds
 v_mfma_f32_16x16x32_bf16 v[136:139], v[32:35], v[48:51], v[136:139]
 ds_read_b64_tr_b16 v[70:71], v9 offset:12288
 v_mfma_f32_16x16x32_bf16 v[140:143], v[36:39], v[48:51], v[140:143]
 ds_read_b128 v[84:87], v3 offset:50176
 v_mfma_f32_16x16x32_bf16 v[156:159], v[36:39], v[52:55], v[156:159]
 v_mfma_f32_16x16x32_bf16 v[152:155], v[32:35], v[52:55], v[152:155]
 v_mfma_f32_16x16x32_bf16 v[148:151], v[28:31], v[52:55], v[148:151]
 v_mfma_f32_16x16x32_bf16 v[144:147], v[24:27], v[52:55], v[144:147]
 s_waitcnt vmcnt(9) lgkmcnt(0)
 s_barrier
 v_mfma_f32_16x16x32_bf16 v[96:99], v[56:59], v[72:75], v[96:99]
 ds_read_b128 v[40:43], v4 offset:0
 v_mfma_f32_16x16x32_bf16 v[100:103], v[60:63], v[72:75], v[100:103]
 ds_read_b64_tr_b16 v[24:25], v6 offset:16384
 v_mfma_f32_16x16x32_bf16 v[104:107], v[64:67], v[72:75], v[104:107]
 ds_read_b64_tr_b16 v[26:27], v6 offset:20480
 s_add_u32 m0, s50, 0
 s_add_u32 s62, s6, 0
 s_and_b32 s62, s62, 7
 s_mul_i32 s62, s62, 16384
 s_add_u32 s62, s62, s54
 v_mfma_f32_16x16x32_bf16 v[108:111], v[68:71], v[72:75], v[108:111]
 ds_read_b64_tr_b16 v[28:29], v7 offset:16384
 buffer_load_dwordx4 v13, s[8:11], s62 offen offset:0 sc1 lds
 v_mfma_f32_16x16x32_bf16 v[124:127], v[68:71], v[76:79], v[124:127]
 ds_read_b64_tr_b16 v[30:31], v7 offset:20480
 v_mfma_f32_16x16x32_bf16 v[120:123], v[64:67], v[76:79], v[120:123]
 ds_read_b128 v[44:47], v4 offset:1024
 buffer_load_dwordx4 v13, s[8:11], s62 offen offset:1024 sc1 lds
 v_mfma_f32_16x16x32_bf16 v[116:119], v[60:63], v[76:79], v[116:119]
 ds_read_b64_tr_b16 v[32:33], v8 offset:16384
 s_add_u32 m0, s50, 16384
 s_add_u32 s62, s6, 1
 s_and_b32 s62, s62, 7
 s_mul_i32 s62, s62, 16384
 s_add_u32 s62, s62, s54
 v_mfma_f32_16x16x32_bf16 v[112:115], v[56:59], v[76:79], v[112:115]
 ds_read_b64_tr_b16 v[34:35], v8 offset:20480
 buffer_load_dwordx4 v13, s[8:11], s62 offen offset:0 sc1 lds
 v_mfma_f32_16x16x32_bf16 v[128:131], v[56:59], v[80:83], v[128:131]
 ds_read_b128 v[48:51], v5 offset:0
 v_mfma_f32_16x16x32_bf16 v[132:135], v[60:63], v[80:83], v[132:135]
 ds_read_b64_tr_b16 v[36:37], v9 offset:16384
 v_mfma_f32_16x16x32_bf16 v[136:139], v[64:67], v[80:83], v[136:139]
 ds_read_b64_tr_b16 v[38:39], v9 offset:20480
 buffer_load_dwordx4 v13, s[8:11], s62 offen offset:1024 sc1 lds
 v_mfma_f32_16x16x32_bf16 v[140:143], v[68:71], v[80:83], v[140:143]
 ds_read_b128 v[52:55], v5 offset:1024
 s_add_u32 m0, s50, 32768
 s_add_u32 s62, s6, 2
 s_and_b32 s62, s62, 7
 s_mul_i32 s62, s62, 16384
 s_add_u32 s62, s62, s54
 v_mfma_f32_16x16x32_bf16 v[156:159], v[68:71], v[84:87], v[156:159]
 buffer_load_dwordx4 v13, s[8:11], s62 offen offset:0 sc1 lds
 v_mfma_f32_16x16x32_bf16 v[152:155], v[64:67], v[84:87], v[152:155]
 v_mfma_f32_16x16x32_bf16 v[148:151], v[60:63], v[84:87], v[148:151]
 buffer_load_dwordx4 v13, s[8:11], s62 offen offset:1024 sc1 lds
 v_mfma_f32_16x16x32_bf16 v[144:147], v[56:59], v[84:87], v[144:147]
 s_waitcnt vmcnt(11) lgkmcnt(0)
 s_barrier
 v_mfma_f32_16x16x32_bf16 v[96:99], v[24:27], v[40:43], v[96:99]
 ds_read_b128 v[72:75], v4 offset:16384
 s_mov_b32 s89, 0xffff0000
 s_waitcnt vmcnt(7)
 v_mfma_f32_16x16x32_bf16 v[100:103], v[28:31], v[40:43], v[100:103]
 ds_read_b64_tr_b16 v[56:57], v6 offset:24576
 v_permlane16_swap_b32 v184, v186
 v_mfma_f32_16x16x32_bf16 v[104:107], v[32:35], v[40:43], v[104:107]
 ds_read_b64_tr_b16 v[58:59], v6 offset:28672
 v_permlane16_swap_b32 v185, v187
 v_permlane16_swap_b32 v188, v190
 s_add_u32 m0, s50, 49152
 s_add_u32 s62, s6, 3
 s_and_b32 s62, s62, 7
 s_mul_i32 s62, s62, 16384
 s_add_u32 s62, s62, s54
 v_mfma_f32_16x16x32_bf16 v[108:111], v[36:39], v[40:43], v[108:111]
 ds_read_b64_tr_b16 v[60:61], v7 offset:24576
 buffer_load_dwordx4 v13, s[8:11], s62 offen offset:0 sc1 lds
 v_permlane16_swap_b32 v189, v191
 v_mfma_f32_16x16x32_bf16 v[124:127], v[36:39], v[44:47], v[124:127]
 ds_read_b64_tr_b16 v[62:63], v7 offset:28672
 v_lshlrev_b32 v192, 16, v184
 v_mfma_f32_16x16x32_bf16 v[120:123], v[32:35], v[44:47], v[120:123]
 ds_read_b128 v[76:79], v4 offset:17408
 buffer_load_dwordx4 v13, s[8:11], s62 offen offset:1024 sc1 lds
 v_and_b32 v193, s89, v184
 v_lshlrev_b32 v194, 16, v185
 v_mfma_f32_16x16x32_bf16 v[116:119], v[28:31], v[44:47], v[116:119]
 ds_read_b64_tr_b16 v[64:65], v8 offset:24576
 v_and_b32 v195, s89, v185
 s_add_u32 m0, s51, 8192
 s_add_u32 s63, s6, 3
 s_and_b32 s63, s63, 7
 s_mul_i32 s63, s63, 65536
 s_add_u32 s63, s63, s65
 v_mfma_f32_16x16x32_bf16 v[112:115], v[24:27], v[44:47], v[112:115]
 ds_read_b64_tr_b16 v[66:67], v8 offset:28672
 buffer_load_dwordx4 v10, s[20:23], s63 offen lds
 v_lshlrev_b32 v196, 16, v186
 v_mfma_f32_16x16x32_bf16 v[128:131], v[24:27], v[48:51], v[128:131]
 ds_read_b128 v[80:83], v5 offset:16384
 v_and_b32 v197, s89, v186
 v_lshlrev_b32 v198, 16, v187
 v_mfma_f32_16x16x32_bf16 v[132:135], v[28:31], v[48:51], v[132:135]
 ds_read_b64_tr_b16 v[68:69], v9 offset:24576
 v_and_b32 v199, s89, v187
 s_add_u32 m0, s50, 65536
 s_add_u32 s62, s6, 4
 s_and_b32 s62, s62, 7
 s_mul_i32 s62, s62, 16384
 s_add_u32 s62, s62, s54
 v_mfma_f32_16x16x32_bf16 v[136:139], v[32:35], v[48:51], v[136:139]
 ds_read_b64_tr_b16 v[70:71], v9 offset:28672
 buffer_load_dwordx4 v13, s[8:11], s62 offen offset:0 sc1 lds
 v_lshlrev_b32 v200, 16, v188
 v_and_b32 v201, s89, v188
 v_mfma_f32_16x16x32_bf16 v[140:143], v[36:39], v[48:51], v[140:143]
 ds_read_b128 v[84:87], v5 offset:17408
 v_lshlrev_b32 v202, 16, v189
 v_mfma_f32_16x16x32_bf16 v[156:159], v[36:39], v[52:55], v[156:159]
 buffer_load_dwordx4 v13, s[8:11], s62 offen offset:1024 sc1 lds
 v_and_b32 v203, s89, v189
 v_mfma_f32_16x16x32_bf16 v[152:155], v[32:35], v[52:55], v[152:155]
 v_lshlrev_b32 v204, 16, v190
 v_and_b32 v205, s89, v190
 s_add_u32 m0, s51, 16384
 s_add_u32 s63, s6, 4
 s_and_b32 s63, s63, 7
 s_mul_i32 s63, s63, 65536
 s_add_u32 s63, s63, s65
 v_mfma_f32_16x16x32_bf16 v[148:151], v[28:31], v[52:55], v[148:151]
 buffer_load_dwordx4 v10, s[20:23], s63 offen lds
 v_lshlrev_b32 v206, 16, v191
 v_mfma_f32_16x16x32_bf16 v[144:147], v[24:27], v[52:55], v[144:147]
 v_and_b32 v207, s89, v191
 s_waitcnt vmcnt(10) lgkmcnt(0)
 s_barrier
 v_mfma_f32_16x16x32_bf16 v[96:99], v[56:59], v[72:75], v[96:99]
 ds_read_b128 v[40:43], v2 offset:0
 v_mfma_f32_16x16x32_bf16 v[100:103], v[60:63], v[72:75], v[100:103]
 ds_read_b64_tr_b16 v[24:25], v6 offset:32768
 v_mfma_f32_16x16x32_bf16 v[104:107], v[64:67], v[72:75], v[104:107]
 ds_read_b64_tr_b16 v[26:27], v6 offset:36864
 v_mfma_f32_16x16x32_bf16 v[108:111], v[68:71], v[72:75], v[108:111]
 ds_read_b64_tr_b16 v[28:29], v7 offset:32768
 s_add_u32 m0, s50, 81920
 s_add_u32 s62, s6, 5
 s_and_b32 s62, s62, 7
 s_mul_i32 s62, s62, 16384
 s_add_u32 s62, s62, s54
 v_mfma_f32_16x16x32_bf16 v[124:127], v[68:71], v[76:79], v[124:127]
 ds_read_b64_tr_b16 v[30:31], v7 offset:36864
 buffer_load_dwordx4 v13, s[8:11], s62 offen offset:0 sc1 lds
 v_mfma_f32_16x16x32_bf16 v[120:123], v[64:67], v[76:79], v[120:123]
 ds_read_b128 v[44:47], v2 offset:1024
 v_mfma_f32_16x16x32_bf16 v[116:119], v[60:63], v[76:79], v[116:119]
 ds_read_b64_tr_b16 v[32:33], v8 offset:32768
 v_mfma_f32_16x16x32_bf16 v[112:115], v[56:59], v[76:79], v[112:115]
 ds_read_b64_tr_b16 v[34:35], v8 offset:36864
 v_mfma_f32_16x16x32_bf16 v[128:131], v[56:59], v[80:83], v[128:131]
 ds_read_b128 v[48:51], v3 offset:0
 v_mfma_f32_16x16x32_bf16 v[132:135], v[60:63], v[80:83], v[132:135]
 ds_read_b64_tr_b16 v[36:37], v9 offset:32768
 buffer_load_dwordx4 v13, s[8:11], s62 offen offset:1024 sc1 lds
 v_mfma_f32_16x16x32_bf16 v[136:139], v[64:67], v[80:83], v[136:139]
 ds_read_b64_tr_b16 v[38:39], v9 offset:36864
 v_mfma_f32_16x16x32_bf16 v[140:143], v[68:71], v[80:83], v[140:143]
 ds_read_b128 v[52:55], v3 offset:1024
 v_mfma_f32_16x16x32_bf16 v[156:159], v[68:71], v[84:87], v[156:159]
 s_add_u32 m0, s51, 24576
 s_add_u32 s63, s6, 5
 s_and_b32 s63, s63, 7
 s_mul_i32 s63, s63, 65536
 s_add_u32 s63, s63, s65
 v_mfma_f32_16x16x32_bf16 v[152:155], v[64:67], v[84:87], v[152:155]
 buffer_load_dwordx4 v10, s[20:23], s63 offen lds
 v_mfma_f32_16x16x32_bf16 v[148:151], v[60:63], v[84:87], v[148:151]
 v_mfma_f32_16x16x32_bf16 v[144:147], v[56:59], v[84:87], v[144:147]
 s_waitcnt vmcnt(11) lgkmcnt(0)
 s_barrier
 v_mfma_f32_16x16x32_bf16 v[96:99], v[24:27], v[40:43], v[96:99]
 ds_read_b128 v[72:75], v2 offset:16384
 v_mfma_f32_16x16x32_bf16 v[100:103], v[28:31], v[40:43], v[100:103]
 ds_read_b64_tr_b16 v[56:57], v6 offset:40960
 v_mfma_f32_16x16x32_bf16 v[104:107], v[32:35], v[40:43], v[104:107]
 ds_read_b64_tr_b16 v[58:59], v6 offset:45056
 v_mfma_f32_16x16x32_bf16 v[108:111], v[36:39], v[40:43], v[108:111]
 ds_read_b64_tr_b16 v[60:61], v7 offset:40960
 s_add_u32 m0, s50, 0
 s_add_u32 s62, s6, 6
 s_and_b32 s62, s62, 7
 s_mul_i32 s62, s62, 16384
 s_add_u32 s62, s62, s54
 v_mfma_f32_16x16x32_bf16 v[124:127], v[36:39], v[44:47], v[124:127]
 ds_read_b64_tr_b16 v[62:63], v7 offset:45056
 buffer_load_dwordx4 v13, s[8:11], s62 offen offset:0 sc1 lds
 v_mfma_f32_16x16x32_bf16 v[120:123], v[32:35], v[44:47], v[120:123]
 ds_read_b128 v[76:79], v2 offset:17408
 v_mfma_f32_16x16x32_bf16 v[116:119], v[28:31], v[44:47], v[116:119]
 ds_read_b64_tr_b16 v[64:65], v8 offset:40960
 s_lshl4_add_u32 s64, s83, s7
 v_mfma_f32_16x16x32_bf16 v[112:115], v[24:27], v[44:47], v[112:115]
 ds_read_b64_tr_b16 v[66:67], v8 offset:45056
 s_lshl_b32 s64, s64, 7
 v_mfma_f32_16x16x32_bf16 v[128:131], v[24:27], v[48:51], v[128:131]
 ds_read_b128 v[80:83], v3 offset:16384
 s_add_u32 s64, s64, 39927808
 v_mfma_f32_16x16x32_bf16 v[132:135], v[28:31], v[48:51], v[132:135]
 ds_read_b64_tr_b16 v[68:69], v9 offset:40960
 buffer_load_dwordx4 v13, s[8:11], s62 offen offset:1024 sc1 lds
 s_buffer_load_dwordx2 s[72:73], s[8:11], s64 offset:0 glc
 s_buffer_load_dwordx2 s[74:75], s[8:11], s64 offset:512 glc
 s_buffer_load_dwordx2 s[76:77], s[8:11], s64 offset:1024 glc
 s_buffer_load_dwordx2 s[78:79], s[8:11], s64 offset:1536 glc
 v_mfma_f32_16x16x32_bf16 v[136:139], v[32:35], v[48:51], v[136:139]
 ds_read_b64_tr_b16 v[70:71], v9 offset:45056
 v_mfma_f32_16x16x32_bf16 v[140:143], v[36:39], v[48:51], v[140:143]
 ds_read_b128 v[84:87], v3 offset:17408
 ds_read_b32 v90, v0
 ds_read_b32 v90, v0
 ds_read_b32 v90, v0
 ds_read_b32 v90, v0
 ds_read_b32 v90, v0
 ds_read_b32 v90, v0
 ds_read_b32 v90, v0
 ds_read_b32 v90, v0
 v_mfma_f32_16x16x32_bf16 v[156:159], v[36:39], v[52:55], v[156:159]
 s_add_u32 m0, s51, 32768
 s_add_u32 s63, s6, 6
 s_and_b32 s63, s63, 7
 s_mul_i32 s63, s63, 65536
 s_add_u32 s63, s63, s65
 v_mfma_f32_16x16x32_bf16 v[152:155], v[32:35], v[52:55], v[152:155]
 buffer_load_dwordx4 v10, s[20:23], s63 offen lds
 v_mfma_f32_16x16x32_bf16 v[148:151], v[28:31], v[52:55], v[148:151]
 v_mfma_f32_16x16x32_bf16 v[144:147], v[24:27], v[52:55], v[144:147]
 s_waitcnt vmcnt(12) lgkmcnt(8)
 s_barrier
 v_mfma_f32_16x16x32_bf16 v[96:99], v[56:59], v[72:75], v[96:99]
 ds_read_b128 v[40:43], v2 offset:32768
 v_mfma_f32_16x16x32_bf16 v[100:103], v[60:63], v[72:75], v[100:103]
 ds_read_b64_tr_b16 v[24:25], v6 offset:0
 v_mfma_f32_16x16x32_bf16 v[104:107], v[64:67], v[72:75], v[104:107]
 ds_read_b64_tr_b16 v[26:27], v6 offset:4096
 v_mfma_f32_16x16x32_bf16 v[108:111], v[68:71], v[72:75], v[108:111]
 ds_read_b64_tr_b16 v[28:29], v7 offset:0
 s_add_u32 m0, s50, 16384
 s_add_u32 s62, s6, 7
 s_and_b32 s62, s62, 7
 s_mul_i32 s62, s62, 16384
 s_add_u32 s62, s62, s54
 v_mfma_f32_16x16x32_bf16 v[124:127], v[68:71], v[76:79], v[124:127]
 ds_read_b64_tr_b16 v[30:31], v7 offset:4096
 buffer_load_dwordx4 v13, s[8:11], s62 offen offset:0 sc1 lds
 v_mfma_f32_16x16x32_bf16 v[120:123], v[64:67], v[76:79], v[120:123]
 ds_read_b128 v[44:47], v2 offset:33792
 v_mfma_f32_16x16x32_bf16 v[116:119], v[60:63], v[76:79], v[116:119]
 ds_read_b64_tr_b16 v[32:33], v8 offset:0
 v_mfma_f32_16x16x32_bf16 v[112:115], v[56:59], v[76:79], v[112:115]
 ds_read_b64_tr_b16 v[34:35], v8 offset:4096
 v_mfma_f32_16x16x32_bf16 v[128:131], v[56:59], v[80:83], v[128:131]
 ds_read_b128 v[48:51], v3 offset:32768
 v_mfma_f32_16x16x32_bf16 v[132:135], v[60:63], v[80:83], v[132:135]
 ds_read_b64_tr_b16 v[36:37], v9 offset:0
 buffer_load_dwordx4 v13, s[8:11], s62 offen offset:1024 sc1 lds
 v_mfma_f32_16x16x32_bf16 v[136:139], v[64:67], v[80:83], v[136:139]
 ds_read_b64_tr_b16 v[38:39], v9 offset:4096
 v_mfma_f32_16x16x32_bf16 v[140:143], v[68:71], v[80:83], v[140:143]
 ds_read_b128 v[52:55], v3 offset:33792
 v_mfma_f32_16x16x32_bf16 v[156:159], v[68:71], v[84:87], v[156:159]
 s_add_u32 m0, s51, 40960
 s_add_u32 s63, s6, 7
 s_and_b32 s63, s63, 7
 s_mul_i32 s63, s63, 65536
 s_add_u32 s63, s63, s65
 v_mfma_f32_16x16x32_bf16 v[152:155], v[64:67], v[84:87], v[152:155]
 buffer_load_dwordx4 v10, s[20:23], s63 offen lds
 v_mfma_f32_16x16x32_bf16 v[148:151], v[60:63], v[84:87], v[148:151]
 v_mfma_f32_16x16x32_bf16 v[144:147], v[56:59], v[84:87], v[144:147]
 s_waitcnt lgkmcnt(0)
 s_and_b64 s[72:73], s[72:73], s[74:75]
 s_and_b64 s[76:77], s[76:77], s[78:79]
 s_and_b64 s[72:73], s[72:73], s[76:77]
 s_and_b32 s72, s72, s73
 s_cmp_eq_u32 s72, 0x1010101
 s_cbranch_scc0 Lsp_189
Lok_190:
 s_waitcnt vmcnt(12) lgkmcnt(0)
 s_barrier
 v_mfma_f32_16x16x32_bf16 v[96:99], v[24:27], v[40:43], v[96:99]
 ds_read_b128 v[72:75], v2 offset:49152
 v_mfma_f32_16x16x32_bf16 v[100:103], v[28:31], v[40:43], v[100:103]
 ds_read_b64_tr_b16 v[56:57], v6 offset:8192
 v_mfma_f32_16x16x32_bf16 v[104:107], v[32:35], v[40:43], v[104:107]
 ds_read_b64_tr_b16 v[58:59], v6 offset:12288
 v_mfma_f32_16x16x32_bf16 v[108:111], v[36:39], v[40:43], v[108:111]
 ds_read_b64_tr_b16 v[60:61], v7 offset:8192
 s_add_u32 m0, s50, 32768
 s_bfe_u32 s62, s52, 0x40000
 s_lshl_b32 s62, s62, 15
 s_add_u32 s62, s62, s57
 v_mfma_f32_16x16x32_bf16 v[124:127], v[36:39], v[44:47], v[124:127]
 ds_read_b64_tr_b16 v[62:63], v7 offset:12288
 buffer_load_dwordx4 v0, s[8:11], s62 offen offset:0 sc1 lds
 v_mfma_f32_16x16x32_bf16 v[120:123], v[32:35], v[44:47], v[120:123]
 ds_read_b128 v[76:79], v2 offset:50176
 v_mfma_f32_16x16x32_bf16 v[116:119], v[28:31], v[44:47], v[116:119]
 ds_read_b64_tr_b16 v[64:65], v8 offset:8192
 v_mfma_f32_16x16x32_bf16 v[112:115], v[24:27], v[44:47], v[112:115]
 ds_read_b64_tr_b16 v[66:67], v8 offset:12288
 v_mfma_f32_16x16x32_bf16 v[128:131], v[24:27], v[48:51], v[128:131]
 ds_read_b128 v[80:83], v3 offset:49152
 v_mfma_f32_16x16x32_bf16 v[132:135], v[28:31], v[48:51], v[132:135]
 ds_read_b64_tr_b16 v[68:69], v9 offset:8192
 buffer_load_dwordx4 v0, s[8:11], s62 offen offset:1024 sc1 lds
 v_mfma_f32_16x16x32_bf16 v[136:139], v[32:35], v[48:51], v[136:139]
 ds_read_b64_tr_b16 v[70:71], v9 offset:12288
 v_mfma_f32_16x16x32_bf16 v[140:143], v[36:39], v[48:51], v[140:143]
 ds_read_b128 v[84:87], v3 offset:50176
 v_mfma_f32_16x16x32_bf16 v[156:159], v[36:39], v[52:55], v[156:159]
 s_add_u32 m0, s51, 0
 s_bfe_u32 s63, s52, 0x40000
 s_lshl_b32 s63, s63, 17
 s_add_u32 s63, s63, s58
 v_mfma_f32_16x16x32_bf16 v[152:155], v[32:35], v[52:55], v[152:155]
 buffer_load_dwordx4 v11, s[20:23], s63 offen lds
 v_mfma_f32_16x16x32_bf16 v[148:151], v[28:31], v[52:55], v[148:151]
 v_mfma_f32_16x16x32_bf16 v[144:147], v[24:27], v[52:55], v[144:147]
 s_waitcnt vmcnt(12) lgkmcnt(0)
 s_barrier
 v_mfma_f32_16x16x32_bf16 v[96:99], v[56:59], v[72:75], v[96:99]
 ds_read_b128 v[40:43], v4 offset:0
 v_mfma_f32_16x16x32_bf16 v[100:103], v[60:63], v[72:75], v[100:103]
 ds_read_b64_tr_b16 v[24:25], v6 offset:16384
 v_mfma_f32_16x16x32_bf16 v[104:107], v[64:67], v[72:75], v[104:107]
 ds_read_b64_tr_b16 v[26:27], v6 offset:20480
 v_mfma_f32_16x16x32_bf16 v[108:111], v[68:71], v[72:75], v[108:111]
 ds_read_b64_tr_b16 v[28:29], v7 offset:16384
 s_add_u32 m0, s50, 49152
 s_bfe_u32 s62, s52, 0x40004
 s_lshl_b32 s62, s62, 15
 s_add_u32 s62, s62, s57
 v_mfma_f32_16x16x32_bf16 v[124:127], v[68:71], v[76:79], v[124:127]
 ds_read_b64_tr_b16 v[30:31], v7 offset:20480
 buffer_load_dwordx4 v0, s[8:11], s62 offen offset:0 sc1 lds
 v_mfma_f32_16x16x32_bf16 v[120:123], v[64:67], v[76:79], v[120:123]
 ds_read_b128 v[44:47], v4 offset:1024
 v_mfma_f32_16x16x32_bf16 v[116:119], v[60:63], v[76:79], v[116:119]
 ds_read_b64_tr_b16 v[32:33], v8 offset:16384
 v_mfma_f32_16x16x32_bf16 v[112:115], v[56:59], v[76:79], v[112:115]
 ds_read_b64_tr_b16 v[34:35], v8 offset:20480
 v_mfma_f32_16x16x32_bf16 v[128:131], v[56:59], v[80:83], v[128:131]
 ds_read_b128 v[48:51], v5 offset:0
 v_mfma_f32_16x16x32_bf16 v[132:135], v[60:63], v[80:83], v[132:135]
 ds_read_b64_tr_b16 v[36:37], v9 offset:16384
 buffer_load_dwordx4 v0, s[8:11], s62 offen offset:1024 sc1 lds
 v_mfma_f32_16x16x32_bf16 v[136:139], v[64:67], v[80:83], v[136:139]
 ds_read_b64_tr_b16 v[38:39], v9 offset:20480
 v_mfma_f32_16x16x32_bf16 v[140:143], v[68:71], v[80:83], v[140:143]
 ds_read_b128 v[52:55], v5 offset:1024
 v_mfma_f32_16x16x32_bf16 v[156:159], v[68:71], v[84:87], v[156:159]
 s_add_u32 m0, s51, 8192
 s_bfe_u32 s63, s52, 0x40004
 s_lshl_b32 s63, s63, 17
 s_add_u32 s63, s63, s58
 v_mfma_f32_16x16x32_bf16 v[152:155], v[64:67], v[84:87], v[152:155]
 buffer_load_dwordx4 v11, s[20:23], s63 offen lds
 v_mfma_f32_16x16x32_bf16 v[148:151], v[60:63], v[84:87], v[148:151]
 v_mfma_f32_16x16x32_bf16 v[144:147], v[56:59], v[84:87], v[144:147]
 s_waitcnt vmcnt(12) lgkmcnt(0)
 s_barrier
 v_mfma_f32_16x16x32_bf16 v[96:99], v[24:27], v[40:43], v[96:99]
 ds_read_b128 v[72:75], v4 offset:16384
 v_mfma_f32_16x16x32_bf16 v[100:103], v[28:31], v[40:43], v[100:103]
 ds_read_b64_tr_b16 v[56:57], v6 offset:24576
 v_mfma_f32_16x16x32_bf16 v[104:107], v[32:35], v[40:43], v[104:107]
 ds_read_b64_tr_b16 v[58:59], v6 offset:28672
 v_mfma_f32_16x16x32_bf16 v[108:111], v[36:39], v[40:43], v[108:111]
 ds_read_b64_tr_b16 v[60:61], v7 offset:24576
 s_add_u32 m0, s50, 65536
 s_bfe_u32 s62, s52, 0x40008
 s_lshl_b32 s62, s62, 15
 s_add_u32 s62, s62, s57
 v_mfma_f32_16x16x32_bf16 v[124:127], v[36:39], v[44:47], v[124:127]
 ds_read_b64_tr_b16 v[62:63], v7 offset:28672
 buffer_load_dwordx4 v0, s[8:11], s62 offen offset:0 sc1 lds
 v_mfma_f32_16x16x32_bf16 v[120:123], v[32:35], v[44:47], v[120:123]
 ds_read_b128 v[76:79], v4 offset:17408
 v_mfma_f32_16x16x32_bf16 v[116:119], v[28:31], v[44:47], v[116:119]
 ds_read_b64_tr_b16 v[64:65], v8 offset:24576
 v_mfma_f32_16x16x32_bf16 v[112:115], v[24:27], v[44:47], v[112:115]
 ds_read_b64_tr_b16 v[66:67], v8 offset:28672
 v_mfma_f32_16x16x32_bf16 v[128:131], v[24:27], v[48:51], v[128:131]
 ds_read_b128 v[80:83], v5 offset:16384
 v_mfma_f32_16x16x32_bf16 v[132:135], v[28:31], v[48:51], v[132:135]
 ds_read_b64_tr_b16 v[68:69], v9 offset:24576
 buffer_load_dwordx4 v0, s[8:11], s62 offen offset:1024 sc1 lds
 v_mfma_f32_16x16x32_bf16 v[136:139], v[32:35], v[48:51], v[136:139]
 ds_read_b64_tr_b16 v[70:71], v9 offset:28672
 v_mfma_f32_16x16x32_bf16 v[140:143], v[36:39], v[48:51], v[140:143]
 ds_read_b128 v[84:87], v5 offset:17408
 v_mfma_f32_16x16x32_bf16 v[156:159], v[36:39], v[52:55], v[156:159]
 s_add_u32 m0, s51, 16384
 s_bfe_u32 s63, s52, 0x40008
 s_lshl_b32 s63, s63, 17
 s_add_u32 s63, s63, s58
 v_mfma_f32_16x16x32_bf16 v[152:155], v[32:35], v[52:55], v[152:155]
 buffer_load_dwordx4 v11, s[20:23], s63 offen lds
 v_mfma_f32_16x16x32_bf16 v[148:151], v[28:31], v[52:55], v[148:151]
 v_mfma_f32_16x16x32_bf16 v[144:147], v[24:27], v[52:55], v[144:147]
 s_waitcnt vmcnt(12) lgkmcnt(0)
 s_barrier
 v_mfma_f32_16x16x32_bf16 v[96:99], v[56:59], v[72:75], v[96:99]
 ds_read_b128 v[40:43], v2 offset:0
 v_mfma_f32_16x16x32_bf16 v[100:103], v[60:63], v[72:75], v[100:103]
 ds_read_b64_tr_b16 v[24:25], v6 offset:32768
 v_mfma_f32_16x16x32_bf16 v[104:107], v[64:67], v[72:75], v[104:107]
 ds_read_b64_tr_b16 v[26:27], v6 offset:36864
 v_mfma_f32_16x16x32_bf16 v[108:111], v[68:71], v[72:75], v[108:111]
 ds_read_b64_tr_b16 v[28:29], v7 offset:32768
 s_add_u32 m0, s50, 81920
 s_bfe_u32 s62, s52, 0x4000c
 s_lshl_b32 s62, s62, 15
 s_add_u32 s62, s62, s57
 v_mfma_f32_16x16x32_bf16 v[124:127], v[68:71], v[76:79], v[124:127]
 ds_read_b64_tr_b16 v[30:31], v7 offset:36864
 buffer_load_dwordx4 v0, s[8:11], s62 offen offset:0 sc1 lds
 v_mfma_f32_16x16x32_bf16 v[120:123], v[64:67], v[76:79], v[120:123]
 ds_read_b128 v[44:47], v2 offset:1024
 v_mfma_f32_16x16x32_bf16 v[116:119], v[60:63], v[76:79], v[116:119]
 ds_read_b64_tr_b16 v[32:33], v8 offset:32768
 v_mfma_f32_16x16x32_bf16 v[112:115], v[56:59], v[76:79], v[112:115]
 ds_read_b64_tr_b16 v[34:35], v8 offset:36864
 v_mfma_f32_16x16x32_bf16 v[128:131], v[56:59], v[80:83], v[128:131]
 ds_read_b128 v[48:51], v3 offset:0
 v_mfma_f32_16x16x32_bf16 v[132:135], v[60:63], v[80:83], v[132:135]
 ds_read_b64_tr_b16 v[36:37], v9 offset:32768
 buffer_load_dwordx4 v0, s[8:11], s62 offen offset:1024 sc1 lds
 v_mfma_f32_16x16x32_bf16 v[136:139], v[64:67], v[80:83], v[136:139]
 ds_read_b64_tr_b16 v[38:39], v9 offset:36864
 v_mfma_f32_16x16x32_bf16 v[140:143], v[68:71], v[80:83], v[140:143]
 ds_read_b128 v[52:55], v3 offset:1024
 v_mfma_f32_16x16x32_bf16 v[156:159], v[68:71], v[84:87], v[156:159]
 s_add_u32 m0, s51, 24576
 s_bfe_u32 s63, s52, 0x4000c
 s_lshl_b32 s63, s63, 17
 s_add_u32 s63, s63, s58
 v_mfma_f32_16x16x32_bf16 v[152:155], v[64:67], v[84:87], v[152:155]
 buffer_load_dwordx4 v11, s[20:23], s63 offen lds
 v_mfma_f32_16x16x32_bf16 v[148:151], v[60:63], v[84:87], v[148:151]
 v_mfma_f32_16x16x32_bf16 v[144:147], v[56:59], v[84:87], v[144:147]
 s_waitcnt vmcnt(12) lgkmcnt(0)
 s_barrier
 v_mfma_f32_16x16x32_bf16 v[96:99], v[24:27], v[40:43], v[96:99]
 ds_read_b128 v[72:75], v2 offset:16384
 v_mfma_f32_16x16x32_bf16 v[100:103], v[28:31], v[40:43], v[100:103]
 ds_read_b64_tr_b16 v[56:57], v6 offset:40960
 v_mfma_f32_16x16x32_bf16 v[104:107], v[32:35], v[40:43], v[104:107]
 ds_read_b64_tr_b16 v[58:59], v6 offset:45056
 v_mfma_f32_16x16x32_bf16 v[108:111], v[36:39], v[40:43], v[108:111]
 ds_read_b64_tr_b16 v[60:61], v7 offset:40960
 s_add_u32 m0, s50, 0
 s_bfe_u32 s62, s52, 0x40010
 s_lshl_b32 s62, s62, 15
 s_add_u32 s62, s62, s57
 v_mfma_f32_16x16x32_bf16 v[124:127], v[36:39], v[44:47], v[124:127]
 ds_read_b64_tr_b16 v[62:63], v7 offset:45056
 buffer_load_dwordx4 v0, s[8:11], s62 offen offset:0 sc1 lds
 v_mfma_f32_16x16x32_bf16 v[120:123], v[32:35], v[44:47], v[120:123]
 ds_read_b128 v[76:79], v2 offset:17408
 v_mfma_f32_16x16x32_bf16 v[116:119], v[28:31], v[44:47], v[116:119]
 ds_read_b64_tr_b16 v[64:65], v8 offset:40960
 v_mfma_f32_16x16x32_bf16 v[112:115], v[24:27], v[44:47], v[112:115]
 ds_read_b64_tr_b16 v[66:67], v8 offset:45056
 v_mfma_f32_16x16x32_bf16 v[128:131], v[24:27], v[48:51], v[128:131]
 ds_read_b128 v[80:83], v3 offset:16384
 v_mfma_f32_16x16x32_bf16 v[132:135], v[28:31], v[48:51], v[132:135]
 ds_read_b64_tr_b16 v[68:69], v9 offset:40960
 buffer_load_dwordx4 v0, s[8:11], s62 offen offset:1024 sc1 lds
 v_mfma_f32_16x16x32_bf16 v[136:139], v[32:35], v[48:51], v[136:139]
 ds_read_b64_tr_b16 v[70:71], v9 offset:45056
 v_mfma_f32_16x16x32_bf16 v[140:143], v[36:39], v[48:51], v[140:143]
 ds_read_b128 v[84:87], v3 offset:17408
 v_mfma_f32_16x16x32_bf16 v[156:159], v[36:39], v[52:55], v[156:159]
 s_add_u32 m0, s51, 32768
 s_bfe_u32 s63, s52, 0x40010
 s_lshl_b32 s63, s63, 17
 s_add_u32 s63, s63, s58
 v_mfma_f32_16x16x32_bf16 v[152:155], v[32:35], v[52:55], v[152:155]
 buffer_load_dwordx4 v11, s[20:23], s63 offen lds
 v_mfma_f32_16x16x32_bf16 v[148:151], v[28:31], v[52:55], v[148:151]
 v_mfma_f32_16x16x32_bf16 v[144:147], v[24:27], v[52:55], v[144:147]
 s_waitcnt vmcnt(12) lgkmcnt(0)
 s_barrier
 v_mfma_f32_16x16x32_bf16 v[96:99], v[56:59], v[72:75], v[96:99]
 ds_read_b128 v[40:43], v15 offset:32768
 v_mfma_f32_16x16x32_bf16 v[100:103], v[60:63], v[72:75], v[100:103]
 ds_read_b64_tr_b16 v[24:25], v6 offset:0
 v_mfma_f32_16x16x32_bf16 v[104:107], v[64:67], v[72:75], v[104:107]
 ds_read_b64_tr_b16 v[26:27], v6 offset:4096
 v_mfma_f32_16x16x32_bf16 v[108:111], v[68:71], v[72:75], v[108:111]
 ds_read_b64_tr_b16 v[28:29], v7 offset:0
 s_add_u32 m0, s50, 16384
 s_bfe_u32 s62, s52, 0x40014
 s_lshl_b32 s62, s62, 15
 s_add_u32 s62, s62, s57
 v_mfma_f32_16x16x32_bf16 v[124:127], v[68:71], v[76:79], v[124:127]
 ds_read_b64_tr_b16 v[30:31], v7 offset:4096
 buffer_load_dwordx4 v0, s[8:11], s62 offen offset:0 sc1 lds
 v_mfma_f32_16x16x32_bf16 v[120:123], v[64:67], v[76:79], v[120:123]
 ds_read_b128 v[44:47], v15 offset:33792
 v_mfma_f32_16x16x32_bf16 v[116:119], v[60:63], v[76:79], v[116:119]
 ds_read_b64_tr_b16 v[32:33], v8 offset:0
 v_mfma_f32_16x16x32_bf16 v[112:115], v[56:59], v[76:79], v[112:115]
 ds_read_b64_tr_b16 v[34:35], v8 offset:4096
 v_mfma_f32_16x16x32_bf16 v[128:131], v[56:59], v[80:83], v[128:131]
 ds_read_b128 v[48:51], v15 offset:40960
 v_mfma_f32_16x16x32_bf16 v[132:135], v[60:63], v[80:83], v[132:135]
 ds_read_b64_tr_b16 v[36:37], v9 offset:0
 buffer_load_dwordx4 v0, s[8:11], s62 offen offset:1024 sc1 lds
 v_mfma_f32_16x16x32_bf16 v[136:139], v[64:67], v[80:83], v[136:139]
 ds_read_b64_tr_b16 v[38:39], v9 offset:4096
 v_mfma_f32_16x16x32_bf16 v[140:143], v[68:71], v[80:83], v[140:143]
 ds_read_b128 v[52:55], v15 offset:41984
 v_mfma_f32_16x16x32_bf16 v[156:159], v[68:71], v[84:87], v[156:159]
 s_add_u32 m0, s51, 40960
 s_bfe_u32 s63, s52, 0x40014
 s_lshl_b32 s63, s63, 17
 s_add_u32 s63, s63, s58
 v_mfma_f32_16x16x32_bf16 v[152:155], v[64:67], v[84:87], v[152:155]
 buffer_load_dwordx4 v11, s[20:23], s63 offen lds
 v_mfma_f32_16x16x32_bf16 v[148:151], v[60:63], v[84:87], v[148:151]
 v_mfma_f32_16x16x32_bf16 v[144:147], v[56:59], v[84:87], v[144:147]
 s_waitcnt vmcnt(12) lgkmcnt(0)
 s_barrier
 v_mfma_f32_16x16x32_bf16 v[96:99], v[24:27], v[40:43], v[96:99]
 ds_read_b128 v[72:75], v15 offset:49152
 ds_read_b64_tr_b16 v[56:57], v6 offset:8192
 v_cvt_pk_bf16_f32 v104, v104, v105
 v_cvt_pk_bf16_f32 v105, v106, v107
 v_cvt_pk_bf16_f32 v106, v108, v109
 v_cvt_pk_bf16_f32 v107, v110, v111
 s_xor_b32 s85, s4, 1
 s_mul_i32 s85, s85, 49152
 s_add_u32 s85, s85, s60
 v_mfma_f32_16x16x32_bf16 v[100:103], v[28:31], v[40:43], v[100:103]
 ds_read_b64_tr_b16 v[58:59], v6 offset:12288
 ds_read_b64_tr_b16 v[60:61], v7 offset:8192
 buffer_store_dwordx4 v[104:107], v13, s[8:11], s85 offen offset:0 sc1
 v_cvt_pk_bf16_f32 v120, v120, v121
 v_cvt_pk_bf16_f32 v121, v122, v123
 v_cvt_pk_bf16_f32 v122, v124, v125
 v_cvt_pk_bf16_f32 v123, v126, v127
 s_xor_b32 s85, s4, 1
 v_mfma_f32_16x16x32_bf16 v[116:119], v[28:31], v[44:47], v[116:119]
 ds_read_b64_tr_b16 v[62:63], v7 offset:12288
 ds_read_b128 v[76:79], v15 offset:50176
 s_mul_i32 s85, s85, 49152
 s_add_u32 s85, s85, s60
 buffer_store_dwordx4 v[120:123], v13, s[8:11], s85 offen offset:1024 sc1
 v_cvt_pk_bf16_f32 v128, v128, v129
 v_cvt_pk_bf16_f32 v129, v130, v131
 v_cvt_pk_bf16_f32 v130, v132, v133
 v_cvt_pk_bf16_f32 v131, v134, v135
 v_mfma_f32_16x16x32_bf16 v[112:115], v[24:27], v[44:47], v[112:115]
 ds_read_b64_tr_b16 v[64:65], v8 offset:8192
 ds_read_b64_tr_b16 v[66:67], v8 offset:12288
 s_xor_b32 s85, s4, 2
 s_mul_i32 s85, s85, 49152
 s_add_u32 s85, s85, s60
 s_add_u32 s85, s85, 16384
 buffer_store_dwordx4 v[128:131], v13, s[8:11], s85 offen offset:0 sc1
 v_cvt_pk_bf16_f32 v144, v144, v145
 v_mfma_f32_16x16x32_bf16 v[96:99], v[32:35], v[48:51], v[96:99]
 ds_read_b128 v[80:83], v15 offset:57344
 ds_read_b64_tr_b16 v[68:69], v9 offset:8192
 v_cvt_pk_bf16_f32 v145, v146, v147
 v_cvt_pk_bf16_f32 v146, v148, v149
 v_cvt_pk_bf16_f32 v147, v150, v151
 s_xor_b32 s85, s4, 2
 s_mul_i32 s85, s85, 49152
 s_add_u32 s85, s85, s60
 s_add_u32 s85, s85, 16384
 v_mfma_f32_16x16x32_bf16 v[100:103], v[36:39], v[48:51], v[100:103]
 ds_read_b64_tr_b16 v[70:71], v9 offset:12288
 ds_read_b128 v[84:87], v15 offset:58368
 buffer_store_dwordx4 v[144:147], v13, s[8:11], s85 offen offset:1024 sc1
 v_cvt_pk_bf16_f32 v136, v136, v137
 v_cvt_pk_bf16_f32 v137, v138, v139
 v_cvt_pk_bf16_f32 v138, v140, v141
 v_cvt_pk_bf16_f32 v139, v142, v143
 s_xor_b32 s85, s4, 3
 v_mfma_f32_16x16x32_bf16 v[116:119], v[36:39], v[52:55], v[116:119]
 s_mul_i32 s85, s85, 49152
 s_add_u32 s85, s85, s60
 s_add_u32 s85, s85, 32768
 buffer_store_dwordx4 v[136:139], v13, s[8:11], s85 offen offset:0 sc1
 v_cvt_pk_bf16_f32 v152, v152, v153
 v_cvt_pk_bf16_f32 v153, v154, v155
 v_cvt_pk_bf16_f32 v154, v156, v157
 v_mfma_f32_16x16x32_bf16 v[112:115], v[32:35], v[52:55], v[112:115]
 v_cvt_pk_bf16_f32 v155, v158, v159
 s_xor_b32 s85, s4, 3
 s_mul_i32 s85, s85, 49152
 s_add_u32 s85, s85, s60
 s_add_u32 s85, s85, 32768
 buffer_store_dwordx4 v[152:155], v13, s[8:11], s85 offen offset:1024 sc1
 s_waitcnt vmcnt(6) lgkmcnt(0)
 s_barrier
 v_mfma_f32_16x16x32_bf16 v[96:99], v[56:59], v[72:75], v[96:99]
 ds_read_b128 v[40:43], v17 offset:0
 ds_read_b64_tr_b16 v[24:25], v6 offset:16384
 v_mfma_f32_16x16x32_bf16 v[100:103], v[60:63], v[72:75], v[100:103]
 ds_read_b64_tr_b16 v[26:27], v6 offset:20480
 ds_read_b64_tr_b16 v[28:29], v7 offset:16384
 v_mfma_f32_16x16x32_bf16 v[116:119], v[60:63], v[76:79], v[116:119]
 ds_read_b64_tr_b16 v[30:31], v7 offset:20480
 ds_read_b128 v[44:47], v17 offset:1024
 v_mfma_f32_16x16x32_bf16 v[112:115], v[56:59], v[76:79], v[112:115]
 ds_read_b64_tr_b16 v[32:33], v8 offset:16384
 ds_read_b64_tr_b16 v[34:35], v8 offset:20480
 v_mfma_f32_16x16x32_bf16 v[96:99], v[64:67], v[80:83], v[96:99]
 ds_read_b128 v[48:51], v17 offset:8192
 ds_read_b64_tr_b16 v[36:37], v9 offset:16384
 v_mfma_f32_16x16x32_bf16 v[100:103], v[68:71], v[80:83], v[100:103]
 ds_read_b64_tr_b16 v[38:39], v9 offset:20480
 ds_read_b128 v[52:55], v17 offset:9216
 v_mfma_f32_16x16x32_bf16 v[116:119], v[68:71], v[84:87], v[116:119]
 v_mfma_f32_16x16x32_bf16 v[112:115], v[64:67], v[84:87], v[112:115]
 s_waitcnt lgkmcnt(0)
 v_mfma_f32_16x16x32_bf16 v[96:99], v[24:27], v[40:43], v[96:99]
 ds_read_b128 v[72:75], v17 offset:16384
 ds_read_b64_tr_b16 v[56:57], v6 offset:24576
 s_xor_b32 s92, s71, 1024
 v_mov_b32 v91, 1
 v_mfma_f32_16x16x32_bf16 v[100:103], v[28:31], v[40:43], v[100:103]
 ds_read_b64_tr_b16 v[58:59], v6 offset:28672
 ds_read_b64_tr_b16 v[60:61], v7 offset:24576
 s_waitcnt vmcnt(4)
 v_mfma_f32_16x16x32_bf16 v[116:119], v[28:31], v[44:47], v[116:119]
 ds_read_b64_tr_b16 v[62:63], v7 offset:28672
 ds_read_b128 v[76:79], v17 offset:17408
 buffer_store_byte v91, off, s[8:11], s92 sc1
 s_xor_b32 s92, s71, 2048
 v_mfma_f32_16x16x32_bf16 v[112:115], v[24:27], v[44:47], v[112:115]
 ds_read_b64_tr_b16 v[64:65], v8 offset:24576
 ds_read_b64_tr_b16 v[66:67], v8 offset:28672
 v_mov_b32 v91, 1
 v_mfma_f32_16x16x32_bf16 v[96:99], v[32:35], v[48:51], v[96:99]
 ds_read_b128 v[80:83], v17 offset:24576
 ds_read_b64_tr_b16 v[68:69], v9 offset:24576
 s_waitcnt vmcnt(3)
 buffer_store_byte v91, off, s[8:11], s92 offset:1 sc1
 v_mfma_f32_16x16x32_bf16 v[100:103], v[36:39], v[48:51], v[100:103]
 ds_read_b64_tr_b16 v[70:71], v9 offset:28672
 ds_read_b128 v[84:87], v17 offset:25600
 s_xor_b32 s92, s71, 3072
 v_mfma_f32_16x16x32_bf16 v[116:119], v[36:39], v[52:55], v[116:119]
 v_mov_b32 v91, 1
 s_waitcnt vmcnt(2)
 v_mfma_f32_16x16x32_bf16 v[112:115], v[32:35], v[52:55], v[112:115]
 buffer_store_byte v91, off, s[8:11], s92 offset:2 sc1
 s_waitcnt lgkmcnt(0)
 v_mfma_f32_16x16x32_bf16 v[96:99], v[56:59], v[72:75], v[96:99]
 ds_read_b128 v[40:43], v15 offset:0
 ds_read_b64_tr_b16 v[24:25], v6 offset:32768
 v_mfma_f32_16x16x32_bf16 v[100:103], v[60:63], v[72:75], v[100:103]
 ds_read_b64_tr_b16 v[26:27], v6 offset:36864
 ds_read_b64_tr_b16 v[28:29], v7 offset:32768
 v_mfma_f32_16x16x32_bf16 v[116:119], v[60:63], v[76:79], v[116:119]
 ds_read_b64_tr_b16 v[30:31], v7 offset:36864
 ds_read_b128 v[44:47], v15 offset:1024
 v_mfma_f32_16x16x32_bf16 v[112:115], v[56:59], v[76:79], v[112:115]
 ds_read_b64_tr_b16 v[32:33], v8 offset:32768
 ds_read_b64_tr_b16 v[34:35], v8 offset:36864
 v_mfma_f32_16x16x32_bf16 v[96:99], v[64:67], v[80:83], v[96:99]
 ds_read_b128 v[48:51], v15 offset:8192
 ds_read_b64_tr_b16 v[36:37], v9 offset:32768
 v_mfma_f32_16x16x32_bf16 v[100:103], v[68:71], v[80:83], v[100:103]
 ds_read_b64_tr_b16 v[38:39], v9 offset:36864
 ds_read_b128 v[52:55], v15 offset:9216
 v_mfma_f32_16x16x32_bf16 v[116:119], v[68:71], v[84:87], v[116:119]
 v_mfma_f32_16x16x32_bf16 v[112:115], v[64:67], v[84:87], v[112:115]
 s_waitcnt lgkmcnt(0)
 v_mfma_f32_16x16x32_bf16 v[96:99], v[24:27], v[40:43], v[96:99]
 ds_read_b128 v[72:75], v15 offset:16384
 ds_read_b64_tr_b16 v[56:57], v6 offset:40960
 v_mfma_f32_16x16x32_bf16 v[100:103], v[28:31], v[40:43], v[100:103]
 ds_read_b64_tr_b16 v[58:59], v6 offset:45056
 ds_read_b64_tr_b16 v[60:61], v7 offset:40960
 v_mfma_f32_16x16x32_bf16 v[116:119], v[28:31], v[44:47], v[116:119]
 ds_read_b64_tr_b16 v[62:63], v7 offset:45056
 ds_read_b128 v[76:79], v15 offset:17408
 v_mfma_f32_16x16x32_bf16 v[112:115], v[24:27], v[44:47], v[112:115]
 ds_read_b64_tr_b16 v[64:65], v8 offset:40960
 ds_read_b64_tr_b16 v[66:67], v8 offset:45056
 v_mfma_f32_16x16x32_bf16 v[96:99], v[32:35], v[48:51], v[96:99]
 ds_read_b128 v[80:83], v15 offset:24576
 ds_read_b64_tr_b16 v[68:69], v9 offset:40960
 v_mfma_f32_16x16x32_bf16 v[100:103], v[36:39], v[48:51], v[100:103]
 ds_read_b64_tr_b16 v[70:71], v9 offset:45056
 ds_read_b128 v[84:87], v15 offset:25600
 v_mfma_f32_16x16x32_bf16 v[116:119], v[36:39], v[52:55], v[116:119]
 v_mfma_f32_16x16x32_bf16 v[112:115], v[32:35], v[52:55], v[112:115]
 s_waitcnt lgkmcnt(0)
 v_mfma_f32_16x16x32_bf16 v[96:99], v[56:59], v[72:75], v[96:99]
 s_buffer_load_dword s72, s[8:11], s71 glc
 v_mfma_f32_16x16x32_bf16 v[100:103], v[60:63], v[72:75], v[100:103]
 v_mfma_f32_16x16x32_bf16 v[116:119], v[60:63], v[76:79], v[116:119]
 v_mfma_f32_16x16x32_bf16 v[112:115], v[56:59], v[76:79], v[112:115]
 v_mfma_f32_16x16x32_bf16 v[96:99], v[64:67], v[80:83], v[96:99]
 v_mfma_f32_16x16x32_bf16 v[100:103], v[68:71], v[80:83], v[100:103]
 v_mfma_f32_16x16x32_bf16 v[116:119], v[68:71], v[84:87], v[116:119]
 v_mfma_f32_16x16x32_bf16 v[112:115], v[64:67], v[84:87], v[112:115]
 s_waitcnt lgkmcnt(0)
 s_cmp_eq_u32 s72, 0x10101
 s_cbranch_scc0 Lsp_192
Lok_193:
 s_mul_i32 s85, s4, 49152
 s_add_u32 s85, s85, s60
 buffer_load_dwordx4 v[160:163], v13, s[8:11], s85 offen offset:0 sc1
 buffer_load_dwordx4 v[164:167], v13, s[8:11], s85 offen offset:1024 sc1
 s_mul_i32 s85, s4, 49152
 s_add_u32 s85, s85, s60
 s_add_u32 s85, s85, 16384
 buffer_load_dwordx4 v[168:171], v13, s[8:11], s85 offen offset:0 sc1
 buffer_load_dwordx4 v[172:175], v13, s[8:11], s85 offen offset:1024 sc1
 s_mul_i32 s85, s4, 49152
 s_add_u32 s85, s85, s60
 s_add_u32 s85, s85, 32768
 buffer_load_dwordx4 v[176:179], v13, s[8:11], s85 offen offset:0 sc1
 buffer_load_dwordx4 v[180:183], v13, s[8:11], s85 offen offset:1024 sc1
 s_waitcnt vmcnt(4)
 v_lshlrev_b32 v208, 16, v160
 v_and_b32 v209, s89, v160
 v_add_f32 v192, v192, v208
 v_add_f32 v193, v193, v209
 v_lshlrev_b32 v210, 16, v161
 v_and_b32 v211, s89, v161
 v_add_f32 v194, v194, v210
 v_add_f32 v195, v195, v211
 v_lshlrev_b32 v208, 16, v162
 v_and_b32 v209, s89, v162
 v_add_f32 v196, v196, v208
 v_add_f32 v197, v197, v209
 v_lshlrev_b32 v210, 16, v163
 v_and_b32 v211, s89, v163
 v_add_f32 v198, v198, v210
 v_add_f32 v199, v199, v211
 v_lshlrev_b32 v208, 16, v164
 v_and_b32 v209, s89, v164
 v_add_f32 v200, v200, v208
 v_add_f32 v201, v201, v209
 v_lshlrev_b32 v210, 16, v165
 v_and_b32 v211, s89, v165
 v_add_f32 v202, v202, v210
 v_add_f32 v203, v203, v211
 v_lshlrev_b32 v208, 16, v166
 v_and_b32 v209, s89, v166
 v_add_f32 v204, v204, v208
 v_add_f32 v205, v205, v209
 v_lshlrev_b32 v210, 16, v167
 v_and_b32 v211, s89, v167
 v_add_f32 v206, v206, v210
 v_add_f32 v207, v207, v211
 s_waitcnt vmcnt(2)
 v_lshlrev_b32 v208, 16, v168
 v_and_b32 v209, s89, v168
 v_add_f32 v192, v192, v208
 v_add_f32 v193, v193, v209
 v_lshlrev_b32 v210, 16, v169
 v_and_b32 v211, s89, v169
 v_add_f32 v194, v194, v210
 v_add_f32 v195, v195, v211
 v_lshlrev_b32 v208, 16, v170
 v_and_b32 v209, s89, v170
 v_add_f32 v196, v196, v208
 v_add_f32 v197, v197, v209
 v_lshlrev_b32 v210, 16, v171
 v_and_b32 v211, s89, v171
 v_add_f32 v198, v198, v210
 v_add_f32 v199, v199, v211
 v_lshlrev_b32 v208, 16, v172
 v_and_b32 v209, s89, v172
 v_add_f32 v200, v200, v208
 v_add_f32 v201, v201, v209
 v_lshlrev_b32 v210, 16, v173
 v_and_b32 v211, s89, v173
 v_add_f32 v202, v202, v210
 v_add_f32 v203, v203, v211
 v_lshlrev_b32 v208, 16, v174
 v_and_b32 v209, s89, v174
 v_add_f32 v204, v204, v208
 v_add_f32 v205, v205, v209
 v_lshlrev_b32 v210, 16, v175
 v_and_b32 v211, s89, v175
 v_add_f32 v206, v206, v210
 v_add_f32 v207, v207, v211
 s_waitcnt vmcnt(0)
 v_lshlrev_b32 v208, 16, v176
 v_and_b32 v209, s89, v176
 v_add_f32 v192, v192, v208
 v_add_f32 v193, v193, v209
 v_lshlrev_b32 v210, 16, v177
 v_and_b32 v211, s89, v177
 v_add_f32 v194, v194, v210
 v_add_f32 v195, v195, v211
 v_lshlrev_b32 v208, 16, v178
 v_and_b32 v209, s89, v178
 v_add_f32 v196, v196, v208
 v_add_f32 v197, v197, v209
 v_lshlrev_b32 v210, 16, v179
 v_and_b32 v211, s89, v179
 v_add_f32 v198, v198, v210
 v_add_f32 v199, v199, v211
 v_lshlrev_b32 v208, 16, v180
 v_and_b32 v209, s89, v180
 v_add_f32 v200, v200, v208
 v_add_f32 v201, v201, v209
 v_lshlrev_b32 v210, 16, v181
 v_and_b32 v211, s89, v181
 v_add_f32 v202, v202, v210
 v_add_f32 v203, v203, v211
 v_lshlrev_b32 v208, 16, v182
 v_and_b32 v209, s89, v182
 v_add_f32 v204, v204, v208
 v_add_f32 v205, v205, v209
 v_lshlrev_b32 v210, 16, v183
 v_and_b32 v211, s89, v183
 v_add_f32 v206, v206, v210
 v_add_f32 v207, v207, v211
 v_add_f32 v96, v96, v192
 v_add_f32 v97, v97, v193
 v_add_f32 v98, v98, v194
 v_add_f32 v99, v99, v195
 v_add_f32 v100, v100, v196
 v_add_f32 v101, v101, v197
 v_add_f32 v102, v102, v198
 v_add_f32 v103, v103, v199
 v_cvt_pk_bf16_f32 v96, v96, v97
 v_cvt_pk_bf16_f32 v97, v98, v99
 v_cvt_pk_bf16_f32 v98, v100, v101
 v_cvt_pk_bf16_f32 v99, v102, v103
 s_nop 0
 v_permlane16_swap_b32 v96, v98
 v_permlane16_swap_b32 v97, v99
 buffer_store_dwordx4 v[96:99], v94, s[28:31], s61 offen
 v_add_f32 v112, v112, v200
 v_add_f32 v113, v113, v201
 v_add_f32 v114, v114, v202
 v_add_f32 v115, v115, v203
 v_add_f32 v116, v116, v204
 v_add_f32 v117, v117, v205
 v_add_f32 v118, v118, v206
 v_add_f32 v119, v119, v207
 v_cvt_pk_bf16_f32 v112, v112, v113
 v_cvt_pk_bf16_f32 v113, v114, v115
 v_cvt_pk_bf16_f32 v114, v116, v117
 v_cvt_pk_bf16_f32 v115, v118, v119
 s_nop 0
 v_permlane16_swap_b32 v112, v114
 v_permlane16_swap_b32 v113, v115
 buffer_store_dwordx4 v[112:115], v94, s[28:31], s66 offen
 s_endpgm
Lsp_189:
 s_mov_b32 s95, 0
Llp_191:
 s_buffer_load_dwordx2 s[72:73], s[8:11], s64 offset:0 glc
 s_buffer_load_dwordx2 s[74:75], s[8:11], s64 offset:512 glc
 s_buffer_load_dwordx2 s[76:77], s[8:11], s64 offset:1024 glc
 s_buffer_load_dwordx2 s[78:79], s[8:11], s64 offset:1536 glc
 s_waitcnt lgkmcnt(0)
 s_add_u32 s95, s95, 1
 s_and_b64 s[72:73], s[72:73], s[74:75]
 s_and_b64 s[76:77], s[76:77], s[78:79]
 s_and_b64 s[72:73], s[72:73], s[76:77]
 s_and_b32 s72, s72, s73
 s_cmp_eq_u32 s72, 0x1010101
 s_cbranch_scc1 Lok_190
 s_cmp_lt_u32 s95, 0x40000
 s_cbranch_scc1 Llp_191
 s_branch Lok_190
Lsp_192:
 s_mov_b32 s95, 0
Llp_194:
 s_buffer_load_dword s72, s[8:11], s71 glc
 s_waitcnt lgkmcnt(0)
 s_add_u32 s95, s95, 1
 s_cmp_eq_u32 s72, 0x10101
 s_cbranch_scc1 Lok_193
 s_cmp_lt_u32 s95, 0x40000
 s_cbranch_scc1 Llp_194
 s_branch Lok_193
L5_v14:
 s_lshl_b32 s52, s52, 16
 s_lshr_b32 s84, 0x32103210, s84
 s_and_b32 s84, s84, 0xffff
 s_or_b32 s52, s52, s84
 s_xor_b32 s52, s52, s96
 s_waitcnt vmcnt(17) lgkmcnt(0)
 s_barrier
 v_mfma_f32_16x16x32_bf16 v[96:99], v[24:27], v[40:43], v[96:99]
 ds_read_b128 v[72:75], v2 offset:16384
 v_mfma_f32_16x16x32_bf16 v[100:103], v[28:31], v[40:43], v[100:103]
 ds_read_b64_tr_b16 v[56:57], v6 offset:40960
 v_mfma_f32_16x16x32_bf16 v[104:107], v[32:35], v[40:43], v[104:107]
 ds_read_b64_tr_b16 v[58:59], v6 offset:45056
 v_mfma_f32_16x16x32_bf16 v[108:111], v[36:39], v[40:43], v[108:111]
 ds_read_b64_tr_b16 v[60:61], v7 offset:40960
 v_mfma_f32_16x16x32_bf16 v[124:127], v[36:39], v[44:47], v[124:127]
 ds_read_b64_tr_b16 v[62:63], v7 offset:45056
 v_mfma_f32_16x16x32_bf16 v[120:123], v[32:35], v[44:47], v[120:123]
 ds_read_b128 v[76:79], v2 offset:17408
 v_mfma_f32_16x16x32_bf16 v[116:119], v[28:31], v[44:47], v[116:119]
 ds_read_b64_tr_b16 v[64:65], v8 offset:40960
 v_mfma_f32_16x16x32_bf16 v[112:115], v[24:27], v[44:47], v[112:115]
 ds_read_b64_tr_b16 v[66:67], v8 offset:45056
 v_mfma_f32_16x16x32_bf16 v[128:131], v[24:27], v[48:51], v[128:131]
 ds_read_b128 v[80:83], v3 offset:16384
 s_add_u32 m0, s51, 32768
 s_bfe_u32 s63, s52, 0x40000
 s_lshl_b32 s63, s63, 17
 s_add_u32 s63, s63, s58
 v_mfma_f32_16x16x32_bf16 v[132:135], v[28:31], v[48:51], v[132:135]
 ds_read_b64_tr_b16 v[68:69], v9 offset:40960
 buffer_load_dwordx4 v11, s[20:23], s63 offen lds
 v_mfma_f32_16x16x32_bf16 v[136:139], v[32:35], v[48:51], v[136:139]
 ds_read_b64_tr_b16 v[70:71], v9 offset:45056
 v_mfma_f32_16x16x32_bf16 v[140:143], v[36:39], v[48:51], v[140:143]
 ds_read_b128 v[84:87], v3 offset:17408
 v_mfma_f32_16x16x32_bf16 v[156:159], v[36:39], v[52:55], v[156:159]
 v_mfma_f32_16x16x32_bf16 v[152:155], v[32:35], v[52:55], v[152:155]
 v_mfma_f32_16x16x32_bf16 v[148:151], v[28:31], v[52:55], v[148:151]
 v_mfma_f32_16x16x32_bf16 v[144:147], v[24:27], v[52:55], v[144:147]
 s_waitcnt vmcnt(14) lgkmcnt(0)
 s_barrier
 v_mfma_f32_16x16x32_bf16 v[96:99], v[56:59], v[72:75], v[96:99]
 ds_read_b128 v[40:43], v2 offset:32768
 v_and_b32 v94, 15, v1
 v_mfma_f32_16x16x32_bf16 v[100:103], v[60:63], v[72:75], v[100:103]
 ds_read_b64_tr_b16 v[24:25], v6 offset:0
 v_mfma_f32_16x16x32_bf16 v[104:107], v[64:67], v[72:75], v[104:107]
 ds_read_b64_tr_b16 v[26:27], v6 offset:4096
 v_lshlrev_b32 v94, 11, v94
 v_mfma_f32_16x16x32_bf16 v[108:111], v[68:71], v[72:75], v[108:111]
 ds_read_b64_tr_b16 v[28:29], v7 offset:0
 v_mfma_f32_16x16x32_bf16 v[124:127], v[68:71], v[76:79], v[124:127]
 ds_read_b64_tr_b16 v[30:31], v7 offset:4096
 v_bfe_u32 v92, v1, 4, 1
 v_mfma_f32_16x16x32_bf16 v[120:123], v[64:67], v[76:79], v[120:123]
 ds_read_b128 v[44:47], v2 offset:33792
 v_mfma_f32_16x16x32_bf16 v[116:119], v[60:63], v[76:79], v[116:119]
 ds_read_b64_tr_b16 v[32:33], v8 offset:0
 v_lshl_add_u32 v94, v92, 5, v94
 v_mfma_f32_16x16x32_bf16 v[112:115], v[56:59], v[76:79], v[112:115]
 ds_read_b64_tr_b16 v[34:35], v8 offset:4096
 v_mfma_f32_16x16x32_bf16 v[128:131], v[56:59], v[80:83], v[128:131]
 ds_read_b128 v[48:51], v3 offset:32768
 v_lshrrev_b32 v92, 5, v1
 s_add_u32 m0, s51, 40960
 s_bfe_u32 s63, s52, 0x40004
 s_lshl_b32 s63, s63, 17
 s_add_u32 s63, s63, s58
 v_mfma_f32_16x16x32_bf16 v[132:135], v[60:63], v[80:83], v[132:135]
 ds_read_b64_tr_b16 v[36:37], v9 offset:0
 buffer_load_dwordx4 v11, s[20:23], s63 offen lds
 v_mfma_f32_16x16x32_bf16 v[136:139], v[64:67], v[80:83], v[136:139]
 ds_read_b64_tr_b16 v[38:39], v9 offset:4096
 v_lshl_add_u32 v94, v92, 4, v94
 v_mfma_f32_16x16x32_bf16 v[140:143], v[68:71], v[80:83], v[140:143]
 ds_read_b128 v[52:55], v3 offset:33792
 v_mfma_f32_16x16x32_bf16 v[156:159], v[68:71], v[84:87], v[156:159]
 buffer_load_dwordx4 v[184:187], v94, s[16:19], s61 offen
 v_mfma_f32_16x16x32_bf16 v[152:155], v[64:67], v[84:87], v[152:155]
 v_mfma_f32_16x16x32_bf16 v[148:151], v[60:63], v[84:87], v[148:151]
 buffer_load_dwordx4 v[188:191], v94, s[16:19], s66 offen
 v_mfma_f32_16x16x32_bf16 v[144:147], v[56:59], v[84:87], v[144:147]
 s_waitcnt vmcnt(11) lgkmcnt(0)
 s_barrier
 v_mfma_f32_16x16x32_bf16 v[96:99], v[24:27], v[40:43], v[96:99]
 ds_read_b128 v[72:75], v2 offset:49152
 v_mfma_f32_16x16x32_bf16 v[100:103], v[28:31], v[40:43], v[100:103]
 ds_read_b64_tr_b16 v[56:57], v6 offset:8192
 v_mfma_f32_16x16x32_bf16 v[104:107], v[32:35], v[40:43], v[104:107]
 ds_read_b64_tr_b16 v[58:59], v6 offset:12288
 v_mfma_f32_16x16x32_bf16 v[108:111], v[36:39], v[40:43], v[108:111]
 ds_read_b64_tr_b16 v[60:61], v7 offset:8192
 v_mfma_f32_16x16x32_bf16 v[124:127], v[36:39], v[44:47], v[124:127]
 ds_read_b64_tr_b16 v[62:63], v7 offset:12288
 v_mfma_f32_16x16x32_bf16 v[120:123], v[32:35], v[44:47], v[120:123]
 ds_read_b128 v[76:79], v2 offset:50176
 v_mfma_f32_16x16x32_bf16 v[116:119], v[28:31], v[44:47], v[116:119]
 ds_read_b64_tr_b16 v[64:65], v8 offset:8192
 v_mfma_f32_16x16x32_bf16 v[112:115], v[24:27], v[44:47], v[112:115]
 ds_read_b64_tr_b16 v[66:67], v8 offset:12288
 v_mfma_f32_16x16x32_bf16 v[128:131], v[24:27], v[48:51], v[128:131]
 ds_read_b128 v[80:83], v3 offset:49152
 s_add_u32 m0, s51, 0
 s_bfe_u32 s63, s52, 0x40008
 s_lshl_b32 s63, s63, 17
 s_add_u32 s63, s63, s58
 v_mfma_f32_16x16x32_bf16 v[132:135], v[28:31], v[48:51], v[132:135]
 ds_read_b64_tr_b16 v[68:69], v9 offset:8192
 buffer_load_dwordx4 v11, s[20:23], s63 offen lds
 v_mfma_f32_16x16x32_bf16 v[136:139], v[32:35], v[48:51], v[136:139]
 ds_read_b64_tr_b16 v[70:71], v9 offset:12288
 v_mfma_f32_16x16x32_bf16 v[140:143], v[36:39], v[48:51], v[140:143]
 ds_read_b128 v[84:87], v3 offset:50176
 v_mfma_f32_16x16x32_bf16 v[156:159], v[36:39], v[52:55], v[156:159]
 v_mfma_f32_16x16x32_bf16 v[152:155], v[32:35], v[52:55], v[152:155]
 v_mfma_f32_16x16x32_bf16 v[148:151], v[28:31], v[52:55], v[148:151]
 v_mfma_f32_16x16x32_bf16 v[144:147], v[24:27], v[52:55], v[144:147]
 s_waitcnt vmcnt(9) lgkmcnt(0)
 s_barrier
 v_mfma_f32_16x16x32_bf16 v[96:99], v[56:59], v[72:75], v[96:99]
 ds_read_b128 v[40:43], v4 offset:0
 v_mfma_f32_16x16x32_bf16 v[100:103], v[60:63], v[72:75], v[100:103]
 ds_read_b64_tr_b16 v[24:25], v6 offset:16384
 v_mfma_f32_16x16x32_bf16 v[104:107], v[64:67], v[72:75], v[104:107]
 ds_read_b64_tr_b16 v[26:27], v6 offset:20480
 s_add_u32 m0, s50, 0
 s_bfe_u32 s62, s52, 0x40000
 s_lshl_b32 s62, s62, 15
 s_add_u32 s62, s62, s57
 v_mfma_f32_16x16x32_bf16 v[108:111], v[68:71], v[72:75], v[108:111]
 ds_read_b64_tr_b16 v[28:29], v7 offset:16384
 buffer_load_dwordx4 v0, s[8:11], s62 offen offset:0 sc1 lds
 v_mfma_f32_16x16x32_bf16 v[124:127], v[68:71], v[76:79], v[124:127]
 ds_read_b64_tr_b16 v[30:31], v7 offset:20480
 v_mfma_f32_16x16x32_bf16 v[120:123], v[64:67], v[76:79], v[120:123]
 ds_read_b128 v[44:47], v4 offset:1024
 buffer_load_dwordx4 v0, s[8:11], s62 offen offset:1024 sc1 lds
 v_mfma_f32_16x16x32_bf16 v[116:119], v[60:63], v[76:79], v[116:119]
 ds_read_b64_tr_b16 v[32:33], v8 offset:16384
 s_lshl4_add_u32 s64, s83, s7
 s_add_u32 m0, s50, 16384
 s_bfe_u32 s62, s52, 0x40004
 s_lshl_b32 s62, s62, 15
 s_add_u32 s62, s62, s57
 v_mfma_f32_16x16x32_bf16 v[112:115], v[56:59], v[76:79], v[112:115]
 ds_read_b64_tr_b16 v[34:35], v8 offset:20480
 buffer_load_dwordx4 v0, s[8:11], s62 offen offset:0 sc1 lds
 s_lshl_b32 s64, s64, 7
 v_mfma_f32_16x16x32_bf16 v[128:131], v[56:59], v[80:83], v[128:131]
 ds_read_b128 v[48:51], v5 offset:0
 s_add_u32 s64, s64, 39927808
 v_mfma_f32_16x16x32_bf16 v[132:135], v[60:63], v[80:83], v[132:135]
 ds_read_b64_tr_b16 v[36:37], v9 offset:16384
 s_buffer_load_dwordx2 s[72:73], s[8:11], s64 offset:0 glc
 s_buffer_load_dwordx2 s[74:75], s[8:11], s64 offset:512 glc
 s_buffer_load_dwordx2 s[76:77], s[8:11], s64 offset:1024 glc
 s_buffer_load_dwordx2 s[78:79], s[8:11], s64 offset:1536 glc
 v_mfma_f32_16x16x32_bf16 v[136:139], v[64:67], v[80:83], v[136:139]
 ds_read_b64_tr_b16 v[38:39], v9 offset:20480
 buffer_load_dwordx4 v0, s[8:11], s62 offen offset:1024 sc1 lds
 v_mfma_f32_16x16x32_bf16 v[140:143], v[68:71], v[80:83], v[140:143]
 ds_read_b128 v[52:55], v5 offset:1024
 ds_read_b32 v90, v0
 ds_read_b32 v90, v0
 ds_read_b32 v90, v0
 ds_read_b32 v90, v0
 ds_read_b32 v90, v0
 ds_read_b32 v90, v0
 ds_read_b32 v90, v0
 ds_read_b32 v90, v0
 s_add_u32 m0, s50, 32768
 s_bfe_u32 s62, s52, 0x40008
 s_lshl_b32 s62, s62, 15
 s_add_u32 s62, s62, s57
 v_mfma_f32_16x16x32_bf16 v[156:159], v[68:71], v[84:87], v[156:159]
 buffer_load_dwordx4 v0, s[8:11], s62 offen offset:0 sc1 lds
 v_mfma_f32_16x16x32_bf16 v[152:155], v[64:67], v[84:87], v[152:155]
 v_mfma_f32_16x16x32_bf16 v[148:151], v[60:63], v[84:87], v[148:151]
 buffer_load_dwordx4 v0, s[8:11], s62 offen offset:1024 sc1 lds
 v_mfma_f32_16x16x32_bf16 v[144:147], v[56:59], v[84:87], v[144:147]
 s_waitcnt vmcnt(11) lgkmcnt(8)
 s_barrier
 v_mfma_f32_16x16x32_bf16 v[96:99], v[24:27], v[40:43], v[96:99]
 ds_read_b128 v[72:75], v4 offset:16384
 s_mov_b32 s89, 0xffff0000
 s_waitcnt vmcnt(7)
 v_mfma_f32_16x16x32_bf16 v[100:103], v[28:31], v[40:43], v[100:103]
 ds_read_b64_tr_b16 v[56:57], v6 offset:24576
 v_permlane16_swap_b32 v184, v186
 v_mfma_f32_16x16x32_bf16 v[104:107], v[32:35], v[40:43], v[104:107]
 ds_read_b64_tr_b16 v[58:59], v6 offset:28672
 v_permlane16_swap_b32 v185, v187
 v_permlane16_swap_b32 v188, v190
 s_add_u32 m0, s50, 49152
 s_bfe_u32 s62, s52, 0x4000c
 s_lshl_b32 s62, s62, 15
 s_add_u32 s62, s62, s57
 v_mfma_f32_16x16x32_bf16 v[108:111], v[36:39], v[40:43], v[108:111]
 ds_read_b64_tr_b16 v[60:61], v7 offset:24576
 buffer_load_dwordx4 v0, s[8:11], s62 offen offset:0 sc1 lds
 v_permlane16_swap_b32 v189, v191
 v_mfma_f32_16x16x32_bf16 v[124:127], v[36:39], v[44:47], v[124:127]
 ds_read_b64_tr_b16 v[62:63], v7 offset:28672
 v_lshlrev_b32 v192, 16, v184
 v_and_b32 v193, s89, v184
 v_mfma_f32_16x16x32_bf16 v[120:123], v[32:35], v[44:47], v[120:123]
 ds_read_b128 v[76:79], v4 offset:17408
 v_lshlrev_b32 v194, 16, v185
 v_mfma_f32_16x16x32_bf16 v[116:119], v[28:31], v[44:47], v[116:119]
 ds_read_b64_tr_b16 v[64:65], v8 offset:24576
 v_and_b32 v195, s89, v185
 v_lshlrev_b32 v196, 16, v186
 v_mfma_f32_16x16x32_bf16 v[112:115], v[24:27], v[44:47], v[112:115]
 ds_read_b64_tr_b16 v[66:67], v8 offset:28672
 buffer_load_dwordx4 v0, s[8:11], s62 offen offset:1024 sc1 lds
 v_and_b32 v197, s89, v186
 v_mfma_f32_16x16x32_bf16 v[128:131], v[24:27], v[48:51], v[128:131]
 ds_read_b128 v[80:83], v5 offset:16384
 v_lshlrev_b32 v198, 16, v187
 v_mfma_f32_16x16x32_bf16 v[132:135], v[28:31], v[48:51], v[132:135]
 ds_read_b64_tr_b16 v[68:69], v9 offset:24576
 v_and_b32 v199, s89, v187
 v_lshlrev_b32 v200, 16, v188
 s_add_u32 m0, s51, 8192
 s_bfe_u32 s63, s52, 0x4000c
 s_lshl_b32 s63, s63, 17
 s_add_u32 s63, s63, s58
 v_mfma_f32_16x16x32_bf16 v[136:139], v[32:35], v[48:51], v[136:139]
 ds_read_b64_tr_b16 v[70:71], v9 offset:28672
 buffer_load_dwordx4 v11, s[20:23], s63 offen lds
 v_and_b32 v201, s89, v188
 v_mfma_f32_16x16x32_bf16 v[140:143], v[36:39], v[48:51], v[140:143]
 ds_read_b128 v[84:87], v5 offset:17408
 v_lshlrev_b32 v202, 16, v189
 v_and_b32 v203, s89, v189
 v_mfma_f32_16x16x32_bf16 v[156:159], v[36:39], v[52:55], v[156:159]
 v_lshlrev_b32 v204, 16, v190
 v_mfma_f32_16x16x32_bf16 v[152:155], v[32:35], v[52:55], v[152:155]
 v_and_b32 v205, s89, v190
 v_lshlrev_b32 v206, 16, v191
 s_add_u32 m0, s51, 16384
 s_bfe_u32 s63, s52, 0x40010
 s_lshl_b32 s63, s63, 17
 s_add_u32 s63, s63, s58
 v_mfma_f32_16x16x32_bf16 v[148:151], v[28:31], v[52:55], v[148:151]
 buffer_load_dwordx4 v11, s[20:23], s63 offen lds
 v_and_b32 v207, s89, v191
 v_mfma_f32_16x16x32_bf16 v[144:147], v[24:27], v[52:55], v[144:147]
 s_waitcnt lgkmcnt(0)
 s_and_b64 s[72:73], s[72:73], s[74:75]
 s_and_b64 s[76:77], s[76:77], s[78:79]
 s_and_b64 s[72:73], s[72:73], s[76:77]
 s_and_b32 s72, s72, s73
 s_cmp_eq_u32 s72, 0x1010101
 s_cbranch_scc0 Lsp_195
Lok_196:
 s_waitcnt vmcnt(8) lgkmcnt(0)
 s_barrier
 v_mfma_f32_16x16x32_bf16 v[96:99], v[56:59], v[72:75], v[96:99]
 ds_read_b128 v[40:43], v15 offset:0
 v_mfma_f32_16x16x32_bf16 v[100:103], v[60:63], v[72:75], v[100:103]
 ds_read_b64_tr_b16 v[24:25], v6 offset:32768
 v_mfma_f32_16x16x32_bf16 v[104:107], v[64:67], v[72:75], v[104:107]
 ds_read_b64_tr_b16 v[26:27], v6 offset:36864
 s_add_u32 m0, s50, 65536
 s_bfe_u32 s62, s52, 0x40010
 s_lshl_b32 s62, s62, 15
 s_add_u32 s62, s62, s57
 v_mfma_f32_16x16x32_bf16 v[108:111], v[68:71], v[72:75], v[108:111]
 ds_read_b64_tr_b16 v[28:29], v7 offset:32768
 buffer_load_dwordx4 v0, s[8:11], s62 offen offset:0 sc1 lds
 v_mfma_f32_16x16x32_bf16 v[124:127], v[68:71], v[76:79], v[124:127]
 ds_read_b64_tr_b16 v[30:31], v7 offset:36864
 v_mfma_f32_16x16x32_bf16 v[120:123], v[64:67], v[76:79], v[120:123]
 ds_read_b128 v[44:47], v15 offset:1024
 v_mfma_f32_16x16x32_bf16 v[116:119], v[60:63], v[76:79], v[116:119]
 ds_read_b64_tr_b16 v[32:33], v8 offset:32768
 buffer_load_dwordx4 v0, s[8:11], s62 offen offset:1024 sc1 lds
 v_mfma_f32_16x16x32_bf16 v[112:115], v[56:59], v[76:79], v[112:115]
 ds_read_b64_tr_b16 v[34:35], v8 offset:36864
 v_mfma_f32_16x16x32_bf16 v[128:131], v[56:59], v[80:83], v[128:131]
 ds_read_b128 v[48:51], v15 offset:8192
 s_add_u32 m0, s50, 81920
 s_bfe_u32 s62, s52, 0x40014
 s_lshl_b32 s62, s62, 15
 s_add_u32 s62, s62, s57
 v_mfma_f32_16x16x32_bf16 v[132:135], v[60:63], v[80:83], v[132:135]
 ds_read_b64_tr_b16 v[36:37], v9 offset:32768
 buffer_load_dwordx4 v0, s[8:11], s62 offen offset:0 sc1 lds
 v_mfma_f32_16x16x32_bf16 v[136:139], v[64:67], v[80:83], v[136:139]
 ds_read_b64_tr_b16 v[38:39], v9 offset:36864
 v_mfma_f32_16x16x32_bf16 v[140:143], v[68:71], v[80:83], v[140:143]
 ds_read_b128 v[52:55], v15 offset:9216
 buffer_load_dwordx4 v0, s[8:11], s62 offen offset:1024 sc1 lds
 v_mfma_f32_16x16x32_bf16 v[156:159], v[68:71], v[84:87], v[156:159]
 v_mfma_f32_16x16x32_bf16 v[152:155], v[64:67], v[84:87], v[152:155]
 s_add_u32 m0, s51, 24576
 s_bfe_u32 s63, s52, 0x40014
 s_lshl_b32 s63, s63, 17
 s_add_u32 s63, s63, s58
 v_mfma_f32_16x16x32_bf16 v[148:151], v[60:63], v[84:87], v[148:151]
 buffer_load_dwordx4 v11, s[20:23], s63 offen lds
 v_mfma_f32_16x16x32_bf16 v[144:147], v[56:59], v[84:87], v[144:147]
 s_waitcnt vmcnt(11) lgkmcnt(0)
 s_barrier
 v_mfma_f32_16x16x32_bf16 v[96:99], v[24:27], v[40:43], v[96:99]
 ds_read_b128 v[72:75], v15 offset:16384
 ds_read_b64_tr_b16 v[56:57], v6 offset:40960
 v_cvt_pk_bf16_f32 v104, v104, v105
 v_cvt_pk_bf16_f32 v105, v106, v107
 v_cvt_pk_bf16_f32 v106, v108, v109
 v_cvt_pk_bf16_f32 v107, v110, v111
 s_xor_b32 s85, s4, 1
 s_mul_i32 s85, s85, 49152
 s_add_u32 s85, s85, s60
 v_mfma_f32_16x16x32_bf16 v[100:103], v[28:31], v[40:43], v[100:103]
 ds_read_b64_tr_b16 v[58:59], v6 offset:45056
 ds_read_b64_tr_b16 v[60:61], v7 offset:40960
 buffer_store_dwordx4 v[104:107], v13, s[8:11], s85 offen offset:0 sc1
 v_cvt_pk_bf16_f32 v120, v120, v121
 v_cvt_pk_bf16_f32 v121, v122, v123
 v_cvt_pk_bf16_f32 v122, v124, v125
 v_cvt_pk_bf16_f32 v123, v126, v127
 s_xor_b32 s85, s4, 1
 v_mfma_f32_16x16x32_bf16 v[116:119], v[28:31], v[44:47], v[116:119]
 ds_read_b64_tr_b16 v[62:63], v7 offset:45056
 ds_read_b128 v[76:79], v15 offset:17408
 s_mul_i32 s85, s85, 49152
 s_add_u32 s85, s85, s60
 buffer_store_dwordx4 v[120:123], v13, s[8:11], s85 offen offset:1024 sc1
 v_cvt_pk_bf16_f32 v128, v128, v129
 v_cvt_pk_bf16_f32 v129, v130, v131
 v_cvt_pk_bf16_f32 v130, v132, v133
 v_cvt_pk_bf16_f32 v131, v134, v135
 v_mfma_f32_16x16x32_bf16 v[112:115], v[24:27], v[44:47], v[112:115]
 ds_read_b64_tr_b16 v[64:65], v8 offset:40960
 ds_read_b64_tr_b16 v[66:67], v8 offset:45056
 s_xor_b32 s85, s4, 2
 s_mul_i32 s85, s85, 49152
 s_add_u32 s85, s85, s60
 s_add_u32 s85, s85, 16384
 buffer_store_dwordx4 v[128:131], v13, s[8:11], s85 offen offset:0 sc1
 v_cvt_pk_bf16_f32 v144, v144, v145
 v_mfma_f32_16x16x32_bf16 v[96:99], v[32:35], v[48:51], v[96:99]
 ds_read_b128 v[80:83], v15 offset:24576
 ds_read_b64_tr_b16 v[68:69], v9 offset:40960
 v_cvt_pk_bf16_f32 v145, v146, v147
 v_cvt_pk_bf16_f32 v146, v148, v149
 v_cvt_pk_bf16_f32 v147, v150, v151
 s_xor_b32 s85, s4, 2
 s_mul_i32 s85, s85, 49152
 s_add_u32 s85, s85, s60
 s_add_u32 s85, s85, 16384
 v_mfma_f32_16x16x32_bf16 v[100:103], v[36:39], v[48:51], v[100:103]
 ds_read_b64_tr_b16 v[70:71], v9 offset:45056
 ds_read_b128 v[84:87], v15 offset:25600
 buffer_store_dwordx4 v[144:147], v13, s[8:11], s85 offen offset:1024 sc1
 v_cvt_pk_bf16_f32 v136, v136, v137
 v_cvt_pk_bf16_f32 v137, v138, v139
 v_cvt_pk_bf16_f32 v138, v140, v141
 v_cvt_pk_bf16_f32 v139, v142, v143
 s_xor_b32 s85, s4, 3
 v_mfma_f32_16x16x32_bf16 v[116:119], v[36:39], v[52:55], v[116:119]
 s_mul_i32 s85, s85, 49152
 s_add_u32 s85, s85, s60
 s_add_u32 s85, s85, 32768
 buffer_store_dwordx4 v[136:139], v13, s[8:11], s85 offen offset:0 sc1
 v_cvt_pk_bf16_f32 v152, v152, v153
 v_cvt_pk_bf16_f32 v153, v154, v155
 v_cvt_pk_bf16_f32 v154, v156, v157
 v_mfma_f32_16x16x32_bf16 v[112:115], v[32:35], v[52:55], v[112:115]
 v_cvt_pk_bf16_f32 v155, v158, v159
 s_xor_b32 s85, s4, 3
 s_mul_i32 s85, s85, 49152
 s_add_u32 s85, s85, s60
 s_add_u32 s85, s85, 32768
 buffer_store_dwordx4 v[152:155], v13, s[8:11], s85 offen offset:1024 sc1
 s_waitcnt vmcnt(6) lgkmcnt(0)
 s_barrier
 v_mfma_f32_16x16x32_bf16 v[96:99], v[56:59], v[72:75], v[96:99]
 ds_read_b128 v[40:43], v15 offset:32768
 ds_read_b64_tr_b16 v[24:25], v6 offset:0
 v_mfma_f32_16x16x32_bf16 v[100:103], v[60:63], v[72:75], v[100:103]
 ds_read_b64_tr_b16 v[26:27], v6 offset:4096
 ds_read_b64_tr_b16 v[28:29], v7 offset:0
 v_mfma_f32_16x16x32_bf16 v[116:119], v[60:63], v[76:79], v[116:119]
 ds_read_b64_tr_b16 v[30:31], v7 offset:4096
 ds_read_b128 v[44:47], v15 offset:33792
 v_mfma_f32_16x16x32_bf16 v[112:115], v[56:59], v[76:79], v[112:115]
 ds_read_b64_tr_b16 v[32:33], v8 offset:0
 ds_read_b64_tr_b16 v[34:35], v8 offset:4096
 v_mfma_f32_16x16x32_bf16 v[96:99], v[64:67], v[80:83], v[96:99]
 ds_read_b128 v[48:51], v15 offset:40960
 ds_read_b64_tr_b16 v[36:37], v9 offset:0
 v_mfma_f32_16x16x32_bf16 v[100:103], v[68:71], v[80:83], v[100:103]
 ds_read_b64_tr_b16 v[38:39], v9 offset:4096
 ds_read_b128 v[52:55], v15 offset:41984
 v_mfma_f32_16x16x32_bf16 v[116:119], v[68:71], v[84:87], v[116:119]
 v_mfma_f32_16x16x32_bf16 v[112:115], v[64:67], v[84:87], v[112:115]
 s_waitcnt lgkmcnt(0)
 v_mfma_f32_16x16x32_bf16 v[96:99], v[24:27], v[40:43], v[96:99]
 ds_read_b128 v[72:75], v15 offset:49152
 ds_read_b64_tr_b16 v[56:57], v6 offset:8192
 s_xor_b32 s92, s71, 1024
 v_mov_b32 v91, 1
 v_mfma_f32_16x16x32_bf16 v[100:103], v[28:31], v[40:43], v[100:103]
 ds_read_b64_tr_b16 v[58:59], v6 offset:12288
 ds_read_b64_tr_b16 v[60:61], v7 offset:8192
 s_waitcnt vmcnt(4)
 v_mfma_f32_16x16x32_bf16 v[116:119], v[28:31], v[44:47], v[116:119]
 ds_read_b64_tr_b16 v[62:63], v7 offset:12288
 ds_read_b128 v[76:79], v15 offset:50176
 buffer_store_byte v91, off, s[8:11], s92 sc1
 s_xor_b32 s92, s71, 2048
 v_mfma_f32_16x16x32_bf16 v[112:115], v[24:27], v[44:47], v[112:115]
 ds_read_b64_tr_b16 v[64:65], v8 offset:8192
 ds_read_b64_tr_b16 v[66:67], v8 offset:12288
 v_mov_b32 v91, 1
 v_mfma_f32_16x16x32_bf16 v[96:99], v[32:35], v[48:51], v[96:99]
 ds_read_b128 v[80:83], v15 offset:57344
 ds_read_b64_tr_b16 v[68:69], v9 offset:8192
 s_waitcnt vmcnt(3)
 buffer_store_byte v91, off, s[8:11], s92 offset:1 sc1
 v_mfma_f32_16x16x32_bf16 v[100:103], v[36:39], v[48:51], v[100:103]
 ds_read_b64_tr_b16 v[70:71], v9 offset:12288
 ds_read_b128 v[84:87], v15 offset:58368
 s_xor_b32 s92, s71, 3072
 v_mfma_f32_16x16x32_bf16 v[116:119], v[36:39], v[52:55], v[116:119]
 v_mov_b32 v91, 1
 s_waitcnt vmcnt(2)
 v_mfma_f32_16x16x32_bf16 v[112:115], v[32:35], v[52:55], v[112:115]
 buffer_store_byte v91, off, s[8:11], s92 offset:2 sc1
 s_waitcnt lgkmcnt(0)
 v_mfma_f32_16x16x32_bf16 v[96:99], v[56:59], v[72:75], v[96:99]
 ds_read_b128 v[40:43], v17 offset:0
 ds_read_b64_tr_b16 v[24:25], v6 offset:16384
 v_mfma_f32_16x16x32_bf16 v[100:103], v[60:63], v[72:75], v[100:103]
 ds_read_b64_tr_b16 v[26:27], v6 offset:20480
 ds_read_b64_tr_b16 v[28:29], v7 offset:16384
 v_mfma_f32_16x16x32_bf16 v[116:119], v[60:63], v[76:79], v[116:119]
 ds_read_b64_tr_b16 v[30:31], v7 offset:20480
 ds_read_b128 v[44:47], v17 offset:1024
 v_mfma_f32_16x16x32_bf16 v[112:115], v[56:59], v[76:79], v[112:115]
 ds_read_b64_tr_b16 v[32:33], v8 offset:16384
 ds_read_b64_tr_b16 v[34:35], v8 offset:20480
 v_mfma_f32_16x16x32_bf16 v[96:99], v[64:67], v[80:83], v[96:99]
 ds_read_b128 v[48:51], v17 offset:8192
 ds_read_b64_tr_b16 v[36:37], v9 offset:16384
 v_mfma_f32_16x16x32_bf16 v[100:103], v[68:71], v[80:83], v[100:103]
 ds_read_b64_tr_b16 v[38:39], v9 offset:20480
 ds_read_b128 v[52:55], v17 offset:9216
 v_mfma_f32_16x16x32_bf16 v[116:119], v[68:71], v[84:87], v[116:119]
 v_mfma_f32_16x16x32_bf16 v[112:115], v[64:67], v[84:87], v[112:115]
 s_waitcnt lgkmcnt(0)
 v_mfma_f32_16x16x32_bf16 v[96:99], v[24:27], v[40:43], v[96:99]
 ds_read_b128 v[72:75], v17 offset:16384
 ds_read_b64_tr_b16 v[56:57], v6 offset:24576
 v_mfma_f32_16x16x32_bf16 v[100:103], v[28:31], v[40:43], v[100:103]
 ds_read_b64_tr_b16 v[58:59], v6 offset:28672
 ds_read_b64_tr_b16 v[60:61], v7 offset:24576
 v_mfma_f32_16x16x32_bf16 v[116:119], v[28:31], v[44:47], v[116:119]
 ds_read_b64_tr_b16 v[62:63], v7 offset:28672
 ds_read_b128 v[76:79], v17 offset:17408
 v_mfma_f32_16x16x32_bf16 v[112:115], v[24:27], v[44:47], v[112:115]
 ds_read_b64_tr_b16 v[64:65], v8 offset:24576
 ds_read_b64_tr_b16 v[66:67], v8 offset:28672
 v_mfma_f32_16x16x32_bf16 v[96:99], v[32:35], v[48:51], v[96:99]
 ds_read_b128 v[80:83], v17 offset:24576
 ds_read_b64_tr_b16 v[68:69], v9 offset:24576
 v_mfma_f32_16x16x32_bf16 v[100:103], v[36:39], v[48:51], v[100:103]
 ds_read_b64_tr_b16 v[70:71], v9 offset:28672
 ds_read_b128 v[84:87], v17 offset:25600
 v_mfma_f32_16x16x32_bf16 v[116:119], v[36:39], v[52:55], v[116:119]
 v_mfma_f32_16x16x32_bf16 v[112:115], v[32:35], v[52:55], v[112:115]
 s_waitcnt lgkmcnt(0)
 v_mfma_f32_16x16x32_bf16 v[96:99], v[56:59], v[72:75], v[96:99]
 s_buffer_load_dword s72, s[8:11], s71 glc
 v_mfma_f32_16x16x32_bf16 v[100:103], v[60:63], v[72:75], v[100:103]
 v_mfma_f32_16x16x32_bf16 v[116:119], v[60:63], v[76:79], v[116:119]
 v_mfma_f32_16x16x32_bf16 v[112:115], v[56:59], v[76:79], v[112:115]
 v_mfma_f32_16x16x32_bf16 v[96:99], v[64:67], v[80:83], v[96:99]
 v_mfma_f32_16x16x32_bf16 v[100:103], v[68:71], v[80:83], v[100:103]
 v_mfma_f32_16x16x32_bf16 v[116:119], v[68:71], v[84:87], v[116:119]
 v_mfma_f32_16x16x32_bf16 v[112:115], v[64:67], v[84:87], v[112:115]
 s_waitcnt lgkmcnt(0)
 s_cmp_eq_u32 s72, 0x10101
 s_cbranch_scc0 Lsp_198
Lok_199:
 s_mul_i32 s85, s4, 49152
 s_add_u32 s85, s85, s60
 buffer_load_dwordx4 v[160:163], v13, s[8:11], s85 offen offset:0 sc1
 buffer_load_dwordx4 v[164:167], v13, s[8:11], s85 offen offset:1024 sc1
 s_mul_i32 s85, s4, 49152
 s_add_u32 s85, s85, s60
 s_add_u32 s85, s85, 16384
 buffer_load_dwordx4 v[168:171], v13, s[8:11], s85 offen offset:0 sc1
 buffer_load_dwordx4 v[172:175], v13, s[8:11], s85 offen offset:1024 sc1
 s_mul_i32 s85, s4, 49152
 s_add_u32 s85, s85, s60
 s_add_u32 s85, s85, 32768
 buffer_load_dwordx4 v[176:179], v13, s[8:11], s85 offen offset:0 sc1
 buffer_load_dwordx4 v[180:183], v13, s[8:11], s85 offen offset:1024 sc1
 s_waitcnt vmcnt(4)
 v_lshlrev_b32 v208, 16, v160
 v_and_b32 v209, s89, v160
 v_add_f32 v192, v192, v208
 v_add_f32 v193, v193, v209
 v_lshlrev_b32 v210, 16, v161
 v_and_b32 v211, s89, v161
 v_add_f32 v194, v194, v210
 v_add_f32 v195, v195, v211
 v_lshlrev_b32 v208, 16, v162
 v_and_b32 v209, s89, v162
 v_add_f32 v196, v196, v208
 v_add_f32 v197, v197, v209
 v_lshlrev_b32 v210, 16, v163
 v_and_b32 v211, s89, v163
 v_add_f32 v198, v198, v210
 v_add_f32 v199, v199, v211
 v_lshlrev_b32 v208, 16, v164
 v_and_b32 v209, s89, v164
 v_add_f32 v200, v200, v208
 v_add_f32 v201, v201, v209
 v_lshlrev_b32 v210, 16, v165
 v_and_b32 v211, s89, v165
 v_add_f32 v202, v202, v210
 v_add_f32 v203, v203, v211
 v_lshlrev_b32 v208, 16, v166
 v_and_b32 v209, s89, v166
 v_add_f32 v204, v204, v208
 v_add_f32 v205, v205, v209
 v_lshlrev_b32 v210, 16, v167
 v_and_b32 v211, s89, v167
 v_add_f32 v206, v206, v210
 v_add_f32 v207, v207, v211
 s_waitcnt vmcnt(2)
 v_lshlrev_b32 v208, 16, v168
 v_and_b32 v209, s89, v168
 v_add_f32 v192, v192, v208
 v_add_f32 v193, v193, v209
 v_lshlrev_b32 v210, 16, v169
 v_and_b32 v211, s89, v169
 v_add_f32 v194, v194, v210
 v_add_f32 v195, v195, v211
 v_lshlrev_b32 v208, 16, v170
 v_and_b32 v209, s89, v170
 v_add_f32 v196, v196, v208
 v_add_f32 v197, v197, v209
 v_lshlrev_b32 v210, 16, v171
 v_and_b32 v211, s89, v171
 v_add_f32 v198, v198, v210
 v_add_f32 v199, v199, v211
 v_lshlrev_b32 v208, 16, v172
 v_and_b32 v209, s89, v172
 v_add_f32 v200, v200, v208
 v_add_f32 v201, v201, v209
 v_lshlrev_b32 v210, 16, v173
 v_and_b32 v211, s89, v173
 v_add_f32 v202, v202, v210
 v_add_f32 v203, v203, v211
 v_lshlrev_b32 v208, 16, v174
 v_and_b32 v209, s89, v174
 v_add_f32 v204, v204, v208
 v_add_f32 v205, v205, v209
 v_lshlrev_b32 v210, 16, v175
 v_and_b32 v211, s89, v175
 v_add_f32 v206, v206, v210
 v_add_f32 v207, v207, v211
 s_waitcnt vmcnt(0)
 v_lshlrev_b32 v208, 16, v176
 v_and_b32 v209, s89, v176
 v_add_f32 v192, v192, v208
 v_add_f32 v193, v193, v209
 v_lshlrev_b32 v210, 16, v177
 v_and_b32 v211, s89, v177
 v_add_f32 v194, v194, v210
 v_add_f32 v195, v195, v211
 v_lshlrev_b32 v208, 16, v178
 v_and_b32 v209, s89, v178
 v_add_f32 v196, v196, v208
 v_add_f32 v197, v197, v209
 v_lshlrev_b32 v210, 16, v179
 v_and_b32 v211, s89, v179
 v_add_f32 v198, v198, v210
 v_add_f32 v199, v199, v211
 v_lshlrev_b32 v208, 16, v180
 v_and_b32 v209, s89, v180
 v_add_f32 v200, v200, v208
 v_add_f32 v201, v201, v209
 v_lshlrev_b32 v210, 16, v181
 v_and_b32 v211, s89, v181
 v_add_f32 v202, v202, v210
 v_add_f32 v203, v203, v211
 v_lshlrev_b32 v208, 16, v182
 v_and_b32 v209, s89, v182
 v_add_f32 v204, v204, v208
 v_add_f32 v205, v205, v209
 v_lshlrev_b32 v210, 16, v183
 v_and_b32 v211, s89, v183
 v_add_f32 v206, v206, v210
 v_add_f32 v207, v207, v211
 v_add_f32 v96, v96, v192
 v_add_f32 v97, v97, v193
 v_add_f32 v98, v98, v194
 v_add_f32 v99, v99, v195
 v_add_f32 v100, v100, v196
 v_add_f32 v101, v101, v197
 v_add_f32 v102, v102, v198
 v_add_f32 v103, v103, v199
 v_cvt_pk_bf16_f32 v96, v96, v97
 v_cvt_pk_bf16_f32 v97, v98, v99
 v_cvt_pk_bf16_f32 v98, v100, v101
 v_cvt_pk_bf16_f32 v99, v102, v103
 s_nop 0
 v_permlane16_swap_b32 v96, v98
 v_permlane16_swap_b32 v97, v99
 buffer_store_dwordx4 v[96:99], v94, s[28:31], s61 offen
 v_add_f32 v112, v112, v200
 v_add_f32 v113, v113, v201
 v_add_f32 v114, v114, v202
 v_add_f32 v115, v115, v203
 v_add_f32 v116, v116, v204
 v_add_f32 v117, v117, v205
 v_add_f32 v118, v118, v206
 v_add_f32 v119, v119, v207
 v_cvt_pk_bf16_f32 v112, v112, v113
 v_cvt_pk_bf16_f32 v113, v114, v115
 v_cvt_pk_bf16_f32 v114, v116, v117
 v_cvt_pk_bf16_f32 v115, v118, v119
 s_nop 0
 v_permlane16_swap_b32 v112, v114
 v_permlane16_swap_b32 v113, v115
 buffer_store_dwordx4 v[112:115], v94, s[28:31], s66 offen
 s_endpgm
Lsp_195:
 s_mov_b32 s95, 0
Llp_197:
 s_buffer_load_dwordx2 s[72:73], s[8:11], s64 offset:0 glc
 s_buffer_load_dwordx2 s[74:75], s[8:11], s64 offset:512 glc
 s_buffer_load_dwordx2 s[76:77], s[8:11], s64 offset:1024 glc
 s_buffer_load_dwordx2 s[78:79], s[8:11], s64 offset:1536 glc
 s_waitcnt lgkmcnt(0)
 s_add_u32 s95, s95, 1
 s_and_b64 s[72:73], s[72:73], s[74:75]
 s_and_b64 s[76:77], s[76:77], s[78:79]
 s_and_b64 s[72:73], s[72:73], s[76:77]
 s_and_b32 s72, s72, s73
 s_cmp_eq_u32 s72, 0x1010101
 s_cbranch_scc1 Lok_196
 s_cmp_lt_u32 s95, 0x40000
 s_cbranch_scc1 Llp_197
 s_branch Lok_196
Lsp_198:
 s_mov_b32 s95, 0
Llp_200:
 s_buffer_load_dword s72, s[8:11], s71 glc
 s_waitcnt lgkmcnt(0)
 s_add_u32 s95, s95, 1
 s_cmp_eq_u32 s72, 0x10101
 s_cbranch_scc1 Lok_199
 s_cmp_lt_u32 s95, 0x40000
 s_cbranch_scc1 Llp_200
 s_branch Lok_199
L5_end:
 s_endpgm
.section .rodata,"a"
.p2align 6
.amdhsa_kernel parallel_sum__linear_kernel_hedgehog__geglu_ffn__prompt_kernel
  .amdhsa_next_free_vgpr 256
  .amdhsa_next_free_sgpr 102
  .amdhsa_accum_offset 256
  .amdhsa_group_segment_fixed_size 0
  .amdhsa_kernarg_size 88
  .amdhsa_user_sgpr_count 2
  .amdhsa_user_sgpr_kernarg_segment_ptr 1
  .amdhsa_system_sgpr_workgroup_id_x 1
.end_amdhsa_kernel
```
